```python
import torch

def _softmax(x, axis=-1):
    return torch.softmax(x, dim=axis)
def _gelu(x):
    return torch.nn.functional.gelu(x, approximate="tanh")
def _silu(x):
    return torch.nn.functional.silu(x)
def _sigmoid(x):
    return torch.sigmoid(x)
def _layernorm(x, axis=-1, eps=1e-5):
    m = x.mean(dim=axis, keepdim=True)
    v = x.var(dim=axis, keepdim=True, unbiased=False)
    return (x - m) / torch.sqrt(v + eps)
def _scatter_add(tgt, idx, src, axis=0):
    return tgt.clone().index_add_(axis, idx, src)
def _segment_sum(src, seg, n):
    out = torch.zeros((n,) + src.shape[1:], dtype=src.dtype)
    return out.index_add_(0, seg, src)
def _pad(x, pw):
    flat = tuple(v for pair in reversed(pw) for v in pair)
    return torch.nn.functional.pad(x, flat)

kernel_name = 'parallel_sum__ssm_conv_s5__dense_activation_mish__prompt'

def setup_inputs():

    _w = (lambda a: (lambda t: t.to(torch.bfloat16) if t.is_floating_point() else t)(torch.as_tensor(a)))
    def _A_setup():
        B, S, D = 1, 2048, 640
        P = D
        Lambda_re = -0.5 * (lambda _x: torch.exp(torch.as_tensor(_x)))((lambda *s: torch.randn(*s, dtype=torch.bfloat16) * 0.2)(P))
        Lambda_im = (lambda *s: torch.randn(*s, dtype=torch.bfloat16) * 0.8)(P) * 1.0
        B_re = (lambda *s: torch.randn(*s, dtype=torch.bfloat16) * 0.2)(P, D) * (D ** -0.5)
        B_im = (lambda *s: torch.randn(*s, dtype=torch.bfloat16) * 0.2)(P, D) * (D ** -0.5)
        C_re = (lambda *s: torch.randn(*s, dtype=torch.bfloat16) * 0.2)(D, P) * (P ** -0.5)
        C_im = (lambda *s: torch.randn(*s, dtype=torch.bfloat16) * 0.2)(D, P) * (P ** -0.5)
        log_dt = (lambda *s: torch.randn(*s, dtype=torch.bfloat16) * 0.2)(P) * 0.3 - 2.0
        Dskip = (lambda *s: torch.randn(*s, dtype=torch.bfloat16) * 0.05)(D)
        return {
            "x": _w((lambda *s: torch.randn(*s, dtype=torch.bfloat16) * 0.05)(B, S, D)),
            "Lambda_re": _w(Lambda_re),
            "Lambda_im": _w(Lambda_im),
            "B_re": _w(B_re),
            "B_im": _w(B_im),
            "C_re": _w(C_re),
            "C_im": _w(C_im),
            "log_dt": _w(log_dt),
            "Dskip": _w(Dskip),
        }
    _A_in = _A_setup()

    def _B_setup():
        B, S, D, F = 1, 2048, 640, 1728
        return {
            "x": _w((lambda *s: torch.randn(*s, dtype=torch.bfloat16) * 0.05)(B, S, D)),
            "w1": _w((lambda *s: torch.randn(*s, dtype=torch.bfloat16) * 0.8)(D, F) * (D ** -0.5)),
            "b1": _w((lambda *s: torch.randn(*s, dtype=torch.bfloat16) * 0.2)(F)),
            "w2": _w((lambda *s: torch.randn(*s, dtype=torch.bfloat16) * 0.2)(F, D) * (F ** -0.5)),
        }
    _B_in = _B_setup()

    return {
        "A_x": _A_in["x"],
        "A_Lambda_re": _A_in["Lambda_re"],
        "A_Lambda_im": _A_in["Lambda_im"],
        "A_B_re": _A_in["B_re"],
        "A_B_im": _A_in["B_im"],
        "A_C_re": _A_in["C_re"],
        "A_C_im": _A_in["C_im"],
        "A_log_dt": _A_in["log_dt"],
        "A_Dskip": _A_in["Dskip"],
        "B_x": _B_in["x"],
        "B_w1": _B_in["w1"],
        "B_b1": _B_in["b1"],
        "B_w2": _B_in["w2"],
    }

def reference(A_x, A_Lambda_re, A_Lambda_im, A_B_re, A_B_im, A_C_re, A_C_im, A_log_dt, A_Dskip, B_x, B_w1, B_b1, B_w2):
    def _A_ref(x, Lambda_re, Lambda_im, B_re, B_im, C_re, C_im, log_dt, Dskip):
        Bsz, L, H = x.shape
        Lam = Lambda_re + 1j * Lambda_im
        Bmat = B_re + 1j * B_im
        Cmat = C_re + 1j * C_im
        dt = torch.exp(log_dt)
        Lam_bar = torch.exp(dt * Lam)
        B_bar = ((Lam_bar - 1.0) / Lam)[:, None] * Bmat
        Bu = torch.einsum("bld,pd->blp", x + 0j, B_bar)
        h = torch.zeros_like(Bu[:, 0, :])
        hs = []
        for t in range(L):
            h = Lam_bar[None, :] * h + Bu[:, t, :]
            hs.append(h)
        hseq = torch.stack(hs, 1)
        y = 2.0 * torch.einsum("blp,dp->bld", hseq, Cmat).real + x * Dskip[None, None, :]
        return y

    def _B_ref(x, w1, b1, w2):
        h = torch.einsum("bsd,df->bsf", x, w1) + b1
        sp = torch.log1p(torch.exp(-torch.abs(h))) + torch.where(h > 0, h, torch.zeros_like(h))
        act = h * torch.tanh(sp)
        return torch.einsum("bsf,fd->bsd", act, w2)

    x = A_x
    xn = _layernorm(x, axis=-1)
    return x + _A_ref(xn, A_Lambda_re, A_Lambda_im, A_B_re, A_B_im, A_C_re, A_C_im, A_log_dt, A_Dskip) + _B_ref(xn, B_w1, B_b1, B_w2)
```

```asm
; @launch grid=(256,1,1) block=(256,1,1) lds=163840
.amdgcn_target "amdgcn-amd-amdhsa--gfx950"
.text
.globl parallel_sum__ssm_conv_s5__dense_activation_mish__prompt_kernel
.p2align 8
.type parallel_sum__ssm_conv_s5__dense_activation_mish__prompt_kernel,@function
.set CODE_LAST, 0x12e34
parallel_sum__ssm_conv_s5__dense_activation_mish__prompt_kernel:
    s_cmp_ge_u32 s2, 256
    s_cbranch_scc1 L_end
    s_load_dwordx16 s[16:31], s[0:1], 0
    s_load_dwordx16 s[32:47], s[0:1], 64
    s_memrealtime s[88:89]
    s_getpc_b64 s[96:97]
    s_lshr_b32 s11, s2, 3
    s_mul_i32 s11, s11, 2816
    v_mul_u32_u24 v240, 11, v0
    v_and_b32 v240, 0xf80, v240
    v_add_u32 v240, s11, v240
    v_min_u32 v240, CODE_LAST, v240
    global_load_dword a255, v240, s[96:97]
    v_lshrrev_b32 v240, 6, v0
    v_and_b32 v144, 63, v0
    v_readfirstlane_b32 s3, v240
    s_and_b32 s4, s2, 3
    s_bfe_u32 s11, s2, 0x10002
    s_lshl_b32 s11, s11, 3
    s_lshr_b32 s12, s2, 5
    s_add_u32 s5, s11, s12
    s_bfe_u32 s6, s2, 0x20003
    s_cmp_eq_u32 s4, 3
    s_cselect_b32 s101, 1, 0
    s_sub_u32 s11, 2, s101
    s_cmp_lt_u32 s6, s11
    s_cselect_b32 s8, 1, 0
    s_lshl_b32 s12, s5, 7
    s_lshl_b32 s13, s3, 5
    s_add_u32 s100, s12, s13
    s_add_u32 s7, s5, s6
    s_lshl_b32 s7, s7, 7
    s_lshl_b32 s93, s3, 12
    s_lshl_b32 s94, s3, 10
    v_lshrrev_b32 v240, 3, v144
    v_and_b32 v241, 7, v144
    v_lshrrev_b32 v242, 1, v240
    v_xor_b32 v242, v242, v241
    v_lshlrev_b32 v242, 4, v242
    v_bfe_u32 v243, v240, 1, 1
    v_lshlrev_b32 v243, 2, v243
    v_xor_b32 v243, v243, v241
    v_lshlrev_b32 v243, 4, v243
    v_bfe_u32 v244, v240, 2, 1
    v_lshlrev_b32 v244, 4, v244
    v_and_b32 v245, 1, v240
    v_lshl_or_b32 v244, v245, 3, v244
    v_bfe_u32 v245, v240, 3, 2
    v_lshl_or_b32 v244, v245, 1, v244
    v_bfe_u32 v245, v240, 1, 1
    v_or_b32 v244, v244, v245
    v_add_u32 v244, s100, v244
    v_mul_u32_u24 v244, 1280, v244
    v_add_u32 v148, v244, v242
    v_xor_b32 v245, 64, v242
    v_add_u32 v246, v244, v245
    v_add_u32 v149, 2560, v246
    v_add_u32 v150, 5120, v148
    v_add_u32 v151, 7680, v246
    s_lshl_b32 s12, s3, 3
    s_and_b32 s13, s3, 1
    s_lshl_b32 s13, s13, 6
    v_add_u32 v244, s12, v240
    v_xor_b32 v245, s13, v242
    v_mul_u32_u24 v247, 1280, v244
    v_add_u32 v246, v247, v245
    s_lshl_b32 s12, s4, 1
    s_add_u32 s12, s12, s6
    s_cmp_eq_u32 s8, 1
    s_cbranch_scc1 L_progS
    s_sub_u32 s9, s6, s11
    s_sub_u32 s15, s12, s11
    s_mul_i32 s15, s15, 384
    v_mul_u32_u24 v248, 3456, v244
    v_add3_u32 v152, v248, v243, s15
    v_add_u32 v153, 110592, v152
    v_and_b32 v145, 31, v144
    v_lshrrev_b32 v146, 5, v144
    v_bfe_u32 v248, v144, 1, 3
    v_add_u32 v180, 0, v146
    v_xor_b32 v180, v180, v248
    v_lshlrev_b32 v180, 4, v180
    v_lshl_add_u32 v180, v145, 7, v180
    v_add_u32 v181, 2, v146
    v_xor_b32 v181, v181, v248
    v_lshlrev_b32 v181, 4, v181
    v_lshl_add_u32 v181, v145, 7, v181
    v_add_u32 v182, 4, v146
    v_xor_b32 v182, v182, v248
    v_lshlrev_b32 v182, 4, v182
    v_lshl_add_u32 v182, v145, 7, v182
    v_add_u32 v183, 6, v146
    v_xor_b32 v183, v183, v248
    v_lshlrev_b32 v183, 4, v183
    v_lshl_add_u32 v183, v145, 7, v183
    s_lshl_b32 s13, s3, 5
    v_xor_b32 v166, s13, v180
    v_add_u32 v166, s93, v166
    v_xor_b32 v167, s13, v181
    v_add_u32 v167, s93, v167
    v_xor_b32 v168, s13, v182
    v_add_u32 v168, s93, v168
    v_xor_b32 v169, s13, v183
    v_add_u32 v169, s93, v169
    v_bfe_u32 v248, v144, 2, 2
    v_lshl_add_u32 v178, v146, 3, v248
    v_lshlrev_b32 v178, 7, v178
    v_lshrrev_b32 v248, 1, v248
    v_lshl_or_b32 v178, v248, 6, v178
    v_bfe_u32 v248, v144, 4, 1
    v_lshl_or_b32 v178, v248, 5, v178
    v_and_b32 v248, 1, v144
    v_lshl_or_b32 v249, v248, 4, v178
    v_bfe_u32 v248, v144, 1, 1
    v_lshl_or_b32 v249, v248, 3, v249
    s_lshl_b32 s13, s3, 11
    v_or_b32 v249, s13, v249
    v_xor_b32 v170, 0, v249
    v_xor_b32 v171, 64, v249
    v_xor_b32 v172, 2048, v249
    v_xor_b32 v173, 2112, v249
    v_xor_b32 v174, 4096, v249
    v_xor_b32 v175, 4160, v249
    v_xor_b32 v176, 6144, v249
    v_xor_b32 v177, 6208, v249
    v_bfe_u32 v248, v144, 2, 1
    v_bfe_u32 v249, v144, 4, 1
    v_cmp_eq_u32 vcc, v248, v249
    v_mov_b32 v248, 0x3f803f80
    v_mov_b32 v155, 0
    v_cndmask_b32 v190, 0, v248, vcc
    v_cndmask_b32 v191, 0, v248, vcc
    v_cndmask_b32 v192, 0, v248, vcc
    v_cndmask_b32 v193, 0, v248, vcc
    s_waitcnt lgkmcnt(0)
    s_bitcmp1_b32 s5, 0
    s_cselect_b64 s[80:81], s[16:17], s[36:37]
    s_cselect_b64 s[82:83], s[36:37], s[38:39]
    s_cselect_b64 s[84:85], s[46:47], s[16:17]
    s_cselect_b64 s[90:91], s[16:17], s[36:37]
    s_bitcmp1_b32 s5, 1
    s_cselect_b64 s[80:81], s[82:83], s[80:81]
    s_cselect_b64 s[84:85], s[90:91], s[84:85]
    s_bitcmp1_b32 s5, 2
    s_cselect_b64 s[80:81], s[84:85], s[80:81]
    global_load_dword a255, v155, s[80:81] offset:128 sc1
    s_mov_b64 s[48:49], s[16:17]
    s_mov_b32 s50, 2621440
    s_mov_b32 s51, 0x20000
    s_mov_b64 s[52:53], s[36:37]
    s_mov_b32 s54, 2211840
    s_mov_b32 s55, 0x20000
    v_and_b32 v253, 0x13, v145
    v_bfe_u32 v254, v145, 2, 1
    v_lshl_or_b32 v253, v254, 3, v253
    v_bfe_u32 v254, v145, 3, 1
    v_lshl_or_b32 v253, v254, 2, v253
    v_lshlrev_b32 v253, 1, v253
    v_add_u32 v253, s15, v253
    global_load_ushort v216, v253, s[38:39] offset:0
    global_load_ushort v217, v253, s[38:39] offset:64
    global_load_ushort v218, v253, s[38:39] offset:128
    global_load_ushort v219, v253, s[38:39] offset:192
    global_load_ushort v220, v253, s[38:39] offset:256
    global_load_ushort v221, v253, s[38:39] offset:320
    s_add_u32 s95, s7, 0
    s_and_b32 s95, s95, 384
    s_add_u32 s95, s95, 0
    s_add_u32 m0, s93, 0
    s_nop 0
    buffer_load_dwordx4 v148, s[48:51], s95 offen lds
    s_add_u32 m0, s93, 1024
    s_nop 0
    buffer_load_dwordx4 v149, s[48:51], s95 offen lds
    s_add_u32 m0, s93, 2048
    s_nop 0
    buffer_load_dwordx4 v150, s[48:51], s95 offen lds
    s_add_u32 m0, s93, 3072
    s_nop 0
    buffer_load_dwordx4 v151, s[48:51], s95 offen lds
    s_mul_i32 s34, s95, 1728
    s_add_u32 m0, s94, 16384
    s_nop 0
    buffer_load_dwordx4 v152, s[52:55], s34 offen offset:0 lds
    s_add_u32 m0, s94, 20480
    s_nop 0
    buffer_load_dwordx4 v153, s[52:55], s34 offen offset:0 lds
    s_add_u32 m0, s94, 24448
    s_nop 0
    buffer_load_dwordx4 v152, s[52:55], s34 offen offset:128 lds
    s_add_u32 m0, s94, 28544
    s_nop 0
    buffer_load_dwordx4 v153, s[52:55], s34 offen offset:128 lds
    s_mov_b64 s[68:69], s[46:47]
    s_mov_b32 s70, 37748736
    s_mov_b32 s71, 0x20000
    s_mov_b64 s[56:57], s[40:41]
    s_mov_b32 s58, 2211840
    s_mov_b32 s59, 0x20000
    s_mov_b64 s[60:61], s[26:27]
    s_add_u32 s95, s7, 128
    s_and_b32 s95, s95, 384
    s_add_u32 s95, s95, 0
    s_add_u32 m0, s93, 32768
    s_nop 0
    buffer_load_dwordx4 v148, s[48:51], s95 offen lds
    s_mov_b32 s62, 819200
    s_mov_b32 s63, 0x20000
    s_mov_b64 s[64:65], s[28:29]
    s_mov_b32 s66, 819200
    s_mov_b32 s67, 0x20000
    s_mov_b64 s[72:73], s[42:43]
    s_mov_b32 s74, 5242880
    s_add_u32 m0, s93, 33792
    s_nop 0
    buffer_load_dwordx4 v149, s[48:51], s95 offen lds
    s_mov_b32 s75, 0x20000
    s_lshl_b32 s10, s6, 7
    s_cmp_eq_u32 s6, 3
    s_cselect_b32 s10, 448, s10
    s_sub_u32 s11, 2, s101
    s_add_u32 s15, s101, 2
    s_cmp_lt_u32 s6, 2
    s_cselect_b32 s12, 0, s9
    s_add_u32 m0, s93, 34816
    s_nop 0
    buffer_load_dwordx4 v150, s[48:51], s95 offen lds
    s_add_u32 s13, s12, 1
    s_cmp_eq_u32 s13, s15
    s_cselect_b32 s13, 0, s13
    s_add_u32 s14, s13, 1
    s_cmp_eq_u32 s14, 3
    s_cselect_b32 s14, 0, s14
    s_cmp_eq_u32 s101, 1
    s_cselect_b32 s14, s14, 2
    s_add_u32 m0, s93, 35840
    s_nop 0
    buffer_load_dwordx4 v151, s[48:51], s95 offen lds
    s_add_u32 s15, s12, s11
    s_lshl_b32 s16, 1, s15
    s_add_u32 s15, s13, s11
    s_lshl_b32 s17, 1, s15
    s_add_u32 s15, s14, 1
    s_lshl_b32 s18, 1, s15
    s_cmp_eq_u32 s101, 1
    s_cselect_b32 s18, s18, 3
    s_cselect_b32 s19, 1, 3
    s_mul_i32 s34, s95, 1728
    s_add_u32 m0, s94, 49152
    s_nop 0
    buffer_load_dwordx4 v152, s[52:55], s34 offen offset:0 lds
    s_lshl_b32 s15, s5, 2
    s_add_u32 s15, s15, s3
    s_lshl_b32 s15, s15, 2
    s_add_u32 s15, s15, s4
    s_lshl_b32 s24, s15, 8
    s_add_u32 s24, s24, 458752
    s_add_u32 s31, s24, 589824
    s_add_u32 m0, s94, 53248
    s_nop 0
    buffer_load_dwordx4 v153, s[52:55], s34 offen offset:0 lds
    s_mul_i32 s15, s15, 49152
    s_add_u32 s15, s15, 8388608
    s_mul_i32 s20, s12, 12288
    s_add_u32 s20, s20, s15
    s_mul_i32 s21, s13, 12288
    s_add_u32 s21, s21, s15
    s_mul_i32 s22, s14, 12288
    s_add_u32 m0, s94, 57216
    s_nop 0
    buffer_load_dwordx4 v152, s[52:55], s34 offen offset:128 lds
    s_add_u32 s22, s22, s15
    s_add_u32 s23, s15, 36864
    s_lshr_b32 s11, s6, 1
    s_and_b32 s11, s11, s6
    s_andn2_b32 s11, s11, s101
    s_mov_b64 s[96:97], s[60:61]
    s_mov_b32 s98, s22
    s_add_u32 m0, s94, 61312
    s_nop 0
    buffer_load_dwordx4 v153, s[52:55], s34 offen offset:128 lds
    s_bitcmp1_b32 s11, 0
    s_cselect_b64 s[60:61], s[64:65], s[60:61]
    s_cselect_b64 s[64:65], s[96:97], s[64:65]
    s_cselect_b32 s22, s23, s22
    s_cselect_b32 s23, s98, s23
    s_lshl_b32 s15, s4, 1
    s_add_u32 s11, s15, s12
    s_add_u32 s95, s7, 256
    s_and_b32 s95, s95, 384
    s_add_u32 s95, s95, 0
    s_add_u32 m0, s93, 65536
    s_nop 0
    buffer_load_dwordx4 v148, s[48:51], s95 offen lds
    s_mul_i32 s80, s11, 245760
    s_add_u32 s11, s15, s13
    s_mul_i32 s81, s11, 245760
    s_add_u32 s11, s15, s14
    s_mul_i32 s82, s11, 245760
    s_mul_i32 s83, s4, 384
    s_cmp_eq_u32 s101, 1
    s_cselect_b32 s82, s82, s83
    s_add_u32 m0, s93, 66560
    s_nop 0
    buffer_load_dwordx4 v149, s[48:51], s95 offen lds
    s_add_u32 s12, s4, 1
    s_cmp_ge_u32 s12, 3
    s_cselect_b32 s11, 3, 0
    s_sub_u32 s12, s12, s11
    s_add_u32 s13, s12, 1
    s_cmp_eq_u32 s13, 3
    s_cselect_b32 s13, 0, s13
    s_add_u32 m0, s93, 67584
    s_nop 0
    buffer_load_dwordx4 v150, s[48:51], s95 offen lds
    s_sub_u32 s14, 3, s12
    s_sub_u32 s14, s14, s13
    s_xor_b32 s26, s4, 3
    s_xor_b32 s27, s4, 2
    s_xor_b32 s28, s4, 1
    s_lshr_b32 s15, s4, 1
    s_xor_b32 s11, s15, 1
    s_add_u32 m0, s93, 68608
    s_nop 0
    buffer_load_dwordx4 v151, s[48:51], s95 offen lds
    s_cmp_lt_u32 s6, 2
    s_cselect_b32 s26, s26, s12
    s_cselect_b32 s27, s27, s13
    s_cselect_b32 s28, s28, s14
    s_cselect_b32 s12, s11, s12
    s_cselect_b32 s13, s15, s13
    s_lshl_b32 s11, s12, 6
    s_mul_i32 s34, s95, 1728
    s_add_u32 m0, s94, 81920
    s_nop 0
    buffer_load_dwordx4 v152, s[52:55], s34 offen offset:0 lds
    s_add_u32 s11, s11, s10
    s_lshl_b32 s84, s11, 1
    s_mul_i32 s90, s11, 1280
    s_lshl_b32 s11, s13, 6
    s_add_u32 s11, s11, s10
    s_lshl_b32 s85, s11, 1
    s_mul_i32 s91, s11, 1280
    s_add_u32 m0, s94, 86016
    s_nop 0
    buffer_load_dwordx4 v153, s[52:55], s34 offen offset:0 lds
    s_lshl_b32 s11, s14, 6
    s_add_u32 s11, s11, s10
    s_lshl_b32 s86, s11, 1
    s_mul_i32 s92, s11, 1280
    s_add_u32 s76, s80, s84
    s_add_u32 s12, s80, s85
    s_add_u32 s13, s80, s86
    s_add_u32 m0, s94, 89984
    s_nop 0
    buffer_load_dwordx4 v152, s[52:55], s34 offen offset:128 lds
    s_add_u32 s14, s81, s84
    s_add_u32 s15, s81, s85
    s_cmp_lt_u32 s6, 2
    s_cselect_b32 s77, s14, s12
    s_cselect_b32 s78, s12, s13
    s_cselect_b32 s79, s15, s14
    s_lshl_b32 s15, s5, 2
    s_add_u32 m0, s94, 94080
    s_nop 0
    buffer_load_dwordx4 v153, s[52:55], s34 offen offset:128 lds
    s_add_u32 s15, s15, s6
    s_lshl_b32 s15, s15, 2
    s_add_u32 s15, s15, s3
    s_lshl_b32 s15, s15, 2
    s_add_u32 s26, s26, s15
    s_lshl_b32 s26, s26, 2
    s_add_u32 s26, s26, s4
    s_add_u32 s95, s7, 384
    s_and_b32 s95, s95, 384
    s_add_u32 s95, s95, 0
    s_add_u32 m0, s93, 98304
    s_nop 0
    buffer_load_dwordx4 v148, s[48:51], s95 offen lds
    s_add_u32 s27, s27, s15
    s_lshl_b32 s27, s27, 2
    s_add_u32 s27, s27, s4
    s_add_u32 s28, s28, s15
    s_lshl_b32 s28, s28, 2
    s_add_u32 s28, s28, s4
    s_add_u32 s25, s15, s4
    s_add_u32 m0, s93, 99328
    s_nop 0
    buffer_load_dwordx4 v149, s[48:51], s95 offen lds
    s_lshl_b32 s25, s25, 2
    s_cmp_lt_u32 s6, 2
    s_cselect_b32 s11, 5, 6
    s_lshl_b32 s11, s4, s11
    s_add_u32 s11, s11, s10
    s_lshl_b32 s30, s11, 1
    s_lshl_b32 s11, s11, 2
    s_add_u32 m0, s93, 100352
    s_nop 0
    buffer_load_dwordx4 v150, s[48:51], s95 offen lds
    s_mul_i32 s29, s100, 2560
    s_add_u32 s29, s29, s11
    s_and_b32 s11, s4, 1
    s_xor_b32 s11, s11, 1
    s_cmp_lt_u32 s6, 2
    s_cselect_b32 s11, s11, 0
    s_lshl_b32 s12, s11, 6
    s_add_u32 m0, s93, 101376
    s_nop 0
    buffer_load_dwordx4 v151, s[48:51], s95 offen lds
    s_mul_i32 s13, s11, 40960
    s_sub_u32 s14, 40960, s13
    v_xor_b32 v248, s12, v243
    v_add_u32 v158, v247, v248
    v_add_u32 v164, s13, v246
    v_add_u32 v165, s14, v246
    v_add_u32 v159, 40960, v158
    s_mul_i32 s34, s95, 1728
    s_add_u32 m0, s94, 114688
    s_nop 0
    buffer_load_dwordx4 v152, s[52:55], s34 offen offset:0 lds
    v_add_u32 v160, 81920, v158
    v_add_u32 v161, 122880, v158
    v_add_u32 v162, 163840, v158
    v_add_u32 v163, 204800, v158
    v_and_b32 v248, 3, v144
    v_lshl_or_b32 v178, v248, 3, v178
    v_xor_b32 v179, 64, v178
    s_add_u32 m0, s94, 118784
    s_nop 0
    buffer_load_dwordx4 v153, s[52:55], s34 offen offset:0 lds
    v_lshlrev_b32 v239, 6, v248
    v_lshlrev_b32 v147, 4, v144
    v_mul_u32_u24 v156, 2560, v240
    v_lshl_add_u32 v156, v241, 4, v156
    s_add_u32 s11, s93, 147456
    v_add_u32 v157, s11, v147
    s_add_u32 m0, s94, 122752
    s_nop 0
    buffer_load_dwordx4 v152, s[52:55], s34 offen offset:128 lds
    s_add_u32 m0, s94, 126848
    s_nop 0
    buffer_load_dwordx4 v153, s[52:55], s34 offen offset:128 lds
    s_lshl_b32 s15, s4, 2
    s_add_u32 s15, s15, s6
    s_lshl_b32 s13, s5, 7
    s_lshl_b32 s14, s15, 3
    s_add_u32 s13, s13, s14
    s_lshl_b32 s14, s3, 1
    s_add_u32 s13, s13, s14
    v_add_u32 v252, s13, v146
    v_mul_u32_u24 v254, 1280, v252
    v_lshl_add_u32 v254, v145, 3, v254
    buffer_load_dwordx2 v[96:97], v254, s[48:51], 0 offen offset:0
    buffer_load_dwordx2 v[98:99], v254, s[48:51], 0 offen offset:256
    buffer_load_dwordx2 v[100:101], v254, s[48:51], 0 offen offset:512
    buffer_load_dwordx2 v[102:103], v254, s[48:51], 0 offen offset:768
    buffer_load_dwordx2 v[104:105], v254, s[48:51], 0 offen offset:1024
    global_load_dwordx2 v[198:199], v155, s[44:45] sc1
    s_lshl_b32 s96, s25, 12
    s_add_u32 s96, s96, 20971520
    s_bitcmp1_b32 s3, 0
    s_cselect_b32 s96, s96, s20
    s_lshl_b32 s97, s25, 6
    s_add_u32 s97, s97, 786432
    v_mov_b32 v202, s96
    v_add_u32 v203, s31, v239
    v_cmp_gt_u32 vcc, 4, v144
    v_add_u32 v204, s97, v239
    v_min_u32 v205, 9, v144
    v_cndmask_b32 v202, v202, v203, vcc
    v_cmp_lt_u32 vcc, 59, v144
    v_lshlrev_b32 v205, 7, v205
    s_bitcmp1_b32 s3, 0
    s_cselect_b64 s[96:97], s[60:61], s[64:65]
    s_cselect_b64 s[98:99], s[56:57], s[32:33]
    v_cndmask_b32 v202, v202, v204, vcc
    s_bitcmp1_b32 s3, 1
    s_cselect_b64 s[96:97], s[96:97], s[98:99]
    buffer_load_dword a255, v202, s[68:71], 0 offen sc1
    global_load_dword a255, v205, s[96:97]
    buffer_load_dword a255, v155, s[72:75], s29 offen sc1
    s_waitcnt vmcnt(33)
    s_barrier
    ds_read_b128 a[0:3], v166 offset:0
    ds_read_b64_tr_b16 a[160:161], v170 offset:16384
    ds_read_b64_tr_b16 a[162:163], v170 offset:16896
    ds_read_b64_tr_b16 a[164:165], v171 offset:16384
    ds_read_b64_tr_b16 a[166:167], v171 offset:16896
    ds_read_b64_tr_b16 a[168:169], v170 offset:24576
    ds_read_b64_tr_b16 a[170:171], v170 offset:25088
    ds_read_b64_tr_b16 a[172:173], v171 offset:24576
    ds_read_b64_tr_b16 a[174:175], v171 offset:25088
    ds_read_b128 a[4:7], v167 offset:0
    ds_read_b64_tr_b16 a[176:177], v172 offset:16384
    ds_read_b64_tr_b16 a[178:179], v172 offset:16896
    ds_read_b64_tr_b16 a[180:181], v173 offset:16384
    ds_read_b64_tr_b16 a[182:183], v173 offset:16896
    ds_read_b64_tr_b16 a[184:185], v172 offset:24576
    ds_read_b64_tr_b16 a[186:187], v172 offset:25088
    ds_read_b64_tr_b16 a[188:189], v173 offset:24576
    ds_read_b64_tr_b16 a[190:191], v173 offset:25088
    s_waitcnt lgkmcnt(9)
    v_mfma_f32_32x32x16_bf16 v[0:15], a[160:163], a[0:3], 0
    ds_read_b128 a[8:11], v168 offset:0
    ds_read_b64_tr_b16 a[192:193], v174 offset:16384
    ds_read_b64_tr_b16 a[194:195], v174 offset:16896
    v_mfma_f32_16x16x32_bf16 a[208:211], v[190:193], a[160:163], 0
    ds_read_b64_tr_b16 a[196:197], v175 offset:16384
    v_mfma_f32_32x32x16_bf16 v[16:31], a[164:167], a[0:3], 0
    ds_read_b64_tr_b16 a[198:199], v175 offset:16896
    ds_read_b64_tr_b16 a[200:201], v174 offset:24576
    v_mfma_f32_32x32x16_bf16 v[32:47], a[168:171], a[0:3], 0
    ds_read_b64_tr_b16 a[202:203], v174 offset:25088
    ds_read_b64_tr_b16 a[204:205], v175 offset:24576
    v_mfma_f32_32x32x16_bf16 v[48:63], a[172:175], a[0:3], 0
    ds_read_b64_tr_b16 a[206:207], v175 offset:25088
    s_waitcnt lgkmcnt(9)
    v_mfma_f32_32x32x16_bf16 v[0:15], a[176:179], a[4:7], v[0:15]
    ds_read_b128 a[12:15], v169 offset:0
    ds_read_b64_tr_b16 a[160:161], v176 offset:16384
    ds_read_b64_tr_b16 a[162:163], v176 offset:16896
    v_mfma_f32_32x32x16_bf16 v[16:31], a[180:183], a[4:7], v[16:31]
    ds_read_b64_tr_b16 a[164:165], v177 offset:16384
    ds_read_b64_tr_b16 a[166:167], v177 offset:16896
    v_mfma_f32_16x16x32_bf16 a[212:215], v[190:193], a[180:183], 0
    ds_read_b64_tr_b16 a[168:169], v176 offset:24576
    v_mfma_f32_32x32x16_bf16 v[32:47], a[184:187], a[4:7], v[32:47]
    ds_read_b64_tr_b16 a[170:171], v176 offset:25088
    ds_read_b64_tr_b16 a[172:173], v177 offset:24576
    v_mfma_f32_32x32x16_bf16 v[48:63], a[188:191], a[4:7], v[48:63]
    ds_read_b64_tr_b16 a[174:175], v177 offset:25088
    s_waitcnt lgkmcnt(9)
    v_mfma_f32_32x32x16_bf16 v[0:15], a[192:195], a[8:11], v[0:15]
    v_mfma_f32_32x32x16_bf16 v[16:31], a[196:199], a[8:11], v[16:31]
    s_waitcnt lgkmcnt(0)
    s_waitcnt vmcnt(25)
    s_barrier
    v_mfma_f32_32x32x16_bf16 v[32:47], a[200:203], a[8:11], v[32:47]
    ds_read_b128 a[16:19], v166 offset:32768
    ds_read_b64_tr_b16 a[176:177], v170 offset:49152
    ds_read_b64_tr_b16 a[178:179], v170 offset:49664
    ds_read_b64_tr_b16 a[180:181], v171 offset:49152
    ds_read_b64_tr_b16 a[182:183], v171 offset:49664
    v_add_u32 v170, 57344, v170
    s_add_u32 s95, s7, 0
    s_and_b32 s95, s95, 384
    s_add_u32 s95, s95, 512
    s_add_u32 m0, s93, 0
    v_mfma_f32_16x16x32_bf16 a[216:219], v[190:193], a[200:203], 0
    ds_read_b64_tr_b16 a[184:185], v170 offset:0
    buffer_load_dwordx4 v148, s[48:51], s95 offen lds
    s_add_u32 m0, s93, 1024
    v_mfma_f32_32x32x16_bf16 v[48:63], a[204:207], a[8:11], v[48:63]
    ds_read_b64_tr_b16 a[186:187], v170 offset:512
    v_add_u32 v171, 57344, v171
    ds_read_b64_tr_b16 a[188:189], v171 offset:0
    ds_read_b64_tr_b16 a[190:191], v171 offset:512
    buffer_load_dwordx4 v149, s[48:51], s95 offen lds
    s_add_u32 m0, s93, 2048
    v_mfma_f32_32x32x16_bf16 v[0:15], a[160:163], a[12:15], v[0:15]
    ds_read_b128 a[20:23], v167 offset:32768
    ds_read_b64_tr_b16 a[192:193], v172 offset:49152
    ds_read_b64_tr_b16 a[194:195], v172 offset:49664
    v_mfma_f32_32x32x16_bf16 v[16:31], a[164:167], a[12:15], v[16:31]
    ds_read_b64_tr_b16 a[196:197], v173 offset:49152
    ds_read_b64_tr_b16 a[198:199], v173 offset:49664
    v_add_u32 v172, 57344, v172
    buffer_load_dwordx4 v150, s[48:51], s95 offen lds
    s_add_u32 m0, s93, 3072
    v_mfma_f32_32x32x16_bf16 v[32:47], a[168:171], a[12:15], v[32:47]
    ds_read_b64_tr_b16 a[200:201], v172 offset:0
    ds_read_b64_tr_b16 a[202:203], v172 offset:512
    v_add_u32 v173, 57344, v173
    v_mfma_f32_32x32x16_bf16 v[48:63], a[172:175], a[12:15], v[48:63]
    ds_read_b64_tr_b16 a[204:205], v173 offset:0
    ds_read_b64_tr_b16 a[206:207], v173 offset:512
    buffer_load_dwordx4 v151, s[48:51], s95 offen lds
    s_mul_i32 s34, s95, 1728
    s_add_u32 m0, s94, 16384
    v_mfma_f32_16x16x32_bf16 a[220:223], v[190:193], a[172:175], 0
    s_waitcnt lgkmcnt(9)
    v_mfma_f32_32x32x16_bf16 v[0:15], a[176:179], a[16:19], v[0:15]
    ds_read_b128 a[24:27], v168 offset:32768
    ds_read_b64_tr_b16 a[160:161], v174 offset:49152
    ds_read_b64_tr_b16 a[162:163], v174 offset:49664
    v_mfma_f32_16x16x32_bf16 a[208:211], v[190:193], a[176:179], a[208:211]
    ds_read_b64_tr_b16 a[164:165], v175 offset:49152
    buffer_load_dwordx4 v152, s[52:55], s34 offen offset:0 lds
    s_add_u32 m0, s94, 20480
    v_mfma_f32_32x32x16_bf16 v[16:31], a[180:183], a[16:19], v[16:31]
    ds_read_b64_tr_b16 a[166:167], v175 offset:49664
    v_add_u32 v174, 57344, v174
    ds_read_b64_tr_b16 a[168:169], v174 offset:0
    v_mfma_f32_32x32x16_bf16 v[32:47], a[184:187], a[16:19], v[32:47]
    ds_read_b64_tr_b16 a[170:171], v174 offset:512
    v_add_u32 v175, 57344, v175
    buffer_load_dwordx4 v153, s[52:55], s34 offen offset:0 lds
    s_add_u32 m0, s94, 24448
    v_mfma_f32_32x32x16_bf16 v[48:63], a[188:191], a[16:19], v[48:63]
    ds_read_b64_tr_b16 a[172:173], v175 offset:0
    ds_read_b64_tr_b16 a[174:175], v175 offset:512
    s_waitcnt lgkmcnt(9)
    v_mfma_f32_32x32x16_bf16 v[0:15], a[192:195], a[20:23], v[0:15]
    ds_read_b128 a[28:31], v169 offset:32768
    ds_read_b64_tr_b16 a[176:177], v176 offset:49152
    ds_read_b64_tr_b16 a[178:179], v176 offset:49664
    buffer_load_dwordx4 v152, s[52:55], s34 offen offset:128 lds
    s_add_u32 m0, s94, 28544
    v_mfma_f32_32x32x16_bf16 v[16:31], a[196:199], a[20:23], v[16:31]
    ds_read_b64_tr_b16 a[180:181], v177 offset:49152
    ds_read_b64_tr_b16 a[182:183], v177 offset:49664
    v_add_u32 v176, 57344, v176
    v_mfma_f32_16x16x32_bf16 a[212:215], v[190:193], a[196:199], a[212:215]
    ds_read_b64_tr_b16 a[184:185], v176 offset:0
    v_mfma_f32_32x32x16_bf16 v[32:47], a[200:203], a[20:23], v[32:47]
    ds_read_b64_tr_b16 a[186:187], v176 offset:512
    v_add_u32 v177, 57344, v177
    buffer_load_dwordx4 v153, s[52:55], s34 offen offset:128 lds
    s_add_u32 s95, s7, 0
    s_and_b32 s95, s95, 384
    s_add_u32 s95, s95, 0
    s_mul_i32 s34, s95, 1728
    s_add_u32 m0, s94, 130816
    v_mfma_f32_32x32x16_bf16 v[48:63], a[204:207], a[20:23], v[48:63]
    ds_read_b64_tr_b16 a[188:189], v177 offset:0
    ds_read_b64_tr_b16 a[190:191], v177 offset:512
    s_waitcnt lgkmcnt(9)
    v_mfma_f32_32x32x16_bf16 v[0:15], a[160:163], a[24:27], v[0:15]
    buffer_load_dwordx4 v152, s[52:55], s34 offen offset:256 lds
    s_add_u32 m0, s94, 134912
    s_waitcnt vmcnt(13)
    v_lshlrev_b32 v116, 16, v96
    v_and_b32 v117, 0xffff0000, v96
    v_lshlrev_b32 v118, 16, v97
    v_mfma_f32_32x32x16_bf16 v[16:31], a[164:167], a[24:27], v[16:31]
    v_and_b32 v119, 0xffff0000, v97
    v_lshlrev_b32 v120, 16, v98
    v_and_b32 v121, 0xffff0000, v98
    v_lshlrev_b32 v122, 16, v99
    v_and_b32 v123, 0xffff0000, v99
    v_lshlrev_b32 v124, 16, v100
    s_waitcnt lgkmcnt(0)
    s_barrier
    v_mfma_f32_32x32x16_bf16 v[32:47], a[168:171], a[24:27], v[32:47]
    v_add_u32 v166, 65536, v166
    ds_read_b128 a[32:35], v166 offset:0
    ds_read_b64_tr_b16 a[192:193], v170 offset:24576
    ds_read_b64_tr_b16 a[194:195], v170 offset:25088
    ds_read_b64_tr_b16 a[196:197], v171 offset:24576
    buffer_load_dwordx4 v153, s[52:55], s34 offen offset:256 lds
    s_add_u32 s95, s7, 128
    s_and_b32 s95, s95, 384
    s_add_u32 s95, s95, 0
    s_mul_i32 s34, s95, 1728
    s_add_u32 m0, s94, 139008
    v_mfma_f32_16x16x32_bf16 a[216:219], v[190:193], a[168:171], a[216:219]
    ds_read_b64_tr_b16 a[198:199], v171 offset:25088
    v_mfma_f32_32x32x16_bf16 v[48:63], a[172:175], a[24:27], v[48:63]
    ds_read_b64_tr_b16 a[200:201], v170 offset:32768
    ds_read_b64_tr_b16 a[202:203], v170 offset:33280
    ds_read_b64_tr_b16 a[204:205], v171 offset:32768
    ds_read_b64_tr_b16 a[206:207], v171 offset:33280
    buffer_load_dwordx4 v152, s[52:55], s34 offen offset:256 lds
    s_add_u32 m0, s94, 143104
    v_mfma_f32_32x32x16_bf16 v[0:15], a[176:179], a[28:31], v[0:15]
    v_add_u32 v167, 65536, v167
    ds_read_b128 a[36:39], v167 offset:0
    ds_read_b64_tr_b16 a[160:161], v172 offset:24576
    v_and_b32 v125, 0xffff0000, v100
    v_lshlrev_b32 v126, 16, v101
    v_and_b32 v127, 0xffff0000, v101
    v_mfma_f32_32x32x16_bf16 v[16:31], a[180:183], a[28:31], v[16:31]
    ds_read_b64_tr_b16 a[162:163], v172 offset:25088
    ds_read_b64_tr_b16 a[164:165], v173 offset:24576
    ds_read_b64_tr_b16 a[166:167], v173 offset:25088
    buffer_load_dwordx4 v153, s[52:55], s34 offen offset:256 lds
    s_add_u32 s95, s7, 128
    s_and_b32 s95, s95, 384
    s_add_u32 s95, s95, 512
    s_add_u32 m0, s93, 32768
    v_mfma_f32_32x32x16_bf16 v[32:47], a[184:187], a[28:31], v[32:47]
    ds_read_b64_tr_b16 a[168:169], v172 offset:32768
    ds_read_b64_tr_b16 a[170:171], v172 offset:33280
    v_lshlrev_b32 v128, 16, v102
    v_and_b32 v129, 0xffff0000, v102
    v_lshlrev_b32 v130, 16, v103
    v_and_b32 v131, 0xffff0000, v103
    v_mfma_f32_32x32x16_bf16 v[48:63], a[188:191], a[28:31], v[48:63]
    ds_read_b64_tr_b16 a[172:173], v173 offset:32768
    ds_read_b64_tr_b16 a[174:175], v173 offset:33280
    buffer_load_dwordx4 v148, s[48:51], s95 offen lds
    s_add_u32 m0, s93, 33792
    v_lshlrev_b32 v132, 16, v104
    v_and_b32 v133, 0xffff0000, v104
    v_mfma_f32_16x16x32_bf16 a[220:223], v[190:193], a[188:191], a[220:223]
    v_lshlrev_b32 v134, 16, v105
    s_waitcnt lgkmcnt(9)
    v_mfma_f32_32x32x16_bf16 v[0:15], a[192:195], a[32:35], v[0:15]
    v_add_u32 v168, 65536, v168
    ds_read_b128 a[40:43], v168 offset:0
    ds_read_b64_tr_b16 a[176:177], v174 offset:24576
    v_and_b32 v135, 0xffff0000, v105
    v_add_f32 v136, v116, v117
    v_add_f32 v137, v118, v119
    v_mfma_f32_16x16x32_bf16 a[208:211], v[190:193], a[192:195], a[208:211]
    ds_read_b64_tr_b16 a[178:179], v174 offset:25088
    buffer_load_dwordx4 v149, s[48:51], s95 offen lds
    s_add_u32 m0, s93, 34816
    v_mfma_f32_32x32x16_bf16 v[16:31], a[196:199], a[32:35], v[16:31]
    ds_read_b64_tr_b16 a[180:181], v175 offset:24576
    ds_read_b64_tr_b16 a[182:183], v175 offset:25088
    v_add_f32 v136, v136, v120
    v_add_f32 v137, v137, v121
    v_add_f32 v136, v136, v122
    v_add_f32 v137, v137, v123
    v_mfma_f32_32x32x16_bf16 v[32:47], a[200:203], a[32:35], v[32:47]
    ds_read_b64_tr_b16 a[184:185], v174 offset:32768
    ds_read_b64_tr_b16 a[186:187], v174 offset:33280
    buffer_load_dwordx4 v150, s[48:51], s95 offen lds
    s_add_u32 m0, s93, 35840
    v_add_f32 v136, v136, v124
    v_add_f32 v137, v137, v125
    v_mfma_f32_32x32x16_bf16 v[48:63], a[204:207], a[32:35], v[48:63]
    ds_read_b64_tr_b16 a[188:189], v175 offset:32768
    ds_read_b64_tr_b16 a[190:191], v175 offset:33280
    v_add_f32 v136, v136, v126
    v_add_f32 v137, v137, v127
    v_add_f32 v136, v136, v128
    v_add_f32 v137, v137, v129
    s_waitcnt lgkmcnt(9)
    v_mfma_f32_32x32x16_bf16 v[0:15], a[160:163], a[36:39], v[0:15]
    v_add_u32 v169, 65536, v169
    ds_read_b128 a[44:47], v169 offset:0
    ds_read_b64_tr_b16 a[192:193], v176 offset:24576
    buffer_load_dwordx4 v151, s[48:51], s95 offen lds
    s_mul_i32 s34, s95, 1728
    s_add_u32 m0, s94, 49152
    v_mfma_f32_32x32x16_bf16 v[16:31], a[164:167], a[36:39], v[16:31]
    ds_read_b64_tr_b16 a[194:195], v176 offset:25088
    ds_read_b64_tr_b16 a[196:197], v177 offset:24576
    ds_read_b64_tr_b16 a[198:199], v177 offset:25088
    v_add_f32 v136, v136, v130
    v_add_f32 v137, v137, v131
    v_add_f32 v136, v136, v132
    v_mfma_f32_16x16x32_bf16 a[212:215], v[190:193], a[164:167], a[212:215]
    ds_read_b64_tr_b16 a[200:201], v176 offset:32768
    v_mfma_f32_32x32x16_bf16 v[32:47], a[168:171], a[36:39], v[32:47]
    ds_read_b64_tr_b16 a[202:203], v176 offset:33280
    ds_read_b64_tr_b16 a[204:205], v177 offset:32768
    buffer_load_dwordx4 v152, s[52:55], s34 offen offset:0 lds
    s_add_u32 m0, s94, 53248
    v_add_f32 v137, v137, v133
    v_add_f32 v136, v136, v134
    v_mfma_f32_32x32x16_bf16 v[48:63], a[172:175], a[36:39], v[48:63]
    ds_read_b64_tr_b16 a[206:207], v177 offset:33280
    v_add_f32 v137, v137, v135
    v_add_f32 v136, v136, v137
    s_nop 1
    v_add_f32_dpp v136, v136, v136 quad_perm:[1,0,3,2] row_mask:0xf bank_mask:0xf
    s_nop 1
    v_add_f32_dpp v136, v136, v136 quad_perm:[2,3,0,1] row_mask:0xf bank_mask:0xf
    s_nop 1
    v_add_f32_dpp v136, v136, v136 row_half_mirror row_mask:0xf bank_mask:0xf
    s_waitcnt lgkmcnt(9)
    v_mfma_f32_32x32x16_bf16 v[0:15], a[176:179], a[40:43], v[0:15]
    buffer_load_dwordx4 v153, s[52:55], s34 offen offset:0 lds
    s_add_u32 m0, s94, 57216
    v_add_f32_dpp v136, v136, v136 row_mirror row_mask:0xf bank_mask:0xf
    v_mov_b32 v137, v136
    s_nop 1
    v_permlane16_swap_b32 v136, v137
    v_add_f32 v136, v136, v137
    v_mfma_f32_32x32x16_bf16 v[16:31], a[180:183], a[40:43], v[16:31]
    v_mul_f32 v136, 0x3acccccd, v136
    v_mov_b32 v138, 0
    v_mov_b32 v139, 0
    v_sub_f32 v240, v116, v136
    v_sub_f32 v241, v117, v136
    v_fmac_f32 v138, v240, v240
    s_waitcnt lgkmcnt(0)
    s_barrier
    v_mfma_f32_32x32x16_bf16 v[32:47], a[184:187], a[40:43], v[32:47]
    ds_read_b128 a[48:51], v166 offset:32768
    v_add_u32 v170, 57344, v170
    ds_read_b64_tr_b16 a[160:161], v170 offset:0
    ds_read_b64_tr_b16 a[162:163], v170 offset:512
    v_add_u32 v171, 57344, v171
    ds_read_b64_tr_b16 a[164:165], v171 offset:0
    buffer_load_dwordx4 v152, s[52:55], s34 offen offset:128 lds
    s_add_u32 m0, s94, 61312
    v_mfma_f32_16x16x32_bf16 a[216:219], v[190:193], a[184:187], a[216:219]
    ds_read_b64_tr_b16 a[166:167], v171 offset:512
    v_mfma_f32_32x32x16_bf16 v[48:63], a[188:191], a[40:43], v[48:63]
    ds_read_b64_tr_b16 a[168:169], v170 offset:8192
    ds_read_b64_tr_b16 a[170:171], v170 offset:8704
    ds_read_b64_tr_b16 a[172:173], v171 offset:8192
    ds_read_b64_tr_b16 a[174:175], v171 offset:8704
    buffer_load_dwordx4 v153, s[52:55], s34 offen offset:128 lds
    s_add_u32 s95, s7, 256
    s_and_b32 s95, s95, 384
    s_add_u32 s95, s95, 512
    s_add_u32 m0, s93, 65536
    v_mfma_f32_32x32x16_bf16 v[0:15], a[192:195], a[44:47], v[0:15]
    ds_read_b128 a[52:55], v167 offset:32768
    v_add_u32 v172, 57344, v172
    ds_read_b64_tr_b16 a[176:177], v172 offset:0
    v_fmac_f32 v139, v241, v241
    v_sub_f32 v240, v118, v136
    v_sub_f32 v241, v119, v136
    v_mfma_f32_32x32x16_bf16 v[16:31], a[196:199], a[44:47], v[16:31]
    ds_read_b64_tr_b16 a[178:179], v172 offset:512
    v_add_u32 v173, 57344, v173
    ds_read_b64_tr_b16 a[180:181], v173 offset:0
    buffer_load_dwordx4 v148, s[48:51], s95 offen lds
    s_add_u32 m0, s93, 66560
    v_fmac_f32 v138, v240, v240
    v_mfma_f32_32x32x16_bf16 v[32:47], a[200:203], a[44:47], v[32:47]
    ds_read_b64_tr_b16 a[182:183], v173 offset:512
    ds_read_b64_tr_b16 a[184:185], v172 offset:8192
    ds_read_b64_tr_b16 a[186:187], v172 offset:8704
    v_fmac_f32 v139, v241, v241
    v_sub_f32 v240, v120, v136
    v_sub_f32 v241, v121, v136
    v_mfma_f32_32x32x16_bf16 v[48:63], a[204:207], a[44:47], v[48:63]
    ds_read_b64_tr_b16 a[188:189], v173 offset:8192
    ds_read_b64_tr_b16 a[190:191], v173 offset:8704
    buffer_load_dwordx4 v149, s[48:51], s95 offen lds
    s_add_u32 m0, s93, 67584
    v_fmac_f32 v138, v240, v240
    v_fmac_f32 v139, v241, v241
    v_mfma_f32_16x16x32_bf16 a[220:223], v[190:193], a[204:207], a[220:223]
    v_sub_f32 v240, v122, v136
    s_waitcnt lgkmcnt(9)
    v_mfma_f32_32x32x16_bf16 v[0:15], a[160:163], a[48:51], v[0:15]
    ds_read_b128 a[56:59], v168 offset:32768
    v_add_u32 v174, 57344, v174
    ds_read_b64_tr_b16 a[192:193], v174 offset:0
    v_sub_f32 v241, v123, v136
    v_fmac_f32 v138, v240, v240
    v_fmac_f32 v139, v241, v241
    v_mfma_f32_16x16x32_bf16 a[208:211], v[190:193], a[160:163], a[208:211]
    ds_read_b64_tr_b16 a[194:195], v174 offset:512
    buffer_load_dwordx4 v150, s[48:51], s95 offen lds
    s_add_u32 m0, s93, 68608
    v_mfma_f32_32x32x16_bf16 v[16:31], a[164:167], a[48:51], v[16:31]
    v_add_u32 v175, 57344, v175
    ds_read_b64_tr_b16 a[196:197], v175 offset:0
    ds_read_b64_tr_b16 a[198:199], v175 offset:512
    v_sub_f32 v240, v124, v136
    v_sub_f32 v241, v125, v136
    v_fmac_f32 v138, v240, v240
    v_mfma_f32_32x32x16_bf16 v[32:47], a[168:171], a[48:51], v[32:47]
    ds_read_b64_tr_b16 a[200:201], v174 offset:8192
    ds_read_b64_tr_b16 a[202:203], v174 offset:8704
    buffer_load_dwordx4 v151, s[48:51], s95 offen lds
    s_mul_i32 s34, s95, 1728
    s_add_u32 m0, s94, 81920
    v_fmac_f32 v139, v241, v241
    v_mfma_f32_32x32x16_bf16 v[48:63], a[172:175], a[48:51], v[48:63]
    ds_read_b64_tr_b16 a[204:205], v175 offset:8192
    ds_read_b64_tr_b16 a[206:207], v175 offset:8704
    v_sub_f32 v240, v126, v136
    v_sub_f32 v241, v127, v136
    v_fmac_f32 v138, v240, v240
    v_fmac_f32 v139, v241, v241
    s_waitcnt lgkmcnt(9)
    v_mfma_f32_32x32x16_bf16 v[0:15], a[176:179], a[52:55], v[0:15]
    ds_read_b128 a[60:63], v169 offset:32768
    v_add_u32 v176, 57344, v176
    ds_read_b64_tr_b16 a[160:161], v176 offset:0
    buffer_load_dwordx4 v152, s[52:55], s34 offen offset:0 lds
    s_add_u32 m0, s94, 86016
    v_sub_f32 v240, v128, v136
    v_mfma_f32_32x32x16_bf16 v[16:31], a[180:183], a[52:55], v[16:31]
    ds_read_b64_tr_b16 a[162:163], v176 offset:512
    v_add_u32 v177, 57344, v177
    ds_read_b64_tr_b16 a[164:165], v177 offset:0
    v_sub_f32 v241, v129, v136
    v_fmac_f32 v138, v240, v240
    v_fmac_f32 v139, v241, v241
    v_mfma_f32_16x16x32_bf16 a[212:215], v[190:193], a[180:183], a[212:215]
    ds_read_b64_tr_b16 a[166:167], v177 offset:512
    v_mfma_f32_32x32x16_bf16 v[32:47], a[184:187], a[52:55], v[32:47]
    ds_read_b64_tr_b16 a[168:169], v176 offset:8192
    ds_read_b64_tr_b16 a[170:171], v176 offset:8704
    buffer_load_dwordx4 v153, s[52:55], s34 offen offset:0 lds
    s_add_u32 m0, s94, 89984
    v_sub_f32 v240, v130, v136
    v_sub_f32 v241, v131, v136
    v_mfma_f32_32x32x16_bf16 v[48:63], a[188:191], a[52:55], v[48:63]
    ds_read_b64_tr_b16 a[172:173], v177 offset:8192
    ds_read_b64_tr_b16 a[174:175], v177 offset:8704
    v_fmac_f32 v138, v240, v240
    v_fmac_f32 v139, v241, v241
    v_sub_f32 v240, v132, v136
    v_sub_f32 v241, v133, v136
    s_waitcnt lgkmcnt(9)
    v_mfma_f32_32x32x16_bf16 v[0:15], a[192:195], a[56:59], v[0:15]
    buffer_load_dwordx4 v152, s[52:55], s34 offen offset:128 lds
    s_add_u32 m0, s94, 94080
    v_fmac_f32 v138, v240, v240
    v_fmac_f32 v139, v241, v241
    v_sub_f32 v240, v134, v136
    v_sub_f32 v241, v135, v136
    v_mfma_f32_32x32x16_bf16 v[16:31], a[196:199], a[56:59], v[16:31]
    v_fmac_f32 v138, v240, v240
    v_fmac_f32 v139, v241, v241
    v_add_f32 v138, v138, v139
    s_nop 1
    v_add_f32_dpp v138, v138, v138 quad_perm:[1,0,3,2] row_mask:0xf bank_mask:0xf
    s_nop 1
    v_add_f32_dpp v138, v138, v138 quad_perm:[2,3,0,1] row_mask:0xf bank_mask:0xf
    s_nop 1
    v_add_f32_dpp v138, v138, v138 row_half_mirror row_mask:0xf bank_mask:0xf
    s_waitcnt lgkmcnt(0)
    s_waitcnt vmcnt(19)
    s_barrier
    v_mfma_f32_32x32x16_bf16 v[32:47], a[200:203], a[56:59], v[32:47]
    v_add_u32 v166, 4294901760, v166
    ds_read_b128 a[64:67], v166 offset:0
    v_add_u32 v170, 4294868992, v170
    ds_read_b64_tr_b16 a[176:177], v170 offset:0
    ds_read_b64_tr_b16 a[178:179], v170 offset:512
    v_add_u32 v171, 4294868992, v171
    buffer_load_dwordx4 v153, s[52:55], s34 offen offset:128 lds
    s_add_u32 s95, s7, 384
    s_and_b32 s95, s95, 384
    s_add_u32 s95, s95, 512
    s_add_u32 m0, s93, 98304
    v_mfma_f32_16x16x32_bf16 a[216:219], v[190:193], a[200:203], a[216:219]
    ds_read_b64_tr_b16 a[180:181], v171 offset:0
    v_mfma_f32_32x32x16_bf16 v[48:63], a[204:207], a[56:59], v[48:63]
    ds_read_b64_tr_b16 a[182:183], v171 offset:512
    ds_read_b64_tr_b16 a[184:185], v170 offset:8192
    ds_read_b64_tr_b16 a[186:187], v170 offset:8704
    ds_read_b64_tr_b16 a[188:189], v171 offset:8192
    ds_read_b64_tr_b16 a[190:191], v171 offset:8704
    buffer_load_dwordx4 v148, s[48:51], s95 offen lds
    s_add_u32 m0, s93, 99328
    v_mfma_f32_32x32x16_bf16 v[0:15], a[160:163], a[60:63], v[0:15]
    v_add_u32 v167, 4294901760, v167
    ds_read_b128 a[68:71], v167 offset:0
    v_add_u32 v172, 4294868992, v172
    v_add_f32_dpp v138, v138, v138 row_mirror row_mask:0xf bank_mask:0xf
    v_mov_b32 v139, v138
    s_nop 1
    v_permlane16_swap_b32 v138, v139
    v_mfma_f32_32x32x16_bf16 v[16:31], a[164:167], a[60:63], v[16:31]
    ds_read_b64_tr_b16 a[192:193], v172 offset:0
    ds_read_b64_tr_b16 a[194:195], v172 offset:512
    v_add_u32 v173, 4294868992, v173
    buffer_load_dwordx4 v149, s[48:51], s95 offen lds
    s_add_u32 m0, s93, 100352
    v_add_f32 v138, v138, v139
    v_mfma_f32_32x32x16_bf16 v[32:47], a[168:171], a[60:63], v[32:47]
    ds_read_b64_tr_b16 a[196:197], v173 offset:0
    ds_read_b64_tr_b16 a[198:199], v173 offset:512
    ds_read_b64_tr_b16 a[200:201], v172 offset:8192
    v_mul_f32 v138, 0x3acccccd, v138
    v_cvt_pk_bf16_f32 v138, v138, v138
    v_and_b32 v138, 0xffff0000, v138
    v_mfma_f32_32x32x16_bf16 v[48:63], a[172:175], a[60:63], v[48:63]
    ds_read_b64_tr_b16 a[202:203], v172 offset:8704
    ds_read_b64_tr_b16 a[204:205], v173 offset:8192
    ds_read_b64_tr_b16 a[206:207], v173 offset:8704
    buffer_load_dwordx4 v150, s[48:51], s95 offen lds
    s_add_u32 m0, s93, 101376
    v_add_f32 v138, 0x3727c5ac, v138
    v_mfma_f32_16x16x32_bf16 a[220:223], v[190:193], a[172:175], a[220:223]
    v_cvt_pk_bf16_f32 v138, v138, v138
    s_waitcnt lgkmcnt(9)
    v_mfma_f32_32x32x16_bf16 v[0:15], a[176:179], a[64:67], v[0:15]
    v_add_u32 v168, 4294901760, v168
    ds_read_b128 a[72:75], v168 offset:0
    v_add_u32 v174, 4294868992, v174
    v_and_b32 v138, 0xffff0000, v138
    v_sqrt_f32 v138, v138
    v_mfma_f32_16x16x32_bf16 a[208:211], v[190:193], a[176:179], a[208:211]
    ds_read_b64_tr_b16 a[160:161], v174 offset:0
    buffer_load_dwordx4 v151, s[48:51], s95 offen lds
    s_mul_i32 s34, s95, 1728
    s_add_u32 m0, s94, 114688
    v_mfma_f32_32x32x16_bf16 v[16:31], a[180:183], a[64:67], v[16:31]
    ds_read_b64_tr_b16 a[162:163], v174 offset:512
    v_add_u32 v175, 4294868992, v175
    ds_read_b64_tr_b16 a[164:165], v175 offset:0
    v_cvt_pk_bf16_f32 v195, v138, v138
    v_and_b32 v195, 0xffff0000, v195
    v_cvt_pk_bf16_f32 v194, v136, v136
    v_mfma_f32_32x32x16_bf16 v[32:47], a[184:187], a[64:67], v[32:47]
    ds_read_b64_tr_b16 a[166:167], v175 offset:512
    ds_read_b64_tr_b16 a[168:169], v174 offset:8192
    ds_read_b64_tr_b16 a[170:171], v174 offset:8704
    buffer_load_dwordx4 v152, s[52:55], s34 offen offset:0 lds
    s_add_u32 m0, s94, 118784
    v_and_b32 v194, 0xffff0000, v194
    v_mfma_f32_32x32x16_bf16 v[48:63], a[188:191], a[64:67], v[48:63]
    ds_read_b64_tr_b16 a[172:173], v175 offset:8192
    ds_read_b64_tr_b16 a[174:175], v175 offset:8704
    v_lshlrev_b32 v201, 4, v252
    v_readfirstlane_b32 s88, v198
    v_readfirstlane_b32 s89, v199
    s_nop 0
    s_cmp_lg_u32 s88, 0
    s_cbranch_scc0 L_rt_2
L_ok_1:
    s_waitcnt lgkmcnt(9)
    v_mfma_f32_32x32x16_bf16 v[0:15], a[192:195], a[68:71], v[0:15]
    v_add_u32 v169, 4294901760, v169
    ds_read_b128 a[76:79], v169 offset:0
    v_add_u32 v176, 4294868992, v176
    buffer_load_dwordx4 v153, s[52:55], s34 offen offset:0 lds
    s_add_u32 m0, s94, 122752
    v_mov_b32 v196, s88
    v_mov_b32 v197, s89
    s_mov_b32 exec_lo, 1
    s_mov_b32 exec_hi, 1
    buffer_store_dwordx4 v[194:197], v201, s[68:71], 0 offen sc1
    s_mov_b64 exec, -1
    v_mfma_f32_32x32x16_bf16 v[16:31], a[196:199], a[68:71], v[16:31]
    ds_read_b64_tr_b16 a[176:177], v176 offset:0
    ds_read_b64_tr_b16 a[178:179], v176 offset:512
    v_add_u32 v177, 4294868992, v177
    v_mfma_f32_16x16x32_bf16 a[212:215], v[190:193], a[196:199], a[212:215]
    ds_read_b64_tr_b16 a[180:181], v177 offset:0
    v_mfma_f32_32x32x16_bf16 v[32:47], a[200:203], a[68:71], v[32:47]
    ds_read_b64_tr_b16 a[182:183], v177 offset:512
    ds_read_b64_tr_b16 a[184:185], v176 offset:8192
    ds_read_b64_tr_b16 a[186:187], v176 offset:8704
    buffer_load_dwordx4 v152, s[52:55], s34 offen offset:128 lds
    s_add_u32 m0, s94, 126848
    v_mfma_f32_32x32x16_bf16 v[48:63], a[204:207], a[68:71], v[48:63]
    ds_read_b64_tr_b16 a[188:189], v177 offset:8192
    ds_read_b64_tr_b16 a[190:191], v177 offset:8704
    s_waitcnt lgkmcnt(9)
    v_mfma_f32_32x32x16_bf16 v[0:15], a[160:163], a[72:75], v[0:15]
    buffer_load_dwordx4 v153, s[52:55], s34 offen offset:128 lds
    v_mfma_f32_32x32x16_bf16 v[16:31], a[164:167], a[72:75], v[16:31]
    s_waitcnt lgkmcnt(0)
    s_waitcnt vmcnt(17)
    s_barrier
    v_mfma_f32_32x32x16_bf16 v[32:47], a[168:171], a[72:75], v[32:47]
    ds_read_b128 a[80:83], v166 offset:32768
    ds_read_b64_tr_b16 a[192:193], v170 offset:32768
    ds_read_b64_tr_b16 a[194:195], v170 offset:33280
    ds_read_b64_tr_b16 a[196:197], v171 offset:32768
    ds_read_b64_tr_b16 a[198:199], v171 offset:33280
    s_add_u32 s95, s7, 0
    s_and_b32 s95, s95, 128
    s_add_u32 s95, s95, 1024
    s_add_u32 m0, s93, 0
    v_mfma_f32_16x16x32_bf16 a[216:219], v[190:193], a[168:171], a[216:219]
    ds_read_b64_tr_b16 a[200:201], v170 offset:40960
    buffer_load_dwordx4 v148, s[48:51], s95 offen lds
    s_add_u32 m0, s93, 1024
    v_mfma_f32_32x32x16_bf16 v[48:63], a[172:175], a[72:75], v[48:63]
    ds_read_b64_tr_b16 a[202:203], v170 offset:41472
    ds_read_b64_tr_b16 a[204:205], v171 offset:40960
    ds_read_b64_tr_b16 a[206:207], v171 offset:41472
    buffer_load_dwordx4 v149, s[48:51], s95 offen lds
    s_add_u32 m0, s93, 2048
    v_mfma_f32_32x32x16_bf16 v[0:15], a[176:179], a[76:79], v[0:15]
    ds_read_b128 a[84:87], v167 offset:32768
    ds_read_b64_tr_b16 a[160:161], v172 offset:32768
    ds_read_b64_tr_b16 a[162:163], v172 offset:33280
    v_mfma_f32_32x32x16_bf16 v[16:31], a[180:183], a[76:79], v[16:31]
    ds_read_b64_tr_b16 a[164:165], v173 offset:32768
    ds_read_b64_tr_b16 a[166:167], v173 offset:33280
    buffer_load_dwordx4 v150, s[48:51], s95 offen lds
    s_add_u32 m0, s93, 3072
    v_mfma_f32_32x32x16_bf16 v[32:47], a[184:187], a[76:79], v[32:47]
    ds_read_b64_tr_b16 a[168:169], v172 offset:40960
    ds_read_b64_tr_b16 a[170:171], v172 offset:41472
    v_mfma_f32_32x32x16_bf16 v[48:63], a[188:191], a[76:79], v[48:63]
    ds_read_b64_tr_b16 a[172:173], v173 offset:40960
    ds_read_b64_tr_b16 a[174:175], v173 offset:41472
    buffer_load_dwordx4 v151, s[48:51], s95 offen lds
    s_mul_i32 s34, s95, 1728
    s_add_u32 m0, s94, 16384
    v_mfma_f32_16x16x32_bf16 a[220:223], v[190:193], a[188:191], a[220:223]
    s_waitcnt lgkmcnt(9)
    v_mfma_f32_32x32x16_bf16 v[0:15], a[192:195], a[80:83], v[0:15]
    ds_read_b128 a[88:91], v168 offset:32768
    ds_read_b64_tr_b16 a[176:177], v174 offset:32768
    ds_read_b64_tr_b16 a[178:179], v174 offset:33280
    v_mfma_f32_16x16x32_bf16 a[208:211], v[190:193], a[192:195], a[208:211]
    ds_read_b64_tr_b16 a[180:181], v175 offset:32768
    buffer_load_dwordx4 v152, s[52:55], s34 offen offset:0 lds
    s_add_u32 m0, s94, 20480
    v_mfma_f32_32x32x16_bf16 v[16:31], a[196:199], a[80:83], v[16:31]
    ds_read_b64_tr_b16 a[182:183], v175 offset:33280
    ds_read_b64_tr_b16 a[184:185], v174 offset:40960
    v_mfma_f32_32x32x16_bf16 v[32:47], a[200:203], a[80:83], v[32:47]
    ds_read_b64_tr_b16 a[186:187], v174 offset:41472
    ds_read_b64_tr_b16 a[188:189], v175 offset:40960
    buffer_load_dwordx4 v153, s[52:55], s34 offen offset:0 lds
    s_add_u32 m0, s94, 24448
    v_mfma_f32_32x32x16_bf16 v[48:63], a[204:207], a[80:83], v[48:63]
    ds_read_b64_tr_b16 a[190:191], v175 offset:41472
    s_waitcnt lgkmcnt(9)
    v_mfma_f32_32x32x16_bf16 v[0:15], a[160:163], a[84:87], v[0:15]
    ds_read_b128 a[92:95], v169 offset:32768
    ds_read_b64_tr_b16 a[192:193], v176 offset:32768
    ds_read_b64_tr_b16 a[194:195], v176 offset:33280
    buffer_load_dwordx4 v152, s[52:55], s34 offen offset:128 lds
    s_add_u32 m0, s94, 28544
    v_mfma_f32_32x32x16_bf16 v[16:31], a[164:167], a[84:87], v[16:31]
    ds_read_b64_tr_b16 a[196:197], v177 offset:32768
    ds_read_b64_tr_b16 a[198:199], v177 offset:33280
    v_mfma_f32_16x16x32_bf16 a[212:215], v[190:193], a[164:167], a[212:215]
    ds_read_b64_tr_b16 a[200:201], v176 offset:40960
    v_mfma_f32_32x32x16_bf16 v[32:47], a[168:171], a[84:87], v[32:47]
    ds_read_b64_tr_b16 a[202:203], v176 offset:41472
    ds_read_b64_tr_b16 a[204:205], v177 offset:40960
    buffer_load_dwordx4 v153, s[52:55], s34 offen offset:128 lds
    v_mfma_f32_32x32x16_bf16 v[48:63], a[172:175], a[84:87], v[48:63]
    ds_read_b64_tr_b16 a[206:207], v177 offset:41472
    s_waitcnt lgkmcnt(9)
    v_mfma_f32_32x32x16_bf16 v[0:15], a[176:179], a[88:91], v[0:15]
    v_mfma_f32_32x32x16_bf16 v[16:31], a[180:183], a[88:91], v[16:31]
    s_waitcnt lgkmcnt(0)
    s_waitcnt vmcnt(17)
    s_barrier
    v_mfma_f32_32x32x16_bf16 v[32:47], a[184:187], a[88:91], v[32:47]
    v_add_u32 v166, 65536, v166
    ds_read_b128 a[96:99], v166 offset:0
    v_add_u32 v170, 65536, v170
    ds_read_b64_tr_b16 a[160:161], v170 offset:0
    ds_read_b64_tr_b16 a[162:163], v170 offset:512
    v_add_u32 v171, 65536, v171
    s_add_u32 s95, s7, 128
    s_and_b32 s95, s95, 128
    s_add_u32 s95, s95, 1024
    s_add_u32 m0, s93, 32768
    v_mfma_f32_16x16x32_bf16 a[216:219], v[190:193], a[184:187], a[216:219]
    ds_read_b64_tr_b16 a[164:165], v171 offset:0
    buffer_load_dwordx4 v148, s[48:51], s95 offen lds
    s_add_u32 m0, s93, 33792
    v_mfma_f32_32x32x16_bf16 v[48:63], a[188:191], a[88:91], v[48:63]
    ds_read_b64_tr_b16 a[166:167], v171 offset:512
    ds_read_b64_tr_b16 a[168:169], v170 offset:8192
    ds_read_b64_tr_b16 a[170:171], v170 offset:8704
    ds_read_b64_tr_b16 a[172:173], v171 offset:8192
    ds_read_b64_tr_b16 a[174:175], v171 offset:8704
    buffer_load_dwordx4 v149, s[48:51], s95 offen lds
    s_add_u32 m0, s93, 34816
    v_mfma_f32_32x32x16_bf16 v[0:15], a[192:195], a[92:95], v[0:15]
    v_add_u32 v167, 65536, v167
    ds_read_b128 a[100:103], v167 offset:0
    v_add_u32 v172, 65536, v172
    v_mfma_f32_32x32x16_bf16 v[16:31], a[196:199], a[92:95], v[16:31]
    ds_read_b64_tr_b16 a[176:177], v172 offset:0
    ds_read_b64_tr_b16 a[178:179], v172 offset:512
    v_add_u32 v173, 65536, v173
    buffer_load_dwordx4 v150, s[48:51], s95 offen lds
    s_add_u32 m0, s93, 35840
    v_mfma_f32_32x32x16_bf16 v[32:47], a[200:203], a[92:95], v[32:47]
    ds_read_b64_tr_b16 a[180:181], v173 offset:0
    ds_read_b64_tr_b16 a[182:183], v173 offset:512
    ds_read_b64_tr_b16 a[184:185], v172 offset:8192
    v_mfma_f32_32x32x16_bf16 v[48:63], a[204:207], a[92:95], v[48:63]
    ds_read_b64_tr_b16 a[186:187], v172 offset:8704
    ds_read_b64_tr_b16 a[188:189], v173 offset:8192
    ds_read_b64_tr_b16 a[190:191], v173 offset:8704
    buffer_load_dwordx4 v151, s[48:51], s95 offen lds
    s_mul_i32 s34, s95, 1728
    s_add_u32 m0, s94, 49152
    v_mfma_f32_16x16x32_bf16 a[220:223], v[190:193], a[204:207], a[220:223]
    s_waitcnt lgkmcnt(9)
    v_mfma_f32_32x32x16_bf16 v[0:15], a[160:163], a[96:99], v[0:15]
    v_add_u32 v168, 65536, v168
    ds_read_b128 a[104:107], v168 offset:0
    v_add_u32 v174, 65536, v174
    v_mfma_f32_16x16x32_bf16 a[208:211], v[190:193], a[160:163], a[208:211]
    ds_read_b64_tr_b16 a[192:193], v174 offset:0
    buffer_load_dwordx4 v152, s[52:55], s34 offen offset:0 lds
    s_add_u32 m0, s94, 53248
    v_mfma_f32_32x32x16_bf16 v[16:31], a[164:167], a[96:99], v[16:31]
    ds_read_b64_tr_b16 a[194:195], v174 offset:512
    v_add_u32 v175, 65536, v175
    ds_read_b64_tr_b16 a[196:197], v175 offset:0
    v_mfma_f32_32x32x16_bf16 v[32:47], a[168:171], a[96:99], v[32:47]
    ds_read_b64_tr_b16 a[198:199], v175 offset:512
    ds_read_b64_tr_b16 a[200:201], v174 offset:8192
    ds_read_b64_tr_b16 a[202:203], v174 offset:8704
    buffer_load_dwordx4 v153, s[52:55], s34 offen offset:0 lds
    s_add_u32 m0, s94, 57216
    v_mfma_f32_32x32x16_bf16 v[48:63], a[172:175], a[96:99], v[48:63]
    ds_read_b64_tr_b16 a[204:205], v175 offset:8192
    ds_read_b64_tr_b16 a[206:207], v175 offset:8704
    s_waitcnt lgkmcnt(9)
    v_mfma_f32_32x32x16_bf16 v[0:15], a[176:179], a[100:103], v[0:15]
    v_add_u32 v169, 65536, v169
    ds_read_b128 a[108:111], v169 offset:0
    v_add_u32 v176, 65536, v176
    buffer_load_dwordx4 v152, s[52:55], s34 offen offset:128 lds
    s_add_u32 m0, s94, 61312
    v_mfma_f32_32x32x16_bf16 v[16:31], a[180:183], a[100:103], v[16:31]
    ds_read_b64_tr_b16 a[160:161], v176 offset:0
    ds_read_b64_tr_b16 a[162:163], v176 offset:512
    v_add_u32 v177, 65536, v177
    v_mfma_f32_16x16x32_bf16 a[212:215], v[190:193], a[180:183], a[212:215]
    ds_read_b64_tr_b16 a[164:165], v177 offset:0
    v_mfma_f32_32x32x16_bf16 v[32:47], a[184:187], a[100:103], v[32:47]
    ds_read_b64_tr_b16 a[166:167], v177 offset:512
    ds_read_b64_tr_b16 a[168:169], v176 offset:8192
    ds_read_b64_tr_b16 a[170:171], v176 offset:8704
    buffer_load_dwordx4 v153, s[52:55], s34 offen offset:128 lds
    v_mfma_f32_32x32x16_bf16 v[48:63], a[188:191], a[100:103], v[48:63]
    ds_read_b64_tr_b16 a[172:173], v177 offset:8192
    ds_read_b64_tr_b16 a[174:175], v177 offset:8704
    s_waitcnt lgkmcnt(9)
    v_mfma_f32_32x32x16_bf16 v[0:15], a[192:195], a[104:107], v[0:15]
    v_mfma_f32_32x32x16_bf16 v[16:31], a[196:199], a[104:107], v[16:31]
    s_waitcnt lgkmcnt(0)
    s_waitcnt vmcnt(16)
    s_barrier
    v_mfma_f32_32x32x16_bf16 v[32:47], a[200:203], a[104:107], v[32:47]
    ds_read_b128 a[112:115], v166 offset:32768
    ds_read_b64_tr_b16 a[176:177], v170 offset:32768
    ds_read_b64_tr_b16 a[178:179], v170 offset:33280
    ds_read_b64_tr_b16 a[180:181], v171 offset:32768
    ds_read_b64_tr_b16 a[182:183], v171 offset:33280
    s_add_u32 s95, s7, 256
    s_and_b32 s95, s95, 384
    s_add_u32 s95, s95, 0
    s_mul_i32 s34, s95, 1728
    s_add_u32 m0, s94, 65280
    v_mfma_f32_16x16x32_bf16 a[216:219], v[190:193], a[200:203], a[216:219]
    ds_read_b64_tr_b16 a[184:185], v170 offset:40960
    buffer_load_dwordx4 v152, s[52:55], s34 offen offset:256 lds
    s_add_u32 m0, s94, 69376
    v_mfma_f32_32x32x16_bf16 v[48:63], a[204:207], a[104:107], v[48:63]
    ds_read_b64_tr_b16 a[186:187], v170 offset:41472
    ds_read_b64_tr_b16 a[188:189], v171 offset:40960
    ds_read_b64_tr_b16 a[190:191], v171 offset:41472
    buffer_load_dwordx4 v153, s[52:55], s34 offen offset:256 lds
    s_add_u32 s95, s7, 384
    s_and_b32 s95, s95, 384
    s_add_u32 s95, s95, 0
    s_mul_i32 s34, s95, 1728
    s_add_u32 m0, s94, 73472
    v_mfma_f32_32x32x16_bf16 v[0:15], a[160:163], a[108:111], v[0:15]
    ds_read_b128 a[116:119], v167 offset:32768
    ds_read_b64_tr_b16 a[192:193], v172 offset:32768
    ds_read_b64_tr_b16 a[194:195], v172 offset:33280
    v_mfma_f32_32x32x16_bf16 v[16:31], a[164:167], a[108:111], v[16:31]
    ds_read_b64_tr_b16 a[196:197], v173 offset:32768
    ds_read_b64_tr_b16 a[198:199], v173 offset:33280
    buffer_load_dwordx4 v152, s[52:55], s34 offen offset:256 lds
    s_add_u32 m0, s94, 77568
    v_mfma_f32_32x32x16_bf16 v[32:47], a[168:171], a[108:111], v[32:47]
    ds_read_b64_tr_b16 a[200:201], v172 offset:40960
    ds_read_b64_tr_b16 a[202:203], v172 offset:41472
    v_mfma_f32_32x32x16_bf16 v[48:63], a[172:175], a[108:111], v[48:63]
    ds_read_b64_tr_b16 a[204:205], v173 offset:40960
    ds_read_b64_tr_b16 a[206:207], v173 offset:41472
    buffer_load_dwordx4 v153, s[52:55], s34 offen offset:256 lds
    s_add_u32 s95, s7, 0
    s_and_b32 s95, s95, 384
    s_add_u32 s95, s95, 512
    s_mul_i32 s34, s95, 1728
    s_add_u32 m0, s94, 81664
    v_mfma_f32_16x16x32_bf16 a[220:223], v[190:193], a[172:175], a[220:223]
    s_waitcnt lgkmcnt(9)
    v_mfma_f32_32x32x16_bf16 v[0:15], a[176:179], a[112:115], v[0:15]
    ds_read_b128 a[120:123], v168 offset:32768
    ds_read_b64_tr_b16 a[160:161], v174 offset:32768
    ds_read_b64_tr_b16 a[162:163], v174 offset:33280
    v_bfe_u32 v201, v145, 2, 1
    v_lshlrev_b32 v201, 4, v201
    v_and_b32 v200, 1, v145
    v_mfma_f32_16x16x32_bf16 a[208:211], v[190:193], a[176:179], a[208:211]
    ds_read_b64_tr_b16 a[164:165], v175 offset:32768
    buffer_load_dwordx4 v152, s[52:55], s34 offen offset:256 lds
    s_add_u32 m0, s94, 85760
    v_mfma_f32_32x32x16_bf16 v[16:31], a[180:183], a[112:115], v[16:31]
    ds_read_b64_tr_b16 a[166:167], v175 offset:33280
    ds_read_b64_tr_b16 a[168:169], v174 offset:40960
    v_lshl_or_b32 v201, v200, 3, v201
    v_bfe_u32 v200, v145, 3, 2
    v_lshl_or_b32 v201, v200, 1, v201
    v_bfe_u32 v200, v145, 1, 1
    v_mfma_f32_32x32x16_bf16 v[32:47], a[184:187], a[112:115], v[32:47]
    ds_read_b64_tr_b16 a[170:171], v174 offset:41472
    ds_read_b64_tr_b16 a[172:173], v175 offset:40960
    buffer_load_dwordx4 v153, s[52:55], s34 offen offset:256 lds
    s_add_u32 s95, s7, 128
    s_and_b32 s95, s95, 384
    s_add_u32 s95, s95, 512
    s_mul_i32 s34, s95, 1728
    s_add_u32 m0, s94, 89856
    v_mfma_f32_32x32x16_bf16 v[48:63], a[188:191], a[112:115], v[48:63]
    ds_read_b64_tr_b16 a[174:175], v175 offset:41472
    v_or_b32 v201, v201, v200
    v_add_u32 v201, s100, v201
    v_lshlrev_b32 v201, 4, v201
    s_waitcnt lgkmcnt(9)
    v_mfma_f32_32x32x16_bf16 v[0:15], a[192:195], a[116:119], v[0:15]
    ds_read_b128 a[124:127], v169 offset:32768
    ds_read_b64_tr_b16 a[176:177], v176 offset:32768
    ds_read_b64_tr_b16 a[178:179], v176 offset:33280
    buffer_load_dwordx4 v[194:197], v201, s[68:71], 0 offen sc1
    v_mfma_f32_32x32x16_bf16 v[16:31], a[196:199], a[116:119], v[16:31]
    ds_read_b64_tr_b16 a[180:181], v177 offset:32768
    ds_read_b64_tr_b16 a[182:183], v177 offset:33280
    v_mfma_f32_16x16x32_bf16 a[212:215], v[190:193], a[196:199], a[212:215]
    ds_read_b64_tr_b16 a[184:185], v176 offset:40960
    v_mfma_f32_32x32x16_bf16 v[32:47], a[200:203], a[116:119], v[32:47]
    ds_read_b64_tr_b16 a[186:187], v176 offset:41472
    ds_read_b64_tr_b16 a[188:189], v177 offset:40960
    buffer_load_dwordx4 v152, s[52:55], s34 offen offset:256 lds
    s_add_u32 m0, s94, 93952
    v_mfma_f32_32x32x16_bf16 v[48:63], a[204:207], a[116:119], v[48:63]
    ds_read_b64_tr_b16 a[190:191], v177 offset:41472
    s_waitcnt lgkmcnt(9)
    v_mfma_f32_32x32x16_bf16 v[0:15], a[160:163], a[120:123], v[0:15]
    buffer_load_dwordx4 v153, s[52:55], s34 offen offset:256 lds
    v_mfma_f32_32x32x16_bf16 v[16:31], a[164:167], a[120:123], v[16:31]
    s_waitcnt lgkmcnt(0)
    s_waitcnt vmcnt(17)
    s_barrier
    v_mfma_f32_32x32x16_bf16 v[32:47], a[168:171], a[120:123], v[32:47]
    v_add_u32 v166, 4294901760, v166
    ds_read_b128 a[128:131], v166 offset:0
    v_add_u32 v170, 4294901760, v170
    ds_read_b64_tr_b16 a[192:193], v170 offset:0
    ds_read_b64_tr_b16 a[194:195], v170 offset:512
    v_add_u32 v171, 4294901760, v171
    s_add_u32 s95, s7, 256
    s_and_b32 s95, s95, 384
    s_add_u32 s95, s95, 512
    s_mul_i32 s34, s95, 1728
    s_add_u32 m0, s94, 98048
    v_mfma_f32_16x16x32_bf16 a[216:219], v[190:193], a[168:171], a[216:219]
    ds_read_b64_tr_b16 a[196:197], v171 offset:0
    buffer_load_dwordx4 v152, s[52:55], s34 offen offset:256 lds
    s_add_u32 m0, s94, 102144
    v_mfma_f32_32x32x16_bf16 v[48:63], a[172:175], a[120:123], v[48:63]
    ds_read_b64_tr_b16 a[198:199], v171 offset:512
    ds_read_b64_tr_b16 a[200:201], v170 offset:8192
    ds_read_b64_tr_b16 a[202:203], v170 offset:8704
    ds_read_b64_tr_b16 a[204:205], v171 offset:8192
    ds_read_b64_tr_b16 a[206:207], v171 offset:8704
    buffer_load_dwordx4 v153, s[52:55], s34 offen offset:256 lds
    s_add_u32 s95, s7, 384
    s_and_b32 s95, s95, 384
    s_add_u32 s95, s95, 512
    s_mul_i32 s34, s95, 1728
    s_add_u32 m0, s94, 106240
    v_mfma_f32_32x32x16_bf16 v[0:15], a[176:179], a[124:127], v[0:15]
    v_add_u32 v167, 4294901760, v167
    ds_read_b128 a[132:135], v167 offset:0
    v_add_u32 v172, 4294901760, v172
    v_mfma_f32_32x32x16_bf16 v[16:31], a[180:183], a[124:127], v[16:31]
    ds_read_b64_tr_b16 a[160:161], v172 offset:0
    ds_read_b64_tr_b16 a[162:163], v172 offset:512
    v_add_u32 v173, 4294901760, v173
    buffer_load_dwordx4 v152, s[52:55], s34 offen offset:256 lds
    s_add_u32 m0, s94, 110336
    v_mfma_f32_32x32x16_bf16 v[32:47], a[184:187], a[124:127], v[32:47]
    ds_read_b64_tr_b16 a[164:165], v173 offset:0
    ds_read_b64_tr_b16 a[166:167], v173 offset:512
    ds_read_b64_tr_b16 a[168:169], v172 offset:8192
    v_mfma_f32_32x32x16_bf16 v[48:63], a[188:191], a[124:127], v[48:63]
    ds_read_b64_tr_b16 a[170:171], v172 offset:8704
    ds_read_b64_tr_b16 a[172:173], v173 offset:8192
    ds_read_b64_tr_b16 a[174:175], v173 offset:8704
    buffer_load_dwordx4 v153, s[52:55], s34 offen offset:256 lds
    s_add_u32 s95, s7, 0
    s_and_b32 s95, s95, 128
    s_add_u32 s95, s95, 1024
    s_mul_i32 s34, s95, 1728
    s_add_u32 m0, s94, 114432
    v_mfma_f32_16x16x32_bf16 a[220:223], v[190:193], a[188:191], a[220:223]
    s_waitcnt lgkmcnt(9)
    v_mfma_f32_32x32x16_bf16 v[0:15], a[192:195], a[128:131], v[0:15]
    v_add_u32 v168, 4294901760, v168
    ds_read_b128 a[136:139], v168 offset:0
    v_add_u32 v174, 4294901760, v174
    v_mfma_f32_16x16x32_bf16 a[208:211], v[190:193], a[192:195], a[208:211]
    ds_read_b64_tr_b16 a[176:177], v174 offset:0
    buffer_load_dwordx4 v152, s[52:55], s34 offen offset:256 lds
    s_add_u32 m0, s94, 118528
    v_mfma_f32_32x32x16_bf16 v[16:31], a[196:199], a[128:131], v[16:31]
    ds_read_b64_tr_b16 a[178:179], v174 offset:512
    v_add_u32 v175, 4294901760, v175
    ds_read_b64_tr_b16 a[180:181], v175 offset:0
    v_mfma_f32_32x32x16_bf16 v[32:47], a[200:203], a[128:131], v[32:47]
    ds_read_b64_tr_b16 a[182:183], v175 offset:512
    ds_read_b64_tr_b16 a[184:185], v174 offset:8192
    ds_read_b64_tr_b16 a[186:187], v174 offset:8704
    buffer_load_dwordx4 v153, s[52:55], s34 offen offset:256 lds
    s_add_u32 s95, s7, 128
    s_and_b32 s95, s95, 128
    s_add_u32 s95, s95, 1024
    s_mul_i32 s34, s95, 1728
    s_add_u32 m0, s94, 122624
    v_mfma_f32_32x32x16_bf16 v[48:63], a[204:207], a[128:131], v[48:63]
    ds_read_b64_tr_b16 a[188:189], v175 offset:8192
    ds_read_b64_tr_b16 a[190:191], v175 offset:8704
    buffer_load_dwordx4 v152, s[52:55], s34 offen offset:256 lds
    s_add_u32 m0, s94, 126720
    s_nop 0
    buffer_load_dwordx4 v153, s[52:55], s34 offen offset:256 lds
    s_and_b32 s96, s5, 7
    s_lshl_b32 s96, s96, 2
    s_add_u32 s96, s96, s6
    s_xor_b32 s96, s96, 0
    s_lshl_b32 s96, s96, 2
    s_add_u32 s96, s96, s3
    s_cmp_eq_u32 s101, 1
    s_cselect_b32 s97, 45, 30
    s_mul_i32 s98, s96, s97
    s_lshl_b32 s98, s98, 7
    s_mul_i32 s99, s4, 491520
    s_add_u32 s98, s98, s99
    s_sub_u32 s97, s97, 1
    v_min_u32 v186, s97, v144
    v_lshlrev_b32 v186, 7, v186
    buffer_load_dword a255, v186, s[56:59], s98 offen
    s_mul_i32 s98, s96, 6400
    s_add_u32 s98, s98, s83
    s_lshl_b32 s97, s101, 1
    s_sub_u32 s97, 2, s97
    v_lshrrev_b32 v187, 2, v144
    v_min_u32 v187, 4, v187
    v_mul_u32_u24 v187, 1280, v187
    v_and_b32 v186, 3, v144
    v_min_u32 v186, s97, v186
    v_lshl_add_u32 v187, v186, 7, v187
    buffer_load_dword a255, v187, s[60:63], s98 offen
    buffer_load_dword a255, v187, s[64:67], s98 offen
    s_waitcnt lgkmcnt(9)
    v_mfma_f32_32x32x16_bf16 v[0:15], a[160:163], a[132:135], v[0:15]
    v_add_u32 v169, 4294901760, v169
    ds_read_b128 a[140:143], v169 offset:0
    v_add_u32 v176, 4294901760, v176
    v_mfma_f32_32x32x16_bf16 v[16:31], a[164:167], a[132:135], v[16:31]
    ds_read_b64_tr_b16 a[192:193], v176 offset:0
    ds_read_b64_tr_b16 a[194:195], v176 offset:512
    v_add_u32 v177, 4294901760, v177
    v_mfma_f32_16x16x32_bf16 a[212:215], v[190:193], a[164:167], a[212:215]
    ds_read_b64_tr_b16 a[196:197], v177 offset:0
    v_mfma_f32_32x32x16_bf16 v[32:47], a[168:171], a[132:135], v[32:47]
    ds_read_b64_tr_b16 a[198:199], v177 offset:512
    ds_read_b64_tr_b16 a[200:201], v176 offset:8192
    ds_read_b64_tr_b16 a[202:203], v176 offset:8704
    v_mfma_f32_32x32x16_bf16 v[48:63], a[172:175], a[132:135], v[48:63]
    ds_read_b64_tr_b16 a[204:205], v177 offset:8192
    ds_read_b64_tr_b16 a[206:207], v177 offset:8704
    s_waitcnt lgkmcnt(9)
    v_mfma_f32_32x32x16_bf16 v[0:15], a[176:179], a[136:139], v[0:15]
    s_waitcnt vmcnt(13)
    v_cmp_eq_u64 vcc, s[88:89], v[196:197]
    s_nop 1
    s_cmp_eq_u64 vcc, -1
    s_cbranch_scc0 L_rt_4
L_ok_3:
    v_cmp_eq_u32 vcc, 0, v146
    v_xor_b32 v242, 0x80000000, v194
    v_mfma_f32_32x32x16_bf16 v[16:31], a[180:183], a[136:139], v[16:31]
    v_lshrrev_b32 v243, 16, v242
    v_or_b32 v244, v243, v242
    v_or_b32 v245, v243, v195
    v_cndmask_b32 v198, 0, v244, vcc
    v_cndmask_b32 v199, 0, v245, vcc
    v_mov_b32 v200, 0
    s_waitcnt lgkmcnt(0)
    s_barrier
    v_mfma_f32_32x32x16_bf16 v[32:47], a[184:187], a[136:139], v[32:47]
    ds_read_b128 a[144:147], v166 offset:32768
    ds_read_b64_tr_b16 a[160:161], v170 offset:32768
    ds_read_b64_tr_b16 a[162:163], v170 offset:33280
    ds_read_b64_tr_b16 a[164:165], v171 offset:32768
    ds_read_b64_tr_b16 a[166:167], v171 offset:33280
    v_mov_b32 v201, 0
    v_mfma_f32_16x16x32_bf16 a[216:219], v[190:193], a[184:187], a[216:219]
    ds_read_b64_tr_b16 a[168:169], v170 offset:40960
    v_mfma_f32_32x32x16_bf16 v[48:63], a[188:191], a[136:139], v[48:63]
    ds_read_b64_tr_b16 a[170:171], v170 offset:41472
    ds_read_b64_tr_b16 a[172:173], v171 offset:40960
    ds_read_b64_tr_b16 a[174:175], v171 offset:41472
    v_rcp_f32 v196, v195
    v_lshlrev_b32 v240, 4, v145
    v_mfma_f32_32x32x16_bf16 v[0:15], a[192:195], a[140:143], v[0:15]
    ds_read_b64_tr_b16 a[232:233], v170 offset:32768
    ds_read_b64_tr_b16 a[234:235], v170 offset:33280
    ds_read_b64_tr_b16 a[236:237], v173 offset:32768
    ds_read_b64_tr_b16 a[238:239], v173 offset:33280
    ds_read_b64_tr_b16 a[224:225], v174 offset:40960
    s_lshl_b32 s12, s3, 2
    v_mfma_f32_32x32x16_bf16 v[16:31], a[196:199], a[140:143], v[16:31]
    ds_read_b64_tr_b16 a[226:227], v174 offset:41472
    ds_read_b64_tr_b16 a[228:229], v177 offset:40960
    ds_read_b64_tr_b16 a[230:231], v177 offset:41472
    ds_read_b128 a[148:151], v167 offset:32768
    v_add_u32 v240, 147456, v240
    v_add_u32 v241, s12, v240
    v_mfma_f32_32x32x16_bf16 v[32:47], a[200:203], a[140:143], v[32:47]
    ds_read_b64_tr_b16 a[176:177], v172 offset:32768
    ds_read_b64_tr_b16 a[178:179], v172 offset:33280
    ds_read_b64_tr_b16 a[180:181], v173 offset:32768
    ds_read_b64_tr_b16 a[182:183], v173 offset:33280
    v_mov_b32 v242, 0x07060302
    v_mov_b32 v202, 0
    v_mfma_f32_32x32x16_bf16 v[48:63], a[204:207], a[140:143], v[48:63]
    ds_read_b64_tr_b16 a[184:185], v172 offset:40960
    ds_read_b64_tr_b16 a[186:187], v172 offset:41472
    ds_read_b64_tr_b16 a[188:189], v173 offset:40960
    ds_read_b64_tr_b16 a[190:191], v173 offset:41472
    v_mov_b32 v203, 0
    v_mov_b32 v204, 0
    v_mfma_f32_16x16x32_bf16 a[220:223], v[190:193], a[204:207], a[220:223]
    v_mov_b32 v205, 0
    s_waitcnt lgkmcnt(15)
    s_waitcnt lgkmcnt(0)
    v_mfma_f32_32x32x16_bf16 v[0:15], a[160:163], a[144:147], v[0:15]
    ds_read_b128 a[152:155], v168 offset:32768
    ds_read_b64_tr_b16 a[192:193], v174 offset:32768
    v_mov_b32 v206, 0
    v_mov_b32 v207, 0
    v_mov_b32 v208, 0
    v_mov_b32 v209, 0
    v_mfma_f32_16x16x32_bf16 a[208:211], v[190:193], a[232:235], a[208:211]
    ds_read_b64_tr_b16 a[194:195], v174 offset:33280
    v_mfma_f32_32x32x16_bf16 v[16:31], a[164:167], a[144:147], v[16:31]
    ds_read_b64_tr_b16 a[196:197], v175 offset:32768
    ds_read_b64_tr_b16 a[198:199], v175 offset:33280
    v_mov_b32 v210, 0
    v_mov_b32 v211, 0
    v_mov_b32 v212, 0
    v_mov_b32 v213, 0
    v_mfma_f32_16x16x32_bf16 a[212:215], v[190:193], a[236:239], a[212:215]
    ds_read_b64_tr_b16 a[200:201], v174 offset:40960
    v_mfma_f32_32x32x16_bf16 v[32:47], a[168:171], a[144:147], v[32:47]
    ds_read_b64_tr_b16 a[202:203], v174 offset:41472
    ds_read_b64_tr_b16 a[204:205], v175 offset:40960
    v_mov_b32 v214, 0
    v_mov_b32 v215, 0
    v_mfma_f32_16x16x32_bf16 a[216:219], v[190:193], a[224:227], a[216:219]
    ds_read_b64_tr_b16 a[206:207], v175 offset:41472
    v_mfma_f32_32x32x16_bf16 v[48:63], a[172:175], a[144:147], v[48:63]
    v_mfma_f32_16x16x32_bf16 a[220:223], v[190:193], a[228:231], a[220:223]
    v_mfma_f32_32x32x16_bf16 v[0:15], a[176:179], a[148:151], v[0:15]
    ds_read_b128 a[156:159], v169 offset:32768
    ds_read_b64_tr_b16 a[160:161], v176 offset:32768
    ds_read_b64_tr_b16 a[162:163], v176 offset:33280
    ds_write_b32 v241, a208 offset:0
    ds_write_b32 v241, a212 offset:2048
    ds_write_b32 v241, a216 offset:4096
    v_mfma_f32_32x32x16_bf16 v[16:31], a[180:183], a[148:151], v[16:31]
    ds_read_b64_tr_b16 a[164:165], v177 offset:32768
    ds_read_b64_tr_b16 a[166:167], v177 offset:33280
    ds_write_b32 v241, a220 offset:6144
    v_mfma_f32_32x32x16_bf16 v[32:47], a[184:187], a[148:151], v[32:47]
    ds_read_b64_tr_b16 a[168:169], v176 offset:40960
    ds_read_b64_tr_b16 a[170:171], v176 offset:41472
    v_mfma_f32_32x32x16_bf16 v[48:63], a[188:191], a[148:151], v[48:63]
    ds_read_b64_tr_b16 a[172:173], v177 offset:40960
    ds_read_b64_tr_b16 a[174:175], v177 offset:41472
    s_waitcnt lgkmcnt(13)
    v_mfma_f32_32x32x16_bf16 v[0:15], a[192:195], a[152:155], v[0:15]
    s_waitcnt lgkmcnt(0)
    s_barrier
    v_mfma_f32_32x32x16_bf16 v[16:31], a[196:199], a[152:155], v[16:31]
    ds_read_b128 v[96:99], v240 offset:0
    ds_read_b128 v[100:103], v240 offset:2048
    ds_read_b128 v[104:107], v240 offset:4096
    ds_read_b128 v[108:111], v240 offset:6144
    v_mfma_f32_32x32x16_bf16 v[32:47], a[200:203], a[152:155], v[32:47]
    s_waitcnt lgkmcnt(3)
    v_add_f32 v96, v96, v97
    v_add_f32 v98, v98, v99
    v_add_f32 v96, v96, v98
    v_mfma_f32_32x32x16_bf16 v[48:63], a[204:207], a[152:155], v[48:63]
    v_and_b32 v97, 0xffff0000, v96
    v_sub_f32 v98, v96, v97
    v_and_b32 v99, 0xffff0000, v98
    v_sub_f32 v98, v98, v99
    v_alignbit_b32 v203, v216, v98, 16
    v_perm_b32 v202, v99, v96, v242
    v_mfma_f32_32x32x16_bf16 v[0:15], a[160:163], a[156:159], v[0:15]
    s_waitcnt lgkmcnt(2)
    v_add_f32 v100, v100, v101
    v_add_f32 v102, v102, v103
    v_add_f32 v100, v100, v102
    v_and_b32 v101, 0xffff0000, v100
    v_sub_f32 v102, v100, v101
    v_mfma_f32_32x32x16_bf16 v[16:31], a[164:167], a[156:159], v[16:31]
    v_and_b32 v103, 0xffff0000, v102
    v_sub_f32 v102, v102, v103
    v_alignbit_b32 v205, v217, v102, 16
    v_perm_b32 v204, v103, v100, v242
    s_waitcnt lgkmcnt(1)
    v_add_f32 v104, v104, v105
    v_mfma_f32_32x32x16_bf16 v[32:47], a[168:171], a[156:159], v[32:47]
    v_add_f32 v106, v106, v107
    v_add_f32 v104, v104, v106
    v_and_b32 v105, 0xffff0000, v104
    v_sub_f32 v106, v104, v105
    v_and_b32 v107, 0xffff0000, v106
    v_sub_f32 v106, v106, v107
    v_mfma_f32_32x32x16_bf16 v[48:63], a[172:175], a[156:159], v[48:63]
    v_alignbit_b32 v207, v218, v106, 16
    v_perm_b32 v206, v107, v104, v242
    s_waitcnt lgkmcnt(0)
    v_add_f32 v108, v108, v109
    v_add_f32 v110, v110, v111
    v_add_f32 v108, v108, v110
    v_and_b32 v109, 0xffff0000, v108
    v_sub_f32 v110, v108, v109
    v_and_b32 v111, 0xffff0000, v110
    v_sub_f32 v110, v110, v111
    v_alignbit_b32 v209, v219, v110, 16
    v_perm_b32 v208, v111, v108, v242
    v_mfma_f32_32x32x16_bf16 v[0:15], v[202:205], v[198:201], v[0:15]
    v_mfma_f32_32x32x16_bf16 v[16:31], v[204:207], v[198:201], v[16:31]
    v_mfma_f32_32x32x16_bf16 v[32:47], v[206:209], v[198:201], v[32:47]
    v_mfma_f32_32x32x16_bf16 v[48:63], v[208:211], v[198:201], v[48:63]
    v_mov_b32 v246, v196
    v_mul_f32 v247, 1069066811, v196
    s_mov_b32 s41, s20
    s_nop 5
    v_pk_mul_f32 v[222:223], v[0:1], v[246:247] op_sel:[0,1] op_sel_hi:[1,1]
    v_pk_mul_f32 v[224:225], v[2:3], v[246:247] op_sel:[0,1] op_sel_hi:[1,1]
    v_pk_mul_f32 v[226:227], v[4:5], v[246:247] op_sel:[0,1] op_sel_hi:[1,1]
    v_pk_mul_f32 v[228:229], v[6:7], v[246:247] op_sel:[0,1] op_sel_hi:[1,1]
    v_exp_f32 v222, v222
    v_exp_f32 v223, v223
    v_exp_f32 v224, v224
    v_exp_f32 v225, v225
    v_exp_f32 v226, v226
    v_exp_f32 v227, v227
    v_exp_f32 v228, v228
    v_exp_f32 v229, v229
    v_pk_mul_f32 v[0:1], v[0:1], v[246:247] op_sel_hi:[1,0]
    v_pk_mul_f32 v[2:3], v[2:3], v[246:247] op_sel_hi:[1,0]
    v_pk_mul_f32 v[4:5], v[4:5], v[246:247] op_sel_hi:[1,0]
    v_pk_mul_f32 v[6:7], v[6:7], v[246:247] op_sel_hi:[1,0]
    v_pk_fma_f32 v[230:231], v[222:223], -0.5, -1.0 op_sel_hi:[1,0,0]
    v_pk_fma_f32 v[232:233], v[224:225], -0.5, -1.0 op_sel_hi:[1,0,0]
    v_pk_fma_f32 v[234:235], v[226:227], -0.5, -1.0 op_sel_hi:[1,0,0]
    v_pk_fma_f32 v[236:237], v[228:229], -0.5, -1.0 op_sel_hi:[1,0,0]
    v_pk_fma_f32 v[230:231], v[222:223], v[230:231], -1.0 op_sel_hi:[1,1,0]
    v_pk_fma_f32 v[232:233], v[224:225], v[232:233], -1.0 op_sel_hi:[1,1,0]
    v_pk_fma_f32 v[234:235], v[226:227], v[234:235], -1.0 op_sel_hi:[1,1,0]
    v_pk_fma_f32 v[236:237], v[228:229], v[236:237], -1.0 op_sel_hi:[1,1,0]
    v_rcp_f32 v230, v230
    v_rcp_f32 v231, v231
    v_rcp_f32 v232, v232
    v_rcp_f32 v233, v233
    v_rcp_f32 v234, v234
    v_rcp_f32 v235, v235
    v_rcp_f32 v236, v236
    v_rcp_f32 v237, v237
    v_pk_fma_f32 v[0:1], v[0:1], v[230:231], v[0:1]
    v_pk_fma_f32 v[2:3], v[2:3], v[232:233], v[2:3]
    v_pk_fma_f32 v[4:5], v[4:5], v[234:235], v[4:5]
    v_pk_fma_f32 v[6:7], v[6:7], v[236:237], v[6:7]
    v_cvt_pk_bf16_f32 v96, v0, v1
    v_cvt_pk_bf16_f32 v97, v2, v3
    v_cvt_pk_bf16_f32 v98, v4, v5
    v_cvt_pk_bf16_f32 v99, v6, v7
    buffer_store_dwordx4 v[96:99], v147, s[68:71], s41 offen offset:0 sc1
    v_pk_mul_f32 v[222:223], v[8:9], v[246:247] op_sel:[0,1] op_sel_hi:[1,1]
    v_pk_mul_f32 v[224:225], v[10:11], v[246:247] op_sel:[0,1] op_sel_hi:[1,1]
    v_pk_mul_f32 v[226:227], v[12:13], v[246:247] op_sel:[0,1] op_sel_hi:[1,1]
    v_pk_mul_f32 v[228:229], v[14:15], v[246:247] op_sel:[0,1] op_sel_hi:[1,1]
    v_exp_f32 v222, v222
    v_exp_f32 v223, v223
    v_exp_f32 v224, v224
    v_exp_f32 v225, v225
    v_exp_f32 v226, v226
    v_exp_f32 v227, v227
    v_exp_f32 v228, v228
    v_exp_f32 v229, v229
    v_pk_mul_f32 v[8:9], v[8:9], v[246:247] op_sel_hi:[1,0]
    v_pk_mul_f32 v[10:11], v[10:11], v[246:247] op_sel_hi:[1,0]
    v_pk_mul_f32 v[12:13], v[12:13], v[246:247] op_sel_hi:[1,0]
    v_pk_mul_f32 v[14:15], v[14:15], v[246:247] op_sel_hi:[1,0]
    v_pk_fma_f32 v[230:231], v[222:223], -0.5, -1.0 op_sel_hi:[1,0,0]
    v_pk_fma_f32 v[232:233], v[224:225], -0.5, -1.0 op_sel_hi:[1,0,0]
    v_pk_fma_f32 v[234:235], v[226:227], -0.5, -1.0 op_sel_hi:[1,0,0]
    v_pk_fma_f32 v[236:237], v[228:229], -0.5, -1.0 op_sel_hi:[1,0,0]
    v_pk_fma_f32 v[230:231], v[222:223], v[230:231], -1.0 op_sel_hi:[1,1,0]
    v_pk_fma_f32 v[232:233], v[224:225], v[232:233], -1.0 op_sel_hi:[1,1,0]
    v_pk_fma_f32 v[234:235], v[226:227], v[234:235], -1.0 op_sel_hi:[1,1,0]
    v_pk_fma_f32 v[236:237], v[228:229], v[236:237], -1.0 op_sel_hi:[1,1,0]
    v_rcp_f32 v230, v230
    v_rcp_f32 v231, v231
    v_rcp_f32 v232, v232
    v_rcp_f32 v233, v233
    v_rcp_f32 v234, v234
    v_rcp_f32 v235, v235
    v_rcp_f32 v236, v236
    v_rcp_f32 v237, v237
    v_pk_fma_f32 v[8:9], v[8:9], v[230:231], v[8:9]
    v_pk_fma_f32 v[10:11], v[10:11], v[232:233], v[10:11]
    v_pk_fma_f32 v[12:13], v[12:13], v[234:235], v[12:13]
    v_pk_fma_f32 v[14:15], v[14:15], v[236:237], v[14:15]
    v_cvt_pk_bf16_f32 v100, v8, v9
    v_cvt_pk_bf16_f32 v101, v10, v11
    v_cvt_pk_bf16_f32 v102, v12, v13
    v_cvt_pk_bf16_f32 v103, v14, v15
    buffer_store_dwordx4 v[100:103], v147, s[68:71], s41 offen offset:1024 sc1
    v_pk_mul_f32 v[222:223], v[16:17], v[246:247] op_sel:[0,1] op_sel_hi:[1,1]
    v_pk_mul_f32 v[224:225], v[18:19], v[246:247] op_sel:[0,1] op_sel_hi:[1,1]
    v_pk_mul_f32 v[226:227], v[20:21], v[246:247] op_sel:[0,1] op_sel_hi:[1,1]
    v_pk_mul_f32 v[228:229], v[22:23], v[246:247] op_sel:[0,1] op_sel_hi:[1,1]
    v_exp_f32 v222, v222
    v_exp_f32 v223, v223
    v_exp_f32 v224, v224
    v_exp_f32 v225, v225
    v_exp_f32 v226, v226
    v_exp_f32 v227, v227
    v_exp_f32 v228, v228
    v_exp_f32 v229, v229
    v_pk_mul_f32 v[16:17], v[16:17], v[246:247] op_sel_hi:[1,0]
    v_pk_mul_f32 v[18:19], v[18:19], v[246:247] op_sel_hi:[1,0]
    v_pk_mul_f32 v[20:21], v[20:21], v[246:247] op_sel_hi:[1,0]
    v_pk_mul_f32 v[22:23], v[22:23], v[246:247] op_sel_hi:[1,0]
    v_pk_fma_f32 v[230:231], v[222:223], -0.5, -1.0 op_sel_hi:[1,0,0]
    v_pk_fma_f32 v[232:233], v[224:225], -0.5, -1.0 op_sel_hi:[1,0,0]
    v_pk_fma_f32 v[234:235], v[226:227], -0.5, -1.0 op_sel_hi:[1,0,0]
    v_pk_fma_f32 v[236:237], v[228:229], -0.5, -1.0 op_sel_hi:[1,0,0]
    v_pk_fma_f32 v[230:231], v[222:223], v[230:231], -1.0 op_sel_hi:[1,1,0]
    v_pk_fma_f32 v[232:233], v[224:225], v[232:233], -1.0 op_sel_hi:[1,1,0]
    v_pk_fma_f32 v[234:235], v[226:227], v[234:235], -1.0 op_sel_hi:[1,1,0]
    v_pk_fma_f32 v[236:237], v[228:229], v[236:237], -1.0 op_sel_hi:[1,1,0]
    v_rcp_f32 v230, v230
    v_rcp_f32 v231, v231
    v_rcp_f32 v232, v232
    v_rcp_f32 v233, v233
    v_rcp_f32 v234, v234
    v_rcp_f32 v235, v235
    v_rcp_f32 v236, v236
    v_rcp_f32 v237, v237
    v_pk_fma_f32 v[16:17], v[16:17], v[230:231], v[16:17]
    v_pk_fma_f32 v[18:19], v[18:19], v[232:233], v[18:19]
    v_pk_fma_f32 v[20:21], v[20:21], v[234:235], v[20:21]
    v_pk_fma_f32 v[22:23], v[22:23], v[236:237], v[22:23]
    v_cvt_pk_bf16_f32 v104, v16, v17
    v_cvt_pk_bf16_f32 v105, v18, v19
    v_cvt_pk_bf16_f32 v106, v20, v21
    v_cvt_pk_bf16_f32 v107, v22, v23
    buffer_store_dwordx4 v[104:107], v147, s[68:71], s41 offen offset:2048 sc1
    v_pk_mul_f32 v[222:223], v[24:25], v[246:247] op_sel:[0,1] op_sel_hi:[1,1]
    v_pk_mul_f32 v[224:225], v[26:27], v[246:247] op_sel:[0,1] op_sel_hi:[1,1]
    v_pk_mul_f32 v[226:227], v[28:29], v[246:247] op_sel:[0,1] op_sel_hi:[1,1]
    v_pk_mul_f32 v[228:229], v[30:31], v[246:247] op_sel:[0,1] op_sel_hi:[1,1]
    v_exp_f32 v222, v222
    v_exp_f32 v223, v223
    v_exp_f32 v224, v224
    v_exp_f32 v225, v225
    v_exp_f32 v226, v226
    v_exp_f32 v227, v227
    v_exp_f32 v228, v228
    v_exp_f32 v229, v229
    v_pk_mul_f32 v[24:25], v[24:25], v[246:247] op_sel_hi:[1,0]
    v_pk_mul_f32 v[26:27], v[26:27], v[246:247] op_sel_hi:[1,0]
    v_pk_mul_f32 v[28:29], v[28:29], v[246:247] op_sel_hi:[1,0]
    v_pk_mul_f32 v[30:31], v[30:31], v[246:247] op_sel_hi:[1,0]
    v_pk_fma_f32 v[230:231], v[222:223], -0.5, -1.0 op_sel_hi:[1,0,0]
    v_pk_fma_f32 v[232:233], v[224:225], -0.5, -1.0 op_sel_hi:[1,0,0]
    v_pk_fma_f32 v[234:235], v[226:227], -0.5, -1.0 op_sel_hi:[1,0,0]
    v_pk_fma_f32 v[236:237], v[228:229], -0.5, -1.0 op_sel_hi:[1,0,0]
    v_pk_fma_f32 v[230:231], v[222:223], v[230:231], -1.0 op_sel_hi:[1,1,0]
    v_pk_fma_f32 v[232:233], v[224:225], v[232:233], -1.0 op_sel_hi:[1,1,0]
    v_pk_fma_f32 v[234:235], v[226:227], v[234:235], -1.0 op_sel_hi:[1,1,0]
    v_pk_fma_f32 v[236:237], v[228:229], v[236:237], -1.0 op_sel_hi:[1,1,0]
    v_rcp_f32 v230, v230
    v_rcp_f32 v231, v231
    v_rcp_f32 v232, v232
    v_rcp_f32 v233, v233
    v_rcp_f32 v234, v234
    v_rcp_f32 v235, v235
    v_rcp_f32 v236, v236
    v_rcp_f32 v237, v237
    v_pk_fma_f32 v[24:25], v[24:25], v[230:231], v[24:25]
    v_pk_fma_f32 v[26:27], v[26:27], v[232:233], v[26:27]
    v_pk_fma_f32 v[28:29], v[28:29], v[234:235], v[28:29]
    v_pk_fma_f32 v[30:31], v[30:31], v[236:237], v[30:31]
    v_cvt_pk_bf16_f32 v108, v24, v25
    v_cvt_pk_bf16_f32 v109, v26, v27
    v_cvt_pk_bf16_f32 v110, v28, v29
    v_cvt_pk_bf16_f32 v111, v30, v31
    buffer_store_dwordx4 v[108:111], v147, s[68:71], s41 offen offset:3072 sc1
    s_add_u32 s41, s41, 4096
    v_pk_mul_f32 v[222:223], v[32:33], v[246:247] op_sel:[0,1] op_sel_hi:[1,1]
    v_pk_mul_f32 v[224:225], v[34:35], v[246:247] op_sel:[0,1] op_sel_hi:[1,1]
    v_pk_mul_f32 v[226:227], v[36:37], v[246:247] op_sel:[0,1] op_sel_hi:[1,1]
    v_pk_mul_f32 v[228:229], v[38:39], v[246:247] op_sel:[0,1] op_sel_hi:[1,1]
    v_exp_f32 v222, v222
    v_exp_f32 v223, v223
    v_exp_f32 v224, v224
    v_exp_f32 v225, v225
    v_exp_f32 v226, v226
    v_exp_f32 v227, v227
    v_exp_f32 v228, v228
    v_exp_f32 v229, v229
    v_pk_mul_f32 v[32:33], v[32:33], v[246:247] op_sel_hi:[1,0]
    v_pk_mul_f32 v[34:35], v[34:35], v[246:247] op_sel_hi:[1,0]
    v_pk_mul_f32 v[36:37], v[36:37], v[246:247] op_sel_hi:[1,0]
    v_pk_mul_f32 v[38:39], v[38:39], v[246:247] op_sel_hi:[1,0]
    v_pk_fma_f32 v[230:231], v[222:223], -0.5, -1.0 op_sel_hi:[1,0,0]
    v_pk_fma_f32 v[232:233], v[224:225], -0.5, -1.0 op_sel_hi:[1,0,0]
    v_pk_fma_f32 v[234:235], v[226:227], -0.5, -1.0 op_sel_hi:[1,0,0]
    v_pk_fma_f32 v[236:237], v[228:229], -0.5, -1.0 op_sel_hi:[1,0,0]
    v_pk_fma_f32 v[230:231], v[222:223], v[230:231], -1.0 op_sel_hi:[1,1,0]
    v_pk_fma_f32 v[232:233], v[224:225], v[232:233], -1.0 op_sel_hi:[1,1,0]
    v_pk_fma_f32 v[234:235], v[226:227], v[234:235], -1.0 op_sel_hi:[1,1,0]
    v_pk_fma_f32 v[236:237], v[228:229], v[236:237], -1.0 op_sel_hi:[1,1,0]
    v_rcp_f32 v230, v230
    v_rcp_f32 v231, v231
    v_rcp_f32 v232, v232
    v_rcp_f32 v233, v233
    v_rcp_f32 v234, v234
    v_rcp_f32 v235, v235
    v_rcp_f32 v236, v236
    v_rcp_f32 v237, v237
    v_pk_fma_f32 v[32:33], v[32:33], v[230:231], v[32:33]
    v_pk_fma_f32 v[34:35], v[34:35], v[232:233], v[34:35]
    v_pk_fma_f32 v[36:37], v[36:37], v[234:235], v[36:37]
    v_pk_fma_f32 v[38:39], v[38:39], v[236:237], v[38:39]
    v_cvt_pk_bf16_f32 v112, v32, v33
    v_cvt_pk_bf16_f32 v113, v34, v35
    v_cvt_pk_bf16_f32 v114, v36, v37
    v_cvt_pk_bf16_f32 v115, v38, v39
    buffer_store_dwordx4 v[112:115], v147, s[68:71], s41 offen offset:0 sc1
    v_pk_mul_f32 v[222:223], v[40:41], v[246:247] op_sel:[0,1] op_sel_hi:[1,1]
    v_pk_mul_f32 v[224:225], v[42:43], v[246:247] op_sel:[0,1] op_sel_hi:[1,1]
    v_pk_mul_f32 v[226:227], v[44:45], v[246:247] op_sel:[0,1] op_sel_hi:[1,1]
    v_pk_mul_f32 v[228:229], v[46:47], v[246:247] op_sel:[0,1] op_sel_hi:[1,1]
    v_exp_f32 v222, v222
    v_exp_f32 v223, v223
    v_exp_f32 v224, v224
    v_exp_f32 v225, v225
    v_exp_f32 v226, v226
    v_exp_f32 v227, v227
    v_exp_f32 v228, v228
    v_exp_f32 v229, v229
    v_pk_mul_f32 v[40:41], v[40:41], v[246:247] op_sel_hi:[1,0]
    v_pk_mul_f32 v[42:43], v[42:43], v[246:247] op_sel_hi:[1,0]
    v_pk_mul_f32 v[44:45], v[44:45], v[246:247] op_sel_hi:[1,0]
    v_pk_mul_f32 v[46:47], v[46:47], v[246:247] op_sel_hi:[1,0]
    v_pk_fma_f32 v[230:231], v[222:223], -0.5, -1.0 op_sel_hi:[1,0,0]
    v_pk_fma_f32 v[232:233], v[224:225], -0.5, -1.0 op_sel_hi:[1,0,0]
    v_pk_fma_f32 v[234:235], v[226:227], -0.5, -1.0 op_sel_hi:[1,0,0]
    v_pk_fma_f32 v[236:237], v[228:229], -0.5, -1.0 op_sel_hi:[1,0,0]
    v_pk_fma_f32 v[230:231], v[222:223], v[230:231], -1.0 op_sel_hi:[1,1,0]
    v_pk_fma_f32 v[232:233], v[224:225], v[232:233], -1.0 op_sel_hi:[1,1,0]
    v_pk_fma_f32 v[234:235], v[226:227], v[234:235], -1.0 op_sel_hi:[1,1,0]
    v_pk_fma_f32 v[236:237], v[228:229], v[236:237], -1.0 op_sel_hi:[1,1,0]
    v_rcp_f32 v230, v230
    v_rcp_f32 v231, v231
    v_rcp_f32 v232, v232
    v_rcp_f32 v233, v233
    v_rcp_f32 v234, v234
    v_rcp_f32 v235, v235
    v_rcp_f32 v236, v236
    v_rcp_f32 v237, v237
    v_pk_fma_f32 v[40:41], v[40:41], v[230:231], v[40:41]
    v_pk_fma_f32 v[42:43], v[42:43], v[232:233], v[42:43]
    v_pk_fma_f32 v[44:45], v[44:45], v[234:235], v[44:45]
    v_pk_fma_f32 v[46:47], v[46:47], v[236:237], v[46:47]
    v_cvt_pk_bf16_f32 v116, v40, v41
    v_cvt_pk_bf16_f32 v117, v42, v43
    v_cvt_pk_bf16_f32 v118, v44, v45
    v_cvt_pk_bf16_f32 v119, v46, v47
    buffer_store_dwordx4 v[116:119], v147, s[68:71], s41 offen offset:1024 sc1
    v_pk_mul_f32 v[222:223], v[48:49], v[246:247] op_sel:[0,1] op_sel_hi:[1,1]
    v_pk_mul_f32 v[224:225], v[50:51], v[246:247] op_sel:[0,1] op_sel_hi:[1,1]
    v_pk_mul_f32 v[226:227], v[52:53], v[246:247] op_sel:[0,1] op_sel_hi:[1,1]
    v_pk_mul_f32 v[228:229], v[54:55], v[246:247] op_sel:[0,1] op_sel_hi:[1,1]
    v_exp_f32 v222, v222
    v_exp_f32 v223, v223
    v_exp_f32 v224, v224
    v_exp_f32 v225, v225
    v_exp_f32 v226, v226
    v_exp_f32 v227, v227
    v_exp_f32 v228, v228
    v_exp_f32 v229, v229
    v_pk_mul_f32 v[48:49], v[48:49], v[246:247] op_sel_hi:[1,0]
    v_pk_mul_f32 v[50:51], v[50:51], v[246:247] op_sel_hi:[1,0]
    v_pk_mul_f32 v[52:53], v[52:53], v[246:247] op_sel_hi:[1,0]
    v_pk_mul_f32 v[54:55], v[54:55], v[246:247] op_sel_hi:[1,0]
    v_pk_fma_f32 v[230:231], v[222:223], -0.5, -1.0 op_sel_hi:[1,0,0]
    v_pk_fma_f32 v[232:233], v[224:225], -0.5, -1.0 op_sel_hi:[1,0,0]
    v_pk_fma_f32 v[234:235], v[226:227], -0.5, -1.0 op_sel_hi:[1,0,0]
    v_pk_fma_f32 v[236:237], v[228:229], -0.5, -1.0 op_sel_hi:[1,0,0]
    v_pk_fma_f32 v[230:231], v[222:223], v[230:231], -1.0 op_sel_hi:[1,1,0]
    v_pk_fma_f32 v[232:233], v[224:225], v[232:233], -1.0 op_sel_hi:[1,1,0]
    v_pk_fma_f32 v[234:235], v[226:227], v[234:235], -1.0 op_sel_hi:[1,1,0]
    v_pk_fma_f32 v[236:237], v[228:229], v[236:237], -1.0 op_sel_hi:[1,1,0]
    v_rcp_f32 v230, v230
    v_rcp_f32 v231, v231
    v_rcp_f32 v232, v232
    v_rcp_f32 v233, v233
    v_rcp_f32 v234, v234
    v_rcp_f32 v235, v235
    v_rcp_f32 v236, v236
    v_rcp_f32 v237, v237
    v_pk_fma_f32 v[48:49], v[48:49], v[230:231], v[48:49]
    v_pk_fma_f32 v[50:51], v[50:51], v[232:233], v[50:51]
    v_pk_fma_f32 v[52:53], v[52:53], v[234:235], v[52:53]
    v_pk_fma_f32 v[54:55], v[54:55], v[236:237], v[54:55]
    v_cvt_pk_bf16_f32 v120, v48, v49
    v_cvt_pk_bf16_f32 v121, v50, v51
    v_cvt_pk_bf16_f32 v122, v52, v53
    v_cvt_pk_bf16_f32 v123, v54, v55
    buffer_store_dwordx4 v[120:123], v147, s[68:71], s41 offen offset:2048 sc1
    s_waitcnt vmcnt(10)
    s_barrier
    v_add_u32 v170, 114688, v170
    ds_read_b64_tr_b16 a[160:161], v170 offset:0
    ds_read_b64_tr_b16 a[162:163], v170 offset:512
    v_add_u32 v171, 114688, v171
    ds_read_b64_tr_b16 a[164:165], v171 offset:0
    ds_read_b64_tr_b16 a[166:167], v171 offset:512
    v_add_u32 v172, 114688, v172
    ds_read_b64_tr_b16 a[168:169], v172 offset:0
    ds_read_b64_tr_b16 a[170:171], v172 offset:512
    v_add_u32 v173, 114688, v173
    ds_read_b64_tr_b16 a[172:173], v173 offset:0
    ds_read_b64_tr_b16 a[174:175], v173 offset:512
    v_add_u32 v174, 114688, v174
    ds_read_b64_tr_b16 a[176:177], v174 offset:0
    ds_read_b64_tr_b16 a[178:179], v174 offset:512
    v_add_u32 v175, 114688, v175
    ds_read_b64_tr_b16 a[180:181], v175 offset:0
    ds_read_b64_tr_b16 a[182:183], v175 offset:512
    v_add_u32 v176, 114688, v176
    ds_read_b64_tr_b16 a[184:185], v176 offset:0
    ds_read_b64_tr_b16 a[186:187], v176 offset:512
    v_add_u32 v177, 114688, v177
    ds_read_b64_tr_b16 a[188:189], v177 offset:0
    ds_read_b64_tr_b16 a[190:191], v177 offset:512
    v_pk_mul_f32 v[222:223], v[56:57], v[246:247] op_sel:[0,1] op_sel_hi:[1,1]
    v_pk_mul_f32 v[224:225], v[58:59], v[246:247] op_sel:[0,1] op_sel_hi:[1,1]
    v_pk_mul_f32 v[226:227], v[60:61], v[246:247] op_sel:[0,1] op_sel_hi:[1,1]
    v_pk_mul_f32 v[228:229], v[62:63], v[246:247] op_sel:[0,1] op_sel_hi:[1,1]
    v_exp_f32 v222, v222
    v_exp_f32 v223, v223
    v_exp_f32 v224, v224
    v_exp_f32 v225, v225
    v_exp_f32 v226, v226
    v_exp_f32 v227, v227
    v_exp_f32 v228, v228
    v_exp_f32 v229, v229
    v_pk_mul_f32 v[56:57], v[56:57], v[246:247] op_sel_hi:[1,0]
    v_pk_mul_f32 v[58:59], v[58:59], v[246:247] op_sel_hi:[1,0]
    v_pk_mul_f32 v[60:61], v[60:61], v[246:247] op_sel_hi:[1,0]
    v_pk_mul_f32 v[62:63], v[62:63], v[246:247] op_sel_hi:[1,0]
    v_pk_fma_f32 v[230:231], v[222:223], -0.5, -1.0 op_sel_hi:[1,0,0]
    v_pk_fma_f32 v[232:233], v[224:225], -0.5, -1.0 op_sel_hi:[1,0,0]
    v_pk_fma_f32 v[234:235], v[226:227], -0.5, -1.0 op_sel_hi:[1,0,0]
    v_pk_fma_f32 v[236:237], v[228:229], -0.5, -1.0 op_sel_hi:[1,0,0]
    v_pk_fma_f32 v[230:231], v[222:223], v[230:231], -1.0 op_sel_hi:[1,1,0]
    v_pk_fma_f32 v[232:233], v[224:225], v[232:233], -1.0 op_sel_hi:[1,1,0]
    v_pk_fma_f32 v[234:235], v[226:227], v[234:235], -1.0 op_sel_hi:[1,1,0]
    v_pk_fma_f32 v[236:237], v[228:229], v[236:237], -1.0 op_sel_hi:[1,1,0]
    v_rcp_f32 v230, v230
    v_rcp_f32 v231, v231
    v_rcp_f32 v232, v232
    v_rcp_f32 v233, v233
    v_rcp_f32 v234, v234
    v_rcp_f32 v235, v235
    v_rcp_f32 v236, v236
    v_rcp_f32 v237, v237
    v_pk_fma_f32 v[56:57], v[56:57], v[230:231], v[56:57]
    v_pk_fma_f32 v[58:59], v[58:59], v[232:233], v[58:59]
    v_pk_fma_f32 v[60:61], v[60:61], v[234:235], v[60:61]
    v_pk_fma_f32 v[62:63], v[62:63], v[236:237], v[62:63]
    v_cvt_pk_bf16_f32 v124, v56, v57
    v_cvt_pk_bf16_f32 v125, v58, v59
    v_cvt_pk_bf16_f32 v126, v60, v61
    v_cvt_pk_bf16_f32 v127, v62, v63
    buffer_store_dwordx4 v[124:127], v147, s[68:71], s41 offen offset:3072 sc1
    s_add_u32 s41, s41, 4096
    s_waitcnt lgkmcnt(8)
    v_mfma_f32_32x32x16_bf16 v[64:79], a[160:163], a[0:3], 0
    ds_read_b64_tr_b16 a[192:193], v170 offset:8192
    ds_read_b64_tr_b16 a[194:195], v170 offset:8704
    v_mfma_f32_16x16x32_bf16 a[224:227], v[190:193], a[160:163], 0
    ds_read_b64_tr_b16 a[196:197], v171 offset:8192
    v_mfma_f32_32x32x16_bf16 v[80:95], a[164:167], a[0:3], 0
    ds_read_b64_tr_b16 a[198:199], v171 offset:8704
    ds_read_b64_tr_b16 a[200:201], v172 offset:8192
    v_mfma_f32_32x32x16_bf16 v[64:79], a[168:171], a[4:7], v[64:79]
    ds_read_b64_tr_b16 a[202:203], v172 offset:8704
    ds_read_b64_tr_b16 a[204:205], v173 offset:8192
    v_mfma_f32_32x32x16_bf16 v[80:95], a[172:175], a[4:7], v[80:95]
    ds_read_b64_tr_b16 a[206:207], v173 offset:8704
    s_waitcnt lgkmcnt(8)
    v_mfma_f32_32x32x16_bf16 v[64:79], a[176:179], a[8:11], v[64:79]
    ds_read_b64_tr_b16 a[160:161], v174 offset:8192
    ds_read_b64_tr_b16 a[162:163], v174 offset:8704
    v_mfma_f32_32x32x16_bf16 v[80:95], a[180:183], a[8:11], v[80:95]
    ds_read_b64_tr_b16 a[164:165], v175 offset:8192
    ds_read_b64_tr_b16 a[166:167], v175 offset:8704
    v_mfma_f32_16x16x32_bf16 a[228:231], v[190:193], a[180:183], 0
    ds_read_b64_tr_b16 a[168:169], v176 offset:8192
    v_mfma_f32_32x32x16_bf16 v[64:79], a[184:187], a[12:15], v[64:79]
    ds_read_b64_tr_b16 a[170:171], v176 offset:8704
    ds_read_b64_tr_b16 a[172:173], v177 offset:8192
    v_mfma_f32_32x32x16_bf16 v[80:95], a[188:191], a[12:15], v[80:95]
    ds_read_b64_tr_b16 a[174:175], v177 offset:8704
    s_waitcnt lgkmcnt(8)
    v_mfma_f32_32x32x16_bf16 v[64:79], a[192:195], a[16:19], v[64:79]
    v_add_u32 v170, 4294901760, v170
    ds_read_b64_tr_b16 a[176:177], v170 offset:0
    ds_read_b64_tr_b16 a[178:179], v170 offset:512
    s_add_u32 m0, s94, 0
    v_mfma_f32_16x16x32_bf16 a[224:227], v[190:193], a[192:195], a[224:227]
    v_add_u32 v171, 4294901760, v171
    buffer_load_dwordx4 v158, s[56:59], s76 offen lds
    s_add_u32 m0, s94, 4096
    v_mfma_f32_32x32x16_bf16 v[80:95], a[196:199], a[16:19], v[80:95]
    ds_read_b64_tr_b16 a[180:181], v171 offset:0
    ds_read_b64_tr_b16 a[182:183], v171 offset:512
    v_add_u32 v172, 4294901760, v172
    buffer_load_dwordx4 v159, s[56:59], s76 offen lds
    s_add_u32 m0, s94, 8192
    v_mfma_f32_32x32x16_bf16 v[64:79], a[200:203], a[20:23], v[64:79]
    ds_read_b64_tr_b16 a[184:185], v172 offset:0
    ds_read_b64_tr_b16 a[186:187], v172 offset:512
    v_add_u32 v173, 4294901760, v173
    v_mfma_f32_32x32x16_bf16 v[80:95], a[204:207], a[20:23], v[80:95]
    ds_read_b64_tr_b16 a[188:189], v173 offset:0
    ds_read_b64_tr_b16 a[190:191], v173 offset:512
    buffer_load_dwordx4 v160, s[56:59], s76 offen lds
    s_add_u32 m0, s94, 12288
    s_waitcnt lgkmcnt(8)
    v_mfma_f32_32x32x16_bf16 v[64:79], a[160:163], a[24:27], v[64:79]
    v_add_u32 v174, 4294901760, v174
    ds_read_b64_tr_b16 a[192:193], v174 offset:0
    ds_read_b64_tr_b16 a[194:195], v174 offset:512
    v_mfma_f32_32x32x16_bf16 v[80:95], a[164:167], a[24:27], v[80:95]
    v_add_u32 v175, 4294901760, v175
    ds_read_b64_tr_b16 a[196:197], v175 offset:0
    ds_read_b64_tr_b16 a[198:199], v175 offset:512
    buffer_load_dwordx4 v161, s[56:59], s76 offen lds
    s_add_u32 m0, s94, 16384
    v_mfma_f32_16x16x32_bf16 a[228:231], v[190:193], a[164:167], a[228:231]
    v_add_u32 v176, 4294901760, v176
    v_mfma_f32_32x32x16_bf16 v[64:79], a[168:171], a[28:31], v[64:79]
    ds_read_b64_tr_b16 a[200:201], v176 offset:0
    ds_read_b64_tr_b16 a[202:203], v176 offset:512
    v_add_u32 v177, 4294901760, v177
    v_mfma_f32_32x32x16_bf16 v[80:95], a[172:175], a[28:31], v[80:95]
    ds_read_b64_tr_b16 a[204:205], v177 offset:0
    ds_read_b64_tr_b16 a[206:207], v177 offset:512
    buffer_load_dwordx4 v162, s[56:59], s76 offen lds
    s_add_u32 m0, s94, 20480
    s_waitcnt lgkmcnt(8)
    v_mfma_f32_32x32x16_bf16 v[64:79], a[176:179], a[32:35], v[64:79]
    ds_read_b64_tr_b16 a[160:161], v170 offset:8192
    ds_read_b64_tr_b16 a[162:163], v170 offset:8704
    v_mfma_f32_16x16x32_bf16 a[224:227], v[190:193], a[176:179], a[224:227]
    ds_read_b64_tr_b16 a[164:165], v171 offset:8192
    buffer_load_dwordx4 v163, s[56:59], s76 offen lds
    s_add_u32 m0, s94, 24576
    v_mfma_f32_32x32x16_bf16 v[80:95], a[180:183], a[32:35], v[80:95]
    ds_read_b64_tr_b16 a[166:167], v171 offset:8704
    ds_read_b64_tr_b16 a[168:169], v172 offset:8192
    v_mfma_f32_32x32x16_bf16 v[64:79], a[184:187], a[36:39], v[64:79]
    ds_read_b64_tr_b16 a[170:171], v172 offset:8704
    ds_read_b64_tr_b16 a[172:173], v173 offset:8192
    buffer_load_dwordx4 v158, s[56:59], s77 offen lds
    s_add_u32 m0, s94, 28672
    v_mfma_f32_32x32x16_bf16 v[80:95], a[188:191], a[36:39], v[80:95]
    ds_read_b64_tr_b16 a[174:175], v173 offset:8704
    s_waitcnt lgkmcnt(8)
    v_mfma_f32_32x32x16_bf16 v[64:79], a[192:195], a[40:43], v[64:79]
    ds_read_b64_tr_b16 a[176:177], v174 offset:8192
    ds_read_b64_tr_b16 a[178:179], v174 offset:8704
    buffer_load_dwordx4 v159, s[56:59], s77 offen lds
    s_add_u32 m0, s94, 32768
    v_mfma_f32_32x32x16_bf16 v[80:95], a[196:199], a[40:43], v[80:95]
    ds_read_b64_tr_b16 a[180:181], v175 offset:8192
    ds_read_b64_tr_b16 a[182:183], v175 offset:8704
    v_mfma_f32_16x16x32_bf16 a[228:231], v[190:193], a[196:199], a[228:231]
    ds_read_b64_tr_b16 a[184:185], v176 offset:8192
    v_mfma_f32_32x32x16_bf16 v[64:79], a[200:203], a[44:47], v[64:79]
    ds_read_b64_tr_b16 a[186:187], v176 offset:8704
    ds_read_b64_tr_b16 a[188:189], v177 offset:8192
    buffer_load_dwordx4 v160, s[56:59], s77 offen lds
    s_add_u32 m0, s94, 36864
    v_mfma_f32_32x32x16_bf16 v[80:95], a[204:207], a[44:47], v[80:95]
    ds_read_b64_tr_b16 a[190:191], v177 offset:8704
    s_waitcnt lgkmcnt(8)
    v_mfma_f32_32x32x16_bf16 v[64:79], a[160:163], a[48:51], v[64:79]
    ds_read_b64_tr_b16 a[192:193], v170 offset:16384
    ds_read_b64_tr_b16 a[194:195], v170 offset:16896
    buffer_load_dwordx4 v161, s[56:59], s77 offen lds
    s_add_u32 m0, s94, 40960
    v_mfma_f32_16x16x32_bf16 a[224:227], v[190:193], a[160:163], a[224:227]
    ds_read_b64_tr_b16 a[196:197], v171 offset:16384
    v_mfma_f32_32x32x16_bf16 v[80:95], a[164:167], a[48:51], v[80:95]
    ds_read_b64_tr_b16 a[198:199], v171 offset:16896
    ds_read_b64_tr_b16 a[200:201], v172 offset:16384
    buffer_load_dwordx4 v162, s[56:59], s77 offen lds
    s_add_u32 m0, s94, 45056
    v_mfma_f32_32x32x16_bf16 v[64:79], a[168:171], a[52:55], v[64:79]
    ds_read_b64_tr_b16 a[202:203], v172 offset:16896
    ds_read_b64_tr_b16 a[204:205], v173 offset:16384
    v_mfma_f32_32x32x16_bf16 v[80:95], a[172:175], a[52:55], v[80:95]
    ds_read_b64_tr_b16 a[206:207], v173 offset:16896
    buffer_load_dwordx4 v163, s[56:59], s77 offen lds
    v_mov_b32 v248, s88
    v_mov_b32 v249, s89
    s_waitcnt vmcnt(12)
    s_lshl_b32 s12, s6, 6
    s_add_u32 s12, s12, s24
    s_mov_b64 exec, 1
    s_add_u32 s96, s12, 589824
    buffer_store_dwordx2 v[248:249], v155, s[68:71], s96 offen
    buffer_store_dwordx2 v[248:249], v155, s[68:71], s12 offen sc1
    s_mov_b64 exec, -1
    s_waitcnt lgkmcnt(8)
    v_mfma_f32_32x32x16_bf16 v[64:79], a[176:179], a[56:59], v[64:79]
    ds_read_b64_tr_b16 a[160:161], v174 offset:16384
    ds_read_b64_tr_b16 a[162:163], v174 offset:16896
    v_mfma_f32_32x32x16_bf16 v[80:95], a[180:183], a[56:59], v[80:95]
    ds_read_b64_tr_b16 a[164:165], v175 offset:16384
    ds_read_b64_tr_b16 a[166:167], v175 offset:16896
    v_mfma_f32_16x16x32_bf16 a[228:231], v[190:193], a[180:183], a[228:231]
    ds_read_b64_tr_b16 a[168:169], v176 offset:16384
    v_mfma_f32_32x32x16_bf16 v[64:79], a[184:187], a[60:63], v[64:79]
    ds_read_b64_tr_b16 a[170:171], v176 offset:16896
    ds_read_b64_tr_b16 a[172:173], v177 offset:16384
    v_mfma_f32_32x32x16_bf16 v[80:95], a[188:191], a[60:63], v[80:95]
    ds_read_b64_tr_b16 a[174:175], v177 offset:16896
    s_waitcnt lgkmcnt(8)
    v_mfma_f32_32x32x16_bf16 v[64:79], a[192:195], a[64:67], v[64:79]
    ds_read_b64_tr_b16 a[176:177], v170 offset:24576
    ds_read_b64_tr_b16 a[178:179], v170 offset:25088
    v_mfma_f32_16x16x32_bf16 a[224:227], v[190:193], a[192:195], a[224:227]
    ds_read_b64_tr_b16 a[180:181], v171 offset:24576
    v_mfma_f32_32x32x16_bf16 v[80:95], a[196:199], a[64:67], v[80:95]
    ds_read_b64_tr_b16 a[182:183], v171 offset:25088
    ds_read_b64_tr_b16 a[184:185], v172 offset:24576
    v_mfma_f32_32x32x16_bf16 v[64:79], a[200:203], a[68:71], v[64:79]
    ds_read_b64_tr_b16 a[186:187], v172 offset:25088
    ds_read_b64_tr_b16 a[188:189], v173 offset:24576
    v_mfma_f32_32x32x16_bf16 v[80:95], a[204:207], a[68:71], v[80:95]
    ds_read_b64_tr_b16 a[190:191], v173 offset:25088
    s_getpc_b64 s[96:97]
L_pc_5:
    s_sub_u32 s96, s96, L_pc_5-parallel_sum__ssm_conv_s5__dense_activation_mish__prompt_kernel
    s_subb_u32 s97, s97, 0
    s_lshr_b32 s98, s2, 3
    s_lshl_b32 s98, s98, 2
    s_add_u32 s98, s98, s3
    s_mul_i32 s98, s98, 768
    v_min_u32 v252, 5, v144
    v_lshl_add_u32 v252, v252, 7, s98
    v_min_u32 v252, CODE_LAST, v252
    global_load_dword a255, v252, s[96:97]
    s_waitcnt lgkmcnt(8)
    v_mfma_f32_32x32x16_bf16 v[64:79], a[160:163], a[72:75], v[64:79]
    ds_read_b64_tr_b16 a[192:193], v174 offset:24576
    ds_read_b64_tr_b16 a[194:195], v174 offset:25088
    v_mfma_f32_32x32x16_bf16 v[80:95], a[164:167], a[72:75], v[80:95]
    ds_read_b64_tr_b16 a[196:197], v175 offset:24576
    ds_read_b64_tr_b16 a[198:199], v175 offset:25088
    v_mfma_f32_16x16x32_bf16 a[228:231], v[190:193], a[164:167], a[228:231]
    ds_read_b64_tr_b16 a[200:201], v176 offset:24576
    v_mfma_f32_32x32x16_bf16 v[64:79], a[168:171], a[76:79], v[64:79]
    ds_read_b64_tr_b16 a[202:203], v176 offset:25088
    ds_read_b64_tr_b16 a[204:205], v177 offset:24576
    v_mfma_f32_32x32x16_bf16 v[80:95], a[172:175], a[76:79], v[80:95]
    ds_read_b64_tr_b16 a[206:207], v177 offset:25088
    s_waitcnt lgkmcnt(8)
    v_mfma_f32_32x32x16_bf16 v[64:79], a[176:179], a[80:83], v[64:79]
    ds_read_b64_tr_b16 a[160:161], v170 offset:32768
    ds_read_b64_tr_b16 a[162:163], v170 offset:33280
    v_mfma_f32_16x16x32_bf16 a[224:227], v[190:193], a[176:179], a[224:227]
    ds_read_b64_tr_b16 a[164:165], v171 offset:32768
    v_mfma_f32_32x32x16_bf16 v[80:95], a[180:183], a[80:83], v[80:95]
    ds_read_b64_tr_b16 a[166:167], v171 offset:33280
    ds_read_b64_tr_b16 a[168:169], v172 offset:32768
    v_mfma_f32_32x32x16_bf16 v[64:79], a[184:187], a[84:87], v[64:79]
    ds_read_b64_tr_b16 a[170:171], v172 offset:33280
    ds_read_b64_tr_b16 a[172:173], v173 offset:32768
    v_mfma_f32_32x32x16_bf16 v[80:95], a[188:191], a[84:87], v[80:95]
    ds_read_b64_tr_b16 a[174:175], v173 offset:33280
    s_waitcnt lgkmcnt(8)
    v_mfma_f32_32x32x16_bf16 v[64:79], a[192:195], a[88:91], v[64:79]
    s_waitcnt lgkmcnt(0)
    s_barrier
    v_mfma_f32_32x32x16_bf16 v[80:95], a[196:199], a[88:91], v[80:95]
    ds_read_b64_tr_b16 a[176:177], v174 offset:32768
    ds_read_b64_tr_b16 a[178:179], v174 offset:33280
    ds_read_b64_tr_b16 a[180:181], v175 offset:32768
    s_add_u32 m0, s94, 49152
    v_mfma_f32_16x16x32_bf16 a[228:231], v[190:193], a[196:199], a[228:231]
    ds_read_b64_tr_b16 a[182:183], v175 offset:33280
    buffer_load_dwordx4 v158, s[56:59], s78 offen lds
    s_add_u32 m0, s94, 53248
    v_mfma_f32_32x32x16_bf16 v[64:79], a[200:203], a[92:95], v[64:79]
    ds_read_b64_tr_b16 a[184:185], v176 offset:32768
    ds_read_b64_tr_b16 a[186:187], v176 offset:33280
    buffer_load_dwordx4 v159, s[56:59], s78 offen lds
    s_add_u32 m0, s94, 57344
    v_mfma_f32_32x32x16_bf16 v[80:95], a[204:207], a[92:95], v[80:95]
    ds_read_b64_tr_b16 a[188:189], v177 offset:32768
    ds_read_b64_tr_b16 a[190:191], v177 offset:33280
    v_mfma_f32_32x32x16_bf16 v[64:79], a[160:163], a[96:99], v[64:79]
    ds_read_b64_tr_b16 a[192:193], v170 offset:40960
    ds_read_b64_tr_b16 a[194:195], v170 offset:41472
    buffer_load_dwordx4 v160, s[56:59], s78 offen lds
    s_add_u32 m0, s94, 61440
    v_mfma_f32_16x16x32_bf16 a[224:227], v[190:193], a[160:163], a[224:227]
    ds_read_b64_tr_b16 a[196:197], v171 offset:40960
    v_mfma_f32_32x32x16_bf16 v[80:95], a[164:167], a[96:99], v[80:95]
    ds_read_b64_tr_b16 a[198:199], v171 offset:41472
    ds_read_b64_tr_b16 a[200:201], v172 offset:40960
    v_mfma_f32_32x32x16_bf16 v[64:79], a[168:171], a[100:103], v[64:79]
    ds_read_b64_tr_b16 a[202:203], v172 offset:41472
    ds_read_b64_tr_b16 a[204:205], v173 offset:40960
    buffer_load_dwordx4 v161, s[56:59], s78 offen lds
    s_add_u32 m0, s94, 65536
    v_mfma_f32_32x32x16_bf16 v[80:95], a[172:175], a[100:103], v[80:95]
    ds_read_b64_tr_b16 a[206:207], v173 offset:41472
    buffer_load_dwordx4 v[186:189], v239, s[68:71], s31 offen sc1
    s_waitcnt lgkmcnt(8)
    v_mfma_f32_32x32x16_bf16 v[64:79], a[176:179], a[104:107], v[64:79]
    ds_read_b64_tr_b16 a[0:1], v170 offset:49152
    ds_read_b64_tr_b16 a[2:3], v170 offset:49664
    ds_read_b64_tr_b16 a[4:5], v175 offset:49152
    ds_read_b64_tr_b16 a[6:7], v175 offset:49664
    v_add_u32 v170, 57344, v170
    buffer_load_dwordx4 v162, s[56:59], s78 offen lds
    s_add_u32 m0, s94, 69632
    v_mfma_f32_32x32x16_bf16 v[80:95], a[180:183], a[104:107], v[80:95]
    ds_read_b64_tr_b16 a[8:9], v170 offset:0
    ds_read_b64_tr_b16 a[10:11], v170 offset:512
    v_add_u32 v175, 57344, v175
    ds_read_b64_tr_b16 a[12:13], v175 offset:0
    ds_read_b64_tr_b16 a[14:15], v175 offset:512
    v_mfma_f32_16x16x32_bf16 a[228:231], v[190:193], a[180:183], a[228:231]
    ds_read_b64_tr_b16 a[160:161], v174 offset:40960
    buffer_load_dwordx4 v163, s[56:59], s78 offen lds
    s_add_u32 m0, s94, 73728
    v_mfma_f32_32x32x16_bf16 v[64:79], a[184:187], a[108:111], v[64:79]
    ds_read_b64_tr_b16 a[162:163], v174 offset:41472
    v_add_u32 v175, 4294950912, v175
    ds_read_b64_tr_b16 a[164:165], v175 offset:0
    ds_read_b64_tr_b16 a[166:167], v175 offset:512
    v_mfma_f32_32x32x16_bf16 v[80:95], a[188:191], a[108:111], v[80:95]
    ds_read_b64_tr_b16 a[168:169], v176 offset:40960
    ds_read_b64_tr_b16 a[170:171], v176 offset:41472
    ds_read_b64_tr_b16 a[172:173], v177 offset:40960
    ds_read_b64_tr_b16 a[174:175], v177 offset:41472
    buffer_load_dwordx4 v158, s[56:59], s79 offen lds
    s_add_u32 m0, s94, 77824
    s_waitcnt lgkmcnt(15)
    v_mfma_f32_32x32x16_bf16 v[64:79], a[192:195], a[112:115], v[64:79]
    v_add_u32 v170, 4294959104, v170
    ds_read_b64_tr_b16 a[176:177], v170 offset:0
    ds_read_b64_tr_b16 a[178:179], v170 offset:512
    v_mfma_f32_16x16x32_bf16 a[224:227], v[190:193], a[192:195], a[224:227]
    ds_read_b64_tr_b16 a[180:181], v171 offset:49152
    v_mfma_f32_32x32x16_bf16 v[80:95], a[196:199], a[112:115], v[80:95]
    ds_read_b64_tr_b16 a[182:183], v171 offset:49664
    ds_read_b64_tr_b16 a[184:185], v172 offset:49152
    buffer_load_dwordx4 v159, s[56:59], s79 offen lds
    s_add_u32 m0, s94, 81920
    v_mfma_f32_32x32x16_bf16 v[64:79], a[200:203], a[116:119], v[64:79]
    ds_read_b64_tr_b16 a[186:187], v172 offset:49664
    ds_read_b64_tr_b16 a[188:189], v173 offset:49152
    v_mfma_f32_32x32x16_bf16 v[80:95], a[204:207], a[116:119], v[80:95]
    ds_read_b64_tr_b16 a[190:191], v173 offset:49664
    buffer_load_dwordx4 v160, s[56:59], s79 offen lds
    s_add_u32 m0, s94, 86016
    s_waitcnt lgkmcnt(8)
    v_mfma_f32_32x32x16_bf16 v[64:79], a[160:163], a[120:123], v[64:79]
    ds_read_b64_tr_b16 a[192:193], v174 offset:49152
    ds_read_b64_tr_b16 a[194:195], v174 offset:49664
    v_mfma_f32_16x16x32_bf16 a[224:227], v[190:193], a[0:3], a[224:227]
    ds_read_b64_tr_b16 a[196:197], v175 offset:8192
    buffer_load_dwordx4 v161, s[56:59], s79 offen lds
    s_add_u32 m0, s94, 90112
    v_mfma_f32_32x32x16_bf16 v[80:95], a[164:167], a[120:123], v[80:95]
    ds_read_b64_tr_b16 a[198:199], v175 offset:8704
    ds_read_b64_tr_b16 a[200:201], v176 offset:49152
    v_mfma_f32_16x16x32_bf16 a[228:231], v[190:193], a[164:167], a[228:231]
    ds_read_b64_tr_b16 a[202:203], v176 offset:49664
    v_mfma_f32_16x16x32_bf16 a[228:231], v[190:193], a[4:7], a[228:231]
    ds_read_b64_tr_b16 a[204:205], v177 offset:49152
    buffer_load_dwordx4 v162, s[56:59], s79 offen lds
    s_add_u32 m0, s94, 94208
    v_mfma_f32_32x32x16_bf16 v[64:79], a[168:171], a[124:127], v[64:79]
    ds_read_b64_tr_b16 a[206:207], v177 offset:49664
    v_mfma_f32_16x16x32_bf16 a[224:227], v[190:193], a[8:11], a[224:227]
    v_mfma_f32_32x32x16_bf16 v[80:95], a[172:175], a[124:127], v[80:95]
    buffer_load_dwordx4 v163, s[56:59], s79 offen lds
    v_mfma_f32_16x16x32_bf16 a[228:231], v[190:193], a[12:15], a[228:231]
    s_waitcnt vmcnt(8)
    v_cmp_eq_u64 vcc, s[88:89], v[186:187]
    s_nop 1
    s_and_b32 s12, vcc_lo, s17
    s_cmp_eq_u32 s12, s17
    s_cbranch_scc0 L_rt_7
L_ok_6:
    s_waitcnt lgkmcnt(8)
    ds_write_b32 v241, a224 offset:15360
    ds_write_b32 v241, a228 offset:15872
    v_mfma_f32_32x32x16_bf16 v[64:79], a[176:179], a[128:131], v[64:79]
    ds_read_b64_tr_b16 a[160:161], v170 offset:8192
    ds_read_b64_tr_b16 a[162:163], v170 offset:8704
    v_add_u32 v171, 57344, v171
    s_add_u32 s40, s21, 0
    v_mfma_f32_32x32x16_bf16 v[80:95], a[180:183], a[128:131], v[80:95]
    ds_read_b64_tr_b16 a[164:165], v171 offset:0
    ds_read_b64_tr_b16 a[166:167], v171 offset:512
    v_add_u32 v172, 57344, v172
    buffer_load_dwordx4 a[72:75], v147, s[68:71], s40 offen offset:0 sc1
    v_mfma_f32_32x32x16_bf16 v[64:79], a[184:187], a[132:135], v[64:79]
    ds_read_b64_tr_b16 a[168:169], v172 offset:0
    ds_read_b64_tr_b16 a[170:171], v172 offset:512
    v_add_u32 v173, 57344, v173
    buffer_load_dwordx4 a[76:79], v147, s[68:71], s40 offen offset:1024 sc1
    v_mfma_f32_32x32x16_bf16 v[80:95], a[188:191], a[132:135], v[80:95]
    ds_read_b64_tr_b16 a[172:173], v173 offset:0
    ds_read_b64_tr_b16 a[174:175], v173 offset:512
    s_waitcnt lgkmcnt(10)
    v_mfma_f32_32x32x16_bf16 v[64:79], a[192:195], a[136:139], v[64:79]
    v_add_u32 v174, 57344, v174
    ds_read_b64_tr_b16 a[176:177], v174 offset:0
    ds_read_b64_tr_b16 a[178:179], v174 offset:512
    buffer_load_dwordx4 a[80:83], v147, s[68:71], s40 offen offset:2048 sc1
    v_mfma_f32_32x32x16_bf16 v[80:95], a[196:199], a[136:139], v[80:95]
    ds_read_b64_tr_b16 a[180:181], v175 offset:16384
    ds_read_b64_tr_b16 a[182:183], v175 offset:16896
    v_add_u32 v176, 57344, v176
    v_mfma_f32_32x32x16_bf16 v[64:79], a[200:203], a[140:143], v[64:79]
    ds_read_b64_tr_b16 a[184:185], v176 offset:0
    ds_read_b64_tr_b16 a[186:187], v176 offset:512
    v_add_u32 v177, 57344, v177
    buffer_load_dwordx4 a[84:87], v147, s[68:71], s40 offen offset:3072 sc1
    s_add_u32 s40, s21, 4096
    v_mfma_f32_32x32x16_bf16 v[80:95], a[204:207], a[140:143], v[80:95]
    ds_read_b64_tr_b16 a[188:189], v177 offset:0
    ds_read_b64_tr_b16 a[190:191], v177 offset:512
    s_waitcnt lgkmcnt(8)
    v_mfma_f32_32x32x16_bf16 v[64:79], a[160:163], a[144:147], v[64:79]
    buffer_load_dwordx4 a[88:91], v147, s[68:71], s40 offen offset:0 sc1
    s_waitcnt lgkmcnt(0)
    s_barrier
    v_mfma_f32_32x32x16_bf16 v[80:95], a[164:167], a[144:147], v[80:95]
    ds_read_b128 v[136:139], v240 offset:15360
    ds_read_b128 v[140:143], v240 offset:15872
    v_mfma_f32_32x32x16_bf16 v[64:79], a[168:171], a[148:151], v[64:79]
    buffer_load_dwordx4 a[92:95], v147, s[68:71], s40 offen offset:1024 sc1
    s_waitcnt lgkmcnt(1)
    v_add_f32 v136, v136, v137
    v_add_f32 v138, v138, v139
    v_add_f32 v136, v136, v138
    v_and_b32 v137, 0xffff0000, v136
    v_mfma_f32_32x32x16_bf16 v[80:95], a[172:175], a[148:151], v[80:95]
    v_sub_f32 v138, v136, v137
    v_and_b32 v139, 0xffff0000, v138
    v_sub_f32 v138, v138, v139
    v_alignbit_b32 v211, v220, v138, 16
    v_perm_b32 v210, v139, v136, v242
    s_waitcnt lgkmcnt(0)
    v_mfma_f32_32x32x16_bf16 v[64:79], a[176:179], a[152:155], v[64:79]
    buffer_load_dwordx4 a[96:99], v147, s[68:71], s40 offen offset:2048 sc1
    v_add_f32 v140, v140, v141
    v_add_f32 v142, v142, v143
    v_add_f32 v140, v140, v142
    v_and_b32 v141, 0xffff0000, v140
    v_sub_f32 v142, v140, v141
    v_mfma_f32_32x32x16_bf16 v[80:95], a[180:183], a[152:155], v[80:95]
    v_and_b32 v143, 0xffff0000, v142
    v_sub_f32 v142, v142, v143
    v_alignbit_b32 v213, v221, v142, 16
    v_perm_b32 v212, v143, v140, v242
    v_mfma_f32_32x32x16_bf16 v[64:79], a[184:187], a[156:159], v[64:79]
    buffer_load_dwordx4 a[100:103], v147, s[68:71], s40 offen offset:3072 sc1
    v_mfma_f32_32x32x16_bf16 v[80:95], a[188:191], a[156:159], v[80:95]
    v_mfma_f32_32x32x16_bf16 v[64:79], v[210:213], v[198:201], v[64:79]
    v_mfma_f32_32x32x16_bf16 v[80:95], v[212:215], v[198:201], v[80:95]
    s_nop 10
    v_pk_mul_f32 v[222:223], v[64:65], v[246:247] op_sel:[0,1] op_sel_hi:[1,1]
    v_pk_mul_f32 v[224:225], v[66:67], v[246:247] op_sel:[0,1] op_sel_hi:[1,1]
    v_pk_mul_f32 v[226:227], v[68:69], v[246:247] op_sel:[0,1] op_sel_hi:[1,1]
    v_pk_mul_f32 v[228:229], v[70:71], v[246:247] op_sel:[0,1] op_sel_hi:[1,1]
    v_exp_f32 v222, v222
    v_exp_f32 v223, v223
    v_exp_f32 v224, v224
    v_exp_f32 v225, v225
    v_exp_f32 v226, v226
    v_exp_f32 v227, v227
    v_exp_f32 v228, v228
    v_exp_f32 v229, v229
    v_pk_mul_f32 v[64:65], v[64:65], v[246:247] op_sel_hi:[1,0]
    v_pk_mul_f32 v[66:67], v[66:67], v[246:247] op_sel_hi:[1,0]
    v_pk_mul_f32 v[68:69], v[68:69], v[246:247] op_sel_hi:[1,0]
    v_pk_mul_f32 v[70:71], v[70:71], v[246:247] op_sel_hi:[1,0]
    v_pk_fma_f32 v[230:231], v[222:223], -0.5, -1.0 op_sel_hi:[1,0,0]
    v_pk_fma_f32 v[232:233], v[224:225], -0.5, -1.0 op_sel_hi:[1,0,0]
    v_pk_fma_f32 v[234:235], v[226:227], -0.5, -1.0 op_sel_hi:[1,0,0]
    v_pk_fma_f32 v[236:237], v[228:229], -0.5, -1.0 op_sel_hi:[1,0,0]
    v_pk_fma_f32 v[230:231], v[222:223], v[230:231], -1.0 op_sel_hi:[1,1,0]
    v_pk_fma_f32 v[232:233], v[224:225], v[232:233], -1.0 op_sel_hi:[1,1,0]
    v_pk_fma_f32 v[234:235], v[226:227], v[234:235], -1.0 op_sel_hi:[1,1,0]
    v_pk_fma_f32 v[236:237], v[228:229], v[236:237], -1.0 op_sel_hi:[1,1,0]
    v_rcp_f32 v230, v230
    v_rcp_f32 v231, v231
    v_rcp_f32 v232, v232
    v_rcp_f32 v233, v233
    v_rcp_f32 v234, v234
    v_rcp_f32 v235, v235
    v_rcp_f32 v236, v236
    v_rcp_f32 v237, v237
    v_pk_fma_f32 v[64:65], v[64:65], v[230:231], v[64:65]
    v_pk_fma_f32 v[66:67], v[66:67], v[232:233], v[66:67]
    v_pk_fma_f32 v[68:69], v[68:69], v[234:235], v[68:69]
    v_pk_fma_f32 v[70:71], v[70:71], v[236:237], v[70:71]
    v_cvt_pk_bf16_f32 v128, v64, v65
    v_cvt_pk_bf16_f32 v129, v66, v67
    v_cvt_pk_bf16_f32 v130, v68, v69
    v_cvt_pk_bf16_f32 v131, v70, v71
    buffer_store_dwordx4 v[128:131], v147, s[68:71], s41 offen offset:0 sc1
    v_mov_b32 v198, s88
    v_mov_b32 v199, s89
    v_mov_b32 v200, s88
    v_mov_b32 v201, s89
    v_pk_mul_f32 v[222:223], v[72:73], v[246:247] op_sel:[0,1] op_sel_hi:[1,1]
    v_pk_mul_f32 v[224:225], v[74:75], v[246:247] op_sel:[0,1] op_sel_hi:[1,1]
    v_pk_mul_f32 v[226:227], v[76:77], v[246:247] op_sel:[0,1] op_sel_hi:[1,1]
    v_pk_mul_f32 v[228:229], v[78:79], v[246:247] op_sel:[0,1] op_sel_hi:[1,1]
    v_exp_f32 v222, v222
    v_exp_f32 v223, v223
    v_exp_f32 v224, v224
    v_exp_f32 v225, v225
    v_exp_f32 v226, v226
    v_exp_f32 v227, v227
    v_exp_f32 v228, v228
    v_exp_f32 v229, v229
    v_pk_mul_f32 v[72:73], v[72:73], v[246:247] op_sel_hi:[1,0]
    v_pk_mul_f32 v[74:75], v[74:75], v[246:247] op_sel_hi:[1,0]
    v_pk_mul_f32 v[76:77], v[76:77], v[246:247] op_sel_hi:[1,0]
    v_pk_mul_f32 v[78:79], v[78:79], v[246:247] op_sel_hi:[1,0]
    v_pk_fma_f32 v[230:231], v[222:223], -0.5, -1.0 op_sel_hi:[1,0,0]
    v_pk_fma_f32 v[232:233], v[224:225], -0.5, -1.0 op_sel_hi:[1,0,0]
    v_pk_fma_f32 v[234:235], v[226:227], -0.5, -1.0 op_sel_hi:[1,0,0]
    v_pk_fma_f32 v[236:237], v[228:229], -0.5, -1.0 op_sel_hi:[1,0,0]
    v_pk_fma_f32 v[230:231], v[222:223], v[230:231], -1.0 op_sel_hi:[1,1,0]
    v_pk_fma_f32 v[232:233], v[224:225], v[232:233], -1.0 op_sel_hi:[1,1,0]
    v_pk_fma_f32 v[234:235], v[226:227], v[234:235], -1.0 op_sel_hi:[1,1,0]
    v_pk_fma_f32 v[236:237], v[228:229], v[236:237], -1.0 op_sel_hi:[1,1,0]
    v_rcp_f32 v230, v230
    v_rcp_f32 v231, v231
    v_rcp_f32 v232, v232
    v_rcp_f32 v233, v233
    v_rcp_f32 v234, v234
    v_rcp_f32 v235, v235
    v_rcp_f32 v236, v236
    v_rcp_f32 v237, v237
    v_pk_fma_f32 v[72:73], v[72:73], v[230:231], v[72:73]
    v_pk_fma_f32 v[74:75], v[74:75], v[232:233], v[74:75]
    v_pk_fma_f32 v[76:77], v[76:77], v[234:235], v[76:77]
    v_pk_fma_f32 v[78:79], v[78:79], v[236:237], v[78:79]
    v_cvt_pk_bf16_f32 v132, v72, v73
    v_cvt_pk_bf16_f32 v133, v74, v75
    v_cvt_pk_bf16_f32 v134, v76, v77
    v_cvt_pk_bf16_f32 v135, v78, v79
    buffer_store_dwordx4 v[132:135], v147, s[68:71], s41 offen offset:1024 sc1
    v_pk_mul_f32 v[222:223], v[80:81], v[246:247] op_sel:[0,1] op_sel_hi:[1,1]
    v_pk_mul_f32 v[224:225], v[82:83], v[246:247] op_sel:[0,1] op_sel_hi:[1,1]
    v_pk_mul_f32 v[226:227], v[84:85], v[246:247] op_sel:[0,1] op_sel_hi:[1,1]
    v_pk_mul_f32 v[228:229], v[86:87], v[246:247] op_sel:[0,1] op_sel_hi:[1,1]
    v_exp_f32 v222, v222
    v_exp_f32 v223, v223
    v_exp_f32 v224, v224
    v_exp_f32 v225, v225
    v_exp_f32 v226, v226
    v_exp_f32 v227, v227
    v_exp_f32 v228, v228
    v_exp_f32 v229, v229
    v_pk_mul_f32 v[80:81], v[80:81], v[246:247] op_sel_hi:[1,0]
    v_pk_mul_f32 v[82:83], v[82:83], v[246:247] op_sel_hi:[1,0]
    v_pk_mul_f32 v[84:85], v[84:85], v[246:247] op_sel_hi:[1,0]
    v_pk_mul_f32 v[86:87], v[86:87], v[246:247] op_sel_hi:[1,0]
    v_pk_fma_f32 v[230:231], v[222:223], -0.5, -1.0 op_sel_hi:[1,0,0]
    v_pk_fma_f32 v[232:233], v[224:225], -0.5, -1.0 op_sel_hi:[1,0,0]
    v_pk_fma_f32 v[234:235], v[226:227], -0.5, -1.0 op_sel_hi:[1,0,0]
    v_pk_fma_f32 v[236:237], v[228:229], -0.5, -1.0 op_sel_hi:[1,0,0]
    v_pk_fma_f32 v[230:231], v[222:223], v[230:231], -1.0 op_sel_hi:[1,1,0]
    v_pk_fma_f32 v[232:233], v[224:225], v[232:233], -1.0 op_sel_hi:[1,1,0]
    v_pk_fma_f32 v[234:235], v[226:227], v[234:235], -1.0 op_sel_hi:[1,1,0]
    v_pk_fma_f32 v[236:237], v[228:229], v[236:237], -1.0 op_sel_hi:[1,1,0]
    v_rcp_f32 v230, v230
    v_rcp_f32 v231, v231
    v_rcp_f32 v232, v232
    v_rcp_f32 v233, v233
    v_rcp_f32 v234, v234
    v_rcp_f32 v235, v235
    v_rcp_f32 v236, v236
    v_rcp_f32 v237, v237
    v_pk_fma_f32 v[80:81], v[80:81], v[230:231], v[80:81]
    v_pk_fma_f32 v[82:83], v[82:83], v[232:233], v[82:83]
    v_pk_fma_f32 v[84:85], v[84:85], v[234:235], v[84:85]
    v_pk_fma_f32 v[86:87], v[86:87], v[236:237], v[86:87]
    v_cvt_pk_bf16_f32 v136, v80, v81
    v_cvt_pk_bf16_f32 v137, v82, v83
    v_cvt_pk_bf16_f32 v138, v84, v85
    v_cvt_pk_bf16_f32 v139, v86, v87
    buffer_store_dwordx4 v[136:139], v147, s[68:71], s41 offen offset:2048 sc1
    v_pk_mul_f32 v[222:223], v[88:89], v[246:247] op_sel:[0,1] op_sel_hi:[1,1]
    v_pk_mul_f32 v[224:225], v[90:91], v[246:247] op_sel:[0,1] op_sel_hi:[1,1]
    v_pk_mul_f32 v[226:227], v[92:93], v[246:247] op_sel:[0,1] op_sel_hi:[1,1]
    v_pk_mul_f32 v[228:229], v[94:95], v[246:247] op_sel:[0,1] op_sel_hi:[1,1]
    v_exp_f32 v222, v222
    v_exp_f32 v223, v223
    v_exp_f32 v224, v224
    v_exp_f32 v225, v225
    v_exp_f32 v226, v226
    v_exp_f32 v227, v227
    v_exp_f32 v228, v228
    v_exp_f32 v229, v229
    v_pk_mul_f32 v[88:89], v[88:89], v[246:247] op_sel_hi:[1,0]
    v_pk_mul_f32 v[90:91], v[90:91], v[246:247] op_sel_hi:[1,0]
    v_pk_mul_f32 v[92:93], v[92:93], v[246:247] op_sel_hi:[1,0]
    v_pk_mul_f32 v[94:95], v[94:95], v[246:247] op_sel_hi:[1,0]
    v_pk_fma_f32 v[230:231], v[222:223], -0.5, -1.0 op_sel_hi:[1,0,0]
    v_pk_fma_f32 v[232:233], v[224:225], -0.5, -1.0 op_sel_hi:[1,0,0]
    v_pk_fma_f32 v[234:235], v[226:227], -0.5, -1.0 op_sel_hi:[1,0,0]
    v_pk_fma_f32 v[236:237], v[228:229], -0.5, -1.0 op_sel_hi:[1,0,0]
    v_pk_fma_f32 v[230:231], v[222:223], v[230:231], -1.0 op_sel_hi:[1,1,0]
    v_pk_fma_f32 v[232:233], v[224:225], v[232:233], -1.0 op_sel_hi:[1,1,0]
    v_pk_fma_f32 v[234:235], v[226:227], v[234:235], -1.0 op_sel_hi:[1,1,0]
    v_pk_fma_f32 v[236:237], v[228:229], v[236:237], -1.0 op_sel_hi:[1,1,0]
    v_rcp_f32 v230, v230
    v_rcp_f32 v231, v231
    v_rcp_f32 v232, v232
    v_rcp_f32 v233, v233
    v_rcp_f32 v234, v234
    v_rcp_f32 v235, v235
    v_rcp_f32 v236, v236
    v_rcp_f32 v237, v237
    v_pk_fma_f32 v[88:89], v[88:89], v[230:231], v[88:89]
    v_pk_fma_f32 v[90:91], v[90:91], v[232:233], v[90:91]
    v_pk_fma_f32 v[92:93], v[92:93], v[234:235], v[92:93]
    v_pk_fma_f32 v[94:95], v[94:95], v[236:237], v[94:95]
    v_cvt_pk_bf16_f32 v140, v88, v89
    v_cvt_pk_bf16_f32 v141, v90, v91
    v_cvt_pk_bf16_f32 v142, v92, v93
    v_cvt_pk_bf16_f32 v143, v94, v95
    buffer_store_dwordx4 v[140:143], v147, s[68:71], s41 offen offset:3072 sc1
    s_add_u32 s41, s41, 4096
    s_cmp_lt_u32 s6, 2
    s_cbranch_scc1 LM_narrow
    s_cmp_eq_u32 s101, 1
    s_cbranch_scc1 LW_k3
    v_add_u32 v184, 0, v178
    ds_read_b64_tr_b16 a[0:1], v184 offset:0
    ds_read_b64_tr_b16 a[2:3], v184 offset:512
    v_add_u32 v185, 0, v179
    ds_read_b64_tr_b16 a[4:5], v185 offset:0
    ds_read_b64_tr_b16 a[6:7], v185 offset:512
    ds_read_b64_tr_b16 a[8:9], v184 offset:2048
    ds_read_b64_tr_b16 a[10:11], v184 offset:2560
    ds_read_b64_tr_b16 a[12:13], v185 offset:2048
    ds_read_b64_tr_b16 a[14:15], v185 offset:2560
    ds_read_b64_tr_b16 a[16:17], v184 offset:4096
    ds_read_b64_tr_b16 a[18:19], v184 offset:4608
    ds_read_b64_tr_b16 a[20:21], v185 offset:4096
    ds_read_b64_tr_b16 a[22:23], v185 offset:4608
    ds_read_b64_tr_b16 a[24:25], v184 offset:6144
    ds_read_b64_tr_b16 a[26:27], v184 offset:6656
    ds_read_b64_tr_b16 a[28:29], v185 offset:6144
    ds_read_b64_tr_b16 a[30:31], v185 offset:6656
    ds_read_b64_tr_b16 a[32:33], v184 offset:8192
    ds_read_b64_tr_b16 a[34:35], v184 offset:8704
    ds_read_b64_tr_b16 a[36:37], v185 offset:8192
    ds_read_b64_tr_b16 a[38:39], v185 offset:8704
    ds_read_b64_tr_b16 a[40:41], v184 offset:10240
    ds_read_b64_tr_b16 a[42:43], v184 offset:10752
    ds_read_b64_tr_b16 a[44:45], v185 offset:10240
    ds_read_b64_tr_b16 a[46:47], v185 offset:10752
    s_waitcnt lgkmcnt(12)
    v_mfma_f32_32x32x16_bf16 v[32:47], v[96:99], a[0:3], 0
    ds_read_b64_tr_b16 a[48:49], v184 offset:12288
    ds_read_b64_tr_b16 a[50:51], v184 offset:12800
    s_add_u32 s35, s81, s85
    s_add_u32 m0, s94, 98304
    v_mfma_f32_32x32x16_bf16 v[48:63], v[96:99], a[4:7], 0
    ds_read_b64_tr_b16 a[52:53], v185 offset:12288
    ds_read_b64_tr_b16 a[54:55], v185 offset:12800
    buffer_load_dwordx4 v158, s[56:59], s35 offen lds
    s_add_u32 m0, s94, 102400
    v_mfma_f32_32x32x16_bf16 v[32:47], v[100:103], a[8:11], v[32:47]
    ds_read_b64_tr_b16 a[56:57], v184 offset:14336
    ds_read_b64_tr_b16 a[58:59], v184 offset:14848
    buffer_load_dwordx4 v159, s[56:59], s35 offen lds
    s_add_u32 m0, s94, 106496
    v_mfma_f32_32x32x16_bf16 v[48:63], v[100:103], a[12:15], v[48:63]
    ds_read_b64_tr_b16 a[60:61], v185 offset:14336
    ds_read_b64_tr_b16 a[62:63], v185 offset:14848
    v_mfma_f32_32x32x16_bf16 v[32:47], v[104:107], a[16:19], v[32:47]
    ds_read_b64_tr_b16 a[64:65], v184 offset:16384
    ds_read_b64_tr_b16 a[66:67], v184 offset:16896
    buffer_load_dwordx4 v160, s[56:59], s35 offen lds
    s_add_u32 m0, s94, 110592
    v_mfma_f32_32x32x16_bf16 v[48:63], v[104:107], a[20:23], v[48:63]
    ds_read_b64_tr_b16 a[68:69], v185 offset:16384
    ds_read_b64_tr_b16 a[70:71], v185 offset:16896
    s_waitcnt lgkmcnt(12)
    v_mfma_f32_32x32x16_bf16 v[32:47], v[108:111], a[24:27], v[32:47]
    ds_read_b64_tr_b16 a[0:1], v184 offset:18432
    ds_read_b64_tr_b16 a[2:3], v184 offset:18944
    buffer_load_dwordx4 v161, s[56:59], s35 offen lds
    s_add_u32 m0, s94, 114688
    v_mfma_f32_32x32x16_bf16 v[48:63], v[108:111], a[28:31], v[48:63]
    ds_read_b64_tr_b16 a[4:5], v185 offset:18432
    ds_read_b64_tr_b16 a[6:7], v185 offset:18944
    v_mfma_f32_32x32x16_bf16 v[32:47], v[112:115], a[32:35], v[32:47]
    ds_read_b64_tr_b16 a[8:9], v184 offset:20480
    ds_read_b64_tr_b16 a[10:11], v184 offset:20992
    buffer_load_dwordx4 v162, s[56:59], s35 offen lds
    s_add_u32 m0, s94, 118784
    v_mfma_f32_32x32x16_bf16 v[48:63], v[112:115], a[36:39], v[48:63]
    ds_read_b64_tr_b16 a[12:13], v185 offset:20480
    ds_read_b64_tr_b16 a[14:15], v185 offset:20992
    v_mfma_f32_32x32x16_bf16 v[32:47], v[116:119], a[40:43], v[32:47]
    ds_read_b64_tr_b16 a[16:17], v184 offset:22528
    ds_read_b64_tr_b16 a[18:19], v184 offset:23040
    buffer_load_dwordx4 v163, s[56:59], s35 offen lds
    s_add_u32 s35, s81, s86
    s_add_u32 m0, s94, 122880
    v_mfma_f32_32x32x16_bf16 v[48:63], v[116:119], a[44:47], v[48:63]
    ds_read_b64_tr_b16 a[20:21], v185 offset:22528
    ds_read_b64_tr_b16 a[22:23], v185 offset:23040
    s_waitcnt lgkmcnt(12)
    v_mfma_f32_32x32x16_bf16 v[32:47], v[120:123], a[48:51], v[32:47]
    buffer_load_dwordx4 v158, s[56:59], s35 offen lds
    s_add_u32 m0, s94, 126976
    v_mfma_f32_32x32x16_bf16 v[48:63], v[120:123], a[52:55], v[48:63]
    v_mfma_f32_32x32x16_bf16 v[32:47], v[124:127], a[56:59], v[32:47]
    buffer_load_dwordx4 v159, s[56:59], s35 offen lds
    s_add_u32 m0, s94, 131072
    s_waitcnt lgkmcnt(0)
    s_barrier
    v_mfma_f32_32x32x16_bf16 v[48:63], v[124:127], a[60:63], v[48:63]
    v_add_u32 v184, 24576, v178
    ds_read_b64_tr_b16 a[24:25], v184 offset:0
    ds_read_b64_tr_b16 a[26:27], v184 offset:512
    v_add_u32 v185, 24576, v179
    ds_read_b64_tr_b16 a[28:29], v185 offset:0
    v_mfma_f32_32x32x16_bf16 v[32:47], v[128:131], a[64:67], v[32:47]
    ds_read_b64_tr_b16 a[30:31], v185 offset:512
    ds_read_b64_tr_b16 a[32:33], v184 offset:2048
    ds_read_b64_tr_b16 a[34:35], v184 offset:2560
    ds_read_b64_tr_b16 a[36:37], v185 offset:2048
    ds_read_b64_tr_b16 a[38:39], v185 offset:2560
    buffer_load_dwordx4 v160, s[56:59], s35 offen lds
    s_add_u32 m0, s94, 135168
    v_mfma_f32_32x32x16_bf16 v[48:63], v[128:131], a[68:71], v[48:63]
    ds_read_b64_tr_b16 a[40:41], v184 offset:4096
    ds_read_b64_tr_b16 a[42:43], v184 offset:4608
    ds_read_b64_tr_b16 a[44:45], v185 offset:4096
    ds_read_b64_tr_b16 a[46:47], v185 offset:4608
    v_mfma_f32_32x32x16_bf16 v[32:47], v[132:135], a[0:3], v[32:47]
    ds_read_b64_tr_b16 a[48:49], v184 offset:6144
    ds_read_b64_tr_b16 a[50:51], v184 offset:6656
    buffer_load_dwordx4 v161, s[56:59], s35 offen lds
    s_add_u32 m0, s93, 147456
    v_mfma_f32_32x32x16_bf16 v[48:63], v[132:135], a[4:7], v[48:63]
    ds_read_b64_tr_b16 a[52:53], v185 offset:6144
    ds_read_b64_tr_b16 a[54:55], v185 offset:6656
    buffer_load_dwordx4 v148, s[48:51], s30 offen lds
    s_add_u32 m0, s93, 148480
    v_mfma_f32_32x32x16_bf16 v[32:47], v[136:139], a[8:11], v[32:47]
    ds_read_b64_tr_b16 a[56:57], v184 offset:8192
    ds_read_b64_tr_b16 a[58:59], v184 offset:8704
    buffer_load_dwordx4 v149, s[48:51], s30 offen lds
    s_add_u32 m0, s93, 149504
    v_mfma_f32_32x32x16_bf16 v[48:63], v[136:139], a[12:15], v[48:63]
    ds_read_b64_tr_b16 a[60:61], v185 offset:8192
    ds_read_b64_tr_b16 a[62:63], v185 offset:8704
    buffer_load_dwordx4 v150, s[48:51], s30 offen lds
    s_add_u32 m0, s93, 150528
    v_mfma_f32_32x32x16_bf16 v[32:47], v[140:143], a[16:19], v[32:47]
    ds_read_b64_tr_b16 a[64:65], v184 offset:10240
    ds_read_b64_tr_b16 a[66:67], v184 offset:10752
    buffer_load_dwordx4 v151, s[48:51], s30 offen lds
    s_add_u32 m0, s94, 139264
    v_mfma_f32_32x32x16_bf16 v[48:63], v[140:143], a[20:23], v[48:63]
    ds_read_b64_tr_b16 a[68:69], v185 offset:10240
    ds_read_b64_tr_b16 a[70:71], v185 offset:10752
    s_waitcnt lgkmcnt(12)
    v_mfma_f32_32x32x16_bf16 v[64:79], v[96:99], a[24:27], 0
    s_waitcnt vmcnt(14)
    s_lshl_b32 s12, s6, 6
    s_add_u32 s12, s12, s24
    s_mov_b64 exec, 1
    s_add_u32 s96, s12, 589824
    buffer_store_dwordx4 v[198:201], v155, s[68:71], s96 offen
    buffer_store_dwordx4 v[198:201], v155, s[68:71], s12 offen sc1
    s_mov_b64 exec, -1
    v_mfma_f32_32x32x16_bf16 v[80:95], v[96:99], a[28:31], 0
    ds_read_b64_tr_b16 a[0:1], v184 offset:12288
    ds_read_b64_tr_b16 a[2:3], v184 offset:12800
    ds_read_b64_tr_b16 a[4:5], v185 offset:12288
    v_mfma_f32_32x32x16_bf16 v[64:79], v[100:103], a[32:35], v[64:79]
    ds_read_b64_tr_b16 a[6:7], v185 offset:12800
    ds_read_b64_tr_b16 a[8:9], v184 offset:14336
    ds_read_b64_tr_b16 a[10:11], v184 offset:14848
    v_mfma_f32_32x32x16_bf16 v[80:95], v[100:103], a[36:39], v[80:95]
    ds_read_b64_tr_b16 a[12:13], v185 offset:14336
    ds_read_b64_tr_b16 a[14:15], v185 offset:14848
    v_mfma_f32_32x32x16_bf16 v[64:79], v[104:107], a[40:43], v[64:79]
    ds_read_b64_tr_b16 a[16:17], v184 offset:16384
    ds_read_b64_tr_b16 a[18:19], v184 offset:16896
    buffer_load_dwordx4 v162, s[56:59], s35 offen lds
    s_add_u32 m0, s94, 143360
    v_mfma_f32_32x32x16_bf16 v[80:95], v[104:107], a[44:47], v[80:95]
    ds_read_b64_tr_b16 a[20:21], v185 offset:16384
    ds_read_b64_tr_b16 a[22:23], v185 offset:16896
    s_waitcnt lgkmcnt(12)
    v_mfma_f32_32x32x16_bf16 v[64:79], v[108:111], a[48:51], v[64:79]
    ds_read_b64_tr_b16 a[24:25], v184 offset:18432
    ds_read_b64_tr_b16 a[26:27], v184 offset:18944
    buffer_load_dwordx4 v163, s[56:59], s35 offen lds
    s_add_u32 s35, s82, s90
    s_add_u32 m0, s94, 0
    v_mfma_f32_32x32x16_bf16 v[80:95], v[108:111], a[52:55], v[80:95]
    ds_read_b64_tr_b16 a[28:29], v185 offset:18432
    ds_read_b64_tr_b16 a[30:31], v185 offset:18944
    v_mfma_f32_32x32x16_bf16 v[64:79], v[112:115], a[56:59], v[64:79]
    ds_read_b64_tr_b16 a[32:33], v184 offset:20480
    ds_read_b64_tr_b16 a[34:35], v184 offset:20992
    buffer_load_dwordx4 v164, s[60:63], s35 offen offset:0 lds
    s_add_u32 m0, s94, 4096
    v_mfma_f32_32x32x16_bf16 v[80:95], v[112:115], a[60:63], v[80:95]
    ds_read_b64_tr_b16 a[36:37], v185 offset:20480
    ds_read_b64_tr_b16 a[38:39], v185 offset:20992
    v_mfma_f32_32x32x16_bf16 v[64:79], v[116:119], a[64:67], v[64:79]
    ds_read_b64_tr_b16 a[40:41], v184 offset:22528
    ds_read_b64_tr_b16 a[42:43], v184 offset:23040
    buffer_load_dwordx4 v165, s[60:63], s35 offen offset:0 lds
    s_add_u32 m0, s94, 8064
    v_mfma_f32_32x32x16_bf16 v[80:95], v[116:119], a[68:71], v[80:95]
    ds_read_b64_tr_b16 a[44:45], v185 offset:22528
    ds_read_b64_tr_b16 a[46:47], v185 offset:23040
    s_waitcnt lgkmcnt(12)
    v_mfma_f32_32x32x16_bf16 v[64:79], v[120:123], a[0:3], v[64:79]
    buffer_load_dwordx4 v164, s[60:63], s35 offen offset:128 lds
    s_add_u32 m0, s94, 12160
    v_mfma_f32_32x32x16_bf16 v[80:95], v[120:123], a[4:7], v[80:95]
    v_mfma_f32_32x32x16_bf16 v[64:79], v[124:127], a[8:11], v[64:79]
    buffer_load_dwordx4 v165, s[60:63], s35 offen offset:128 lds
    s_add_u32 m0, s94, 16128
    s_waitcnt lgkmcnt(0)
    s_barrier
    v_mfma_f32_32x32x16_bf16 v[80:95], v[124:127], a[12:15], v[80:95]
    v_add_u32 v184, 49152, v178
    ds_read_b64_tr_b16 a[48:49], v184 offset:0
    ds_read_b64_tr_b16 a[50:51], v184 offset:512
    v_add_u32 v185, 49152, v179
    ds_read_b64_tr_b16 a[52:53], v185 offset:0
    v_mfma_f32_32x32x16_bf16 v[64:79], v[128:131], a[16:19], v[64:79]
    ds_read_b64_tr_b16 a[54:55], v185 offset:512
    ds_read_b64_tr_b16 a[56:57], v184 offset:2048
    ds_read_b64_tr_b16 a[58:59], v184 offset:2560
    ds_read_b64_tr_b16 a[60:61], v185 offset:2048
    ds_read_b64_tr_b16 a[62:63], v185 offset:2560
    buffer_load_dwordx4 v164, s[60:63], s35 offen offset:256 lds
    s_add_u32 m0, s94, 20224
    v_mfma_f32_32x32x16_bf16 v[80:95], v[128:131], a[20:23], v[80:95]
    ds_read_b64_tr_b16 a[64:65], v184 offset:4096
    ds_read_b64_tr_b16 a[66:67], v184 offset:4608
    ds_read_b64_tr_b16 a[68:69], v185 offset:4096
    ds_read_b64_tr_b16 a[70:71], v185 offset:4608
    v_mfma_f32_32x32x16_bf16 v[64:79], v[132:135], a[24:27], v[64:79]
    ds_read_b64_tr_b16 a[0:1], v184 offset:6144
    ds_read_b64_tr_b16 a[2:3], v184 offset:6656
    buffer_load_dwordx4 v165, s[60:63], s35 offen offset:256 lds
    s_add_u32 s35, s83, s90
    s_add_u32 m0, s94, 24576
    v_mfma_f32_32x32x16_bf16 v[80:95], v[132:135], a[28:31], v[80:95]
    ds_read_b64_tr_b16 a[4:5], v185 offset:6144
    ds_read_b64_tr_b16 a[6:7], v185 offset:6656
    v_mfma_f32_32x32x16_bf16 v[64:79], v[136:139], a[32:35], v[64:79]
    ds_read_b64_tr_b16 a[8:9], v184 offset:8192
    ds_read_b64_tr_b16 a[10:11], v184 offset:8704
    buffer_load_dwordx4 v164, s[64:67], s35 offen offset:0 lds
    s_add_u32 m0, s94, 28672
    v_mfma_f32_32x32x16_bf16 v[80:95], v[136:139], a[36:39], v[80:95]
    ds_read_b64_tr_b16 a[12:13], v185 offset:8192
    ds_read_b64_tr_b16 a[14:15], v185 offset:8704
    v_mfma_f32_32x32x16_bf16 v[64:79], v[140:143], a[40:43], v[64:79]
    ds_read_b64_tr_b16 a[16:17], v184 offset:10240
    ds_read_b64_tr_b16 a[18:19], v184 offset:10752
    buffer_load_dwordx4 v165, s[64:67], s35 offen offset:0 lds
    s_add_u32 m0, s94, 32640
    v_mfma_f32_32x32x16_bf16 v[80:95], v[140:143], a[44:47], v[80:95]
    ds_read_b64_tr_b16 a[20:21], v185 offset:10240
    ds_read_b64_tr_b16 a[22:23], v185 offset:10752
    s_waitcnt lgkmcnt(12)
    v_mfma_f32_32x32x16_bf16 v[0:15], v[96:99], a[48:51], 0
    buffer_load_dwordx4 v[190:193], v239, s[68:71], s31 offen sc1
    ds_read_b64_tr_b16 a[24:25], v184 offset:12288
    ds_read_b64_tr_b16 a[26:27], v184 offset:12800
    buffer_load_dwordx4 v164, s[64:67], s35 offen offset:128 lds
    s_add_u32 m0, s94, 36736
    v_mfma_f32_32x32x16_bf16 v[16:31], v[96:99], a[52:55], 0
    ds_read_b64_tr_b16 a[28:29], v185 offset:12288
    ds_read_b64_tr_b16 a[30:31], v185 offset:12800
    v_mfma_f32_32x32x16_bf16 v[0:15], v[100:103], a[56:59], v[0:15]
    ds_read_b64_tr_b16 a[32:33], v184 offset:14336
    ds_read_b64_tr_b16 a[34:35], v184 offset:14848
    buffer_load_dwordx4 v165, s[64:67], s35 offen offset:128 lds
    s_add_u32 m0, s94, 40704
    v_mfma_f32_32x32x16_bf16 v[16:31], v[100:103], a[60:63], v[16:31]
    ds_read_b64_tr_b16 a[36:37], v185 offset:14336
    ds_read_b64_tr_b16 a[38:39], v185 offset:14848
    v_mfma_f32_32x32x16_bf16 v[0:15], v[104:107], a[64:67], v[0:15]
    ds_read_b64_tr_b16 a[40:41], v184 offset:16384
    ds_read_b64_tr_b16 a[42:43], v184 offset:16896
    buffer_load_dwordx4 v164, s[64:67], s35 offen offset:256 lds
    s_add_u32 m0, s94, 44800
    v_mfma_f32_32x32x16_bf16 v[16:31], v[104:107], a[68:71], v[16:31]
    ds_read_b64_tr_b16 a[44:45], v185 offset:16384
    ds_read_b64_tr_b16 a[46:47], v185 offset:16896
    s_waitcnt lgkmcnt(12)
    v_mfma_f32_32x32x16_bf16 v[0:15], v[108:111], a[0:3], v[0:15]
    ds_read_b64_tr_b16 a[48:49], v184 offset:18432
    ds_read_b64_tr_b16 a[50:51], v184 offset:18944
    buffer_load_dwordx4 v165, s[64:67], s35 offen offset:256 lds
    v_mfma_f32_32x32x16_bf16 v[16:31], v[108:111], a[4:7], v[16:31]
    ds_read_b64_tr_b16 a[52:53], v185 offset:18432
    ds_read_b64_tr_b16 a[54:55], v185 offset:18944
    v_mfma_f32_32x32x16_bf16 v[0:15], v[112:115], a[8:11], v[0:15]
    ds_read_b64_tr_b16 a[56:57], v184 offset:20480
    ds_read_b64_tr_b16 a[58:59], v184 offset:20992
    v_mfma_f32_32x32x16_bf16 v[16:31], v[112:115], a[12:15], v[16:31]
    ds_read_b64_tr_b16 a[60:61], v185 offset:20480
    ds_read_b64_tr_b16 a[62:63], v185 offset:20992
    v_mfma_f32_32x32x16_bf16 v[0:15], v[116:119], a[16:19], v[0:15]
    ds_read_b64_tr_b16 a[64:65], v184 offset:22528
    ds_read_b64_tr_b16 a[66:67], v184 offset:23040
    v_mfma_f32_32x32x16_bf16 v[16:31], v[116:119], a[20:23], v[16:31]
    ds_read_b64_tr_b16 a[68:69], v185 offset:22528
    ds_read_b64_tr_b16 a[70:71], v185 offset:23040
    s_waitcnt lgkmcnt(12)
    v_mfma_f32_32x32x16_bf16 v[0:15], v[120:123], a[24:27], v[0:15]
    v_mfma_f32_32x32x16_bf16 v[16:31], v[120:123], a[28:31], v[16:31]
    v_mfma_f32_32x32x16_bf16 v[0:15], v[124:127], a[32:35], v[0:15]
    s_waitcnt lgkmcnt(0)
    s_barrier
    v_mfma_f32_32x32x16_bf16 v[16:31], v[124:127], a[36:39], v[16:31]
    v_add_u32 v184, 73728, v178
    ds_read_b64_tr_b16 a[0:1], v184 offset:0
    ds_read_b64_tr_b16 a[2:3], v184 offset:512
    v_add_u32 v185, 73728, v179
    ds_read_b64_tr_b16 a[4:5], v185 offset:0
    s_add_u32 s35, s82, s91
    s_add_u32 m0, s94, 49152
    v_mfma_f32_32x32x16_bf16 v[0:15], v[128:131], a[40:43], v[0:15]
    ds_read_b64_tr_b16 a[6:7], v185 offset:512
    ds_read_b64_tr_b16 a[8:9], v184 offset:2048
    ds_read_b64_tr_b16 a[10:11], v184 offset:2560
    ds_read_b64_tr_b16 a[12:13], v185 offset:2048
    ds_read_b64_tr_b16 a[14:15], v185 offset:2560
    buffer_load_dwordx4 v164, s[60:63], s35 offen offset:0 lds
    s_add_u32 m0, s94, 53248
    v_mfma_f32_32x32x16_bf16 v[16:31], v[128:131], a[44:47], v[16:31]
    ds_read_b64_tr_b16 a[16:17], v184 offset:4096
    ds_read_b64_tr_b16 a[18:19], v184 offset:4608
    ds_read_b64_tr_b16 a[20:21], v185 offset:4096
    ds_read_b64_tr_b16 a[22:23], v185 offset:4608
    buffer_load_dwordx4 v165, s[60:63], s35 offen offset:0 lds
    s_add_u32 m0, s94, 57216
    v_mfma_f32_32x32x16_bf16 v[0:15], v[132:135], a[48:51], v[0:15]
    s_waitcnt vmcnt(6)
    v_cmp_eq_u64 vcc, s[88:89], v[192:193]
    s_nop 1
    s_and_b32 s12, vcc_lo, s17
    s_cmp_eq_u32 s12, s17
    s_cbranch_scc0 L_rt_9
L_ok_8:
    v_mfma_f32_32x32x16_bf16 v[16:31], v[132:135], a[52:55], v[16:31]
    ds_read_b64_tr_b16 a[24:25], v184 offset:6144
    ds_read_b64_tr_b16 a[26:27], v184 offset:6656
    ds_read_b64_tr_b16 a[28:29], v185 offset:6144
    buffer_load_dwordx4 v164, s[60:63], s35 offen offset:128 lds
    s_add_u32 s40, s21, 8192
    v_mfma_f32_32x32x16_bf16 v[0:15], v[136:139], a[56:59], v[0:15]
    ds_read_b64_tr_b16 a[30:31], v185 offset:6656
    ds_read_b64_tr_b16 a[32:33], v184 offset:8192
    ds_read_b64_tr_b16 a[34:35], v184 offset:8704
    s_add_u32 s15, s93, 147456
    v_add_u32 v148, s15, v180
    v_mfma_f32_32x32x16_bf16 v[16:31], v[136:139], a[60:63], v[16:31]
    ds_read_b64_tr_b16 a[36:37], v185 offset:8192
    ds_read_b64_tr_b16 a[38:39], v185 offset:8704
    buffer_load_dwordx4 a[104:107], v147, s[68:71], s40 offen offset:0 sc1
    ds_read_b128 v[202:205], v148
    v_add_u32 v148, s15, v181
    ds_read_b128 v[206:209], v148
    v_mfma_f32_32x32x16_bf16 v[0:15], v[140:143], a[64:67], v[0:15]
    ds_read_b64_tr_b16 a[40:41], v184 offset:10240
    ds_read_b64_tr_b16 a[42:43], v184 offset:10752
    v_add_u32 v148, s15, v182
    ds_read_b128 v[210:213], v148
    v_add_u32 v148, s15, v183
    ds_read_b128 v[214:217], v148
    v_mfma_f32_32x32x16_bf16 v[16:31], v[140:143], a[68:71], v[16:31]
    ds_read_b64_tr_b16 a[44:45], v185 offset:10240
    ds_read_b64_tr_b16 a[46:47], v185 offset:10752
    buffer_load_dwordx4 a[108:111], v147, s[68:71], s40 offen offset:1024 sc1
    v_lshl_add_u32 v149, v145, 1, s30
    v_min_u32 v149, 1214, v149
    s_waitcnt lgkmcnt(15)
    v_mfma_f32_32x32x16_bf16 v[32:47], a[72:75], a[0:3], v[32:47]
    buffer_load_dwordx4 a[112:115], v147, s[68:71], s40 offen offset:2048 sc1
    v_mfma_f32_32x32x16_bf16 v[48:63], a[72:75], a[4:7], v[48:63]
    v_mfma_f32_32x32x16_bf16 v[32:47], a[76:79], a[8:11], v[32:47]
    global_load_ushort v152, v149, s[32:33] offset:0
    s_waitcnt lgkmcnt(0)
    s_barrier
    v_mfma_f32_32x32x16_bf16 v[48:63], a[76:79], a[12:15], v[48:63]
    ds_read_b64_tr_b16 a[48:49], v184 offset:12288
    ds_read_b64_tr_b16 a[50:51], v184 offset:12800
    ds_read_b64_tr_b16 a[52:53], v185 offset:12288
    ds_read_b64_tr_b16 a[54:55], v185 offset:12800
    ds_read_b64_tr_b16 a[56:57], v184 offset:14336
    global_load_ushort v153, v149, s[32:33] offset:64
    v_mfma_f32_32x32x16_bf16 v[32:47], a[80:83], a[16:19], v[32:47]
    ds_read_b64_tr_b16 a[58:59], v184 offset:14848
    ds_read_b64_tr_b16 a[60:61], v185 offset:14336
    ds_read_b64_tr_b16 a[62:63], v185 offset:14848
    v_add_u32 v184, 98304, v178
    ds_read_b64_tr_b16 a[64:65], v184 offset:0
    buffer_load_dwordx4 a[116:119], v147, s[68:71], s40 offen offset:3072 sc1
    s_add_u32 m0, s94, 61312
    v_mfma_f32_32x32x16_bf16 v[48:63], a[80:83], a[20:23], v[48:63]
    ds_read_b64_tr_b16 a[66:67], v184 offset:512
    v_add_u32 v185, 98304, v179
    ds_read_b64_tr_b16 a[68:69], v185 offset:0
    ds_read_b64_tr_b16 a[70:71], v185 offset:512
    v_and_b32 v150, 1, v145
    v_lshlrev_b32 v150, 4, v150
    v_mfma_f32_32x32x16_bf16 v[32:47], a[84:87], a[24:27], v[32:47]
    ds_read_b64_tr_b16 a[0:1], v184 offset:2048
    ds_read_b64_tr_b16 a[2:3], v184 offset:2560
    v_mov_b32 v151, 0x3f80
    v_lshlrev_b32 v151, v150, v151
    v_lshrrev_b32 v148, 1, v145
    v_lshlrev_b32 v149, 2, v146
    v_mfma_f32_32x32x16_bf16 v[48:63], a[84:87], a[28:31], v[48:63]
    ds_read_b64_tr_b16 a[4:5], v185 offset:2048
    ds_read_b64_tr_b16 a[6:7], v185 offset:2560
    buffer_load_dwordx4 v165, s[60:63], s35 offen offset:128 lds
    s_add_u32 m0, s94, 65280
    v_sub_u32 v148, v148, v149
    v_mul_f32 v195, v194, v196
    v_mfma_f32_32x32x16_bf16 v[32:47], a[88:91], a[32:35], v[32:47]
    ds_read_b64_tr_b16 a[8:9], v184 offset:4096
    ds_read_b64_tr_b16 a[10:11], v184 offset:4608
    v_mfma_f32_32x32x16_bf16 v[48:63], a[88:91], a[36:39], v[48:63]
    ds_read_b64_tr_b16 a[12:13], v185 offset:4096
    ds_read_b64_tr_b16 a[14:15], v185 offset:4608
    buffer_load_dwordx4 v164, s[60:63], s35 offen offset:256 lds
    s_add_u32 m0, s94, 69376
    v_mfma_f32_32x32x16_bf16 v[32:47], a[92:95], a[40:43], v[32:47]
    ds_read_b64_tr_b16 a[16:17], v184 offset:6144
    ds_read_b64_tr_b16 a[18:19], v184 offset:6656
    v_mfma_f32_32x32x16_bf16 v[48:63], a[92:95], a[44:47], v[48:63]
    ds_read_b64_tr_b16 a[20:21], v185 offset:6144
    ds_read_b64_tr_b16 a[22:23], v185 offset:6656
    buffer_load_dwordx4 v165, s[60:63], s35 offen offset:256 lds
    s_waitcnt lgkmcnt(12)
    v_mfma_f32_32x32x16_bf16 v[32:47], a[96:99], a[48:51], v[32:47]
    ds_read_b64_tr_b16 a[24:25], v184 offset:8192
    ds_read_b64_tr_b16 a[26:27], v184 offset:8704
    v_mfma_f32_32x32x16_bf16 v[48:63], a[96:99], a[52:55], v[48:63]
    ds_read_b64_tr_b16 a[28:29], v185 offset:8192
    ds_read_b64_tr_b16 a[30:31], v185 offset:8704
    v_mfma_f32_32x32x16_bf16 v[32:47], a[100:103], a[56:59], v[32:47]
    ds_read_b64_tr_b16 a[32:33], v184 offset:10240
    ds_read_b64_tr_b16 a[34:35], v184 offset:10752
    v_mfma_f32_32x32x16_bf16 v[48:63], a[100:103], a[60:63], v[48:63]
    ds_read_b64_tr_b16 a[36:37], v185 offset:10240
    ds_read_b64_tr_b16 a[38:39], v185 offset:10752
    v_mfma_f32_32x32x16_bf16 v[64:79], a[72:75], a[64:67], v[64:79]
    ds_read_b64_tr_b16 a[40:41], v184 offset:12288
    ds_read_b64_tr_b16 a[42:43], v184 offset:12800
    v_mfma_f32_32x32x16_bf16 v[80:95], a[72:75], a[68:71], v[80:95]
    ds_read_b64_tr_b16 a[44:45], v185 offset:12288
    ds_read_b64_tr_b16 a[46:47], v185 offset:12800
    s_waitcnt lgkmcnt(12)
    v_mfma_f32_32x32x16_bf16 v[64:79], a[76:79], a[0:3], v[64:79]
    ds_read_b64_tr_b16 a[48:49], v184 offset:14336
    ds_read_b64_tr_b16 a[50:51], v184 offset:14848
    ds_read_b64_tr_b16 a[52:53], v185 offset:14336
    v_mfma_f32_32x32x16_bf16 v[80:95], a[76:79], a[4:7], v[80:95]
    ds_read_b64_tr_b16 a[54:55], v185 offset:14848
    v_add_u32 v184, 122880, v178
    ds_read_b64_tr_b16 a[56:57], v184 offset:0
    v_mfma_f32_32x32x16_bf16 v[64:79], a[80:83], a[8:11], v[64:79]
    ds_read_b64_tr_b16 a[58:59], v184 offset:512
    v_add_u32 v185, 122880, v179
    v_mfma_f32_32x32x16_bf16 v[80:95], a[80:83], a[12:15], v[80:95]
    ds_read_b64_tr_b16 a[60:61], v185 offset:0
    ds_read_b64_tr_b16 a[62:63], v185 offset:512
    v_mfma_f32_32x32x16_bf16 v[64:79], a[84:87], a[16:19], v[64:79]
    ds_read_b64_tr_b16 a[64:65], v184 offset:2048
    ds_read_b64_tr_b16 a[66:67], v184 offset:2560
    v_mfma_f32_32x32x16_bf16 v[80:95], a[84:87], a[20:23], v[80:95]
    ds_read_b64_tr_b16 a[68:69], v185 offset:2048
    ds_read_b64_tr_b16 a[70:71], v185 offset:2560
    s_waitcnt lgkmcnt(12)
    v_mfma_f32_32x32x16_bf16 v[64:79], a[88:91], a[24:27], v[64:79]
    buffer_load_dwordx4 v[190:193], v239, s[68:71], s31 offen sc1
    ds_read_b64_tr_b16 a[0:1], v184 offset:4096
    ds_read_b64_tr_b16 a[2:3], v184 offset:4608
    v_mfma_f32_32x32x16_bf16 v[80:95], a[88:91], a[28:31], v[80:95]
    ds_read_b64_tr_b16 a[4:5], v185 offset:4096
    ds_read_b64_tr_b16 a[6:7], v185 offset:4608
    v_mfma_f32_32x32x16_bf16 v[64:79], a[92:95], a[32:35], v[64:79]
    ds_read_b64_tr_b16 a[8:9], v184 offset:6144
    ds_read_b64_tr_b16 a[10:11], v184 offset:6656
    v_mfma_f32_32x32x16_bf16 v[80:95], a[92:95], a[36:39], v[80:95]
    ds_read_b64_tr_b16 a[12:13], v185 offset:6144
    ds_read_b64_tr_b16 a[14:15], v185 offset:6656
    v_mfma_f32_32x32x16_bf16 v[64:79], a[96:99], a[40:43], v[64:79]
    ds_read_b64_tr_b16 a[16:17], v184 offset:8192
    ds_read_b64_tr_b16 a[18:19], v184 offset:8704
    v_mfma_f32_32x32x16_bf16 v[80:95], a[96:99], a[44:47], v[80:95]
    ds_read_b64_tr_b16 a[20:21], v185 offset:8192
    ds_read_b64_tr_b16 a[22:23], v185 offset:8704
    s_waitcnt lgkmcnt(12)
    v_mfma_f32_32x32x16_bf16 v[64:79], a[100:103], a[48:51], v[64:79]
    ds_read_b64_tr_b16 a[24:25], v184 offset:10240
    ds_read_b64_tr_b16 a[26:27], v184 offset:10752
    s_waitcnt vmcnt(5)
    v_lshlrev_b32 v152, v150, v152
    v_lshlrev_b32 v153, v150, v153
    v_mfma_f32_32x32x16_bf16 v[80:95], a[100:103], a[52:55], v[80:95]
    ds_read_b64_tr_b16 a[28:29], v185 offset:10240
    ds_read_b64_tr_b16 a[30:31], v185 offset:10752
    v_cmp_eq_u32 s[76:77], 0, v148
    v_lshlrev_b32 v248, 16, v202
    v_and_b32 v249, 0xffff0000, v202
    v_cndmask_b32 v166, 0, v151, s[76:77]
    v_mfma_f32_32x32x16_bf16 v[0:15], a[72:75], a[56:59], v[0:15]
    ds_read_b64_tr_b16 a[32:33], v184 offset:12288
    ds_read_b64_tr_b16 a[34:35], v184 offset:12800
    v_cndmask_b32 v174, 0, v152, s[76:77]
    v_cndmask_b32 v240, 0, v153, s[76:77]
    v_fma_f32 v248, v248, v196, -v195
    v_fma_f32 v249, v249, v196, -v195
    v_mfma_f32_32x32x16_bf16 v[16:31], a[72:75], a[60:63], v[16:31]
    ds_read_b64_tr_b16 a[36:37], v185 offset:12288
    ds_read_b64_tr_b16 a[38:39], v185 offset:12800
    v_cvt_pk_bf16_f32 v218, v248, v249
    v_cmp_eq_u32 s[76:77], 1, v148
    v_lshlrev_b32 v248, 16, v203
    v_and_b32 v249, 0xffff0000, v203
    v_mfma_f32_32x32x16_bf16 v[0:15], a[76:79], a[64:67], v[0:15]
    ds_read_b64_tr_b16 a[40:41], v184 offset:14336
    ds_read_b64_tr_b16 a[42:43], v184 offset:14848
    v_cndmask_b32 v167, 0, v151, s[76:77]
    v_cndmask_b32 v175, 0, v152, s[76:77]
    v_cndmask_b32 v241, 0, v153, s[76:77]
    v_fma_f32 v248, v248, v196, -v195
    v_mfma_f32_32x32x16_bf16 v[16:31], a[76:79], a[68:71], v[16:31]
    ds_read_b64_tr_b16 a[44:45], v185 offset:14336
    ds_read_b64_tr_b16 a[46:47], v185 offset:14848
    v_fma_f32 v249, v249, v196, -v195
    v_cvt_pk_bf16_f32 v219, v248, v249
    v_cmp_eq_u32 s[76:77], 2, v148
    v_lshlrev_b32 v248, 16, v204
    s_waitcnt lgkmcnt(12)
    v_mfma_f32_32x32x16_bf16 v[0:15], a[80:83], a[0:3], v[0:15]
    v_add_u32 v184, 73728, v178
    ds_read_b64_tr_b16 a[48:49], v184 offset:16384
    ds_read_b64_tr_b16 a[50:51], v184 offset:16896
    v_and_b32 v249, 0xffff0000, v204
    v_cndmask_b32 v168, 0, v151, s[76:77]
    v_cndmask_b32 v176, 0, v152, s[76:77]
    v_mfma_f32_32x32x16_bf16 v[16:31], a[80:83], a[4:7], v[16:31]
    v_add_u32 v185, 73728, v179
    ds_read_b64_tr_b16 a[52:53], v185 offset:16384
    ds_read_b64_tr_b16 a[54:55], v185 offset:16896
    v_cndmask_b32 v242, 0, v153, s[76:77]
    v_fma_f32 v248, v248, v196, -v195
    v_fma_f32 v249, v249, v196, -v195
    v_mfma_f32_32x32x16_bf16 v[0:15], a[84:87], a[8:11], v[0:15]
    ds_read_b64_tr_b16 a[56:57], v184 offset:18432
    ds_read_b64_tr_b16 a[58:59], v184 offset:18944
    v_cvt_pk_bf16_f32 v220, v248, v249
    v_cmp_eq_u32 s[76:77], 3, v148
    v_lshlrev_b32 v248, 16, v205
    v_and_b32 v249, 0xffff0000, v205
    v_mfma_f32_32x32x16_bf16 v[16:31], a[84:87], a[12:15], v[16:31]
    ds_read_b64_tr_b16 a[60:61], v185 offset:18432
    ds_read_b64_tr_b16 a[62:63], v185 offset:18944
    v_cndmask_b32 v169, 0, v151, s[76:77]
    v_cndmask_b32 v177, 0, v152, s[76:77]
    v_cndmask_b32 v243, 0, v153, s[76:77]
    v_fma_f32 v248, v248, v196, -v195
    v_mfma_f32_32x32x16_bf16 v[0:15], a[88:91], a[16:19], v[0:15]
    ds_read_b64_tr_b16 a[64:65], v184 offset:20480
    ds_read_b64_tr_b16 a[66:67], v184 offset:20992
    v_fma_f32 v249, v249, v196, -v195
    v_cvt_pk_bf16_f32 v221, v248, v249
    v_cmp_eq_u32 s[76:77], 8, v148
    v_lshlrev_b32 v248, 16, v206
    v_mfma_f32_32x32x16_bf16 v[16:31], a[88:91], a[20:23], v[16:31]
    ds_read_b64_tr_b16 a[68:69], v185 offset:20480
    ds_read_b64_tr_b16 a[70:71], v185 offset:20992
    v_and_b32 v249, 0xffff0000, v206
    v_cndmask_b32 v170, 0, v151, s[76:77]
    v_cndmask_b32 v234, 0, v152, s[76:77]
    v_cndmask_b32 v244, 0, v153, s[76:77]
    s_waitcnt lgkmcnt(12)
    v_mfma_f32_32x32x16_bf16 v[0:15], a[92:95], a[24:27], v[0:15]
    s_waitcnt vmcnt(0)
    v_cmp_eq_u64 vcc, s[88:89], v[190:191]
    s_nop 1
    s_and_b32 s12, vcc_lo, s18
    s_cmp_eq_u32 s12, s18
    s_cbranch_scc0 L_rt_11
L_ok_10:
    v_mfma_f32_32x32x16_bf16 v[16:31], a[92:95], a[28:31], v[16:31]
    ds_read_b64_tr_b16 a[0:1], v184 offset:22528
    ds_read_b64_tr_b16 a[2:3], v184 offset:23040
    ds_read_b64_tr_b16 a[4:5], v185 offset:22528
    s_add_u32 s40, s22, 0
    v_fma_f32 v248, v248, v196, -v195
    v_fma_f32 v249, v249, v196, -v195
    v_mfma_f32_32x32x16_bf16 v[0:15], a[96:99], a[32:35], v[0:15]
    ds_read_b64_tr_b16 a[6:7], v185 offset:23040
    v_add_u32 v184, 98304, v178
    ds_read_b64_tr_b16 a[8:9], v184 offset:16384
    buffer_load_dwordx4 a[120:123], v147, s[68:71], s40 offen offset:0 sc1
    v_cvt_pk_bf16_f32 v222, v248, v249
    v_cmp_eq_u32 s[76:77], 9, v148
    v_mfma_f32_32x32x16_bf16 v[16:31], a[96:99], a[36:39], v[16:31]
    ds_read_b64_tr_b16 a[10:11], v184 offset:16896
    v_add_u32 v185, 98304, v179
    ds_read_b64_tr_b16 a[12:13], v185 offset:16384
    buffer_load_dwordx4 a[124:127], v147, s[68:71], s40 offen offset:1024 sc1
    v_lshlrev_b32 v248, 16, v207
    v_and_b32 v249, 0xffff0000, v207
    v_mfma_f32_32x32x16_bf16 v[0:15], a[100:103], a[40:43], v[0:15]
    ds_read_b64_tr_b16 a[14:15], v185 offset:16896
    ds_read_b64_tr_b16 a[16:17], v184 offset:18432
    ds_read_b64_tr_b16 a[18:19], v184 offset:18944
    buffer_load_dwordx4 a[128:131], v147, s[68:71], s40 offen offset:2048 sc1
    v_cndmask_b32 v171, 0, v151, s[76:77]
    v_cndmask_b32 v235, 0, v152, s[76:77]
    v_mfma_f32_32x32x16_bf16 v[16:31], a[100:103], a[44:47], v[16:31]
    ds_read_b64_tr_b16 a[20:21], v185 offset:18432
    ds_read_b64_tr_b16 a[22:23], v185 offset:18944
    buffer_load_dwordx4 a[132:135], v147, s[68:71], s40 offen offset:3072 sc1
    s_add_u32 s40, s22, 6144
    v_cndmask_b32 v245, 0, v153, s[76:77]
    v_fma_f32 v248, v248, v196, -v195
    s_waitcnt lgkmcnt(12)
    v_mfma_f32_32x32x16_bf16 v[32:47], a[104:107], a[48:51], v[32:47]
    buffer_load_dwordx4 a[144:147], v147, s[68:71], s40 offen offset:0 sc1
    v_fma_f32 v249, v249, v196, -v195
    v_cvt_pk_bf16_f32 v223, v248, v249
    v_cmp_eq_u32 s[76:77], 10, v148
    v_lshlrev_b32 v248, 16, v208
    v_and_b32 v249, 0xffff0000, v208
    v_mfma_f32_32x32x16_bf16 v[48:63], a[104:107], a[52:55], v[48:63]
    buffer_load_dwordx4 a[148:151], v147, s[68:71], s40 offen offset:1024 sc1
    v_cndmask_b32 v172, 0, v151, s[76:77]
    v_cndmask_b32 v236, 0, v152, s[76:77]
    v_cndmask_b32 v246, 0, v153, s[76:77]
    v_fma_f32 v248, v248, v196, -v195
    v_fma_f32 v249, v249, v196, -v195
    v_mfma_f32_32x32x16_bf16 v[32:47], a[108:111], a[56:59], v[32:47]
    buffer_load_dwordx4 a[152:155], v147, s[68:71], s40 offen offset:2048 sc1
    v_cvt_pk_bf16_f32 v224, v248, v249
    v_cmp_eq_u32 s[76:77], 11, v148
    v_lshlrev_b32 v248, 16, v209
    v_and_b32 v249, 0xffff0000, v209
    v_cndmask_b32 v173, 0, v151, s[76:77]
    s_waitcnt lgkmcnt(0)
    s_barrier
    v_mfma_f32_32x32x16_bf16 v[48:63], a[108:111], a[60:63], v[48:63]
    ds_read_b64_tr_b16 a[24:25], v184 offset:20480
    ds_read_b64_tr_b16 a[26:27], v184 offset:20992
    ds_read_b64_tr_b16 a[28:29], v185 offset:20480
    ds_read_b64_tr_b16 a[30:31], v185 offset:20992
    ds_read_b64_tr_b16 a[32:33], v184 offset:22528
    buffer_load_dwordx4 a[156:159], v147, s[68:71], s40 offen offset:3072 sc1
    s_add_u32 s40, s23, 0
    v_mfma_f32_32x32x16_bf16 v[32:47], a[112:115], a[64:67], v[32:47]
    ds_read_b64_tr_b16 a[34:35], v184 offset:23040
    ds_read_b64_tr_b16 a[36:37], v185 offset:22528
    ds_read_b64_tr_b16 a[38:39], v185 offset:23040
    v_add_u32 v184, 122880, v178
    ds_read_b64_tr_b16 a[40:41], v184 offset:16384
    buffer_load_dwordx4 a[168:171], v147, s[68:71], s40 offen offset:0 sc1
    v_mfma_f32_32x32x16_bf16 v[48:63], a[112:115], a[68:71], v[48:63]
    ds_read_b64_tr_b16 a[42:43], v184 offset:16896
    v_add_u32 v185, 122880, v179
    ds_read_b64_tr_b16 a[44:45], v185 offset:16384
    ds_read_b64_tr_b16 a[46:47], v185 offset:16896
    v_cndmask_b32 v237, 0, v152, s[76:77]
    v_cndmask_b32 v247, 0, v153, s[76:77]
    v_mfma_f32_32x32x16_bf16 v[32:47], a[116:119], a[0:3], v[32:47]
    buffer_load_dwordx4 a[172:175], v147, s[68:71], s40 offen offset:1024 sc1
    v_fma_f32 v248, v248, v196, -v195
    v_fma_f32 v249, v249, v196, -v195
    v_cvt_pk_bf16_f32 v225, v248, v249
    v_lshlrev_b32 v248, 16, v210
    v_and_b32 v249, 0xffff0000, v210
    v_mfma_f32_32x32x16_bf16 v[48:63], a[116:119], a[4:7], v[48:63]
    v_fma_f32 v248, v248, v196, -v195
    v_fma_f32 v249, v249, v196, -v195
    v_cvt_pk_bf16_f32 v226, v248, v249
    v_lshlrev_b32 v248, 16, v211
    v_and_b32 v249, 0xffff0000, v211
    v_fma_f32 v248, v248, v196, -v195
    v_mfma_f32_32x32x16_bf16 v[64:79], a[104:107], a[8:11], v[64:79]
    buffer_load_dwordx4 a[176:179], v147, s[68:71], s40 offen offset:2048 sc1
    v_fma_f32 v249, v249, v196, -v195
    v_cvt_pk_bf16_f32 v227, v248, v249
    v_lshlrev_b32 v248, 16, v212
    v_and_b32 v249, 0xffff0000, v212
    v_fma_f32 v248, v248, v196, -v195
    s_waitcnt lgkmcnt(0)
    s_barrier
    v_mfma_f32_32x32x16_bf16 v[80:95], a[104:107], a[12:15], v[80:95]
    ds_read_b64_tr_b16 a[48:49], v184 offset:18432
    ds_read_b64_tr_b16 a[50:51], v184 offset:18944
    ds_read_b64_tr_b16 a[52:53], v185 offset:18432
    ds_read_b64_tr_b16 a[54:55], v185 offset:18944
    v_fma_f32 v249, v249, v196, -v195
    v_cvt_pk_bf16_f32 v228, v248, v249
    v_mfma_f32_32x32x16_bf16 v[64:79], a[108:111], a[16:19], v[64:79]
    ds_read_b64_tr_b16 a[56:57], v184 offset:20480
    ds_read_b64_tr_b16 a[58:59], v184 offset:20992
    ds_read_b64_tr_b16 a[60:61], v185 offset:20480
    ds_read_b64_tr_b16 a[62:63], v185 offset:20992
    buffer_load_dwordx4 a[180:183], v147, s[68:71], s40 offen offset:3072 sc1
    s_add_u32 s40, s23, 6144
    v_mfma_f32_32x32x16_bf16 v[80:95], a[108:111], a[20:23], v[80:95]
    ds_read_b64_tr_b16 a[64:65], v184 offset:22528
    ds_read_b64_tr_b16 a[66:67], v184 offset:23040
    ds_read_b64_tr_b16 a[68:69], v185 offset:22528
    ds_read_b64_tr_b16 a[70:71], v185 offset:23040
    v_lshlrev_b32 v248, 16, v213
    v_and_b32 v249, 0xffff0000, v213
    v_mfma_f32_32x32x16_bf16 v[64:79], a[112:115], a[24:27], v[64:79]
    buffer_load_dwordx4 a[192:195], v147, s[68:71], s40 offen offset:0 sc1
    v_fma_f32 v248, v248, v196, -v195
    v_fma_f32 v249, v249, v196, -v195
    v_cvt_pk_bf16_f32 v229, v248, v249
    v_lshlrev_b32 v248, 16, v214
    v_and_b32 v249, 0xffff0000, v214
    v_mfma_f32_32x32x16_bf16 v[80:95], a[112:115], a[28:31], v[80:95]
    v_fma_f32 v248, v248, v196, -v195
    v_fma_f32 v249, v249, v196, -v195
    v_cvt_pk_bf16_f32 v230, v248, v249
    v_lshlrev_b32 v248, 16, v215
    v_and_b32 v249, 0xffff0000, v215
    v_fma_f32 v248, v248, v196, -v195
    v_mfma_f32_32x32x16_bf16 v[64:79], a[116:119], a[32:35], v[64:79]
    buffer_load_dwordx4 a[196:199], v147, s[68:71], s40 offen offset:1024 sc1
    v_fma_f32 v249, v249, v196, -v195
    v_cvt_pk_bf16_f32 v231, v248, v249
    v_lshlrev_b32 v248, 16, v216
    v_and_b32 v249, 0xffff0000, v216
    v_fma_f32 v248, v248, v196, -v195
    s_waitcnt lgkmcnt(0)
    s_barrier
    v_mfma_f32_32x32x16_bf16 v[80:95], a[116:119], a[36:39], v[80:95]
    v_add_u32 v186, 0, v180
    ds_read_b128 a[0:3], v186 offset:0
    ds_read_b128 a[4:7], v186 offset:4096
    v_fma_f32 v249, v249, v196, -v195
    v_cvt_pk_bf16_f32 v232, v248, v249
    v_lshlrev_b32 v248, 16, v217
    v_mfma_f32_32x32x16_bf16 v[0:15], a[104:107], a[40:43], v[0:15]
    v_add_u32 v187, 0, v181
    ds_read_b128 a[8:11], v187 offset:0
    ds_read_b128 a[12:15], v187 offset:4096
    buffer_load_dwordx4 a[200:203], v147, s[68:71], s40 offen offset:2048 sc1
    v_and_b32 v249, 0xffff0000, v217
    v_fma_f32 v248, v248, v196, -v195
    v_mfma_f32_32x32x16_bf16 v[16:31], a[104:107], a[44:47], v[16:31]
    v_add_u32 v188, 0, v182
    ds_read_b128 a[16:19], v188 offset:0
    ds_read_b128 a[20:23], v188 offset:4096
    v_fma_f32 v249, v249, v196, -v195
    v_cvt_pk_bf16_f32 v233, v248, v249
    v_mfma_f32_32x32x16_bf16 v[0:15], a[108:111], a[48:51], v[0:15]
    v_add_u32 v189, 0, v183
    ds_read_b128 a[24:27], v189 offset:0
    buffer_load_dwordx4 a[204:207], v147, s[68:71], s40 offen offset:3072 sc1
    s_add_u32 s35, s83, s91
    s_add_u32 m0, s94, 73728
    v_mfma_f32_32x32x16_bf16 v[16:31], a[108:111], a[52:55], v[16:31]
    ds_read_b128 a[28:31], v189 offset:4096
    v_mfma_f32_32x32x16_bf16 v[0:15], a[112:115], a[56:59], v[0:15]
    ds_read_b128 a[32:35], v188 offset:8192
    v_mfma_f32_32x32x16_bf16 v[16:31], a[112:115], a[60:63], v[16:31]
    ds_read_b128 a[36:39], v188 offset:12288
    v_mfma_f32_32x32x16_bf16 v[0:15], a[116:119], a[64:67], v[0:15]
    ds_read_b128 a[40:43], v189 offset:8192
    v_mfma_f32_32x32x16_bf16 v[16:31], a[116:119], a[68:71], v[16:31]
    ds_read_b128 a[44:47], v189 offset:12288
    s_waitcnt vmcnt(12)
    s_waitcnt lgkmcnt(6)
    v_mfma_f32_32x32x16_bf16 v[32:47], a[120:123], a[0:3], v[32:47]
    buffer_load_dwordx4 v[190:193], v239, s[68:71], s31 offen sc1
    ds_read_b128 a[48:51], v186 offset:16384
    ds_read_b128 a[52:55], v186 offset:20480
    v_mfma_f32_32x32x16_bf16 v[48:63], a[120:123], a[4:7], v[48:63]
    ds_read_b128 a[56:59], v187 offset:16384
    v_mfma_f32_32x32x16_bf16 v[32:47], a[124:127], a[8:11], v[32:47]
    ds_read_b128 a[60:63], v187 offset:20480
    v_mfma_f32_32x32x16_bf16 v[48:63], a[124:127], a[12:15], v[48:63]
    v_add_u32 v186, 24576, v180
    buffer_load_dwordx4 v164, s[64:67], s35 offen offset:0 lds
    s_add_u32 m0, s94, 77824
    v_mfma_f32_32x32x16_bf16 v[32:47], a[128:131], a[16:19], v[32:47]
    ds_read_b128 a[64:67], v186 offset:0
    v_mfma_f32_32x32x16_bf16 v[48:63], a[128:131], a[20:23], v[48:63]
    ds_read_b128 a[68:71], v186 offset:4096
    buffer_load_dwordx4 v165, s[64:67], s35 offen offset:0 lds
    s_add_u32 m0, s94, 81792
    s_waitcnt vmcnt(11)
    s_waitcnt lgkmcnt(6)
    v_mfma_f32_32x32x16_bf16 v[32:47], a[132:135], a[24:27], v[32:47]
    v_add_u32 v187, 24576, v181
    ds_read_b128 a[0:3], v187 offset:0
    v_mfma_f32_32x32x16_bf16 v[48:63], a[132:135], a[28:31], v[48:63]
    ds_read_b128 a[4:7], v187 offset:4096
    v_add_u32 v188, 24576, v182
    buffer_load_dwordx4 v164, s[64:67], s35 offen offset:128 lds
    s_add_u32 m0, s94, 85888
    v_mfma_f32_32x32x16_bf16 v[32:47], a[144:147], a[32:35], v[32:47]
    ds_read_b128 a[8:11], v188 offset:0
    ds_read_b128 a[12:15], v188 offset:4096
    v_mfma_f32_32x32x16_bf16 v[48:63], a[144:147], a[36:39], v[48:63]
    v_add_u32 v189, 24576, v183
    buffer_load_dwordx4 v165, s[64:67], s35 offen offset:128 lds
    s_add_u32 m0, s94, 89856
    v_mfma_f32_32x32x16_bf16 v[32:47], a[148:151], a[40:43], v[32:47]
    ds_read_b128 a[16:19], v189 offset:0
    v_mfma_f32_32x32x16_bf16 v[48:63], a[148:151], a[44:47], v[48:63]
    ds_read_b128 a[20:23], v189 offset:4096
    buffer_load_dwordx4 v164, s[64:67], s35 offen offset:256 lds
    s_add_u32 m0, s94, 93952
    v_mfma_f32_32x32x16_bf16 v[0:15], v[202:205], v[166:169], v[0:15]
    v_mfma_f32_32x32x16_bf16 v[16:31], v[210:213], v[166:169], v[16:31]
    buffer_load_dwordx4 v165, s[64:67], s35 offen offset:256 lds
    s_add_u32 s35, s82, s92
    s_add_u32 m0, s94, 98304
    v_mfma_f32_32x32x16_bf16 v[0:15], v[206:209], v[170:173], v[0:15]
    v_mfma_f32_32x32x16_bf16 v[16:31], v[214:217], v[170:173], v[16:31]
    buffer_load_dwordx4 v164, s[60:63], s35 offen offset:0 lds
    s_add_u32 m0, s94, 102400
    v_mfma_f32_32x32x16_bf16 v[0:15], v[218:221], v[174:177], v[0:15]
    v_mfma_f32_32x32x16_bf16 v[16:31], v[226:229], v[240:243], v[16:31]
    buffer_load_dwordx4 v165, s[60:63], s35 offen offset:0 lds
    s_add_u32 m0, s94, 106368
    v_mfma_f32_32x32x16_bf16 v[0:15], v[222:225], v[234:237], v[0:15]
    v_mfma_f32_32x32x16_bf16 v[16:31], v[230:233], v[244:247], v[16:31]
    buffer_load_dwordx4 v164, s[60:63], s35 offen offset:128 lds
    s_add_u32 m0, s94, 110464
    s_waitcnt vmcnt(14)
    s_waitcnt lgkmcnt(6)
    v_mfma_f32_32x32x16_bf16 v[32:47], a[152:155], a[48:51], v[32:47]
    ds_read_b128 a[24:27], v188 offset:8192
    v_mfma_f32_32x32x16_bf16 v[48:63], a[152:155], a[52:55], v[48:63]
    ds_read_b128 a[28:31], v188 offset:12288
    buffer_load_dwordx4 v165, s[60:63], s35 offen offset:128 lds
    s_add_u32 m0, s94, 114432
    v_mfma_f32_32x32x16_bf16 v[32:47], a[156:159], a[56:59], v[32:47]
    ds_read_b128 a[32:35], v189 offset:8192
    v_mfma_f32_32x32x16_bf16 v[48:63], a[156:159], a[60:63], v[48:63]
    ds_read_b128 a[36:39], v189 offset:12288
    buffer_load_dwordx4 v164, s[60:63], s35 offen offset:256 lds
    s_add_u32 m0, s94, 118528
    v_mfma_f32_32x32x16_bf16 v[32:47], a[168:171], a[64:67], v[32:47]
    ds_read_b128 a[40:43], v186 offset:16384
    v_mfma_f32_32x32x16_bf16 v[48:63], a[168:171], a[68:71], v[48:63]
    ds_read_b128 a[44:47], v186 offset:20480
    buffer_load_dwordx4 v165, s[60:63], s35 offen offset:256 lds
    s_add_u32 s35, s83, s92
    s_add_u32 m0, s94, 122880
    s_waitcnt lgkmcnt(6)
    v_mfma_f32_32x32x16_bf16 v[32:47], a[172:175], a[0:3], v[32:47]
    s_waitcnt vmcnt(12)
    v_cmp_eq_u64 vcc, s[88:89], v[192:193]
    s_nop 1
    s_and_b32 s12, vcc_lo, s18
    s_cmp_eq_u32 s12, s18
    s_cbranch_scc0 L_rt_13
L_ok_12:
    v_mfma_f32_32x32x16_bf16 v[48:63], a[172:175], a[4:7], v[48:63]
    ds_read_b128 a[48:51], v187 offset:16384
    ds_read_b128 a[52:55], v187 offset:20480
    buffer_load_dwordx4 v164, s[64:67], s35 offen offset:0 lds
    s_add_u32 s40, s22, 4096
    v_mfma_f32_32x32x16_bf16 v[32:47], a[176:179], a[8:11], v[32:47]
    v_add_u32 v186, 49152, v180
    ds_read_b128 a[56:59], v186 offset:0
    buffer_load_dwordx4 a[136:139], v147, s[68:71], s40 offen offset:0 sc1
    v_mfma_f32_32x32x16_bf16 v[48:63], a[176:179], a[12:15], v[48:63]
    ds_read_b128 a[60:63], v186 offset:4096
    v_add_u32 v187, 49152, v181
    buffer_load_dwordx4 a[140:143], v147, s[68:71], s40 offen offset:1024 sc1
    s_add_u32 s40, s22, 10240
    v_mfma_f32_32x32x16_bf16 v[32:47], a[180:183], a[16:19], v[32:47]
    ds_read_b128 a[64:67], v187 offset:0
    buffer_load_dwordx4 a[160:163], v147, s[68:71], s40 offen offset:0 sc1
    v_mfma_f32_32x32x16_bf16 v[48:63], a[180:183], a[20:23], v[48:63]
    ds_read_b128 a[68:71], v187 offset:4096
    buffer_load_dwordx4 a[164:167], v147, s[68:71], s40 offen offset:1024 sc1
    s_add_u32 s40, s23, 4096
    s_waitcnt lgkmcnt(6)
    v_mfma_f32_32x32x16_bf16 v[32:47], a[192:195], a[24:27], v[32:47]
    v_add_u32 v188, 49152, v182
    ds_read_b128 a[0:3], v188 offset:0
    buffer_load_dwordx4 a[184:187], v147, s[68:71], s40 offen offset:0 sc1
    v_mfma_f32_32x32x16_bf16 v[48:63], a[192:195], a[28:31], v[48:63]
    ds_read_b128 a[4:7], v188 offset:4096
    v_add_u32 v189, 49152, v183
    buffer_load_dwordx4 a[188:191], v147, s[68:71], s40 offen offset:1024 sc1
    s_add_u32 s40, s23, 10240
    v_mfma_f32_32x32x16_bf16 v[32:47], a[196:199], a[32:35], v[32:47]
    ds_read_b128 a[8:11], v189 offset:0
    buffer_load_dwordx4 a[208:211], v147, s[68:71], s40 offen offset:0 sc1
    v_mfma_f32_32x32x16_bf16 v[48:63], a[196:199], a[36:39], v[48:63]
    ds_read_b128 a[12:15], v189 offset:4096
    v_mfma_f32_32x32x16_bf16 v[32:47], a[200:203], a[40:43], v[32:47]
    ds_read_b128 a[16:19], v188 offset:8192
    buffer_load_dwordx4 a[212:215], v147, s[68:71], s40 offen offset:1024 sc1
    s_add_u32 m0, s94, 126976
    v_mfma_f32_32x32x16_bf16 v[48:63], a[200:203], a[44:47], v[48:63]
    ds_read_b128 a[20:23], v188 offset:12288
    s_waitcnt lgkmcnt(6)
    v_mfma_f32_32x32x16_bf16 v[32:47], a[204:207], a[48:51], v[32:47]
    ds_read_b128 a[24:27], v189 offset:8192
    v_mfma_f32_32x32x16_bf16 v[48:63], a[204:207], a[52:55], v[48:63]
    ds_read_b128 a[28:31], v189 offset:12288
    v_mfma_f32_32x32x16_bf16 v[64:79], a[120:123], a[56:59], v[64:79]
    ds_read_b128 a[32:35], v186 offset:16384
    v_mfma_f32_32x32x16_bf16 v[80:95], a[120:123], a[60:63], v[80:95]
    ds_read_b128 a[36:39], v186 offset:20480
    v_mfma_f32_32x32x16_bf16 v[64:79], a[124:127], a[64:67], v[64:79]
    ds_read_b128 a[40:43], v187 offset:16384
    v_mfma_f32_32x32x16_bf16 v[80:95], a[124:127], a[68:71], v[80:95]
    ds_read_b128 a[44:47], v187 offset:20480
    s_waitcnt lgkmcnt(6)
    v_mfma_f32_32x32x16_bf16 v[64:79], a[128:131], a[0:3], v[64:79]
    v_add_u32 v186, 0, v180
    ds_read_b128 a[48:51], v186 offset:8192
    v_mfma_f32_32x32x16_bf16 v[80:95], a[128:131], a[4:7], v[80:95]
    ds_read_b128 a[52:55], v186 offset:12288
    v_add_u32 v187, 0, v181
    buffer_load_dwordx4 v165, s[64:67], s35 offen offset:0 lds
    s_add_u32 m0, s94, 130944
    v_mfma_f32_32x32x16_bf16 v[64:79], a[132:135], a[8:11], v[64:79]
    ds_read_b128 a[56:59], v187 offset:8192
    ds_read_b128 a[60:63], v187 offset:12288
    v_mfma_f32_32x32x16_bf16 v[80:95], a[132:135], a[12:15], v[80:95]
    v_add_u32 v188, 0, v182
    buffer_load_dwordx4 v164, s[64:67], s35 offen offset:128 lds
    s_add_u32 m0, s94, 135040
    v_mfma_f32_32x32x16_bf16 v[64:79], a[144:147], a[16:19], v[64:79]
    ds_read_b128 a[64:67], v188 offset:16384
    v_mfma_f32_32x32x16_bf16 v[80:95], a[144:147], a[20:23], v[80:95]
    ds_read_b128 a[68:71], v188 offset:20480
    buffer_load_dwordx4 v165, s[64:67], s35 offen offset:128 lds
    s_add_u32 m0, s94, 139008
    s_waitcnt lgkmcnt(6)
    v_mfma_f32_32x32x16_bf16 v[64:79], a[148:151], a[24:27], v[64:79]
    v_add_u32 v189, 0, v183
    ds_read_b128 a[0:3], v189 offset:16384
    v_mfma_f32_32x32x16_bf16 v[80:95], a[148:151], a[28:31], v[80:95]
    ds_read_b128 a[4:7], v189 offset:20480
    v_add_u32 v186, 24576, v180
    buffer_load_dwordx4 v164, s[64:67], s35 offen offset:256 lds
    s_add_u32 m0, s94, 143104
    v_mfma_f32_32x32x16_bf16 v[64:79], a[152:155], a[32:35], v[64:79]
    ds_read_b128 a[8:11], v186 offset:8192
    ds_read_b128 a[12:15], v186 offset:12288
    v_mfma_f32_32x32x16_bf16 v[80:95], a[152:155], a[36:39], v[80:95]
    v_add_u32 v187, 24576, v181
    buffer_load_dwordx4 v165, s[64:67], s35 offen offset:256 lds
    v_mfma_f32_32x32x16_bf16 v[64:79], a[156:159], a[40:43], v[64:79]
    ds_read_b128 a[16:19], v187 offset:8192
    v_mfma_f32_32x32x16_bf16 v[80:95], a[156:159], a[44:47], v[80:95]
    ds_read_b128 a[20:23], v187 offset:12288
    s_waitcnt vmcnt(9)
    s_waitcnt lgkmcnt(6)
    v_mfma_f32_32x32x16_bf16 v[32:47], a[136:139], a[48:51], v[32:47]
    v_mfma_f32_32x32x16_bf16 v[48:63], a[136:139], a[52:55], v[48:63]
    v_mfma_f32_32x32x16_bf16 v[32:47], a[140:143], a[56:59], v[32:47]
    s_waitcnt lgkmcnt(0)
    s_barrier
    v_mfma_f32_32x32x16_bf16 v[48:63], a[140:143], a[60:63], v[48:63]
    v_add_u32 v188, 24576, v182
    ds_read_b128 a[24:27], v188 offset:16384
    ds_read_b128 a[28:31], v188 offset:20480
    v_mfma_f32_32x32x16_bf16 v[32:47], a[160:163], a[64:67], v[32:47]
    v_add_u32 v189, 24576, v183
    ds_read_b128 a[32:35], v189 offset:16384
    ds_read_b128 a[36:39], v189 offset:20480
    v_mfma_f32_32x32x16_bf16 v[48:63], a[160:163], a[68:71], v[48:63]
    v_add_u32 v186, 73728, v180
    ds_read_b128 a[40:43], v186 offset:0
    ds_read_b128 a[44:47], v186 offset:4096
    s_waitcnt vmcnt(5)
    v_mfma_f32_32x32x16_bf16 v[32:47], a[164:167], a[0:3], v[32:47]
    v_add_u32 v187, 73728, v181
    ds_read_b128 a[48:51], v187 offset:0
    v_mfma_f32_32x32x16_bf16 v[48:63], a[164:167], a[4:7], v[48:63]
    ds_read_b128 a[52:55], v187 offset:4096
    v_add_u32 v188, 73728, v182
    v_mfma_f32_32x32x16_bf16 v[32:47], a[184:187], a[8:11], v[32:47]
    ds_read_b128 a[56:59], v188 offset:0
    ds_read_b128 a[60:63], v188 offset:4096
    v_mfma_f32_32x32x16_bf16 v[48:63], a[184:187], a[12:15], v[48:63]
    v_add_u32 v189, 73728, v183
    v_mfma_f32_32x32x16_bf16 v[32:47], a[188:191], a[16:19], v[32:47]
    ds_read_b128 a[64:67], v189 offset:0
    v_mfma_f32_32x32x16_bf16 v[48:63], a[188:191], a[20:23], v[48:63]
    ds_read_b128 a[68:71], v189 offset:4096
    s_waitcnt lgkmcnt(6)
    v_mfma_f32_32x32x16_bf16 v[32:47], a[208:211], a[24:27], v[32:47]
    ds_read_b128 a[0:3], v188 offset:8192
    v_mfma_f32_32x32x16_bf16 v[48:63], a[208:211], a[28:31], v[48:63]
    ds_read_b128 a[4:7], v188 offset:12288
    v_mfma_f32_32x32x16_bf16 v[32:47], a[212:215], a[32:35], v[32:47]
    ds_read_b128 a[8:11], v189 offset:8192
    v_mfma_f32_32x32x16_bf16 v[48:63], a[212:215], a[36:39], v[48:63]
    ds_read_b128 a[12:15], v189 offset:12288
    v_mfma_f32_32x32x16_bf16 v[64:79], a[168:171], a[40:43], v[64:79]
    ds_read_b128 a[16:19], v186 offset:16384
    v_mfma_f32_32x32x16_bf16 v[80:95], a[168:171], a[44:47], v[80:95]
    ds_read_b128 a[20:23], v186 offset:20480
    s_waitcnt lgkmcnt(6)
    v_mfma_f32_32x32x16_bf16 v[64:79], a[172:175], a[48:51], v[64:79]
    ds_read_b128 a[24:27], v187 offset:16384
    ds_read_b128 a[28:31], v187 offset:20480
    s_lshl_b32 s41, s26, 12
    s_add_u32 s41, s41, 20971520
    v_cvt_pk_bf16_f32 v32, v32, v33
    v_cvt_pk_bf16_f32 v33, v34, v35
    v_mfma_f32_32x32x16_bf16 v[80:95], a[172:175], a[52:55], v[80:95]
    v_add_u32 v186, 49152, v180
    ds_read_b128 a[32:35], v186 offset:8192
    v_cvt_pk_bf16_f32 v34, v36, v37
    v_cvt_pk_bf16_f32 v35, v38, v39
    buffer_store_dwordx4 v[32:35], v147, s[68:71], s41 offen offset:0 sc1
    v_mfma_f32_32x32x16_bf16 v[64:79], a[176:179], a[56:59], v[64:79]
    ds_read_b128 a[36:39], v186 offset:12288
    v_cvt_pk_bf16_f32 v40, v40, v41
    v_cvt_pk_bf16_f32 v41, v42, v43
    v_cvt_pk_bf16_f32 v42, v44, v45
    v_cvt_pk_bf16_f32 v43, v46, v47
    buffer_store_dwordx4 v[40:43], v147, s[68:71], s41 offen offset:1024 sc1
    v_mfma_f32_32x32x16_bf16 v[80:95], a[176:179], a[60:63], v[80:95]
    v_add_u32 v187, 49152, v181
    v_cvt_pk_bf16_f32 v48, v48, v49
    v_cvt_pk_bf16_f32 v49, v50, v51
    v_cvt_pk_bf16_f32 v50, v52, v53
    v_cvt_pk_bf16_f32 v51, v54, v55
    v_mfma_f32_32x32x16_bf16 v[64:79], a[180:183], a[64:67], v[64:79]
    ds_read_b128 a[40:43], v187 offset:8192
    buffer_store_dwordx4 v[48:51], v147, s[68:71], s41 offen offset:2048 sc1
    v_cvt_pk_bf16_f32 v56, v56, v57
    v_cvt_pk_bf16_f32 v57, v58, v59
    v_cvt_pk_bf16_f32 v58, v60, v61
    v_mfma_f32_32x32x16_bf16 v[80:95], a[180:183], a[68:71], v[80:95]
    ds_read_b128 a[44:47], v187 offset:12288
    v_cvt_pk_bf16_f32 v59, v62, v63
    s_waitcnt lgkmcnt(6)
    v_mfma_f32_32x32x16_bf16 v[64:79], a[192:195], a[0:3], v[64:79]
    v_add_u32 v188, 49152, v182
    ds_read_b128 a[48:51], v188 offset:16384
    buffer_store_dwordx4 v[56:59], v147, s[68:71], s41 offen offset:3072 sc1
    v_mfma_f32_32x32x16_bf16 v[80:95], a[192:195], a[4:7], v[80:95]
    ds_read_b128 a[52:55], v188 offset:20480
    v_add_u32 v189, 49152, v183
    v_mfma_f32_32x32x16_bf16 v[64:79], a[196:199], a[8:11], v[64:79]
    ds_read_b128 a[56:59], v189 offset:16384
    ds_read_b128 a[60:63], v189 offset:20480
    v_mfma_f32_32x32x16_bf16 v[80:95], a[196:199], a[12:15], v[80:95]
    v_add_u32 v186, 73728, v180
    v_mfma_f32_32x32x16_bf16 v[64:79], a[200:203], a[16:19], v[64:79]
    ds_read_b128 a[64:67], v186 offset:8192
    v_mfma_f32_32x32x16_bf16 v[80:95], a[200:203], a[20:23], v[80:95]
    ds_read_b128 a[68:71], v186 offset:12288
    s_waitcnt lgkmcnt(6)
    v_mfma_f32_32x32x16_bf16 v[64:79], a[204:207], a[24:27], v[64:79]
    v_add_u32 v187, 73728, v181
    ds_read_b128 a[0:3], v187 offset:8192
    v_mfma_f32_32x32x16_bf16 v[80:95], a[204:207], a[28:31], v[80:95]
    ds_read_b128 a[4:7], v187 offset:12288
    v_add_u32 v188, 73728, v182
    v_mfma_f32_32x32x16_bf16 v[64:79], a[136:139], a[32:35], v[64:79]
    ds_read_b128 a[8:11], v188 offset:16384
    ds_read_b128 a[12:15], v188 offset:20480
    v_mfma_f32_32x32x16_bf16 v[80:95], a[136:139], a[36:39], v[80:95]
    v_add_u32 v189, 73728, v183
    v_mfma_f32_32x32x16_bf16 v[64:79], a[140:143], a[40:43], v[64:79]
    ds_read_b128 a[16:19], v189 offset:16384
    v_mfma_f32_32x32x16_bf16 v[80:95], a[140:143], a[44:47], v[80:95]
    ds_read_b128 a[20:23], v189 offset:20480
    s_waitcnt lgkmcnt(6)
    v_mfma_f32_32x32x16_bf16 v[64:79], a[160:163], a[48:51], v[64:79]
    v_add_u32 v186, 98304, v180
    ds_read_b128 a[24:27], v186 offset:0
    v_mfma_f32_32x32x16_bf16 v[80:95], a[160:163], a[52:55], v[80:95]
    ds_read_b128 a[28:31], v186 offset:4096
    v_add_u32 v187, 98304, v181
    v_mfma_f32_32x32x16_bf16 v[64:79], a[164:167], a[56:59], v[64:79]
    ds_read_b128 a[32:35], v187 offset:0
    ds_read_b128 a[36:39], v187 offset:4096
    v_mfma_f32_32x32x16_bf16 v[80:95], a[164:167], a[60:63], v[80:95]
    v_add_u32 v188, 98304, v182
    v_mfma_f32_32x32x16_bf16 v[64:79], a[184:187], a[64:67], v[64:79]
    ds_read_b128 a[40:43], v188 offset:0
    v_mfma_f32_32x32x16_bf16 v[80:95], a[184:187], a[68:71], v[80:95]
    ds_read_b128 a[44:47], v188 offset:4096
    s_waitcnt lgkmcnt(6)
    v_mfma_f32_32x32x16_bf16 v[64:79], a[188:191], a[0:3], v[64:79]
    v_add_u32 v189, 98304, v183
    ds_read_b128 a[48:51], v189 offset:0
    v_mfma_f32_32x32x16_bf16 v[80:95], a[188:191], a[4:7], v[80:95]
    ds_read_b128 a[52:55], v189 offset:4096
    v_mfma_f32_32x32x16_bf16 v[64:79], a[208:211], a[8:11], v[64:79]
    ds_read_b128 a[56:59], v186 offset:8192
    v_mfma_f32_32x32x16_bf16 v[80:95], a[208:211], a[12:15], v[80:95]
    ds_read_b128 a[60:63], v186 offset:12288
    v_mfma_f32_32x32x16_bf16 v[64:79], a[212:215], a[16:19], v[64:79]
    ds_read_b128 a[64:67], v187 offset:8192
    v_mfma_f32_32x32x16_bf16 v[80:95], a[212:215], a[20:23], v[80:95]
    ds_read_b128 a[68:71], v187 offset:12288
    s_waitcnt lgkmcnt(6)
    v_mfma_f32_32x32x16_bf16 v[0:15], a[120:123], a[24:27], v[0:15]
    s_waitcnt vmcnt(0)
    s_lshl_b32 s12, s26, 6
    s_add_u32 s12, s12, 786432
    s_mov_b64 exec, 1
    buffer_store_dwordx2 v[198:199], v155, s[68:71], s12 offen sc1
    s_mov_b64 exec, -1
    v_mfma_f32_32x32x16_bf16 v[16:31], a[120:123], a[28:31], v[16:31]
    ds_read_b128 a[0:3], v188 offset:8192
    ds_read_b128 a[4:7], v188 offset:12288
    s_lshl_b32 s41, s27, 12
    s_add_u32 s41, s41, 20971520
    v_cvt_pk_bf16_f32 v64, v64, v65
    v_cvt_pk_bf16_f32 v65, v66, v67
    v_mfma_f32_32x32x16_bf16 v[0:15], a[124:127], a[32:35], v[0:15]
    ds_read_b128 a[8:11], v189 offset:8192
    v_cvt_pk_bf16_f32 v66, v68, v69
    v_cvt_pk_bf16_f32 v67, v70, v71
    buffer_store_dwordx4 v[64:67], v147, s[68:71], s41 offen offset:0 sc1
    v_cvt_pk_bf16_f32 v72, v72, v73
    v_mfma_f32_32x32x16_bf16 v[16:31], a[124:127], a[36:39], v[16:31]
    ds_read_b128 a[12:15], v189 offset:12288
    v_cvt_pk_bf16_f32 v73, v74, v75
    v_cvt_pk_bf16_f32 v74, v76, v77
    v_cvt_pk_bf16_f32 v75, v78, v79
    buffer_store_dwordx4 v[72:75], v147, s[68:71], s41 offen offset:1024 sc1
    v_mfma_f32_32x32x16_bf16 v[0:15], a[128:131], a[40:43], v[0:15]
    ds_read_b128 a[16:19], v186 offset:16384
    v_cvt_pk_bf16_f32 v80, v80, v81
    v_cvt_pk_bf16_f32 v81, v82, v83
    v_cvt_pk_bf16_f32 v82, v84, v85
    v_cvt_pk_bf16_f32 v83, v86, v87
    v_mfma_f32_32x32x16_bf16 v[16:31], a[128:131], a[44:47], v[16:31]
    ds_read_b128 a[20:23], v186 offset:20480
    buffer_store_dwordx4 v[80:83], v147, s[68:71], s41 offen offset:2048 sc1
    v_cvt_pk_bf16_f32 v88, v88, v89
    v_cvt_pk_bf16_f32 v89, v90, v91
    v_cvt_pk_bf16_f32 v90, v92, v93
    s_waitcnt lgkmcnt(6)
    v_mfma_f32_32x32x16_bf16 v[0:15], a[132:135], a[48:51], v[0:15]
    ds_read_b128 a[24:27], v187 offset:16384
    v_cvt_pk_bf16_f32 v91, v94, v95
    v_mfma_f32_32x32x16_bf16 v[16:31], a[132:135], a[52:55], v[16:31]
    ds_read_b128 a[28:31], v187 offset:20480
    buffer_store_dwordx4 v[88:91], v147, s[68:71], s41 offen offset:3072 sc1
    v_mfma_f32_32x32x16_bf16 v[0:15], a[136:139], a[56:59], v[0:15]
    ds_read_b128 a[32:35], v188 offset:16384
    v_mfma_f32_32x32x16_bf16 v[16:31], a[136:139], a[60:63], v[16:31]
    ds_read_b128 a[36:39], v188 offset:20480
    v_mfma_f32_32x32x16_bf16 v[0:15], a[140:143], a[64:67], v[0:15]
    ds_read_b128 a[40:43], v189 offset:16384
    v_mfma_f32_32x32x16_bf16 v[16:31], a[140:143], a[68:71], v[16:31]
    ds_read_b128 a[44:47], v189 offset:20480
    s_waitcnt lgkmcnt(6)
    v_mfma_f32_32x32x16_bf16 v[0:15], a[144:147], a[0:3], v[0:15]
    v_mfma_f32_32x32x16_bf16 v[16:31], a[144:147], a[4:7], v[16:31]
    v_mfma_f32_32x32x16_bf16 v[0:15], a[148:151], a[8:11], v[0:15]
    s_waitcnt lgkmcnt(0)
    s_barrier
    v_mfma_f32_32x32x16_bf16 v[16:31], a[148:151], a[12:15], v[16:31]
    v_add_u32 v186, 122880, v180
    ds_read_b128 a[48:51], v186 offset:0
    ds_read_b128 a[52:55], v186 offset:4096
    v_mfma_f32_32x32x16_bf16 v[0:15], a[152:155], a[16:19], v[0:15]
    v_add_u32 v187, 122880, v181
    ds_read_b128 a[56:59], v187 offset:0
    ds_read_b128 a[60:63], v187 offset:4096
    v_mfma_f32_32x32x16_bf16 v[16:31], a[152:155], a[20:23], v[16:31]
    v_add_u32 v188, 122880, v182
    ds_read_b128 a[64:67], v188 offset:0
    ds_read_b128 a[68:71], v188 offset:4096
    v_mfma_f32_32x32x16_bf16 v[0:15], a[156:159], a[24:27], v[0:15]
    s_lshl_b32 s92, s25, 6
    s_add_u32 s92, s92, 786432
    s_lshl_b32 s90, 1, s4
    buffer_load_dwordx4 v[190:193], v239, s[68:71], s92 offen sc1
    s_sub_u32 s80, s4, 1
    s_cmp_eq_u32 s4, 0
    s_cselect_b32 s80, 2, s80
    s_add_u32 s84, s80, s25
    s_lshl_b32 s84, s84, 12
    s_add_u32 s84, s84, 20971520
    s_mov_b32 s81, 3
    s_add_u32 s85, s81, s25
    s_lshl_b32 s85, s85, 12
    s_add_u32 s85, s85, 20971520
    s_add_u32 s82, s4, 1
    s_cmp_eq_u32 s82, 3
    s_cselect_b32 s82, 0, s82
    s_add_u32 s86, s82, s25
    s_lshl_b32 s86, s86, 12
    s_add_u32 s86, s86, 20971520
    v_mfma_f32_32x32x16_bf16 v[16:31], a[156:159], a[28:31], v[16:31]
    v_add_u32 v189, 122880, v183
    ds_read_b128 a[0:3], v189 offset:0
    v_mfma_f32_32x32x16_bf16 v[0:15], a[160:163], a[32:35], v[0:15]
    ds_read_b128 a[4:7], v189 offset:4096
    ds_read_b128 a[8:11], v186 offset:8192
    v_mfma_f32_32x32x16_bf16 v[16:31], a[160:163], a[36:39], v[16:31]
    ds_read_b128 a[12:15], v186 offset:12288
    v_mfma_f32_32x32x16_bf16 v[0:15], a[164:167], a[40:43], v[0:15]
    ds_read_b128 a[16:19], v187 offset:8192
    v_mfma_f32_32x32x16_bf16 v[16:31], a[164:167], a[44:47], v[16:31]
    ds_read_b128 a[20:23], v187 offset:12288
    s_waitcnt lgkmcnt(6)
    v_mfma_f32_32x32x16_bf16 v[0:15], a[168:171], a[48:51], v[0:15]
    ds_read_b128 a[24:27], v188 offset:8192
    v_mfma_f32_32x32x16_bf16 v[16:31], a[168:171], a[52:55], v[16:31]
    ds_read_b128 a[28:31], v188 offset:12288
    v_mfma_f32_32x32x16_bf16 v[0:15], a[172:175], a[56:59], v[0:15]
    ds_read_b128 a[32:35], v189 offset:8192
    v_mfma_f32_32x32x16_bf16 v[16:31], a[172:175], a[60:63], v[16:31]
    ds_read_b128 a[36:39], v189 offset:12288
    v_mfma_f32_32x32x16_bf16 v[0:15], a[176:179], a[64:67], v[0:15]
    ds_read_b128 a[40:43], v186 offset:16384
    v_mfma_f32_32x32x16_bf16 v[16:31], a[176:179], a[68:71], v[16:31]
    ds_read_b128 a[44:47], v186 offset:20480
    s_waitcnt lgkmcnt(6)
    v_mfma_f32_32x32x16_bf16 v[0:15], a[180:183], a[0:3], v[0:15]
    s_waitcnt vmcnt(1)
    s_lshl_b32 s12, s27, 6
    s_add_u32 s12, s12, 786432
    s_mov_b64 exec, 1
    buffer_store_dwordx2 v[198:199], v155, s[68:71], s12 offen sc1
    s_mov_b64 exec, -1
    v_mfma_f32_32x32x16_bf16 v[16:31], a[180:183], a[4:7], v[16:31]
    ds_read_b128 a[48:51], v187 offset:16384
    ds_read_b128 a[52:55], v187 offset:20480
    v_mfma_f32_32x32x16_bf16 v[0:15], a[184:187], a[8:11], v[0:15]
    ds_read_b128 a[56:59], v188 offset:16384
    v_mfma_f32_32x32x16_bf16 v[16:31], a[184:187], a[12:15], v[16:31]
    ds_read_b128 a[60:63], v188 offset:20480
    v_mfma_f32_32x32x16_bf16 v[0:15], a[188:191], a[16:19], v[0:15]
    ds_read_b128 a[64:67], v189 offset:16384
    v_mfma_f32_32x32x16_bf16 v[16:31], a[188:191], a[20:23], v[16:31]
    ds_read_b128 a[68:71], v189 offset:20480
    s_waitcnt lgkmcnt(6)
    v_mfma_f32_32x32x16_bf16 v[0:15], a[192:195], a[24:27], v[0:15]
    s_waitcnt vmcnt(1)
    v_cmp_eq_u64 vcc, s[88:89], v[190:191]
    s_nop 1
    s_and_b32 s91, vcc_lo, 15
    s_andn2_b32 s91, s91, s90
    s_or_b32 s90, s90, s91
    s_bitcmp1_b32 s91, s80
    s_cbranch_scc0 L_rs_14
    buffer_load_dwordx4 v[96:99], v147, s[68:71], s84 offen offset:0 sc1
    buffer_load_dwordx4 v[100:103], v147, s[68:71], s84 offen offset:1024 sc1
    buffer_load_dwordx4 v[104:107], v147, s[68:71], s84 offen offset:2048 sc1
    buffer_load_dwordx4 v[108:111], v147, s[68:71], s84 offen offset:3072 sc1
L_rs_14:
    s_bitcmp1_b32 s91, s81
    s_cbranch_scc0 L_rs_15
    buffer_load_dwordx4 v[112:115], v147, s[68:71], s85 offen offset:0 sc1
    buffer_load_dwordx4 v[116:119], v147, s[68:71], s85 offen offset:1024 sc1
    buffer_load_dwordx4 v[120:123], v147, s[68:71], s85 offen offset:2048 sc1
    buffer_load_dwordx4 v[124:127], v147, s[68:71], s85 offen offset:3072 sc1
L_rs_15:
    s_bitcmp1_b32 s91, s82
    s_cbranch_scc0 L_rs_16
    buffer_load_dwordx4 v[128:131], v147, s[68:71], s86 offen offset:0 sc1
    buffer_load_dwordx4 v[132:135], v147, s[68:71], s86 offen offset:1024 sc1
    buffer_load_dwordx4 v[136:139], v147, s[68:71], s86 offen offset:2048 sc1
    buffer_load_dwordx4 v[140:143], v147, s[68:71], s86 offen offset:3072 sc1
L_rs_16:
    buffer_load_dwordx4 v[190:193], v239, s[68:71], s92 offen sc1
    v_mfma_f32_32x32x16_bf16 v[16:31], a[192:195], a[28:31], v[16:31]
    v_mfma_f32_32x32x16_bf16 v[0:15], a[196:199], a[32:35], v[0:15]
    v_mfma_f32_32x32x16_bf16 v[16:31], a[196:199], a[36:39], v[16:31]
    v_mfma_f32_32x32x16_bf16 v[0:15], a[200:203], a[40:43], v[0:15]
    v_mfma_f32_32x32x16_bf16 v[16:31], a[200:203], a[44:47], v[16:31]
    s_waitcnt lgkmcnt(0)
    v_mfma_f32_32x32x16_bf16 v[0:15], a[204:207], a[48:51], v[0:15]
    v_mfma_f32_32x32x16_bf16 v[16:31], a[204:207], a[52:55], v[16:31]
    v_mfma_f32_32x32x16_bf16 v[0:15], a[208:211], a[56:59], v[0:15]
    v_mfma_f32_32x32x16_bf16 v[16:31], a[208:211], a[60:63], v[16:31]
    v_mfma_f32_32x32x16_bf16 v[0:15], a[212:215], a[64:67], v[0:15]
    v_mfma_f32_32x32x16_bf16 v[16:31], a[212:215], a[68:71], v[16:31]
    s_add_u32 s13, s93, 147456
    v_lshl_add_u32 v184, v145, 2, s13
    v_lshl_add_u32 v184, v146, 11, v184
    v_add_u32 v185, 128, v184
    s_mov_b32 s87, 0
    s_nop 7
L_rl_17:
    s_waitcnt vmcnt(0)
    s_mov_b32 s14, s91
    s_mov_b32 s15, s90
    v_cmp_eq_u64 vcc, s[88:89], v[190:191]
    s_nop 1
    s_and_b32 s91, vcc_lo, 15
    s_andn2_b32 s91, s91, s90
    s_or_b32 s90, s90, s91
    s_bitcmp1_b32 s91, s80
    s_cbranch_scc0 L_rs_19
    buffer_load_dwordx4 v[96:99], v147, s[68:71], s84 offen offset:0 sc1
    buffer_load_dwordx4 v[100:103], v147, s[68:71], s84 offen offset:1024 sc1
    buffer_load_dwordx4 v[104:107], v147, s[68:71], s84 offen offset:2048 sc1
    buffer_load_dwordx4 v[108:111], v147, s[68:71], s84 offen offset:3072 sc1
L_rs_19:
    s_bitcmp1_b32 s91, s81
    s_cbranch_scc0 L_rs_20
    buffer_load_dwordx4 v[112:115], v147, s[68:71], s85 offen offset:0 sc1
    buffer_load_dwordx4 v[116:119], v147, s[68:71], s85 offen offset:1024 sc1
    buffer_load_dwordx4 v[120:123], v147, s[68:71], s85 offen offset:2048 sc1
    buffer_load_dwordx4 v[124:127], v147, s[68:71], s85 offen offset:3072 sc1
L_rs_20:
    s_bitcmp1_b32 s91, s82
    s_cbranch_scc0 L_rs_21
    buffer_load_dwordx4 v[128:131], v147, s[68:71], s86 offen offset:0 sc1
    buffer_load_dwordx4 v[132:135], v147, s[68:71], s86 offen offset:1024 sc1
    buffer_load_dwordx4 v[136:139], v147, s[68:71], s86 offen offset:2048 sc1
    buffer_load_dwordx4 v[140:143], v147, s[68:71], s86 offen offset:3072 sc1
L_rs_21:
    buffer_load_dwordx4 v[190:193], v239, s[68:71], s92 offen sc1
    s_bitcmp1_b32 s14, s80
    s_cbranch_scc0 L_ra_22
    v_lshlrev_b32 v224, 16, v96
    v_and_b32 v225, 0xffff0000, v96
    v_pk_add_f32 v[0:1], v[0:1], v[224:225]
    v_lshlrev_b32 v226, 16, v97
    v_and_b32 v227, 0xffff0000, v97
    v_pk_add_f32 v[2:3], v[2:3], v[226:227]
    v_lshlrev_b32 v228, 16, v98
    v_and_b32 v229, 0xffff0000, v98
    v_pk_add_f32 v[4:5], v[4:5], v[228:229]
    v_lshlrev_b32 v230, 16, v99
    v_and_b32 v231, 0xffff0000, v99
    v_pk_add_f32 v[6:7], v[6:7], v[230:231]
    v_lshlrev_b32 v224, 16, v100
    v_and_b32 v225, 0xffff0000, v100
    v_pk_add_f32 v[8:9], v[8:9], v[224:225]
    v_lshlrev_b32 v226, 16, v101
    v_and_b32 v227, 0xffff0000, v101
    v_pk_add_f32 v[10:11], v[10:11], v[226:227]
    v_lshlrev_b32 v228, 16, v102
    v_and_b32 v229, 0xffff0000, v102
    v_pk_add_f32 v[12:13], v[12:13], v[228:229]
    v_lshlrev_b32 v230, 16, v103
    v_and_b32 v231, 0xffff0000, v103
    v_pk_add_f32 v[14:15], v[14:15], v[230:231]
    v_lshlrev_b32 v224, 16, v104
    v_and_b32 v225, 0xffff0000, v104
    v_pk_add_f32 v[16:17], v[16:17], v[224:225]
    v_lshlrev_b32 v226, 16, v105
    v_and_b32 v227, 0xffff0000, v105
    v_pk_add_f32 v[18:19], v[18:19], v[226:227]
    v_lshlrev_b32 v228, 16, v106
    v_and_b32 v229, 0xffff0000, v106
    v_pk_add_f32 v[20:21], v[20:21], v[228:229]
    v_lshlrev_b32 v230, 16, v107
    v_and_b32 v231, 0xffff0000, v107
    v_pk_add_f32 v[22:23], v[22:23], v[230:231]
    v_lshlrev_b32 v224, 16, v108
    v_and_b32 v225, 0xffff0000, v108
    v_pk_add_f32 v[24:25], v[24:25], v[224:225]
    v_lshlrev_b32 v226, 16, v109
    v_and_b32 v227, 0xffff0000, v109
    v_pk_add_f32 v[26:27], v[26:27], v[226:227]
    v_lshlrev_b32 v228, 16, v110
    v_and_b32 v229, 0xffff0000, v110
    v_pk_add_f32 v[28:29], v[28:29], v[228:229]
    v_lshlrev_b32 v230, 16, v111
    v_and_b32 v231, 0xffff0000, v111
    v_pk_add_f32 v[30:31], v[30:31], v[230:231]
L_ra_22:
    s_bitcmp1_b32 s14, s81
    s_cbranch_scc0 L_ra_23
    v_lshlrev_b32 v224, 16, v112
    v_and_b32 v225, 0xffff0000, v112
    v_pk_add_f32 v[0:1], v[0:1], v[224:225]
    v_lshlrev_b32 v226, 16, v113
    v_and_b32 v227, 0xffff0000, v113
    v_pk_add_f32 v[2:3], v[2:3], v[226:227]
    v_lshlrev_b32 v228, 16, v114
    v_and_b32 v229, 0xffff0000, v114
    v_pk_add_f32 v[4:5], v[4:5], v[228:229]
    v_lshlrev_b32 v230, 16, v115
    v_and_b32 v231, 0xffff0000, v115
    v_pk_add_f32 v[6:7], v[6:7], v[230:231]
    v_lshlrev_b32 v224, 16, v116
    v_and_b32 v225, 0xffff0000, v116
    v_pk_add_f32 v[8:9], v[8:9], v[224:225]
    v_lshlrev_b32 v226, 16, v117
    v_and_b32 v227, 0xffff0000, v117
    v_pk_add_f32 v[10:11], v[10:11], v[226:227]
    v_lshlrev_b32 v228, 16, v118
    v_and_b32 v229, 0xffff0000, v118
    v_pk_add_f32 v[12:13], v[12:13], v[228:229]
    v_lshlrev_b32 v230, 16, v119
    v_and_b32 v231, 0xffff0000, v119
    v_pk_add_f32 v[14:15], v[14:15], v[230:231]
    v_lshlrev_b32 v224, 16, v120
    v_and_b32 v225, 0xffff0000, v120
    v_pk_add_f32 v[16:17], v[16:17], v[224:225]
    v_lshlrev_b32 v226, 16, v121
    v_and_b32 v227, 0xffff0000, v121
    v_pk_add_f32 v[18:19], v[18:19], v[226:227]
    v_lshlrev_b32 v228, 16, v122
    v_and_b32 v229, 0xffff0000, v122
    v_pk_add_f32 v[20:21], v[20:21], v[228:229]
    v_lshlrev_b32 v230, 16, v123
    v_and_b32 v231, 0xffff0000, v123
    v_pk_add_f32 v[22:23], v[22:23], v[230:231]
    v_lshlrev_b32 v224, 16, v124
    v_and_b32 v225, 0xffff0000, v124
    v_pk_add_f32 v[24:25], v[24:25], v[224:225]
    v_lshlrev_b32 v226, 16, v125
    v_and_b32 v227, 0xffff0000, v125
    v_pk_add_f32 v[26:27], v[26:27], v[226:227]
    v_lshlrev_b32 v228, 16, v126
    v_and_b32 v229, 0xffff0000, v126
    v_pk_add_f32 v[28:29], v[28:29], v[228:229]
    v_lshlrev_b32 v230, 16, v127
    v_and_b32 v231, 0xffff0000, v127
    v_pk_add_f32 v[30:31], v[30:31], v[230:231]
L_ra_23:
    s_bitcmp1_b32 s14, s82
    s_cbranch_scc0 L_ra_24
    v_lshlrev_b32 v224, 16, v128
    v_and_b32 v225, 0xffff0000, v128
    v_pk_add_f32 v[0:1], v[0:1], v[224:225]
    v_lshlrev_b32 v226, 16, v129
    v_and_b32 v227, 0xffff0000, v129
    v_pk_add_f32 v[2:3], v[2:3], v[226:227]
    v_lshlrev_b32 v228, 16, v130
    v_and_b32 v229, 0xffff0000, v130
    v_pk_add_f32 v[4:5], v[4:5], v[228:229]
    v_lshlrev_b32 v230, 16, v131
    v_and_b32 v231, 0xffff0000, v131
    v_pk_add_f32 v[6:7], v[6:7], v[230:231]
    v_lshlrev_b32 v224, 16, v132
    v_and_b32 v225, 0xffff0000, v132
    v_pk_add_f32 v[8:9], v[8:9], v[224:225]
    v_lshlrev_b32 v226, 16, v133
    v_and_b32 v227, 0xffff0000, v133
    v_pk_add_f32 v[10:11], v[10:11], v[226:227]
    v_lshlrev_b32 v228, 16, v134
    v_and_b32 v229, 0xffff0000, v134
    v_pk_add_f32 v[12:13], v[12:13], v[228:229]
    v_lshlrev_b32 v230, 16, v135
    v_and_b32 v231, 0xffff0000, v135
    v_pk_add_f32 v[14:15], v[14:15], v[230:231]
    v_lshlrev_b32 v224, 16, v136
    v_and_b32 v225, 0xffff0000, v136
    v_pk_add_f32 v[16:17], v[16:17], v[224:225]
    v_lshlrev_b32 v226, 16, v137
    v_and_b32 v227, 0xffff0000, v137
    v_pk_add_f32 v[18:19], v[18:19], v[226:227]
    v_lshlrev_b32 v228, 16, v138
    v_and_b32 v229, 0xffff0000, v138
    v_pk_add_f32 v[20:21], v[20:21], v[228:229]
    v_lshlrev_b32 v230, 16, v139
    v_and_b32 v231, 0xffff0000, v139
    v_pk_add_f32 v[22:23], v[22:23], v[230:231]
    v_lshlrev_b32 v224, 16, v140
    v_and_b32 v225, 0xffff0000, v140
    v_pk_add_f32 v[24:25], v[24:25], v[224:225]
    v_lshlrev_b32 v226, 16, v141
    v_and_b32 v227, 0xffff0000, v141
    v_pk_add_f32 v[26:27], v[26:27], v[226:227]
    v_lshlrev_b32 v228, 16, v142
    v_and_b32 v229, 0xffff0000, v142
    v_pk_add_f32 v[28:29], v[28:29], v[228:229]
    v_lshlrev_b32 v230, 16, v143
    v_and_b32 v231, 0xffff0000, v143
    v_pk_add_f32 v[30:31], v[30:31], v[230:231]
L_ra_24:
    s_cmp_eq_u32 s15, 15
    s_cbranch_scc1 L_rf_18
    s_add_u32 s87, s87, 1
    s_cmp_lt_u32 s87, 40000
    s_cbranch_scc1 L_rl_17
L_rf_18:
    ds_write2st64_b32 v184, v0, v4 offset0:0 offset1:1
    ds_write2st64_b32 v184, v8, v12 offset0:2 offset1:3
    ds_write2st64_b32 v184, v1, v5 offset0:4 offset1:5
    ds_write2st64_b32 v184, v9, v13 offset0:6 offset1:7
    ds_write2st64_b32 v185, v2, v6 offset0:0 offset1:1
    ds_write2st64_b32 v185, v10, v14 offset0:2 offset1:3
    ds_write2st64_b32 v185, v3, v7 offset0:4 offset1:5
    ds_write2st64_b32 v185, v11, v15 offset0:6 offset1:7
    ds_read_b128 v[0:3], v157 offset:0
    ds_read_b128 v[4:7], v157 offset:1024
    ds_read_b128 v[8:11], v157 offset:2048
    ds_read_b128 v[12:15], v157 offset:3072
    ds_write2st64_b32 v184, v16, v20 offset0:0 offset1:1
    ds_write2st64_b32 v184, v24, v28 offset0:2 offset1:3
    ds_write2st64_b32 v184, v17, v21 offset0:4 offset1:5
    ds_write2st64_b32 v184, v25, v29 offset0:6 offset1:7
    ds_write2st64_b32 v185, v18, v22 offset0:0 offset1:1
    ds_write2st64_b32 v185, v26, v30 offset0:2 offset1:3
    ds_write2st64_b32 v185, v19, v23 offset0:4 offset1:5
    ds_write2st64_b32 v185, v27, v31 offset0:6 offset1:7
    ds_read_b128 v[16:19], v157 offset:0
    ds_read_b128 v[20:23], v157 offset:1024
    ds_read_b128 v[24:27], v157 offset:2048
    ds_read_b128 v[28:31], v157 offset:3072
    s_waitcnt lgkmcnt(15)
    s_add_u32 s13, s29, 0
    buffer_store_dwordx4 v[0:3], v156, s[72:75], s13 offen offset:0 nt
    s_waitcnt lgkmcnt(14)
    s_add_u32 s13, s29, 20480
    buffer_store_dwordx4 v[4:7], v156, s[72:75], s13 offen offset:0 nt
    s_waitcnt lgkmcnt(13)
    s_add_u32 s13, s29, 40960
    buffer_store_dwordx4 v[8:11], v156, s[72:75], s13 offen offset:0 nt
    s_waitcnt lgkmcnt(12)
    s_add_u32 s13, s29, 61440
    buffer_store_dwordx4 v[12:15], v156, s[72:75], s13 offen offset:0 nt
    s_waitcnt lgkmcnt(3)
    s_add_u32 s13, s29, 0
    buffer_store_dwordx4 v[16:19], v156, s[72:75], s13 offen offset:128 nt
    s_waitcnt lgkmcnt(2)
    s_add_u32 s13, s29, 20480
    buffer_store_dwordx4 v[20:23], v156, s[72:75], s13 offen offset:128 nt
    s_waitcnt lgkmcnt(1)
    s_add_u32 s13, s29, 40960
    buffer_store_dwordx4 v[24:27], v156, s[72:75], s13 offen offset:128 nt
    s_waitcnt lgkmcnt(0)
    s_add_u32 s13, s29, 61440
    buffer_store_dwordx4 v[28:31], v156, s[72:75], s13 offen offset:128 nt
    s_endpgm
LW_k3:
    v_add_u32 v184, 0, v178
    ds_read_b64_tr_b16 a[0:1], v184 offset:0
    ds_read_b64_tr_b16 a[2:3], v184 offset:512
    v_add_u32 v185, 0, v179
    ds_read_b64_tr_b16 a[4:5], v185 offset:0
    ds_read_b64_tr_b16 a[6:7], v185 offset:512
    ds_read_b64_tr_b16 a[8:9], v184 offset:2048
    ds_read_b64_tr_b16 a[10:11], v184 offset:2560
    ds_read_b64_tr_b16 a[12:13], v185 offset:2048
    ds_read_b64_tr_b16 a[14:15], v185 offset:2560
    ds_read_b64_tr_b16 a[16:17], v184 offset:4096
    ds_read_b64_tr_b16 a[18:19], v184 offset:4608
    ds_read_b64_tr_b16 a[20:21], v185 offset:4096
    ds_read_b64_tr_b16 a[22:23], v185 offset:4608
    ds_read_b64_tr_b16 a[24:25], v184 offset:6144
    ds_read_b64_tr_b16 a[26:27], v184 offset:6656
    ds_read_b64_tr_b16 a[28:29], v185 offset:6144
    ds_read_b64_tr_b16 a[30:31], v185 offset:6656
    ds_read_b64_tr_b16 a[32:33], v184 offset:8192
    ds_read_b64_tr_b16 a[34:35], v184 offset:8704
    ds_read_b64_tr_b16 a[36:37], v185 offset:8192
    ds_read_b64_tr_b16 a[38:39], v185 offset:8704
    ds_read_b64_tr_b16 a[40:41], v184 offset:10240
    ds_read_b64_tr_b16 a[42:43], v184 offset:10752
    ds_read_b64_tr_b16 a[44:45], v185 offset:10240
    ds_read_b64_tr_b16 a[46:47], v185 offset:10752
    s_waitcnt lgkmcnt(12)
    v_mfma_f32_32x32x16_bf16 v[32:47], v[96:99], a[0:3], 0
    ds_read_b64_tr_b16 a[48:49], v184 offset:12288
    ds_read_b64_tr_b16 a[50:51], v184 offset:12800
    s_add_u32 s35, s81, s85
    s_add_u32 m0, s94, 98304
    v_mfma_f32_32x32x16_bf16 v[48:63], v[96:99], a[4:7], 0
    ds_read_b64_tr_b16 a[52:53], v185 offset:12288
    ds_read_b64_tr_b16 a[54:55], v185 offset:12800
    buffer_load_dwordx4 v158, s[56:59], s35 offen lds
    s_add_u32 m0, s94, 102400
    v_mfma_f32_32x32x16_bf16 v[32:47], v[100:103], a[8:11], v[32:47]
    ds_read_b64_tr_b16 a[56:57], v184 offset:14336
    ds_read_b64_tr_b16 a[58:59], v184 offset:14848
    buffer_load_dwordx4 v159, s[56:59], s35 offen lds
    s_add_u32 m0, s94, 106496
    v_mfma_f32_32x32x16_bf16 v[48:63], v[100:103], a[12:15], v[48:63]
    ds_read_b64_tr_b16 a[60:61], v185 offset:14336
    ds_read_b64_tr_b16 a[62:63], v185 offset:14848
    v_mfma_f32_32x32x16_bf16 v[32:47], v[104:107], a[16:19], v[32:47]
    ds_read_b64_tr_b16 a[64:65], v184 offset:16384
    ds_read_b64_tr_b16 a[66:67], v184 offset:16896
    buffer_load_dwordx4 v160, s[56:59], s35 offen lds
    s_add_u32 m0, s94, 110592
    v_mfma_f32_32x32x16_bf16 v[48:63], v[104:107], a[20:23], v[48:63]
    ds_read_b64_tr_b16 a[68:69], v185 offset:16384
    ds_read_b64_tr_b16 a[70:71], v185 offset:16896
    s_waitcnt lgkmcnt(12)
    v_mfma_f32_32x32x16_bf16 v[32:47], v[108:111], a[24:27], v[32:47]
    ds_read_b64_tr_b16 a[0:1], v184 offset:18432
    ds_read_b64_tr_b16 a[2:3], v184 offset:18944
    buffer_load_dwordx4 v161, s[56:59], s35 offen lds
    s_add_u32 m0, s94, 114688
    v_mfma_f32_32x32x16_bf16 v[48:63], v[108:111], a[28:31], v[48:63]
    ds_read_b64_tr_b16 a[4:5], v185 offset:18432
    ds_read_b64_tr_b16 a[6:7], v185 offset:18944
    v_mfma_f32_32x32x16_bf16 v[32:47], v[112:115], a[32:35], v[32:47]
    ds_read_b64_tr_b16 a[8:9], v184 offset:20480
    ds_read_b64_tr_b16 a[10:11], v184 offset:20992
    buffer_load_dwordx4 v162, s[56:59], s35 offen lds
    s_add_u32 m0, s94, 118784
    v_mfma_f32_32x32x16_bf16 v[48:63], v[112:115], a[36:39], v[48:63]
    ds_read_b64_tr_b16 a[12:13], v185 offset:20480
    ds_read_b64_tr_b16 a[14:15], v185 offset:20992
    v_mfma_f32_32x32x16_bf16 v[32:47], v[116:119], a[40:43], v[32:47]
    ds_read_b64_tr_b16 a[16:17], v184 offset:22528
    ds_read_b64_tr_b16 a[18:19], v184 offset:23040
    buffer_load_dwordx4 v163, s[56:59], s35 offen lds
    s_add_u32 s35, s81, s86
    s_add_u32 m0, s94, 122880
    v_mfma_f32_32x32x16_bf16 v[48:63], v[116:119], a[44:47], v[48:63]
    ds_read_b64_tr_b16 a[20:21], v185 offset:22528
    ds_read_b64_tr_b16 a[22:23], v185 offset:23040
    s_waitcnt lgkmcnt(12)
    v_mfma_f32_32x32x16_bf16 v[32:47], v[120:123], a[48:51], v[32:47]
    buffer_load_dwordx4 v158, s[56:59], s35 offen lds
    s_add_u32 m0, s94, 126976
    v_mfma_f32_32x32x16_bf16 v[48:63], v[120:123], a[52:55], v[48:63]
    v_mfma_f32_32x32x16_bf16 v[32:47], v[124:127], a[56:59], v[32:47]
    buffer_load_dwordx4 v159, s[56:59], s35 offen lds
    s_add_u32 m0, s94, 131072
    s_waitcnt lgkmcnt(0)
    s_barrier
    v_mfma_f32_32x32x16_bf16 v[48:63], v[124:127], a[60:63], v[48:63]
    v_add_u32 v184, 24576, v178
    ds_read_b64_tr_b16 a[24:25], v184 offset:0
    ds_read_b64_tr_b16 a[26:27], v184 offset:512
    v_add_u32 v185, 24576, v179
    ds_read_b64_tr_b16 a[28:29], v185 offset:0
    v_mfma_f32_32x32x16_bf16 v[32:47], v[128:131], a[64:67], v[32:47]
    ds_read_b64_tr_b16 a[30:31], v185 offset:512
    ds_read_b64_tr_b16 a[32:33], v184 offset:2048
    ds_read_b64_tr_b16 a[34:35], v184 offset:2560
    ds_read_b64_tr_b16 a[36:37], v185 offset:2048
    ds_read_b64_tr_b16 a[38:39], v185 offset:2560
    buffer_load_dwordx4 v160, s[56:59], s35 offen lds
    s_add_u32 m0, s94, 135168
    v_mfma_f32_32x32x16_bf16 v[48:63], v[128:131], a[68:71], v[48:63]
    ds_read_b64_tr_b16 a[40:41], v184 offset:4096
    ds_read_b64_tr_b16 a[42:43], v184 offset:4608
    ds_read_b64_tr_b16 a[44:45], v185 offset:4096
    ds_read_b64_tr_b16 a[46:47], v185 offset:4608
    v_mfma_f32_32x32x16_bf16 v[32:47], v[132:135], a[0:3], v[32:47]
    ds_read_b64_tr_b16 a[48:49], v184 offset:6144
    ds_read_b64_tr_b16 a[50:51], v184 offset:6656
    buffer_load_dwordx4 v161, s[56:59], s35 offen lds
    s_add_u32 m0, s94, 139264
    v_mfma_f32_32x32x16_bf16 v[48:63], v[132:135], a[4:7], v[48:63]
    ds_read_b64_tr_b16 a[52:53], v185 offset:6144
    ds_read_b64_tr_b16 a[54:55], v185 offset:6656
    v_mfma_f32_32x32x16_bf16 v[32:47], v[136:139], a[8:11], v[32:47]
    ds_read_b64_tr_b16 a[56:57], v184 offset:8192
    ds_read_b64_tr_b16 a[58:59], v184 offset:8704
    buffer_load_dwordx4 v162, s[56:59], s35 offen lds
    s_add_u32 m0, s94, 143360
    v_mfma_f32_32x32x16_bf16 v[48:63], v[136:139], a[12:15], v[48:63]
    ds_read_b64_tr_b16 a[60:61], v185 offset:8192
    ds_read_b64_tr_b16 a[62:63], v185 offset:8704
    v_mfma_f32_32x32x16_bf16 v[32:47], v[140:143], a[16:19], v[32:47]
    ds_read_b64_tr_b16 a[64:65], v184 offset:10240
    ds_read_b64_tr_b16 a[66:67], v184 offset:10752
    buffer_load_dwordx4 v163, s[56:59], s35 offen lds
    s_add_u32 s35, s82, s84
    s_add_u32 m0, s94, 0
    v_mfma_f32_32x32x16_bf16 v[48:63], v[140:143], a[20:23], v[48:63]
    ds_read_b64_tr_b16 a[68:69], v185 offset:10240
    ds_read_b64_tr_b16 a[70:71], v185 offset:10752
    s_waitcnt lgkmcnt(12)
    v_mfma_f32_32x32x16_bf16 v[64:79], v[96:99], a[24:27], 0
    s_waitcnt vmcnt(12)
    s_lshl_b32 s12, s6, 6
    s_add_u32 s12, s12, s24
    s_mov_b64 exec, 1
    s_add_u32 s96, s12, 589824
    buffer_store_dwordx4 v[198:201], v155, s[68:71], s96 offen
    buffer_store_dwordx4 v[198:201], v155, s[68:71], s12 offen sc1
    s_mov_b64 exec, -1
    v_mfma_f32_32x32x16_bf16 v[80:95], v[96:99], a[28:31], 0
    ds_read_b64_tr_b16 a[0:1], v184 offset:12288
    ds_read_b64_tr_b16 a[2:3], v184 offset:12800
    ds_read_b64_tr_b16 a[4:5], v185 offset:12288
    buffer_load_dwordx4 v158, s[56:59], s35 offen lds
    s_add_u32 m0, s94, 4096
    v_mfma_f32_32x32x16_bf16 v[64:79], v[100:103], a[32:35], v[64:79]
    ds_read_b64_tr_b16 a[6:7], v185 offset:12800
    ds_read_b64_tr_b16 a[8:9], v184 offset:14336
    ds_read_b64_tr_b16 a[10:11], v184 offset:14848
    buffer_load_dwordx4 v159, s[56:59], s35 offen lds
    s_add_u32 m0, s94, 8192
    v_mfma_f32_32x32x16_bf16 v[80:95], v[100:103], a[36:39], v[80:95]
    ds_read_b64_tr_b16 a[12:13], v185 offset:14336
    ds_read_b64_tr_b16 a[14:15], v185 offset:14848
    v_mfma_f32_32x32x16_bf16 v[64:79], v[104:107], a[40:43], v[64:79]
    ds_read_b64_tr_b16 a[16:17], v184 offset:16384
    ds_read_b64_tr_b16 a[18:19], v184 offset:16896
    buffer_load_dwordx4 v160, s[56:59], s35 offen lds
    s_add_u32 m0, s94, 12288
    v_mfma_f32_32x32x16_bf16 v[80:95], v[104:107], a[44:47], v[80:95]
    ds_read_b64_tr_b16 a[20:21], v185 offset:16384
    ds_read_b64_tr_b16 a[22:23], v185 offset:16896
    s_waitcnt lgkmcnt(12)
    v_mfma_f32_32x32x16_bf16 v[64:79], v[108:111], a[48:51], v[64:79]
    ds_read_b64_tr_b16 a[24:25], v184 offset:18432
    ds_read_b64_tr_b16 a[26:27], v184 offset:18944
    buffer_load_dwordx4 v161, s[56:59], s35 offen lds
    s_add_u32 m0, s94, 16384
    v_mfma_f32_32x32x16_bf16 v[80:95], v[108:111], a[52:55], v[80:95]
    ds_read_b64_tr_b16 a[28:29], v185 offset:18432
    ds_read_b64_tr_b16 a[30:31], v185 offset:18944
    v_mfma_f32_32x32x16_bf16 v[64:79], v[112:115], a[56:59], v[64:79]
    ds_read_b64_tr_b16 a[32:33], v184 offset:20480
    ds_read_b64_tr_b16 a[34:35], v184 offset:20992
    buffer_load_dwordx4 v162, s[56:59], s35 offen lds
    s_add_u32 m0, s94, 20480
    v_mfma_f32_32x32x16_bf16 v[80:95], v[112:115], a[60:63], v[80:95]
    ds_read_b64_tr_b16 a[36:37], v185 offset:20480
    ds_read_b64_tr_b16 a[38:39], v185 offset:20992
    v_mfma_f32_32x32x16_bf16 v[64:79], v[116:119], a[64:67], v[64:79]
    ds_read_b64_tr_b16 a[40:41], v184 offset:22528
    ds_read_b64_tr_b16 a[42:43], v184 offset:23040
    buffer_load_dwordx4 v163, s[56:59], s35 offen lds
    v_mfma_f32_32x32x16_bf16 v[80:95], v[116:119], a[68:71], v[80:95]
    ds_read_b64_tr_b16 a[44:45], v185 offset:22528
    ds_read_b64_tr_b16 a[46:47], v185 offset:23040
    s_waitcnt lgkmcnt(12)
    v_mfma_f32_32x32x16_bf16 v[64:79], v[120:123], a[0:3], v[64:79]
    v_mfma_f32_32x32x16_bf16 v[80:95], v[120:123], a[4:7], v[80:95]
    v_mfma_f32_32x32x16_bf16 v[64:79], v[124:127], a[8:11], v[64:79]
    s_waitcnt lgkmcnt(0)
    s_barrier
    v_mfma_f32_32x32x16_bf16 v[80:95], v[124:127], a[12:15], v[80:95]
    v_add_u32 v184, 49152, v178
    ds_read_b64_tr_b16 a[48:49], v184 offset:0
    ds_read_b64_tr_b16 a[50:51], v184 offset:512
    v_add_u32 v185, 49152, v179
    ds_read_b64_tr_b16 a[52:53], v185 offset:0
    s_add_u32 s35, s83, s90
    s_add_u32 m0, s94, 24576
    v_mfma_f32_32x32x16_bf16 v[64:79], v[128:131], a[16:19], v[64:79]
    ds_read_b64_tr_b16 a[54:55], v185 offset:512
    ds_read_b64_tr_b16 a[56:57], v184 offset:2048
    ds_read_b64_tr_b16 a[58:59], v184 offset:2560
    ds_read_b64_tr_b16 a[60:61], v185 offset:2048
    ds_read_b64_tr_b16 a[62:63], v185 offset:2560
    buffer_load_dwordx4 v164, s[60:63], s35 offen lds
    s_add_u32 m0, s94, 28672
    v_mfma_f32_32x32x16_bf16 v[80:95], v[128:131], a[20:23], v[80:95]
    ds_read_b64_tr_b16 a[64:65], v184 offset:4096
    ds_read_b64_tr_b16 a[66:67], v184 offset:4608
    ds_read_b64_tr_b16 a[68:69], v185 offset:4096
    ds_read_b64_tr_b16 a[70:71], v185 offset:4608
    buffer_load_dwordx4 v165, s[60:63], s35 offen lds
    s_add_u32 m0, s94, 32768
    v_mfma_f32_32x32x16_bf16 v[64:79], v[132:135], a[24:27], v[64:79]
    ds_read_b64_tr_b16 a[0:1], v184 offset:6144
    ds_read_b64_tr_b16 a[2:3], v184 offset:6656
    v_mfma_f32_32x32x16_bf16 v[80:95], v[132:135], a[28:31], v[80:95]
    ds_read_b64_tr_b16 a[4:5], v185 offset:6144
    ds_read_b64_tr_b16 a[6:7], v185 offset:6656
    buffer_load_dwordx4 v164, s[64:67], s35 offen lds
    s_add_u32 m0, s94, 36864
    v_mfma_f32_32x32x16_bf16 v[64:79], v[136:139], a[32:35], v[64:79]
    ds_read_b64_tr_b16 a[8:9], v184 offset:8192
    ds_read_b64_tr_b16 a[10:11], v184 offset:8704
    v_mfma_f32_32x32x16_bf16 v[80:95], v[136:139], a[36:39], v[80:95]
    ds_read_b64_tr_b16 a[12:13], v185 offset:8192
    ds_read_b64_tr_b16 a[14:15], v185 offset:8704
    buffer_load_dwordx4 v165, s[64:67], s35 offen lds
    v_mfma_f32_32x32x16_bf16 v[64:79], v[140:143], a[40:43], v[64:79]
    ds_read_b64_tr_b16 a[16:17], v184 offset:10240
    ds_read_b64_tr_b16 a[18:19], v184 offset:10752
    v_mfma_f32_32x32x16_bf16 v[80:95], v[140:143], a[44:47], v[80:95]
    ds_read_b64_tr_b16 a[20:21], v185 offset:10240
    ds_read_b64_tr_b16 a[22:23], v185 offset:10752
    s_waitcnt lgkmcnt(12)
    v_mfma_f32_32x32x16_bf16 v[0:15], v[96:99], a[48:51], 0
    buffer_load_dwordx4 v[190:193], v239, s[68:71], s31 offen sc1
    ds_read_b64_tr_b16 a[24:25], v184 offset:12288
    ds_read_b64_tr_b16 a[26:27], v184 offset:12800
    v_mfma_f32_32x32x16_bf16 v[16:31], v[96:99], a[52:55], 0
    ds_read_b64_tr_b16 a[28:29], v185 offset:12288
    ds_read_b64_tr_b16 a[30:31], v185 offset:12800
    v_mfma_f32_32x32x16_bf16 v[0:15], v[100:103], a[56:59], v[0:15]
    ds_read_b64_tr_b16 a[32:33], v184 offset:14336
    ds_read_b64_tr_b16 a[34:35], v184 offset:14848
    v_mfma_f32_32x32x16_bf16 v[16:31], v[100:103], a[60:63], v[16:31]
    ds_read_b64_tr_b16 a[36:37], v185 offset:14336
    ds_read_b64_tr_b16 a[38:39], v185 offset:14848
    v_mfma_f32_32x32x16_bf16 v[0:15], v[104:107], a[64:67], v[0:15]
    ds_read_b64_tr_b16 a[40:41], v184 offset:16384
    ds_read_b64_tr_b16 a[42:43], v184 offset:16896
    v_mfma_f32_32x32x16_bf16 v[16:31], v[104:107], a[68:71], v[16:31]
    ds_read_b64_tr_b16 a[44:45], v185 offset:16384
    ds_read_b64_tr_b16 a[46:47], v185 offset:16896
    s_waitcnt lgkmcnt(12)
    v_mfma_f32_32x32x16_bf16 v[0:15], v[108:111], a[0:3], v[0:15]
    ds_read_b64_tr_b16 a[48:49], v184 offset:18432
    ds_read_b64_tr_b16 a[50:51], v184 offset:18944
    v_mfma_f32_32x32x16_bf16 v[16:31], v[108:111], a[4:7], v[16:31]
    ds_read_b64_tr_b16 a[52:53], v185 offset:18432
    ds_read_b64_tr_b16 a[54:55], v185 offset:18944
    v_mfma_f32_32x32x16_bf16 v[0:15], v[112:115], a[8:11], v[0:15]
    ds_read_b64_tr_b16 a[56:57], v184 offset:20480
    ds_read_b64_tr_b16 a[58:59], v184 offset:20992
    v_mfma_f32_32x32x16_bf16 v[16:31], v[112:115], a[12:15], v[16:31]
    ds_read_b64_tr_b16 a[60:61], v185 offset:20480
    ds_read_b64_tr_b16 a[62:63], v185 offset:20992
    v_mfma_f32_32x32x16_bf16 v[0:15], v[116:119], a[16:19], v[0:15]
    ds_read_b64_tr_b16 a[64:65], v184 offset:22528
    ds_read_b64_tr_b16 a[66:67], v184 offset:23040
    v_mfma_f32_32x32x16_bf16 v[16:31], v[116:119], a[20:23], v[16:31]
    ds_read_b64_tr_b16 a[68:69], v185 offset:22528
    ds_read_b64_tr_b16 a[70:71], v185 offset:23040
    s_waitcnt lgkmcnt(12)
    v_mfma_f32_32x32x16_bf16 v[0:15], v[120:123], a[24:27], v[0:15]
    v_mfma_f32_32x32x16_bf16 v[16:31], v[120:123], a[28:31], v[16:31]
    v_mfma_f32_32x32x16_bf16 v[0:15], v[124:127], a[32:35], v[0:15]
    s_waitcnt lgkmcnt(0)
    s_barrier
    v_mfma_f32_32x32x16_bf16 v[16:31], v[124:127], a[36:39], v[16:31]
    v_add_u32 v184, 73728, v178
    ds_read_b64_tr_b16 a[0:1], v184 offset:0
    ds_read_b64_tr_b16 a[2:3], v184 offset:512
    v_add_u32 v185, 73728, v179
    ds_read_b64_tr_b16 a[4:5], v185 offset:0
    s_add_u32 s35, s82, s85
    s_add_u32 m0, s94, 49152
    v_mfma_f32_32x32x16_bf16 v[0:15], v[128:131], a[40:43], v[0:15]
    ds_read_b64_tr_b16 a[6:7], v185 offset:512
    ds_read_b64_tr_b16 a[8:9], v184 offset:2048
    ds_read_b64_tr_b16 a[10:11], v184 offset:2560
    ds_read_b64_tr_b16 a[12:13], v185 offset:2048
    ds_read_b64_tr_b16 a[14:15], v185 offset:2560
    buffer_load_dwordx4 v158, s[56:59], s35 offen lds
    s_add_u32 m0, s94, 53248
    v_mfma_f32_32x32x16_bf16 v[16:31], v[128:131], a[44:47], v[16:31]
    ds_read_b64_tr_b16 a[16:17], v184 offset:4096
    ds_read_b64_tr_b16 a[18:19], v184 offset:4608
    ds_read_b64_tr_b16 a[20:21], v185 offset:4096
    ds_read_b64_tr_b16 a[22:23], v185 offset:4608
    buffer_load_dwordx4 v159, s[56:59], s35 offen lds
    s_add_u32 m0, s94, 57344
    v_mfma_f32_32x32x16_bf16 v[0:15], v[132:135], a[48:51], v[0:15]
    s_or_b32 s13, s17, s18
    s_waitcnt vmcnt(2)
    v_cmp_eq_u64 vcc, s[88:89], v[192:193]
    s_nop 1
    s_and_b32 s12, vcc_lo, s13
    s_cmp_eq_u32 s12, s13
    s_cbranch_scc0 L_rt_26
L_ok_25:
    v_mfma_f32_32x32x16_bf16 v[16:31], v[132:135], a[52:55], v[16:31]
    ds_read_b64_tr_b16 a[24:25], v184 offset:6144
    ds_read_b64_tr_b16 a[26:27], v184 offset:6656
    ds_read_b64_tr_b16 a[28:29], v185 offset:6144
    buffer_load_dwordx4 v160, s[56:59], s35 offen lds
    s_add_u32 s40, s21, 8192
    v_mfma_f32_32x32x16_bf16 v[0:15], v[136:139], a[56:59], v[0:15]
    ds_read_b64_tr_b16 a[30:31], v185 offset:6656
    ds_read_b64_tr_b16 a[32:33], v184 offset:8192
    ds_read_b64_tr_b16 a[34:35], v184 offset:8704
    v_mfma_f32_32x32x16_bf16 v[16:31], v[136:139], a[60:63], v[16:31]
    ds_read_b64_tr_b16 a[36:37], v185 offset:8192
    ds_read_b64_tr_b16 a[38:39], v185 offset:8704
    buffer_load_dwordx4 a[104:107], v147, s[68:71], s40 offen offset:0 sc1
    v_mfma_f32_32x32x16_bf16 v[0:15], v[140:143], a[64:67], v[0:15]
    ds_read_b64_tr_b16 a[40:41], v184 offset:10240
    ds_read_b64_tr_b16 a[42:43], v184 offset:10752
    v_mfma_f32_32x32x16_bf16 v[16:31], v[140:143], a[68:71], v[16:31]
    ds_read_b64_tr_b16 a[44:45], v185 offset:10240
    ds_read_b64_tr_b16 a[46:47], v185 offset:10752
    buffer_load_dwordx4 a[108:111], v147, s[68:71], s40 offen offset:1024 sc1
    s_waitcnt lgkmcnt(12)
    v_mfma_f32_32x32x16_bf16 v[32:47], a[72:75], a[0:3], v[32:47]
    buffer_load_dwordx4 a[112:115], v147, s[68:71], s40 offen offset:2048 sc1
    v_mfma_f32_32x32x16_bf16 v[48:63], a[72:75], a[4:7], v[48:63]
    buffer_load_dwordx4 a[116:119], v147, s[68:71], s40 offen offset:3072 sc1
    s_add_u32 s40, s22, 0
    v_mfma_f32_32x32x16_bf16 v[32:47], a[76:79], a[8:11], v[32:47]
    s_waitcnt lgkmcnt(0)
    s_barrier
    v_mfma_f32_32x32x16_bf16 v[48:63], a[76:79], a[12:15], v[48:63]
    ds_read_b64_tr_b16 a[48:49], v184 offset:12288
    ds_read_b64_tr_b16 a[50:51], v184 offset:12800
    ds_read_b64_tr_b16 a[52:53], v185 offset:12288
    ds_read_b64_tr_b16 a[54:55], v185 offset:12800
    ds_read_b64_tr_b16 a[56:57], v184 offset:14336
    v_mfma_f32_32x32x16_bf16 v[32:47], a[80:83], a[16:19], v[32:47]
    ds_read_b64_tr_b16 a[58:59], v184 offset:14848
    ds_read_b64_tr_b16 a[60:61], v185 offset:14336
    ds_read_b64_tr_b16 a[62:63], v185 offset:14848
    v_add_u32 v184, 98304, v178
    ds_read_b64_tr_b16 a[64:65], v184 offset:0
    v_mfma_f32_32x32x16_bf16 v[48:63], a[80:83], a[20:23], v[48:63]
    ds_read_b64_tr_b16 a[66:67], v184 offset:512
    v_add_u32 v185, 98304, v179
    ds_read_b64_tr_b16 a[68:69], v185 offset:0
    ds_read_b64_tr_b16 a[70:71], v185 offset:512
    buffer_load_dwordx4 a[120:123], v147, s[68:71], s40 offen offset:0 sc1
    v_mfma_f32_32x32x16_bf16 v[32:47], a[84:87], a[24:27], v[32:47]
    ds_read_b64_tr_b16 a[0:1], v184 offset:2048
    ds_read_b64_tr_b16 a[2:3], v184 offset:2560
    v_mfma_f32_32x32x16_bf16 v[48:63], a[84:87], a[28:31], v[48:63]
    ds_read_b64_tr_b16 a[4:5], v185 offset:2048
    ds_read_b64_tr_b16 a[6:7], v185 offset:2560
    buffer_load_dwordx4 a[124:127], v147, s[68:71], s40 offen offset:1024 sc1
    v_mfma_f32_32x32x16_bf16 v[32:47], a[88:91], a[32:35], v[32:47]
    ds_read_b64_tr_b16 a[8:9], v184 offset:4096
    ds_read_b64_tr_b16 a[10:11], v184 offset:4608
    v_mfma_f32_32x32x16_bf16 v[48:63], a[88:91], a[36:39], v[48:63]
    ds_read_b64_tr_b16 a[12:13], v185 offset:4096
    ds_read_b64_tr_b16 a[14:15], v185 offset:4608
    buffer_load_dwordx4 a[128:131], v147, s[68:71], s40 offen offset:2048 sc1
    v_mfma_f32_32x32x16_bf16 v[32:47], a[92:95], a[40:43], v[32:47]
    ds_read_b64_tr_b16 a[16:17], v184 offset:6144
    ds_read_b64_tr_b16 a[18:19], v184 offset:6656
    v_mfma_f32_32x32x16_bf16 v[48:63], a[92:95], a[44:47], v[48:63]
    ds_read_b64_tr_b16 a[20:21], v185 offset:6144
    ds_read_b64_tr_b16 a[22:23], v185 offset:6656
    buffer_load_dwordx4 a[132:135], v147, s[68:71], s40 offen offset:3072 sc1
    s_add_u32 s40, s22, 4096
    s_waitcnt lgkmcnt(12)
    v_mfma_f32_32x32x16_bf16 v[32:47], a[96:99], a[48:51], v[32:47]
    ds_read_b64_tr_b16 a[24:25], v184 offset:8192
    ds_read_b64_tr_b16 a[26:27], v184 offset:8704
    v_mfma_f32_32x32x16_bf16 v[48:63], a[96:99], a[52:55], v[48:63]
    ds_read_b64_tr_b16 a[28:29], v185 offset:8192
    ds_read_b64_tr_b16 a[30:31], v185 offset:8704
    buffer_load_dwordx4 a[136:139], v147, s[68:71], s40 offen offset:0 sc1
    v_mfma_f32_32x32x16_bf16 v[32:47], a[100:103], a[56:59], v[32:47]
    ds_read_b64_tr_b16 a[32:33], v184 offset:10240
    ds_read_b64_tr_b16 a[34:35], v184 offset:10752
    v_mfma_f32_32x32x16_bf16 v[48:63], a[100:103], a[60:63], v[48:63]
    ds_read_b64_tr_b16 a[36:37], v185 offset:10240
    ds_read_b64_tr_b16 a[38:39], v185 offset:10752
    buffer_load_dwordx4 a[140:143], v147, s[68:71], s40 offen offset:1024 sc1
    v_mfma_f32_32x32x16_bf16 v[64:79], a[72:75], a[64:67], v[64:79]
    ds_read_b64_tr_b16 a[40:41], v184 offset:12288
    ds_read_b64_tr_b16 a[42:43], v184 offset:12800
    v_mfma_f32_32x32x16_bf16 v[80:95], a[72:75], a[68:71], v[80:95]
    ds_read_b64_tr_b16 a[44:45], v185 offset:12288
    ds_read_b64_tr_b16 a[46:47], v185 offset:12800
    buffer_load_dwordx4 a[144:147], v147, s[68:71], s40 offen offset:2048 sc1
    s_waitcnt lgkmcnt(12)
    v_mfma_f32_32x32x16_bf16 v[64:79], a[76:79], a[0:3], v[64:79]
    buffer_load_dwordx4 v[190:193], v239, s[68:71], s31 offen sc1
    ds_read_b64_tr_b16 a[48:49], v184 offset:14336
    ds_read_b64_tr_b16 a[50:51], v184 offset:14848
    ds_read_b64_tr_b16 a[52:53], v185 offset:14336
    v_mfma_f32_32x32x16_bf16 v[80:95], a[76:79], a[4:7], v[80:95]
    ds_read_b64_tr_b16 a[54:55], v185 offset:14848
    v_add_u32 v184, 122880, v178
    ds_read_b64_tr_b16 a[56:57], v184 offset:0
    buffer_load_dwordx4 a[148:151], v147, s[68:71], s40 offen offset:3072 sc1
    s_add_u32 s40, s22, 8192
    v_mfma_f32_32x32x16_bf16 v[64:79], a[80:83], a[8:11], v[64:79]
    ds_read_b64_tr_b16 a[58:59], v184 offset:512
    v_add_u32 v185, 122880, v179
    v_mfma_f32_32x32x16_bf16 v[80:95], a[80:83], a[12:15], v[80:95]
    ds_read_b64_tr_b16 a[60:61], v185 offset:0
    ds_read_b64_tr_b16 a[62:63], v185 offset:512
    buffer_load_dwordx4 a[152:155], v147, s[68:71], s40 offen offset:0 sc1
    v_mfma_f32_32x32x16_bf16 v[64:79], a[84:87], a[16:19], v[64:79]
    ds_read_b64_tr_b16 a[64:65], v184 offset:2048
    ds_read_b64_tr_b16 a[66:67], v184 offset:2560
    v_mfma_f32_32x32x16_bf16 v[80:95], a[84:87], a[20:23], v[80:95]
    ds_read_b64_tr_b16 a[68:69], v185 offset:2048
    ds_read_b64_tr_b16 a[70:71], v185 offset:2560
    buffer_load_dwordx4 a[156:159], v147, s[68:71], s40 offen offset:1024 sc1
    s_waitcnt lgkmcnt(12)
    v_mfma_f32_32x32x16_bf16 v[64:79], a[88:91], a[24:27], v[64:79]
    ds_read_b64_tr_b16 a[0:1], v184 offset:4096
    ds_read_b64_tr_b16 a[2:3], v184 offset:4608
    v_mfma_f32_32x32x16_bf16 v[80:95], a[88:91], a[28:31], v[80:95]
    ds_read_b64_tr_b16 a[4:5], v185 offset:4096
    ds_read_b64_tr_b16 a[6:7], v185 offset:4608
    buffer_load_dwordx4 a[160:163], v147, s[68:71], s40 offen offset:2048 sc1
    v_mfma_f32_32x32x16_bf16 v[64:79], a[92:95], a[32:35], v[64:79]
    ds_read_b64_tr_b16 a[8:9], v184 offset:6144
    ds_read_b64_tr_b16 a[10:11], v184 offset:6656
    v_mfma_f32_32x32x16_bf16 v[80:95], a[92:95], a[36:39], v[80:95]
    ds_read_b64_tr_b16 a[12:13], v185 offset:6144
    ds_read_b64_tr_b16 a[14:15], v185 offset:6656
    buffer_load_dwordx4 a[164:167], v147, s[68:71], s40 offen offset:3072 sc1
    s_add_u32 m0, s94, 61440
    v_mfma_f32_32x32x16_bf16 v[64:79], a[96:99], a[40:43], v[64:79]
    ds_read_b64_tr_b16 a[16:17], v184 offset:8192
    ds_read_b64_tr_b16 a[18:19], v184 offset:8704
    v_mfma_f32_32x32x16_bf16 v[80:95], a[96:99], a[44:47], v[80:95]
    ds_read_b64_tr_b16 a[20:21], v185 offset:8192
    ds_read_b64_tr_b16 a[22:23], v185 offset:8704
    buffer_load_dwordx4 v161, s[56:59], s35 offen lds
    s_add_u32 m0, s94, 65536
    s_waitcnt lgkmcnt(12)
    v_mfma_f32_32x32x16_bf16 v[64:79], a[100:103], a[48:51], v[64:79]
    ds_read_b64_tr_b16 a[24:25], v184 offset:10240
    ds_read_b64_tr_b16 a[26:27], v184 offset:10752
    v_mfma_f32_32x32x16_bf16 v[80:95], a[100:103], a[52:55], v[80:95]
    ds_read_b64_tr_b16 a[28:29], v185 offset:10240
    ds_read_b64_tr_b16 a[30:31], v185 offset:10752
    buffer_load_dwordx4 v162, s[56:59], s35 offen lds
    s_add_u32 m0, s94, 69632
    v_mfma_f32_32x32x16_bf16 v[0:15], a[72:75], a[56:59], v[0:15]
    ds_read_b64_tr_b16 a[32:33], v184 offset:12288
    ds_read_b64_tr_b16 a[34:35], v184 offset:12800
    v_mfma_f32_32x32x16_bf16 v[16:31], a[72:75], a[60:63], v[16:31]
    ds_read_b64_tr_b16 a[36:37], v185 offset:12288
    ds_read_b64_tr_b16 a[38:39], v185 offset:12800
    buffer_load_dwordx4 v163, s[56:59], s35 offen lds
    v_mfma_f32_32x32x16_bf16 v[0:15], a[76:79], a[64:67], v[0:15]
    ds_read_b64_tr_b16 a[40:41], v184 offset:14336
    ds_read_b64_tr_b16 a[42:43], v184 offset:14848
    v_mfma_f32_32x32x16_bf16 v[16:31], a[76:79], a[68:71], v[16:31]
    ds_read_b64_tr_b16 a[44:45], v185 offset:14336
    ds_read_b64_tr_b16 a[46:47], v185 offset:14848
    s_waitcnt lgkmcnt(12)
    v_mfma_f32_32x32x16_bf16 v[0:15], a[80:83], a[0:3], v[0:15]
    s_waitcnt vmcnt(8)
    v_cmp_eq_u64 vcc, s[88:89], v[192:193]
    s_nop 1
    s_and_b32 s12, vcc_lo, s19
    s_cmp_eq_u32 s12, s19
    s_cbranch_scc0 L_rt_28
L_ok_27:
    v_mfma_f32_32x32x16_bf16 v[16:31], a[80:83], a[4:7], v[16:31]
    v_add_u32 v184, 73728, v178
    ds_read_b64_tr_b16 a[48:49], v184 offset:16384
    ds_read_b64_tr_b16 a[50:51], v184 offset:16896
    s_add_u32 s40, s23, 0
    v_mfma_f32_32x32x16_bf16 v[0:15], a[84:87], a[8:11], v[0:15]
    v_add_u32 v185, 73728, v179
    ds_read_b64_tr_b16 a[52:53], v185 offset:16384
    ds_read_b64_tr_b16 a[54:55], v185 offset:16896
    buffer_load_dwordx4 a[168:171], v147, s[68:71], s40 offen offset:0 sc1
    v_mfma_f32_32x32x16_bf16 v[16:31], a[84:87], a[12:15], v[16:31]
    ds_read_b64_tr_b16 a[56:57], v184 offset:18432
    ds_read_b64_tr_b16 a[58:59], v184 offset:18944
    ds_read_b64_tr_b16 a[60:61], v185 offset:18432
    buffer_load_dwordx4 a[172:175], v147, s[68:71], s40 offen offset:1024 sc1
    v_mfma_f32_32x32x16_bf16 v[0:15], a[88:91], a[16:19], v[0:15]
    ds_read_b64_tr_b16 a[62:63], v185 offset:18944
    ds_read_b64_tr_b16 a[64:65], v184 offset:20480
    ds_read_b64_tr_b16 a[66:67], v184 offset:20992
    v_mfma_f32_32x32x16_bf16 v[16:31], a[88:91], a[20:23], v[16:31]
    ds_read_b64_tr_b16 a[68:69], v185 offset:20480
    ds_read_b64_tr_b16 a[70:71], v185 offset:20992
    buffer_load_dwordx4 a[176:179], v147, s[68:71], s40 offen offset:2048 sc1
    s_waitcnt lgkmcnt(12)
    v_mfma_f32_32x32x16_bf16 v[0:15], a[92:95], a[24:27], v[0:15]
    ds_read_b64_tr_b16 a[0:1], v184 offset:22528
    ds_read_b64_tr_b16 a[2:3], v184 offset:23040
    ds_read_b64_tr_b16 a[4:5], v185 offset:22528
    v_mfma_f32_32x32x16_bf16 v[16:31], a[92:95], a[28:31], v[16:31]
    ds_read_b64_tr_b16 a[6:7], v185 offset:23040
    v_add_u32 v184, 98304, v178
    ds_read_b64_tr_b16 a[8:9], v184 offset:16384
    buffer_load_dwordx4 a[180:183], v147, s[68:71], s40 offen offset:3072 sc1
    s_add_u32 s40, s23, 4096
    v_mfma_f32_32x32x16_bf16 v[0:15], a[96:99], a[32:35], v[0:15]
    ds_read_b64_tr_b16 a[10:11], v184 offset:16896
    v_add_u32 v185, 98304, v179
    v_mfma_f32_32x32x16_bf16 v[16:31], a[96:99], a[36:39], v[16:31]
    ds_read_b64_tr_b16 a[12:13], v185 offset:16384
    ds_read_b64_tr_b16 a[14:15], v185 offset:16896
    buffer_load_dwordx4 a[184:187], v147, s[68:71], s40 offen offset:0 sc1
    v_mfma_f32_32x32x16_bf16 v[0:15], a[100:103], a[40:43], v[0:15]
    ds_read_b64_tr_b16 a[16:17], v184 offset:18432
    ds_read_b64_tr_b16 a[18:19], v184 offset:18944
    v_mfma_f32_32x32x16_bf16 v[16:31], a[100:103], a[44:47], v[16:31]
    ds_read_b64_tr_b16 a[20:21], v185 offset:18432
    ds_read_b64_tr_b16 a[22:23], v185 offset:18944
    buffer_load_dwordx4 a[188:191], v147, s[68:71], s40 offen offset:1024 sc1
    s_waitcnt lgkmcnt(12)
    v_mfma_f32_32x32x16_bf16 v[32:47], a[104:107], a[48:51], v[32:47]
    v_mfma_f32_32x32x16_bf16 v[48:63], a[104:107], a[52:55], v[48:63]
    buffer_load_dwordx4 a[192:195], v147, s[68:71], s40 offen offset:2048 sc1
    v_mfma_f32_32x32x16_bf16 v[32:47], a[108:111], a[56:59], v[32:47]
    s_waitcnt lgkmcnt(0)
    s_barrier
    v_mfma_f32_32x32x16_bf16 v[48:63], a[108:111], a[60:63], v[48:63]
    ds_read_b64_tr_b16 a[24:25], v184 offset:20480
    ds_read_b64_tr_b16 a[26:27], v184 offset:20992
    ds_read_b64_tr_b16 a[28:29], v185 offset:20480
    ds_read_b64_tr_b16 a[30:31], v185 offset:20992
    ds_read_b64_tr_b16 a[32:33], v184 offset:22528
    buffer_load_dwordx4 a[196:199], v147, s[68:71], s40 offen offset:3072 sc1
    s_add_u32 s35, s83, s91
    s_add_u32 m0, s94, 73728
    v_mfma_f32_32x32x16_bf16 v[32:47], a[112:115], a[64:67], v[32:47]
    ds_read_b64_tr_b16 a[34:35], v184 offset:23040
    ds_read_b64_tr_b16 a[36:37], v185 offset:22528
    ds_read_b64_tr_b16 a[38:39], v185 offset:23040
    v_add_u32 v184, 122880, v178
    ds_read_b64_tr_b16 a[40:41], v184 offset:16384
    v_mfma_f32_32x32x16_bf16 v[48:63], a[112:115], a[68:71], v[48:63]
    ds_read_b64_tr_b16 a[42:43], v184 offset:16896
    v_add_u32 v185, 122880, v179
    ds_read_b64_tr_b16 a[44:45], v185 offset:16384
    ds_read_b64_tr_b16 a[46:47], v185 offset:16896
    buffer_load_dwordx4 v164, s[60:63], s35 offen lds
    s_add_u32 m0, s94, 77824
    v_mfma_f32_32x32x16_bf16 v[32:47], a[116:119], a[0:3], v[32:47]
    v_mfma_f32_32x32x16_bf16 v[48:63], a[116:119], a[4:7], v[48:63]
    buffer_load_dwordx4 v165, s[60:63], s35 offen lds
    s_add_u32 m0, s94, 81920
    v_mfma_f32_32x32x16_bf16 v[64:79], a[104:107], a[8:11], v[64:79]
    s_waitcnt lgkmcnt(0)
    s_barrier
    v_mfma_f32_32x32x16_bf16 v[80:95], a[104:107], a[12:15], v[80:95]
    ds_read_b64_tr_b16 a[48:49], v184 offset:18432
    ds_read_b64_tr_b16 a[50:51], v184 offset:18944
    ds_read_b64_tr_b16 a[52:53], v185 offset:18432
    ds_read_b64_tr_b16 a[54:55], v185 offset:18944
    buffer_load_dwordx4 v164, s[64:67], s35 offen lds
    s_add_u32 m0, s94, 86016
    v_mfma_f32_32x32x16_bf16 v[64:79], a[108:111], a[16:19], v[64:79]
    ds_read_b64_tr_b16 a[56:57], v184 offset:20480
    ds_read_b64_tr_b16 a[58:59], v184 offset:20992
    ds_read_b64_tr_b16 a[60:61], v185 offset:20480
    ds_read_b64_tr_b16 a[62:63], v185 offset:20992
    v_mfma_f32_32x32x16_bf16 v[80:95], a[108:111], a[20:23], v[80:95]
    ds_read_b64_tr_b16 a[64:65], v184 offset:22528
    ds_read_b64_tr_b16 a[66:67], v184 offset:23040
    ds_read_b64_tr_b16 a[68:69], v185 offset:22528
    ds_read_b64_tr_b16 a[70:71], v185 offset:23040
    buffer_load_dwordx4 v165, s[64:67], s35 offen lds
    s_add_u32 s35, s82, s86
    s_add_u32 m0, s94, 98304
    v_mfma_f32_32x32x16_bf16 v[64:79], a[112:115], a[24:27], v[64:79]
    v_mfma_f32_32x32x16_bf16 v[80:95], a[112:115], a[28:31], v[80:95]
    buffer_load_dwordx4 v158, s[56:59], s35 offen lds
    s_add_u32 m0, s94, 102400
    v_mfma_f32_32x32x16_bf16 v[64:79], a[116:119], a[32:35], v[64:79]
    s_waitcnt lgkmcnt(0)
    s_barrier
    v_mfma_f32_32x32x16_bf16 v[80:95], a[116:119], a[36:39], v[80:95]
    v_add_u32 v184, 0, v178
    ds_read_b64_tr_b16 a[0:1], v184 offset:0
    ds_read_b64_tr_b16 a[2:3], v184 offset:512
    v_add_u32 v185, 0, v179
    ds_read_b64_tr_b16 a[4:5], v185 offset:0
    buffer_load_dwordx4 v159, s[56:59], s35 offen lds
    s_add_u32 m0, s94, 106496
    v_mfma_f32_32x32x16_bf16 v[0:15], a[104:107], a[40:43], v[0:15]
    ds_read_b64_tr_b16 a[6:7], v185 offset:512
    ds_read_b64_tr_b16 a[8:9], v184 offset:2048
    ds_read_b64_tr_b16 a[10:11], v184 offset:2560
    ds_read_b64_tr_b16 a[12:13], v185 offset:2048
    ds_read_b64_tr_b16 a[14:15], v185 offset:2560
    v_mfma_f32_32x32x16_bf16 v[16:31], a[104:107], a[44:47], v[16:31]
    ds_read_b64_tr_b16 a[16:17], v184 offset:4096
    ds_read_b64_tr_b16 a[18:19], v184 offset:4608
    ds_read_b64_tr_b16 a[20:21], v185 offset:4096
    ds_read_b64_tr_b16 a[22:23], v185 offset:4608
    buffer_load_dwordx4 v160, s[56:59], s35 offen lds
    s_add_u32 m0, s94, 110592
    v_mfma_f32_32x32x16_bf16 v[0:15], a[108:111], a[48:51], v[0:15]
    ds_read_b64_tr_b16 a[24:25], v184 offset:6144
    ds_read_b64_tr_b16 a[26:27], v184 offset:6656
    v_mfma_f32_32x32x16_bf16 v[16:31], a[108:111], a[52:55], v[16:31]
    ds_read_b64_tr_b16 a[28:29], v185 offset:6144
    ds_read_b64_tr_b16 a[30:31], v185 offset:6656
    buffer_load_dwordx4 v161, s[56:59], s35 offen lds
    s_add_u32 m0, s94, 114688
    v_mfma_f32_32x32x16_bf16 v[0:15], a[112:115], a[56:59], v[0:15]
    ds_read_b64_tr_b16 a[32:33], v184 offset:8192
    ds_read_b64_tr_b16 a[34:35], v184 offset:8704
    v_mfma_f32_32x32x16_bf16 v[16:31], a[112:115], a[60:63], v[16:31]
    ds_read_b64_tr_b16 a[36:37], v185 offset:8192
    ds_read_b64_tr_b16 a[38:39], v185 offset:8704
    buffer_load_dwordx4 v162, s[56:59], s35 offen lds
    s_add_u32 m0, s94, 118784
    v_mfma_f32_32x32x16_bf16 v[0:15], a[116:119], a[64:67], v[0:15]
    ds_read_b64_tr_b16 a[40:41], v184 offset:10240
    ds_read_b64_tr_b16 a[42:43], v184 offset:10752
    v_mfma_f32_32x32x16_bf16 v[16:31], a[116:119], a[68:71], v[16:31]
    ds_read_b64_tr_b16 a[44:45], v185 offset:10240
    ds_read_b64_tr_b16 a[46:47], v185 offset:10752
    buffer_load_dwordx4 v163, s[56:59], s35 offen lds
    s_add_u32 s35, s83, s92
    s_add_u32 m0, s94, 122880
    s_waitcnt lgkmcnt(12)
    v_mfma_f32_32x32x16_bf16 v[32:47], a[120:123], a[0:3], v[32:47]
    ds_read_b64_tr_b16 a[48:49], v184 offset:12288
    ds_read_b64_tr_b16 a[50:51], v184 offset:12800
    v_mfma_f32_32x32x16_bf16 v[48:63], a[120:123], a[4:7], v[48:63]
    ds_read_b64_tr_b16 a[52:53], v185 offset:12288
    ds_read_b64_tr_b16 a[54:55], v185 offset:12800
    buffer_load_dwordx4 v164, s[60:63], s35 offen lds
    s_add_u32 m0, s94, 126976
    v_mfma_f32_32x32x16_bf16 v[32:47], a[124:127], a[8:11], v[32:47]
    ds_read_b64_tr_b16 a[56:57], v184 offset:14336
    ds_read_b64_tr_b16 a[58:59], v184 offset:14848
    v_mfma_f32_32x32x16_bf16 v[48:63], a[124:127], a[12:15], v[48:63]
    ds_read_b64_tr_b16 a[60:61], v185 offset:14336
    ds_read_b64_tr_b16 a[62:63], v185 offset:14848
    buffer_load_dwordx4 v165, s[60:63], s35 offen lds
    s_add_u32 m0, s94, 131072
    v_mfma_f32_32x32x16_bf16 v[32:47], a[128:131], a[16:19], v[32:47]
    ds_read_b64_tr_b16 a[64:65], v184 offset:16384
    ds_read_b64_tr_b16 a[66:67], v184 offset:16896
    v_mfma_f32_32x32x16_bf16 v[48:63], a[128:131], a[20:23], v[48:63]
    ds_read_b64_tr_b16 a[68:69], v185 offset:16384
    ds_read_b64_tr_b16 a[70:71], v185 offset:16896
    buffer_load_dwordx4 v164, s[64:67], s35 offen lds
    s_add_u32 m0, s94, 135168
    s_waitcnt vmcnt(28)
    s_waitcnt lgkmcnt(12)
    v_mfma_f32_32x32x16_bf16 v[32:47], a[132:135], a[24:27], v[32:47]
    ds_read_b64_tr_b16 a[0:1], v184 offset:18432
    ds_read_b64_tr_b16 a[2:3], v184 offset:18944
    v_mfma_f32_32x32x16_bf16 v[48:63], a[132:135], a[28:31], v[48:63]
    ds_read_b64_tr_b16 a[4:5], v185 offset:18432
    ds_read_b64_tr_b16 a[6:7], v185 offset:18944
    buffer_load_dwordx4 v165, s[64:67], s35 offen lds
    v_mfma_f32_32x32x16_bf16 v[32:47], a[136:139], a[32:35], v[32:47]
    ds_read_b64_tr_b16 a[8:9], v184 offset:20480
    ds_read_b64_tr_b16 a[10:11], v184 offset:20992
    v_mfma_f32_32x32x16_bf16 v[48:63], a[136:139], a[36:39], v[48:63]
    ds_read_b64_tr_b16 a[12:13], v185 offset:20480
    ds_read_b64_tr_b16 a[14:15], v185 offset:20992
    v_mfma_f32_32x32x16_bf16 v[32:47], a[140:143], a[40:43], v[32:47]
    ds_read_b64_tr_b16 a[16:17], v184 offset:22528
    ds_read_b64_tr_b16 a[18:19], v184 offset:23040
    v_mfma_f32_32x32x16_bf16 v[48:63], a[140:143], a[44:47], v[48:63]
    ds_read_b64_tr_b16 a[20:21], v185 offset:22528
    ds_read_b64_tr_b16 a[22:23], v185 offset:23040
    s_waitcnt vmcnt(25)
    s_waitcnt lgkmcnt(12)
    v_mfma_f32_32x32x16_bf16 v[32:47], a[144:147], a[48:51], v[32:47]
    v_add_u32 v186, 24576, v180
    ds_read_b128 a[24:27], v186 offset:0
    v_mfma_f32_32x32x16_bf16 v[48:63], a[144:147], a[52:55], v[48:63]
    ds_read_b128 a[28:31], v186 offset:4096
    v_add_u32 v187, 24576, v181
    v_mfma_f32_32x32x16_bf16 v[32:47], a[148:151], a[56:59], v[32:47]
    ds_read_b128 a[32:35], v187 offset:0
    ds_read_b128 a[36:39], v187 offset:4096
    v_mfma_f32_32x32x16_bf16 v[48:63], a[148:151], a[60:63], v[48:63]
    v_add_u32 v188, 24576, v182
    v_mfma_f32_32x32x16_bf16 v[32:47], a[152:155], a[64:67], v[32:47]
    ds_read_b128 a[40:43], v188 offset:0
    v_mfma_f32_32x32x16_bf16 v[48:63], a[152:155], a[68:71], v[48:63]
    ds_read_b128 a[44:47], v188 offset:4096
    s_waitcnt lgkmcnt(6)
    v_mfma_f32_32x32x16_bf16 v[32:47], a[156:159], a[0:3], v[32:47]
    v_add_u32 v189, 24576, v183
    ds_read_b128 a[48:51], v189 offset:0
    v_mfma_f32_32x32x16_bf16 v[48:63], a[156:159], a[4:7], v[48:63]
    ds_read_b128 a[52:55], v189 offset:4096
    v_mfma_f32_32x32x16_bf16 v[32:47], a[160:163], a[8:11], v[32:47]
    ds_read_b128 a[56:59], v186 offset:8192
    v_mfma_f32_32x32x16_bf16 v[48:63], a[160:163], a[12:15], v[48:63]
    ds_read_b128 a[60:63], v186 offset:12288
    v_mfma_f32_32x32x16_bf16 v[32:47], a[164:167], a[16:19], v[32:47]
    ds_read_b128 a[64:67], v187 offset:8192
    v_mfma_f32_32x32x16_bf16 v[48:63], a[164:167], a[20:23], v[48:63]
    ds_read_b128 a[68:71], v187 offset:12288
    s_waitcnt vmcnt(18)
    s_waitcnt lgkmcnt(6)
    v_mfma_f32_32x32x16_bf16 v[32:47], a[168:171], a[24:27], v[32:47]
    v_mfma_f32_32x32x16_bf16 v[48:63], a[168:171], a[28:31], v[48:63]
    v_mfma_f32_32x32x16_bf16 v[32:47], a[172:175], a[32:35], v[32:47]
    s_waitcnt lgkmcnt(0)
    s_barrier
    v_mfma_f32_32x32x16_bf16 v[48:63], a[172:175], a[36:39], v[48:63]
    ds_read_b128 a[0:3], v188 offset:8192
    ds_read_b128 a[4:7], v188 offset:12288
    ds_read_b128 a[8:11], v189 offset:8192
    ds_read_b128 a[12:15], v189 offset:12288
    v_mfma_f32_32x32x16_bf16 v[32:47], a[176:179], a[40:43], v[32:47]
    v_add_u32 v184, 49152, v178
    ds_read_b64_tr_b16 a[16:17], v184 offset:0
    ds_read_b64_tr_b16 a[18:19], v184 offset:512
    v_mfma_f32_32x32x16_bf16 v[48:63], a[176:179], a[44:47], v[48:63]
    v_add_u32 v185, 49152, v179
    ds_read_b64_tr_b16 a[20:21], v185 offset:0
    ds_read_b64_tr_b16 a[22:23], v185 offset:512
    s_waitcnt vmcnt(14)
    v_mfma_f32_32x32x16_bf16 v[32:47], a[180:183], a[48:51], v[32:47]
    ds_read_b64_tr_b16 a[24:25], v184 offset:2048
    ds_read_b64_tr_b16 a[26:27], v184 offset:2560
    v_mfma_f32_32x32x16_bf16 v[48:63], a[180:183], a[52:55], v[48:63]
    ds_read_b64_tr_b16 a[28:29], v185 offset:2048
    ds_read_b64_tr_b16 a[30:31], v185 offset:2560
    v_mfma_f32_32x32x16_bf16 v[32:47], a[184:187], a[56:59], v[32:47]
    ds_read_b64_tr_b16 a[32:33], v184 offset:4096
    ds_read_b64_tr_b16 a[34:35], v184 offset:4608
    v_mfma_f32_32x32x16_bf16 v[48:63], a[184:187], a[60:63], v[48:63]
    ds_read_b64_tr_b16 a[36:37], v185 offset:4096
    ds_read_b64_tr_b16 a[38:39], v185 offset:4608
    v_mfma_f32_32x32x16_bf16 v[32:47], a[188:191], a[64:67], v[32:47]
    ds_read_b64_tr_b16 a[40:41], v184 offset:6144
    ds_read_b64_tr_b16 a[42:43], v184 offset:6656
    v_mfma_f32_32x32x16_bf16 v[48:63], a[188:191], a[68:71], v[48:63]
    ds_read_b64_tr_b16 a[44:45], v185 offset:6144
    ds_read_b64_tr_b16 a[46:47], v185 offset:6656
    s_waitcnt lgkmcnt(12)
    v_mfma_f32_32x32x16_bf16 v[32:47], a[192:195], a[0:3], v[32:47]
    ds_read_b64_tr_b16 a[48:49], v184 offset:8192
    ds_read_b64_tr_b16 a[50:51], v184 offset:8704
    v_mfma_f32_32x32x16_bf16 v[48:63], a[192:195], a[4:7], v[48:63]
    ds_read_b64_tr_b16 a[52:53], v185 offset:8192
    ds_read_b64_tr_b16 a[54:55], v185 offset:8704
    v_mfma_f32_32x32x16_bf16 v[32:47], a[196:199], a[8:11], v[32:47]
    ds_read_b64_tr_b16 a[56:57], v184 offset:10240
    ds_read_b64_tr_b16 a[58:59], v184 offset:10752
    v_mfma_f32_32x32x16_bf16 v[48:63], a[196:199], a[12:15], v[48:63]
    ds_read_b64_tr_b16 a[60:61], v185 offset:10240
    ds_read_b64_tr_b16 a[62:63], v185 offset:10752
    v_mfma_f32_32x32x16_bf16 v[64:79], a[120:123], a[16:19], v[64:79]
    ds_read_b64_tr_b16 a[64:65], v184 offset:12288
    ds_read_b64_tr_b16 a[66:67], v184 offset:12800
    v_mfma_f32_32x32x16_bf16 v[80:95], a[120:123], a[20:23], v[80:95]
    ds_read_b64_tr_b16 a[68:69], v185 offset:12288
    ds_read_b64_tr_b16 a[70:71], v185 offset:12800
    s_waitcnt lgkmcnt(12)
    v_mfma_f32_32x32x16_bf16 v[64:79], a[124:127], a[24:27], v[64:79]
    ds_read_b64_tr_b16 a[0:1], v184 offset:14336
    ds_read_b64_tr_b16 a[2:3], v184 offset:14848
    s_lshl_b32 s41, s26, 12
    s_add_u32 s41, s41, 20971520
    v_cvt_pk_bf16_f32 v32, v32, v33
    v_cvt_pk_bf16_f32 v33, v34, v35
    v_mfma_f32_32x32x16_bf16 v[80:95], a[124:127], a[28:31], v[80:95]
    ds_read_b64_tr_b16 a[4:5], v185 offset:14336
    ds_read_b64_tr_b16 a[6:7], v185 offset:14848
    v_cvt_pk_bf16_f32 v34, v36, v37
    v_cvt_pk_bf16_f32 v35, v38, v39
    buffer_store_dwordx4 v[32:35], v147, s[68:71], s41 offen offset:0 sc1
    v_mfma_f32_32x32x16_bf16 v[64:79], a[128:131], a[32:35], v[64:79]
    ds_read_b64_tr_b16 a[8:9], v184 offset:16384
    ds_read_b64_tr_b16 a[10:11], v184 offset:16896
    v_cvt_pk_bf16_f32 v40, v40, v41
    v_cvt_pk_bf16_f32 v41, v42, v43
    v_cvt_pk_bf16_f32 v42, v44, v45
    v_cvt_pk_bf16_f32 v43, v46, v47
    v_mfma_f32_32x32x16_bf16 v[80:95], a[128:131], a[36:39], v[80:95]
    ds_read_b64_tr_b16 a[12:13], v185 offset:16384
    ds_read_b64_tr_b16 a[14:15], v185 offset:16896
    buffer_store_dwordx4 v[40:43], v147, s[68:71], s41 offen offset:1024 sc1
    v_cvt_pk_bf16_f32 v48, v48, v49
    v_cvt_pk_bf16_f32 v49, v50, v51
    v_mfma_f32_32x32x16_bf16 v[64:79], a[132:135], a[40:43], v[64:79]
    ds_read_b64_tr_b16 a[16:17], v184 offset:18432
    ds_read_b64_tr_b16 a[18:19], v184 offset:18944
    v_cvt_pk_bf16_f32 v50, v52, v53
    v_cvt_pk_bf16_f32 v51, v54, v55
    buffer_store_dwordx4 v[48:51], v147, s[68:71], s41 offen offset:2048 sc1
    v_mfma_f32_32x32x16_bf16 v[80:95], a[132:135], a[44:47], v[80:95]
    ds_read_b64_tr_b16 a[20:21], v185 offset:18432
    ds_read_b64_tr_b16 a[22:23], v185 offset:18944
    v_cvt_pk_bf16_f32 v56, v56, v57
    v_cvt_pk_bf16_f32 v57, v58, v59
    v_cvt_pk_bf16_f32 v58, v60, v61
    v_cvt_pk_bf16_f32 v59, v62, v63
    s_waitcnt lgkmcnt(12)
    v_mfma_f32_32x32x16_bf16 v[64:79], a[136:139], a[48:51], v[64:79]
    buffer_store_dwordx4 v[56:59], v147, s[68:71], s41 offen offset:3072 sc1
    v_mfma_f32_32x32x16_bf16 v[80:95], a[136:139], a[52:55], v[80:95]
    v_mfma_f32_32x32x16_bf16 v[64:79], a[140:143], a[56:59], v[64:79]
    s_waitcnt lgkmcnt(0)
    s_waitcnt vmcnt(14)
    s_barrier
    v_mfma_f32_32x32x16_bf16 v[80:95], a[140:143], a[60:63], v[80:95]
    ds_read_b64_tr_b16 a[24:25], v184 offset:20480
    ds_read_b64_tr_b16 a[26:27], v184 offset:20992
    ds_read_b64_tr_b16 a[28:29], v185 offset:20480
    ds_read_b64_tr_b16 a[30:31], v185 offset:20992
    v_mfma_f32_32x32x16_bf16 v[64:79], a[144:147], a[64:67], v[64:79]
    ds_read_b64_tr_b16 a[32:33], v184 offset:22528
    ds_read_b64_tr_b16 a[34:35], v184 offset:23040
    ds_read_b64_tr_b16 a[36:37], v185 offset:22528
    ds_read_b64_tr_b16 a[38:39], v185 offset:23040
    v_mfma_f32_32x32x16_bf16 v[80:95], a[144:147], a[68:71], v[80:95]
    v_add_u32 v186, 73728, v180
    ds_read_b128 a[40:43], v186 offset:0
    ds_read_b128 a[44:47], v186 offset:4096
    v_mfma_f32_32x32x16_bf16 v[64:79], a[148:151], a[0:3], v[64:79]
    v_add_u32 v187, 73728, v181
    ds_read_b128 a[48:51], v187 offset:0
    v_mfma_f32_32x32x16_bf16 v[80:95], a[148:151], a[4:7], v[80:95]
    ds_read_b128 a[52:55], v187 offset:4096
    v_add_u32 v188, 73728, v182
    v_mfma_f32_32x32x16_bf16 v[64:79], a[152:155], a[8:11], v[64:79]
    ds_read_b128 a[56:59], v188 offset:0
    ds_read_b128 a[60:63], v188 offset:4096
    v_mfma_f32_32x32x16_bf16 v[80:95], a[152:155], a[12:15], v[80:95]
    v_add_u32 v189, 73728, v183
    v_mfma_f32_32x32x16_bf16 v[64:79], a[156:159], a[16:19], v[64:79]
    ds_read_b128 a[64:67], v189 offset:0
    v_mfma_f32_32x32x16_bf16 v[80:95], a[156:159], a[20:23], v[80:95]
    ds_read_b128 a[68:71], v189 offset:4096
    s_waitcnt lgkmcnt(6)
    v_mfma_f32_32x32x16_bf16 v[64:79], a[160:163], a[24:27], v[64:79]
    ds_read_b128 a[0:3], v186 offset:8192
    v_mfma_f32_32x32x16_bf16 v[80:95], a[160:163], a[28:31], v[80:95]
    ds_read_b128 a[4:7], v186 offset:12288
    v_mfma_f32_32x32x16_bf16 v[64:79], a[164:167], a[32:35], v[64:79]
    ds_read_b128 a[8:11], v187 offset:8192
    v_mfma_f32_32x32x16_bf16 v[80:95], a[164:167], a[36:39], v[80:95]
    ds_read_b128 a[12:15], v187 offset:12288
    v_mfma_f32_32x32x16_bf16 v[64:79], a[168:171], a[40:43], v[64:79]
    ds_read_b128 a[16:19], v188 offset:8192
    v_mfma_f32_32x32x16_bf16 v[80:95], a[168:171], a[44:47], v[80:95]
    ds_read_b128 a[20:23], v188 offset:12288
    s_waitcnt lgkmcnt(6)
    v_mfma_f32_32x32x16_bf16 v[64:79], a[172:175], a[48:51], v[64:79]
    v_mfma_f32_32x32x16_bf16 v[80:95], a[172:175], a[52:55], v[80:95]
    v_mfma_f32_32x32x16_bf16 v[64:79], a[176:179], a[56:59], v[64:79]
    s_waitcnt lgkmcnt(0)
    s_waitcnt vmcnt(8)
    s_barrier
    v_mfma_f32_32x32x16_bf16 v[80:95], a[176:179], a[60:63], v[80:95]
    ds_read_b128 a[24:27], v189 offset:8192
    ds_read_b128 a[28:31], v189 offset:12288
    v_add_u32 v184, 98304, v178
    ds_read_b64_tr_b16 a[32:33], v184 offset:0
    v_mfma_f32_32x32x16_bf16 v[64:79], a[180:183], a[64:67], v[64:79]
    ds_read_b64_tr_b16 a[34:35], v184 offset:512
    v_add_u32 v185, 98304, v179
    ds_read_b64_tr_b16 a[36:37], v185 offset:0
    ds_read_b64_tr_b16 a[38:39], v185 offset:512
    v_mfma_f32_32x32x16_bf16 v[80:95], a[180:183], a[68:71], v[80:95]
    ds_read_b64_tr_b16 a[40:41], v184 offset:2048
    ds_read_b64_tr_b16 a[42:43], v184 offset:2560
    ds_read_b64_tr_b16 a[44:45], v185 offset:2048
    ds_read_b64_tr_b16 a[46:47], v185 offset:2560
    v_mfma_f32_32x32x16_bf16 v[64:79], a[184:187], a[0:3], v[64:79]
    s_waitcnt vmcnt(0)
    s_lshl_b32 s12, s26, 6
    s_add_u32 s12, s12, 786432
    s_mov_b64 exec, 1
    buffer_store_dwordx2 v[198:199], v155, s[68:71], s12 offen sc1
    s_mov_b64 exec, -1
    v_mfma_f32_32x32x16_bf16 v[80:95], a[184:187], a[4:7], v[80:95]
    ds_read_b64_tr_b16 a[48:49], v184 offset:4096
    ds_read_b64_tr_b16 a[50:51], v184 offset:4608
    ds_read_b64_tr_b16 a[52:53], v185 offset:4096
    v_mfma_f32_32x32x16_bf16 v[64:79], a[188:191], a[8:11], v[64:79]
    ds_read_b64_tr_b16 a[54:55], v185 offset:4608
    ds_read_b64_tr_b16 a[56:57], v184 offset:6144
    ds_read_b64_tr_b16 a[58:59], v184 offset:6656
    v_mfma_f32_32x32x16_bf16 v[80:95], a[188:191], a[12:15], v[80:95]
    ds_read_b64_tr_b16 a[60:61], v185 offset:6144
    ds_read_b64_tr_b16 a[62:63], v185 offset:6656
    v_mfma_f32_32x32x16_bf16 v[64:79], a[192:195], a[16:19], v[64:79]
    ds_read_b64_tr_b16 a[64:65], v184 offset:8192
    ds_read_b64_tr_b16 a[66:67], v184 offset:8704
    v_mfma_f32_32x32x16_bf16 v[80:95], a[192:195], a[20:23], v[80:95]
    ds_read_b64_tr_b16 a[68:69], v185 offset:8192
    ds_read_b64_tr_b16 a[70:71], v185 offset:8704
    s_waitcnt lgkmcnt(12)
    v_mfma_f32_32x32x16_bf16 v[64:79], a[196:199], a[24:27], v[64:79]
    ds_read_b64_tr_b16 a[0:1], v184 offset:10240
    ds_read_b64_tr_b16 a[2:3], v184 offset:10752
    v_mfma_f32_32x32x16_bf16 v[80:95], a[196:199], a[28:31], v[80:95]
    ds_read_b64_tr_b16 a[4:5], v185 offset:10240
    ds_read_b64_tr_b16 a[6:7], v185 offset:10752
    v_mfma_f32_32x32x16_bf16 v[0:15], a[120:123], a[32:35], v[0:15]
    ds_read_b64_tr_b16 a[8:9], v184 offset:12288
    ds_read_b64_tr_b16 a[10:11], v184 offset:12800
    v_mfma_f32_32x32x16_bf16 v[16:31], a[120:123], a[36:39], v[16:31]
    ds_read_b64_tr_b16 a[12:13], v185 offset:12288
    ds_read_b64_tr_b16 a[14:15], v185 offset:12800
    v_mfma_f32_32x32x16_bf16 v[0:15], a[124:127], a[40:43], v[0:15]
    ds_read_b64_tr_b16 a[16:17], v184 offset:14336
    ds_read_b64_tr_b16 a[18:19], v184 offset:14848
    v_mfma_f32_32x32x16_bf16 v[16:31], a[124:127], a[44:47], v[16:31]
    ds_read_b64_tr_b16 a[20:21], v185 offset:14336
    ds_read_b64_tr_b16 a[22:23], v185 offset:14848
    s_waitcnt lgkmcnt(12)
    v_mfma_f32_32x32x16_bf16 v[0:15], a[128:131], a[48:51], v[0:15]
    ds_read_b64_tr_b16 a[24:25], v184 offset:16384
    ds_read_b64_tr_b16 a[26:27], v184 offset:16896
    s_lshl_b32 s41, s27, 12
    s_add_u32 s41, s41, 20971520
    v_cvt_pk_bf16_f32 v64, v64, v65
    v_cvt_pk_bf16_f32 v65, v66, v67
    v_mfma_f32_32x32x16_bf16 v[16:31], a[128:131], a[52:55], v[16:31]
    ds_read_b64_tr_b16 a[28:29], v185 offset:16384
    ds_read_b64_tr_b16 a[30:31], v185 offset:16896
    v_cvt_pk_bf16_f32 v66, v68, v69
    v_cvt_pk_bf16_f32 v67, v70, v71
    buffer_store_dwordx4 v[64:67], v147, s[68:71], s41 offen offset:0 sc1
    v_mfma_f32_32x32x16_bf16 v[0:15], a[132:135], a[56:59], v[0:15]
    ds_read_b64_tr_b16 a[32:33], v184 offset:18432
    ds_read_b64_tr_b16 a[34:35], v184 offset:18944
    v_cvt_pk_bf16_f32 v72, v72, v73
    v_cvt_pk_bf16_f32 v73, v74, v75
    v_cvt_pk_bf16_f32 v74, v76, v77
    v_cvt_pk_bf16_f32 v75, v78, v79
    v_mfma_f32_32x32x16_bf16 v[16:31], a[132:135], a[60:63], v[16:31]
    ds_read_b64_tr_b16 a[36:37], v185 offset:18432
    ds_read_b64_tr_b16 a[38:39], v185 offset:18944
    buffer_store_dwordx4 v[72:75], v147, s[68:71], s41 offen offset:1024 sc1
    v_cvt_pk_bf16_f32 v80, v80, v81
    v_cvt_pk_bf16_f32 v81, v82, v83
    v_mfma_f32_32x32x16_bf16 v[0:15], a[136:139], a[64:67], v[0:15]
    ds_read_b64_tr_b16 a[40:41], v184 offset:20480
    ds_read_b64_tr_b16 a[42:43], v184 offset:20992
    v_cvt_pk_bf16_f32 v82, v84, v85
    v_cvt_pk_bf16_f32 v83, v86, v87
    buffer_store_dwordx4 v[80:83], v147, s[68:71], s41 offen offset:2048 sc1
    v_mfma_f32_32x32x16_bf16 v[16:31], a[136:139], a[68:71], v[16:31]
    ds_read_b64_tr_b16 a[44:45], v185 offset:20480
    ds_read_b64_tr_b16 a[46:47], v185 offset:20992
    v_cvt_pk_bf16_f32 v88, v88, v89
    v_cvt_pk_bf16_f32 v89, v90, v91
    v_cvt_pk_bf16_f32 v90, v92, v93
    v_cvt_pk_bf16_f32 v91, v94, v95
    s_waitcnt lgkmcnt(12)
    v_mfma_f32_32x32x16_bf16 v[0:15], a[140:143], a[0:3], v[0:15]
    buffer_store_dwordx4 v[88:91], v147, s[68:71], s41 offen offset:3072 sc1
    v_mfma_f32_32x32x16_bf16 v[16:31], a[140:143], a[4:7], v[16:31]
    v_mfma_f32_32x32x16_bf16 v[0:15], a[144:147], a[8:11], v[0:15]
    s_waitcnt lgkmcnt(0)
    s_barrier
    v_mfma_f32_32x32x16_bf16 v[16:31], a[144:147], a[12:15], v[16:31]
    ds_read_b64_tr_b16 a[48:49], v184 offset:22528
    ds_read_b64_tr_b16 a[50:51], v184 offset:23040
    ds_read_b64_tr_b16 a[52:53], v185 offset:22528
    ds_read_b64_tr_b16 a[54:55], v185 offset:23040
    v_mfma_f32_32x32x16_bf16 v[0:15], a[148:151], a[16:19], v[0:15]
    v_add_u32 v186, 122880, v180
    ds_read_b128 a[56:59], v186 offset:0
    ds_read_b128 a[60:63], v186 offset:4096
    v_mfma_f32_32x32x16_bf16 v[16:31], a[148:151], a[20:23], v[16:31]
    v_add_u32 v187, 122880, v181
    ds_read_b128 a[64:67], v187 offset:0
    ds_read_b128 a[68:71], v187 offset:4096
    v_mfma_f32_32x32x16_bf16 v[0:15], a[152:155], a[24:27], v[0:15]
    v_add_u32 v188, 122880, v182
    ds_read_b128 a[0:3], v188 offset:0
    v_mfma_f32_32x32x16_bf16 v[16:31], a[152:155], a[28:31], v[16:31]
    ds_read_b128 a[4:7], v188 offset:4096
    v_add_u32 v189, 122880, v183
    v_mfma_f32_32x32x16_bf16 v[0:15], a[156:159], a[32:35], v[0:15]
    ds_read_b128 a[8:11], v189 offset:0
    v_mfma_f32_32x32x16_bf16 v[16:31], a[156:159], a[36:39], v[16:31]
    ds_read_b128 a[12:15], v189 offset:4096
    v_mfma_f32_32x32x16_bf16 v[0:15], a[160:163], a[40:43], v[0:15]
    ds_read_b128 a[16:19], v186 offset:8192
    v_mfma_f32_32x32x16_bf16 v[16:31], a[160:163], a[44:47], v[16:31]
    ds_read_b128 a[20:23], v186 offset:12288
    s_waitcnt lgkmcnt(6)
    v_mfma_f32_32x32x16_bf16 v[0:15], a[164:167], a[48:51], v[0:15]
    ds_read_b128 a[24:27], v187 offset:8192
    v_mfma_f32_32x32x16_bf16 v[16:31], a[164:167], a[52:55], v[16:31]
    ds_read_b128 a[28:31], v187 offset:12288
    v_mfma_f32_32x32x16_bf16 v[0:15], a[168:171], a[56:59], v[0:15]
    ds_read_b128 a[32:35], v188 offset:8192
    v_mfma_f32_32x32x16_bf16 v[16:31], a[168:171], a[60:63], v[16:31]
    ds_read_b128 a[36:39], v188 offset:12288
    v_mfma_f32_32x32x16_bf16 v[0:15], a[172:175], a[64:67], v[0:15]
    ds_read_b128 a[40:43], v189 offset:8192
    v_mfma_f32_32x32x16_bf16 v[16:31], a[172:175], a[68:71], v[16:31]
    ds_read_b128 a[44:47], v189 offset:12288
    s_waitcnt lgkmcnt(6)
    v_mfma_f32_32x32x16_bf16 v[0:15], a[176:179], a[0:3], v[0:15]
    v_mfma_f32_32x32x16_bf16 v[16:31], a[176:179], a[4:7], v[16:31]
    v_mfma_f32_32x32x16_bf16 v[0:15], a[180:183], a[8:11], v[0:15]
    v_mfma_f32_32x32x16_bf16 v[16:31], a[180:183], a[12:15], v[16:31]
    v_mfma_f32_32x32x16_bf16 v[0:15], a[184:187], a[16:19], v[0:15]
    v_mfma_f32_32x32x16_bf16 v[16:31], a[184:187], a[20:23], v[16:31]
    s_waitcnt lgkmcnt(0)
    v_mfma_f32_32x32x16_bf16 v[0:15], a[188:191], a[24:27], v[0:15]
    s_waitcnt vmcnt(0)
    s_lshl_b32 s12, s27, 6
    s_add_u32 s12, s12, 786432
    s_mov_b64 exec, 1
    buffer_store_dwordx2 v[198:199], v155, s[68:71], s12 offen sc1
    s_mov_b64 exec, -1
    v_mfma_f32_32x32x16_bf16 v[16:31], a[188:191], a[28:31], v[16:31]
    v_mfma_f32_32x32x16_bf16 v[0:15], a[192:195], a[32:35], v[0:15]
    v_mfma_f32_32x32x16_bf16 v[16:31], a[192:195], a[36:39], v[16:31]
    v_mfma_f32_32x32x16_bf16 v[0:15], a[196:199], a[40:43], v[0:15]
    v_mfma_f32_32x32x16_bf16 v[16:31], a[196:199], a[44:47], v[16:31]
    s_lshl_b32 s41, s28, 12
    s_add_u32 s41, s41, 20971520
    s_nop 8
    v_cvt_pk_bf16_f32 v0, v0, v1
    v_cvt_pk_bf16_f32 v1, v2, v3
    v_cvt_pk_bf16_f32 v2, v4, v5
    v_cvt_pk_bf16_f32 v3, v6, v7
    buffer_store_dwordx4 v[0:3], v147, s[68:71], s41 offen offset:0 sc1
    v_cvt_pk_bf16_f32 v8, v8, v9
    v_cvt_pk_bf16_f32 v9, v10, v11
    v_cvt_pk_bf16_f32 v10, v12, v13
    v_cvt_pk_bf16_f32 v11, v14, v15
    buffer_store_dwordx4 v[8:11], v147, s[68:71], s41 offen offset:1024 sc1
    v_cvt_pk_bf16_f32 v16, v16, v17
    v_cvt_pk_bf16_f32 v17, v18, v19
    v_cvt_pk_bf16_f32 v18, v20, v21
    v_cvt_pk_bf16_f32 v19, v22, v23
    buffer_store_dwordx4 v[16:19], v147, s[68:71], s41 offen offset:2048 sc1
    v_cvt_pk_bf16_f32 v24, v24, v25
    v_cvt_pk_bf16_f32 v25, v26, v27
    v_cvt_pk_bf16_f32 v26, v28, v29
    v_cvt_pk_bf16_f32 v27, v30, v31
    buffer_store_dwordx4 v[24:27], v147, s[68:71], s41 offen offset:3072 sc1
    s_waitcnt vmcnt(0)
    s_lshl_b32 s12, s28, 6
    s_add_u32 s12, s12, 786432
    s_mov_b64 exec, 1
    buffer_store_dwordx2 v[198:199], v155, s[68:71], s12 offen sc1
    s_mov_b64 exec, -1
    s_endpgm
LM_narrow:
    buffer_load_dwordx4 v[190:193], v239, s[68:71], s31 offen sc1
    s_add_u32 s35, s82, s84
    s_add_u32 m0, s94, 98304
    s_nop 0
    buffer_load_dwordx4 v158, s[56:59], s35 offen lds
    s_add_u32 m0, s94, 102400
    s_nop 0
    buffer_load_dwordx4 v159, s[56:59], s35 offen lds
    s_add_u32 m0, s94, 106496
    s_nop 0
    buffer_load_dwordx4 v160, s[56:59], s35 offen lds
    s_add_u32 m0, s94, 110592
    s_nop 0
    buffer_load_dwordx4 v161, s[56:59], s35 offen lds
    s_add_u32 m0, s94, 114688
    s_nop 0
    buffer_load_dwordx4 v162, s[56:59], s35 offen lds
    s_add_u32 m0, s94, 118784
    s_nop 0
    buffer_load_dwordx4 v163, s[56:59], s35 offen lds
    s_add_u32 s35, s83, s90
    s_add_u32 m0, s94, 122880
    s_nop 0
    buffer_load_dwordx4 v164, s[60:63], s35 offen lds
    s_add_u32 m0, s94, 126976
    s_nop 0
    buffer_load_dwordx4 v165, s[60:63], s35 offen lds
    s_add_u32 m0, s94, 131072
    s_nop 0
    buffer_load_dwordx4 v164, s[64:67], s35 offen lds
    s_add_u32 m0, s94, 135168
    s_nop 0
    buffer_load_dwordx4 v165, s[64:67], s35 offen lds
    s_waitcnt vmcnt(11)
    s_lshl_b32 s12, s6, 6
    s_add_u32 s12, s12, s24
    s_mov_b64 exec, 1
    s_add_u32 s96, s12, 589824
    buffer_store_dwordx4 v[198:201], v155, s[68:71], s96 offen
    buffer_store_dwordx4 v[198:201], v155, s[68:71], s12 offen sc1
    s_mov_b64 exec, -1
    s_or_b32 s13, s16, s17
    s_waitcnt vmcnt(12)
    v_cmp_eq_u64 vcc, s[88:89], v[190:191]
    s_nop 1
    s_and_b32 s12, vcc_lo, s13
    s_cmp_eq_u32 s12, s13
    s_cbranch_scc0 L_rt_30
L_ok_29:
    s_add_u32 s40, s20, 0
    buffer_load_dwordx4 a[72:75], v147, s[68:71], s40 offen offset:0 sc1
    buffer_load_dwordx4 a[76:79], v147, s[68:71], s40 offen offset:1024 sc1
    buffer_load_dwordx4 a[80:83], v147, s[68:71], s40 offen offset:2048 sc1
    buffer_load_dwordx4 a[84:87], v147, s[68:71], s40 offen offset:3072 sc1
    s_add_u32 s40, s20, 4096
    buffer_load_dwordx4 a[88:91], v147, s[68:71], s40 offen offset:0 sc1
    buffer_load_dwordx4 a[92:95], v147, s[68:71], s40 offen offset:1024 sc1
    buffer_load_dwordx4 a[96:99], v147, s[68:71], s40 offen offset:2048 sc1
    buffer_load_dwordx4 a[100:103], v147, s[68:71], s40 offen offset:3072 sc1
    s_waitcnt vmcnt(10)
    s_barrier
    s_branch LN_entry
L_progS:
    s_mul_i32 s9, s12, 96
    s_mul_i32 s13, s9, 1280
    v_add_u32 v152, s13, v246
    v_add_u32 v153, 40960, v152
    v_add_u32 v154, 81920, v152
    v_and_b32 v145, 31, v144
    v_lshrrev_b32 v146, 5, v144
    v_bfe_u32 v248, v144, 1, 3
    v_add_u32 v180, 0, v146
    v_xor_b32 v180, v180, v248
    v_lshlrev_b32 v180, 4, v180
    v_lshl_add_u32 v180, v145, 7, v180
    v_add_u32 v181, 2, v146
    v_xor_b32 v181, v181, v248
    v_lshlrev_b32 v181, 4, v181
    v_lshl_add_u32 v181, v145, 7, v181
    v_add_u32 v182, 4, v146
    v_xor_b32 v182, v182, v248
    v_lshlrev_b32 v182, 4, v182
    v_lshl_add_u32 v182, v145, 7, v182
    v_add_u32 v183, 6, v146
    v_xor_b32 v183, v183, v248
    v_lshlrev_b32 v183, 4, v183
    v_lshl_add_u32 v183, v145, 7, v183
    s_lshl_b32 s13, s3, 5
    v_xor_b32 v170, s13, v180
    v_add_u32 v166, s93, v170
    v_xor_b32 v171, s13, v181
    v_add_u32 v167, s93, v171
    v_xor_b32 v172, s13, v182
    v_add_u32 v168, s93, v172
    v_xor_b32 v173, s13, v183
    v_add_u32 v169, s93, v173
    v_bfe_u32 v248, v144, 2, 2
    v_lshl_add_u32 v178, v146, 3, v248
    v_lshlrev_b32 v178, 7, v178
    v_lshrrev_b32 v248, 1, v248
    v_lshl_or_b32 v178, v248, 6, v178
    v_bfe_u32 v248, v144, 4, 1
    v_lshl_or_b32 v178, v248, 5, v178
    v_bfe_u32 v248, v144, 2, 1
    v_bfe_u32 v249, v144, 4, 1
    v_cmp_eq_u32 vcc, v248, v249
    v_mov_b32 v248, 0x3f803f80
    v_mov_b32 v155, 0
    v_cndmask_b32 v190, 0, v248, vcc
    v_cndmask_b32 v191, 0, v248, vcc
    v_cndmask_b32 v192, 0, v248, vcc
    v_cndmask_b32 v193, 0, v248, vcc
    s_waitcnt lgkmcnt(0)
    s_bitcmp1_b32 s5, 0
    s_cselect_b64 s[80:81], s[24:25], s[22:23]
    s_cselect_b64 s[82:83], s[22:23], s[18:19]
    s_cselect_b64 s[84:85], s[24:25], s[20:21]
    s_cselect_b64 s[90:91], s[44:45], s[30:31]
    s_bitcmp1_b32 s5, 1
    s_cselect_b64 s[80:81], s[82:83], s[80:81]
    s_cselect_b64 s[84:85], s[90:91], s[84:85]
    s_bitcmp1_b32 s5, 2
    s_cselect_b64 s[80:81], s[84:85], s[80:81]
    global_load_dword a255, v155, s[80:81] offset:128 sc1
    s_mov_b64 s[48:49], s[16:17]
    s_mov_b32 s50, 2621440
    s_mov_b32 s51, 0x20000
    s_mov_b64 s[52:53], s[22:23]
    s_mov_b32 s54, 819200
    s_mov_b32 s55, 0x20000
    s_mov_b64 s[36:37], s[24:25]
    s_mov_b32 s38, 819200
    s_mov_b32 s39, 0x20000
    s_or_b32 s13, s2, s3
    s_cmp_lg_u32 s13, 0
    s_cbranch_scc1 L_nn_31
    s_or_b32 s88, s88, 1
    v_mov_b32 v250, s88
    v_mov_b32 v251, s89
    v_mov_b32 v253, 0
    global_store_dwordx2 v253, v[250:251], s[44:45] sc1
L_nn_31:
    v_add_u32 v253, s9, v145
    v_add_u32 v253, 0, v253
    v_min_u32 v253, 639, v253
    v_lshlrev_b32 v253, 1, v253
    global_load_ushort v222, v253, s[18:19]
    global_load_ushort v223, v253, s[20:21]
    global_load_ushort v228, v253, s[30:31]
    v_add_u32 v253, s9, v145
    v_add_u32 v253, 32, v253
    v_min_u32 v253, 639, v253
    v_lshlrev_b32 v253, 1, v253
    global_load_ushort v224, v253, s[18:19]
    global_load_ushort v225, v253, s[20:21]
    global_load_ushort v230, v253, s[30:31]
    v_add_u32 v253, s9, v145
    v_add_u32 v253, 64, v253
    v_min_u32 v253, 639, v253
    v_lshlrev_b32 v253, 1, v253
    global_load_ushort v226, v253, s[18:19]
    global_load_ushort v227, v253, s[20:21]
    global_load_ushort v232, v253, s[30:31]
    s_add_u32 s95, s7, 0
    s_and_b32 s95, s95, 384
    s_add_u32 s95, s95, 0
    s_add_u32 m0, s93, 0
    s_nop 0
    buffer_load_dwordx4 v148, s[48:51], s95 offen lds
    s_add_u32 m0, s93, 1024
    s_nop 0
    buffer_load_dwordx4 v149, s[48:51], s95 offen lds
    s_add_u32 m0, s93, 2048
    s_nop 0
    buffer_load_dwordx4 v150, s[48:51], s95 offen lds
    s_add_u32 m0, s93, 3072
    s_nop 0
    buffer_load_dwordx4 v151, s[48:51], s95 offen lds
    s_add_u32 m0, s94, 16384
    s_nop 0
    buffer_load_dwordx4 v152, s[52:55], s95 offen lds
    s_add_u32 m0, s94, 20480
    s_nop 0
    buffer_load_dwordx4 v153, s[52:55], s95 offen lds
    s_add_u32 m0, s94, 24576
    s_nop 0
    buffer_load_dwordx4 v152, s[36:39], s95 offen lds
    s_add_u32 m0, s94, 28672
    s_nop 0
    buffer_load_dwordx4 v153, s[36:39], s95 offen lds
    s_mov_b64 s[68:69], s[46:47]
    s_mov_b32 s70, 37748736
    s_mov_b32 s71, 0x20000
    s_mov_b64 s[56:57], s[40:41]
    s_mov_b32 s58, 2211840
    s_mov_b32 s59, 0x20000
    s_mov_b64 s[60:61], s[26:27]
    s_add_u32 s95, s7, 128
    s_and_b32 s95, s95, 384
    s_add_u32 s95, s95, 0
    s_add_u32 m0, s93, 32768
    s_nop 0
    buffer_load_dwordx4 v148, s[48:51], s95 offen lds
    s_mov_b32 s62, 819200
    s_mov_b32 s63, 0x20000
    s_mov_b64 s[64:65], s[28:29]
    s_mov_b32 s66, 819200
    s_mov_b32 s67, 0x20000
    s_mov_b64 s[72:73], s[42:43]
    s_mov_b32 s74, 5242880
    s_add_u32 m0, s93, 33792
    s_nop 0
    buffer_load_dwordx4 v149, s[48:51], s95 offen lds
    s_mov_b32 s75, 0x20000
    s_lshl_b32 s10, s6, 7
    s_cmp_eq_u32 s6, 3
    s_cselect_b32 s10, 448, s10
    s_sub_u32 s11, 2, s101
    s_add_u32 s15, s101, 2
    s_cmp_lt_u32 s6, 2
    s_cselect_b32 s12, 0, s9
    s_add_u32 m0, s93, 34816
    s_nop 0
    buffer_load_dwordx4 v150, s[48:51], s95 offen lds
    s_add_u32 s13, s12, 1
    s_cmp_eq_u32 s13, s15
    s_cselect_b32 s13, 0, s13
    s_add_u32 s14, s13, 1
    s_cmp_eq_u32 s14, 3
    s_cselect_b32 s14, 0, s14
    s_cmp_eq_u32 s101, 1
    s_cselect_b32 s14, s14, 2
    s_add_u32 m0, s93, 35840
    s_nop 0
    buffer_load_dwordx4 v151, s[48:51], s95 offen lds
    s_add_u32 s15, s12, s11
    s_lshl_b32 s16, 1, s15
    s_add_u32 s15, s13, s11
    s_lshl_b32 s17, 1, s15
    s_add_u32 s15, s14, 1
    s_lshl_b32 s18, 1, s15
    s_cmp_eq_u32 s101, 1
    s_cselect_b32 s18, s18, 3
    s_cselect_b32 s19, 1, 3
    s_add_u32 m0, s94, 49152
    s_nop 0
    buffer_load_dwordx4 v152, s[52:55], s95 offen lds
    s_lshl_b32 s15, s5, 2
    s_add_u32 s15, s15, s3
    s_lshl_b32 s15, s15, 2
    s_add_u32 s15, s15, s4
    s_lshl_b32 s24, s15, 8
    s_add_u32 s24, s24, 458752
    s_add_u32 s31, s24, 589824
    s_add_u32 m0, s94, 53248
    s_nop 0
    buffer_load_dwordx4 v153, s[52:55], s95 offen lds
    s_mul_i32 s15, s15, 49152
    s_add_u32 s15, s15, 8388608
    s_mul_i32 s20, s12, 12288
    s_add_u32 s20, s20, s15
    s_mul_i32 s21, s13, 12288
    s_add_u32 s21, s21, s15
    s_mul_i32 s22, s14, 12288
    s_add_u32 m0, s94, 57344
    s_nop 0
    buffer_load_dwordx4 v152, s[36:39], s95 offen lds
    s_add_u32 s22, s22, s15
    s_add_u32 s23, s15, 36864
    s_lshr_b32 s11, s6, 1
    s_and_b32 s11, s11, s6
    s_andn2_b32 s11, s11, s101
    s_mov_b64 s[96:97], s[60:61]
    s_mov_b32 s98, s22
    s_add_u32 m0, s94, 61440
    s_nop 0
    buffer_load_dwordx4 v153, s[36:39], s95 offen lds
    s_bitcmp1_b32 s11, 0
    s_cselect_b64 s[60:61], s[64:65], s[60:61]
    s_cselect_b64 s[64:65], s[96:97], s[64:65]
    s_cselect_b32 s22, s23, s22
    s_cselect_b32 s23, s98, s23
    s_lshl_b32 s15, s4, 1
    s_add_u32 s11, s15, s12
    s_add_u32 s95, s7, 256
    s_and_b32 s95, s95, 384
    s_add_u32 s95, s95, 0
    s_add_u32 m0, s93, 65536
    s_nop 0
    buffer_load_dwordx4 v148, s[48:51], s95 offen lds
    s_mul_i32 s80, s11, 245760
    s_add_u32 s11, s15, s13
    s_mul_i32 s81, s11, 245760
    s_add_u32 s11, s15, s14
    s_mul_i32 s82, s11, 245760
    s_mul_i32 s83, s4, 384
    s_cmp_eq_u32 s101, 1
    s_cselect_b32 s82, s82, s83
    s_add_u32 m0, s93, 66560
    s_nop 0
    buffer_load_dwordx4 v149, s[48:51], s95 offen lds
    s_add_u32 s12, s4, 1
    s_cmp_ge_u32 s12, 3
    s_cselect_b32 s11, 3, 0
    s_sub_u32 s12, s12, s11
    s_add_u32 s13, s12, 1
    s_cmp_eq_u32 s13, 3
    s_cselect_b32 s13, 0, s13
    s_add_u32 m0, s93, 67584
    s_nop 0
    buffer_load_dwordx4 v150, s[48:51], s95 offen lds
    s_sub_u32 s14, 3, s12
    s_sub_u32 s14, s14, s13
    s_xor_b32 s26, s4, 3
    s_xor_b32 s27, s4, 2
    s_xor_b32 s28, s4, 1
    s_lshr_b32 s15, s4, 1
    s_xor_b32 s11, s15, 1
    s_add_u32 m0, s93, 68608
    s_nop 0
    buffer_load_dwordx4 v151, s[48:51], s95 offen lds
    s_cmp_lt_u32 s6, 2
    s_cselect_b32 s26, s26, s12
    s_cselect_b32 s27, s27, s13
    s_cselect_b32 s28, s28, s14
    s_cselect_b32 s12, s11, s12
    s_cselect_b32 s13, s15, s13
    s_lshl_b32 s11, s12, 6
    s_add_u32 m0, s94, 81920
    s_nop 0
    buffer_load_dwordx4 v152, s[52:55], s95 offen lds
    s_add_u32 s11, s11, s10
    s_lshl_b32 s84, s11, 1
    s_mul_i32 s90, s11, 1280
    s_lshl_b32 s11, s13, 6
    s_add_u32 s11, s11, s10
    s_lshl_b32 s85, s11, 1
    s_mul_i32 s91, s11, 1280
    s_add_u32 m0, s94, 86016
    s_nop 0
    buffer_load_dwordx4 v153, s[52:55], s95 offen lds
    s_lshl_b32 s11, s14, 6
    s_add_u32 s11, s11, s10
    s_lshl_b32 s86, s11, 1
    s_mul_i32 s92, s11, 1280
    s_add_u32 s76, s80, s84
    s_add_u32 s12, s80, s85
    s_add_u32 s13, s80, s86
    s_add_u32 m0, s94, 90112
    s_nop 0
    buffer_load_dwordx4 v152, s[36:39], s95 offen lds
    s_add_u32 s14, s81, s84
    s_add_u32 s15, s81, s85
    s_cmp_lt_u32 s6, 2
    s_cselect_b32 s77, s14, s12
    s_cselect_b32 s78, s12, s13
    s_cselect_b32 s79, s15, s14
    s_lshl_b32 s15, s5, 2
    s_add_u32 m0, s94, 94208
    s_nop 0
    buffer_load_dwordx4 v153, s[36:39], s95 offen lds
    s_add_u32 s15, s15, s6
    s_lshl_b32 s15, s15, 2
    s_add_u32 s15, s15, s3
    s_lshl_b32 s15, s15, 2
    s_add_u32 s26, s26, s15
    s_lshl_b32 s26, s26, 2
    s_add_u32 s26, s26, s4
    s_add_u32 s95, s7, 384
    s_and_b32 s95, s95, 384
    s_add_u32 s95, s95, 0
    s_add_u32 m0, s93, 98304
    s_nop 0
    buffer_load_dwordx4 v148, s[48:51], s95 offen lds
    s_add_u32 s27, s27, s15
    s_lshl_b32 s27, s27, 2
    s_add_u32 s27, s27, s4
    s_add_u32 s28, s28, s15
    s_lshl_b32 s28, s28, 2
    s_add_u32 s28, s28, s4
    s_add_u32 s25, s15, s4
    s_add_u32 m0, s93, 99328
    s_nop 0
    buffer_load_dwordx4 v149, s[48:51], s95 offen lds
    s_lshl_b32 s25, s25, 2
    s_cmp_lt_u32 s6, 2
    s_cselect_b32 s11, 5, 6
    s_lshl_b32 s11, s4, s11
    s_add_u32 s11, s11, s10
    s_lshl_b32 s30, s11, 1
    s_lshl_b32 s11, s11, 2
    s_add_u32 m0, s93, 100352
    s_nop 0
    buffer_load_dwordx4 v150, s[48:51], s95 offen lds
    s_mul_i32 s29, s100, 2560
    s_add_u32 s29, s29, s11
    s_and_b32 s11, s4, 1
    s_xor_b32 s11, s11, 1
    s_cmp_lt_u32 s6, 2
    s_cselect_b32 s11, s11, 0
    s_lshl_b32 s12, s11, 6
    s_add_u32 m0, s93, 101376
    s_nop 0
    buffer_load_dwordx4 v151, s[48:51], s95 offen lds
    s_mul_i32 s13, s11, 40960
    s_sub_u32 s14, 40960, s13
    v_xor_b32 v248, s12, v243
    v_add_u32 v158, v247, v248
    v_add_u32 v164, s13, v246
    v_add_u32 v165, s14, v246
    v_add_u32 v159, 40960, v158
    s_add_u32 m0, s94, 114688
    s_nop 0
    buffer_load_dwordx4 v152, s[52:55], s95 offen lds
    v_add_u32 v160, 81920, v158
    v_add_u32 v161, 122880, v158
    v_add_u32 v162, 163840, v158
    v_add_u32 v163, 204800, v158
    v_and_b32 v248, 3, v144
    v_lshl_or_b32 v178, v248, 3, v178
    v_xor_b32 v179, 64, v178
    s_add_u32 m0, s94, 118784
    s_nop 0
    buffer_load_dwordx4 v153, s[52:55], s95 offen lds
    v_lshlrev_b32 v239, 6, v248
    v_lshlrev_b32 v147, 4, v144
    v_mul_u32_u24 v156, 2560, v240
    v_lshl_add_u32 v156, v241, 4, v156
    s_add_u32 s11, s93, 147456
    v_add_u32 v157, s11, v147
    s_add_u32 m0, s94, 122880
    s_nop 0
    buffer_load_dwordx4 v152, s[36:39], s95 offen lds
    s_add_u32 m0, s94, 126976
    s_nop 0
    buffer_load_dwordx4 v153, s[36:39], s95 offen lds
    s_lshl_b32 s15, s4, 2
    s_add_u32 s15, s15, s6
    s_lshl_b32 s13, s5, 7
    s_lshl_b32 s14, s15, 3
    s_add_u32 s13, s13, s14
    s_lshl_b32 s14, s3, 1
    s_add_u32 s13, s13, s14
    v_add_u32 v252, s13, v146
    v_mul_u32_u24 v254, 1280, v252
    v_lshl_add_u32 v254, v145, 3, v254
    buffer_load_dwordx2 v[96:97], v254, s[48:51], 0 offen offset:0
    buffer_load_dwordx2 v[98:99], v254, s[48:51], 0 offen offset:256
    buffer_load_dwordx2 v[100:101], v254, s[48:51], 0 offen offset:512
    buffer_load_dwordx2 v[102:103], v254, s[48:51], 0 offen offset:768
    buffer_load_dwordx2 v[104:105], v254, s[48:51], 0 offen offset:1024
    global_load_dwordx2 v[198:199], v155, s[44:45] sc1
    s_lshl_b32 s96, s25, 12
    s_add_u32 s96, s96, 20971520
    s_bitcmp1_b32 s3, 0
    s_cselect_b32 s96, s96, s20
    s_lshl_b32 s97, s25, 6
    s_add_u32 s97, s97, 786432
    v_mov_b32 v202, s96
    v_add_u32 v203, s31, v239
    v_cmp_gt_u32 vcc, 4, v144
    v_add_u32 v204, s97, v239
    v_min_u32 v205, 9, v144
    v_cndmask_b32 v202, v202, v203, vcc
    v_cmp_lt_u32 vcc, 59, v144
    v_lshlrev_b32 v205, 7, v205
    s_bitcmp1_b32 s3, 0
    s_cselect_b64 s[96:97], s[60:61], s[64:65]
    s_cselect_b64 s[98:99], s[56:57], s[32:33]
    v_cndmask_b32 v202, v202, v204, vcc
    s_bitcmp1_b32 s3, 1
    s_cselect_b64 s[96:97], s[96:97], s[98:99]
    buffer_load_dword a255, v202, s[68:71], 0 offen sc1
    global_load_dword a255, v205, s[96:97]
    buffer_load_dword a255, v155, s[72:75], s29 offen sc1
    s_waitcnt vmcnt(33)
    s_barrier
    ds_read_b128 a[0:3], v166 offset:0
    ds_read_b128 a[160:163], v170 offset:16384
    ds_read_b128 a[164:167], v170 offset:20480
    ds_read_b128 a[168:171], v170 offset:24576
    ds_read_b128 a[172:175], v170 offset:28672
    ds_read_b128 a[4:7], v167 offset:0
    ds_read_b128 a[176:179], v171 offset:16384
    ds_read_b128 a[180:183], v171 offset:20480
    ds_read_b128 a[184:187], v171 offset:24576
    ds_read_b128 a[188:191], v171 offset:28672
    s_waitcnt lgkmcnt(5)
    v_mfma_f32_32x32x16_bf16 v[0:15], a[0:3], a[160:163], 0
    ds_read_b128 a[8:11], v168 offset:0
    ds_read_b128 a[192:195], v172 offset:16384
    v_mfma_f32_16x16x32_bf16 a[208:211], v[190:193], a[160:163], 0
    ds_read_b128 a[196:199], v172 offset:20480
    v_mfma_f32_32x32x16_bf16 v[16:31], a[0:3], a[164:167], 0
    ds_read_b128 a[200:203], v172 offset:24576
    v_mfma_f32_32x32x16_bf16 v[48:63], a[0:3], a[168:171], 0
    ds_read_b128 a[204:207], v172 offset:28672
    v_mfma_f32_32x32x16_bf16 v[64:79], a[0:3], a[172:175], 0
    s_waitcnt lgkmcnt(5)
    v_mfma_f32_32x32x16_bf16 v[0:15], a[4:7], a[176:179], v[0:15]
    ds_read_b128 a[12:15], v169 offset:0
    ds_read_b128 a[160:163], v173 offset:16384
    v_lshlrev_b32 v222, 16, v222
    v_lshlrev_b32 v223, 16, v223
    v_lshlrev_b32 v228, 16, v228
    v_mfma_f32_32x32x16_bf16 v[16:31], a[4:7], a[180:183], v[16:31]
    ds_read_b128 a[164:167], v173 offset:20480
    v_mul_f32 v228, 1069066811, v228
    v_exp_f32 v228, v228
    s_nop 0
    v_cvt_pk_bf16_f32 v228, v228, v228
    v_and_b32 v228, 0xffff0000, v228
    v_mfma_f32_16x16x32_bf16 a[212:215], v[190:193], a[180:183], 0
    ds_read_b128 a[168:171], v173 offset:24576
    v_mfma_f32_32x32x16_bf16 v[48:63], a[4:7], a[184:187], v[48:63]
    ds_read_b128 a[172:175], v173 offset:28672
    v_mul_f32 v140, v228, v222
    v_mul_f32 v141, v228, v223
    v_mul_f32 v140, 1069066811, v140
    v_exp_f32 v140, v140
    v_mfma_f32_32x32x16_bf16 v[64:79], a[4:7], a[188:191], v[64:79]
    v_mul_f32 v141, 0.15915494, v141
    v_rndne_f32 v142, v141
    v_sub_f32 v141, v141, v142
    v_cos_f32 v142, v141
    v_sin_f32 v143, v141
    s_waitcnt lgkmcnt(5)
    v_mfma_f32_32x32x16_bf16 v[0:15], a[8:11], a[192:195], v[0:15]
    v_mul_f32 v216, v140, v142
    v_mul_f32 v217, v140, v143
    v_mul_f32 v140, v222, v222
    v_fma_f32 v140, v223, v223, v140
    v_rcp_f32 v140, v140
    v_mfma_f32_32x32x16_bf16 v[16:31], a[8:11], a[196:199], v[16:31]
    v_add_f32 v141, -1.0, v216
    v_add_f32 v140, v140, v140
    v_mul_f32 v142, v141, v222
    v_fma_f32 v142, v217, v223, v142
    v_mul_f32 v143, v217, v222
    v_fma_f32 v143, -v141, v223, v143
    s_waitcnt lgkmcnt(0)
    s_waitcnt vmcnt(25)
    s_barrier
    v_mfma_f32_32x32x16_bf16 v[48:63], a[8:11], a[200:203], v[48:63]
    ds_read_b128 a[16:19], v166 offset:32768
    ds_read_b128 a[176:179], v170 offset:49152
    ds_read_b128 a[180:183], v170 offset:53248
    s_add_u32 s95, s7, 0
    s_and_b32 s95, s95, 384
    s_add_u32 s95, s95, 512
    s_add_u32 m0, s93, 0
    v_mfma_f32_16x16x32_bf16 a[220:223], v[190:193], a[200:203], 0
    v_add_u32 v170, 57344, v170
    buffer_load_dwordx4 v148, s[48:51], s95 offen lds
    s_add_u32 m0, s93, 1024
    v_mfma_f32_32x32x16_bf16 v[64:79], a[8:11], a[204:207], v[64:79]
    ds_read_b128 a[184:187], v170 offset:0
    ds_read_b128 a[188:191], v170 offset:4096
    buffer_load_dwordx4 v149, s[48:51], s95 offen lds
    s_add_u32 m0, s93, 2048
    v_mul_f32 v228, v142, v140
    v_mul_f32 v229, v143, v140
    v_mfma_f32_32x32x16_bf16 v[0:15], a[12:15], a[160:163], v[0:15]
    ds_read_b128 a[20:23], v167 offset:32768
    ds_read_b128 a[192:195], v171 offset:49152
    v_mul_f32 v140, v217, v217
    v_add_f32 v223, v217, v217
    v_mul_f32 v223, v223, v216
    v_fma_f32 v222, v216, v216, -v140
    v_mfma_f32_32x32x16_bf16 v[16:31], a[12:15], a[164:167], v[16:31]
    ds_read_b128 a[196:199], v171 offset:53248
    v_add_u32 v171, 57344, v171
    buffer_load_dwordx4 v150, s[48:51], s95 offen lds
    s_add_u32 m0, s93, 3072
    v_mul_f32 v140, v223, v223
    v_add_f32 v223, v223, v223
    v_mfma_f32_32x32x16_bf16 v[48:63], a[12:15], a[168:171], v[48:63]
    ds_read_b128 a[200:203], v171 offset:0
    v_mul_f32 v223, v223, v222
    v_fma_f32 v222, v222, v222, -v140
    v_mul_f32 v140, v223, v223
    v_add_f32 v223, v223, v223
    v_mul_f32 v223, v223, v222
    v_mfma_f32_32x32x16_bf16 v[64:79], a[12:15], a[172:175], v[64:79]
    ds_read_b128 a[204:207], v171 offset:4096
    buffer_load_dwordx4 v151, s[48:51], s95 offen lds
    s_add_u32 m0, s94, 16384
    v_fma_f32 v222, v222, v222, -v140
    v_lshlrev_b32 v224, 16, v224
    v_lshlrev_b32 v225, 16, v225
    v_mfma_f32_16x16x32_bf16 a[224:227], v[190:193], a[172:175], 0
    v_lshlrev_b32 v230, 16, v230
    s_waitcnt lgkmcnt(5)
    v_mfma_f32_32x32x16_bf16 v[0:15], a[16:19], a[176:179], v[0:15]
    ds_read_b128 a[24:27], v168 offset:32768
    ds_read_b128 a[160:163], v172 offset:49152
    v_mul_f32 v230, 1069066811, v230
    v_exp_f32 v230, v230
    s_nop 0
    v_cvt_pk_bf16_f32 v230, v230, v230
    v_mfma_f32_16x16x32_bf16 a[208:211], v[190:193], a[176:179], a[208:211]
    ds_read_b128 a[164:167], v172 offset:53248
    buffer_load_dwordx4 v152, s[52:55], s95 offen lds
    s_add_u32 m0, s94, 20480
    v_mfma_f32_32x32x16_bf16 v[16:31], a[16:19], a[180:183], v[16:31]
    v_add_u32 v172, 57344, v172
    v_and_b32 v230, 0xffff0000, v230
    v_mul_f32 v140, v230, v224
    v_mul_f32 v141, v230, v225
    v_mul_f32 v140, 1069066811, v140
    v_exp_f32 v140, v140
    v_mfma_f32_32x32x16_bf16 v[48:63], a[16:19], a[184:187], v[48:63]
    ds_read_b128 a[168:171], v172 offset:0
    buffer_load_dwordx4 v153, s[52:55], s95 offen lds
    s_add_u32 m0, s94, 24576
    v_mul_f32 v141, 0.15915494, v141
    v_rndne_f32 v142, v141
    v_sub_f32 v141, v141, v142
    v_mfma_f32_32x32x16_bf16 v[64:79], a[16:19], a[188:191], v[64:79]
    ds_read_b128 a[172:175], v172 offset:4096
    v_cos_f32 v142, v141
    v_sin_f32 v143, v141
    v_mul_f32 v218, v140, v142
    s_waitcnt lgkmcnt(5)
    v_mfma_f32_32x32x16_bf16 v[0:15], a[20:23], a[192:195], v[0:15]
    ds_read_b128 a[28:31], v169 offset:32768
    ds_read_b128 a[176:179], v173 offset:49152
    buffer_load_dwordx4 v152, s[36:39], s95 offen lds
    s_add_u32 m0, s94, 28672
    v_mul_f32 v219, v140, v143
    v_mul_f32 v140, v224, v224
    v_mfma_f32_32x32x16_bf16 v[16:31], a[20:23], a[196:199], v[16:31]
    ds_read_b128 a[180:183], v173 offset:53248
    v_add_u32 v173, 57344, v173
    v_fma_f32 v140, v225, v225, v140
    v_rcp_f32 v140, v140
    v_add_f32 v141, -1.0, v218
    v_mfma_f32_16x16x32_bf16 a[212:215], v[190:193], a[196:199], a[212:215]
    ds_read_b128 a[184:187], v173 offset:0
    v_mfma_f32_32x32x16_bf16 v[48:63], a[20:23], a[200:203], v[48:63]
    ds_read_b128 a[188:191], v173 offset:4096
    buffer_load_dwordx4 v153, s[36:39], s95 offen lds
    s_add_u32 s95, s7, 0
    s_and_b32 s95, s95, 384
    s_add_u32 s95, s95, 0
    s_add_u32 m0, s94, 131072
    v_mfma_f32_32x32x16_bf16 v[64:79], a[20:23], a[204:207], v[64:79]
    v_add_f32 v140, v140, v140
    v_mul_f32 v142, v141, v224
    v_fma_f32 v142, v219, v225, v142
    v_mul_f32 v143, v219, v224
    v_fma_f32 v143, -v141, v225, v143
    v_mul_f32 v230, v142, v140
    s_waitcnt lgkmcnt(5)
    v_mfma_f32_32x32x16_bf16 v[0:15], a[24:27], a[160:163], v[0:15]
    buffer_load_dwordx4 v154, s[52:55], s95 offen lds
    s_add_u32 m0, s94, 135168
    v_mul_f32 v231, v143, v140
    v_mul_f32 v140, v219, v219
    v_add_f32 v225, v219, v219
    v_mul_f32 v225, v225, v218
    v_mfma_f32_32x32x16_bf16 v[16:31], a[24:27], a[164:167], v[16:31]
    v_fma_f32 v224, v218, v218, -v140
    v_mul_f32 v140, v225, v225
    v_add_f32 v225, v225, v225
    v_mul_f32 v225, v225, v224
    v_fma_f32 v224, v224, v224, -v140
    v_mul_f32 v140, v225, v225
    s_waitcnt lgkmcnt(0)
    s_waitcnt vmcnt(26)
    s_barrier
    v_mfma_f32_32x32x16_bf16 v[48:63], a[24:27], a[168:171], v[48:63]
    v_add_u32 v166, 65536, v166
    ds_read_b128 a[32:35], v166 offset:0
    ds_read_b128 a[192:195], v170 offset:24576
    buffer_load_dwordx4 v154, s[36:39], s95 offen lds
    s_add_u32 s95, s7, 128
    s_and_b32 s95, s95, 384
    s_add_u32 s95, s95, 0
    s_add_u32 m0, s94, 139264
    v_mfma_f32_16x16x32_bf16 a[220:223], v[190:193], a[168:171], a[220:223]
    ds_read_b128 a[196:199], v170 offset:28672
    v_mfma_f32_32x32x16_bf16 v[64:79], a[24:27], a[172:175], v[64:79]
    ds_read_b128 a[200:203], v170 offset:32768
    ds_read_b128 a[204:207], v170 offset:36864
    buffer_load_dwordx4 v154, s[52:55], s95 offen lds
    s_add_u32 m0, s94, 143360
    v_add_f32 v225, v225, v225
    v_mul_f32 v225, v225, v224
    v_mfma_f32_32x32x16_bf16 v[0:15], a[28:31], a[176:179], v[0:15]
    v_add_u32 v167, 65536, v167
    ds_read_b128 a[36:39], v167 offset:0
    v_fma_f32 v224, v224, v224, -v140
    v_lshlrev_b32 v226, 16, v226
    v_lshlrev_b32 v227, 16, v227
    v_lshlrev_b32 v232, 16, v232
    v_mfma_f32_32x32x16_bf16 v[16:31], a[28:31], a[180:183], v[16:31]
    ds_read_b128 a[160:163], v171 offset:24576
    ds_read_b128 a[164:167], v171 offset:28672
    buffer_load_dwordx4 v154, s[36:39], s95 offen lds
    s_add_u32 s95, s7, 128
    s_and_b32 s95, s95, 384
    s_add_u32 s95, s95, 512
    s_add_u32 m0, s93, 32768
    v_mfma_f32_32x32x16_bf16 v[48:63], a[28:31], a[184:187], v[48:63]
    ds_read_b128 a[168:171], v171 offset:32768
    v_mul_f32 v232, 1069066811, v232
    v_exp_f32 v232, v232
    s_nop 0
    v_cvt_pk_bf16_f32 v232, v232, v232
    v_and_b32 v232, 0xffff0000, v232
    v_mfma_f32_32x32x16_bf16 v[64:79], a[28:31], a[188:191], v[64:79]
    ds_read_b128 a[172:175], v171 offset:36864
    buffer_load_dwordx4 v148, s[48:51], s95 offen lds
    s_add_u32 m0, s93, 33792
    v_mul_f32 v140, v232, v226
    v_mul_f32 v141, v232, v227
    v_mul_f32 v140, 1069066811, v140
    v_mfma_f32_16x16x32_bf16 a[224:227], v[190:193], a[188:191], a[224:227]
    v_exp_f32 v140, v140
    s_waitcnt lgkmcnt(5)
    v_mfma_f32_32x32x16_bf16 v[0:15], a[32:35], a[192:195], v[0:15]
    v_add_u32 v168, 65536, v168
    ds_read_b128 a[40:43], v168 offset:0
    v_mul_f32 v141, 0.15915494, v141
    v_rndne_f32 v142, v141
    v_sub_f32 v141, v141, v142
    v_cos_f32 v142, v141
    v_mfma_f32_16x16x32_bf16 a[208:211], v[190:193], a[192:195], a[208:211]
    ds_read_b128 a[176:179], v172 offset:24576
    buffer_load_dwordx4 v149, s[48:51], s95 offen lds
    s_add_u32 m0, s93, 34816
    v_mfma_f32_32x32x16_bf16 v[16:31], a[32:35], a[196:199], v[16:31]
    ds_read_b128 a[180:183], v172 offset:28672
    v_sin_f32 v143, v141
    v_mul_f32 v220, v140, v142
    v_mul_f32 v221, v140, v143
    v_mul_f32 v140, v226, v226
    v_mfma_f32_32x32x16_bf16 v[48:63], a[32:35], a[200:203], v[48:63]
    ds_read_b128 a[184:187], v172 offset:32768
    buffer_load_dwordx4 v150, s[48:51], s95 offen lds
    s_add_u32 m0, s93, 35840
    v_fma_f32 v140, v227, v227, v140
    v_rcp_f32 v140, v140
    v_mfma_f32_32x32x16_bf16 v[64:79], a[32:35], a[204:207], v[64:79]
    ds_read_b128 a[188:191], v172 offset:36864
    v_add_f32 v141, -1.0, v220
    v_add_f32 v140, v140, v140
    v_mul_f32 v142, v141, v226
    v_fma_f32 v142, v221, v227, v142
    v_mul_f32 v143, v221, v226
    s_waitcnt lgkmcnt(5)
    v_mfma_f32_32x32x16_bf16 v[0:15], a[36:39], a[160:163], v[0:15]
    v_add_u32 v169, 65536, v169
    ds_read_b128 a[44:47], v169 offset:0
    buffer_load_dwordx4 v151, s[48:51], s95 offen lds
    s_add_u32 m0, s94, 49152
    v_fma_f32 v143, -v141, v227, v143
    v_mul_f32 v232, v142, v140
    v_mfma_f32_32x32x16_bf16 v[16:31], a[36:39], a[164:167], v[16:31]
    ds_read_b128 a[192:195], v173 offset:24576
    ds_read_b128 a[196:199], v173 offset:28672
    v_mul_f32 v233, v143, v140
    v_mul_f32 v140, v221, v221
    v_add_f32 v227, v221, v221
    v_mul_f32 v227, v227, v220
    v_mfma_f32_16x16x32_bf16 a[212:215], v[190:193], a[164:167], a[212:215]
    ds_read_b128 a[200:203], v173 offset:32768
    v_mfma_f32_32x32x16_bf16 v[48:63], a[36:39], a[168:171], v[48:63]
    ds_read_b128 a[204:207], v173 offset:36864
    buffer_load_dwordx4 v152, s[52:55], s95 offen lds
    s_add_u32 m0, s94, 53248
    v_fma_f32 v226, v220, v220, -v140
    v_mul_f32 v140, v227, v227
    v_add_f32 v227, v227, v227
    v_mfma_f32_32x32x16_bf16 v[64:79], a[36:39], a[172:175], v[64:79]
    v_mul_f32 v227, v227, v226
    v_fma_f32 v226, v226, v226, -v140
    v_mul_f32 v140, v227, v227
    v_add_f32 v227, v227, v227
    v_mul_f32 v227, v227, v226
    v_fma_f32 v226, v226, v226, -v140
    s_waitcnt lgkmcnt(5)
    v_mfma_f32_32x32x16_bf16 v[0:15], a[40:43], a[176:179], v[0:15]
    buffer_load_dwordx4 v153, s[52:55], s95 offen lds
    s_add_u32 m0, s94, 57344
    s_cmp_eq_u32 s3, 1
    s_cselect_b64 vcc, -1, 0
    v_cndmask_b32 v234, v222, v224, vcc
    v_cndmask_b32 v235, v223, v225, vcc
    v_mfma_f32_32x32x16_bf16 v[16:31], a[40:43], a[180:183], v[16:31]
    s_cmp_eq_u32 s3, 2
    s_cselect_b64 vcc, -1, 0
    v_cndmask_b32 v234, v234, v226, vcc
    v_cndmask_b32 v235, v235, v227, vcc
    v_mul_f32 v140, v235, v235
    v_add_f32 v235, v235, v235
    s_waitcnt lgkmcnt(0)
    s_waitcnt vmcnt(27)
    s_barrier
    v_mfma_f32_32x32x16_bf16 v[48:63], a[40:43], a[184:187], v[48:63]
    ds_read_b128 a[48:51], v166 offset:32768
    v_add_u32 v170, 57344, v170
    ds_read_b128 a[160:163], v170 offset:0
    buffer_load_dwordx4 v152, s[36:39], s95 offen lds
    s_add_u32 m0, s94, 61440
    v_mul_f32 v235, v235, v234
    v_mfma_f32_16x16x32_bf16 a[220:223], v[190:193], a[184:187], a[220:223]
    ds_read_b128 a[164:167], v170 offset:4096
    v_mfma_f32_32x32x16_bf16 v[64:79], a[40:43], a[188:191], v[64:79]
    ds_read_b128 a[168:171], v170 offset:8192
    ds_read_b128 a[172:175], v170 offset:12288
    buffer_load_dwordx4 v153, s[36:39], s95 offen lds
    s_add_u32 s95, s7, 256
    s_and_b32 s95, s95, 384
    s_add_u32 s95, s95, 512
    s_add_u32 m0, s93, 65536
    v_mfma_f32_32x32x16_bf16 v[0:15], a[44:47], a[192:195], v[0:15]
    ds_read_b128 a[52:55], v167 offset:32768
    v_add_u32 v171, 57344, v171
    v_fma_f32 v234, v234, v234, -v140
    s_mul_i32 s12, s3, 1536
    s_add_u32 s12, s12, 155648
    v_mul_u32_u24 v176, 768, v146
    v_mfma_f32_32x32x16_bf16 v[16:31], a[44:47], a[196:199], v[16:31]
    ds_read_b128 a[176:179], v171 offset:0
    ds_read_b128 a[180:183], v171 offset:4096
    buffer_load_dwordx4 v148, s[48:51], s95 offen lds
    s_add_u32 m0, s93, 66560
    v_lshl_add_u32 v176, v145, 3, v176
    v_add_u32 v176, s12, v176
    v_mfma_f32_32x32x16_bf16 v[48:63], a[44:47], a[200:203], v[48:63]
    ds_read_b128 a[184:187], v171 offset:8192
    s_lshl_b32 s12, s3, 8
    s_add_u32 s12, s12, 155648
    v_lshl_add_u32 v177, v145, 3, s12
    s_lshl_b32 s12, s3, 5
    s_add_u32 s12, s12, s9
    v_mfma_f32_32x32x16_bf16 v[64:79], a[44:47], a[204:207], v[64:79]
    ds_read_b128 a[188:191], v171 offset:12288
    buffer_load_dwordx4 v149, s[48:51], s95 offen lds
    s_add_u32 m0, s93, 67584
    v_add_u32 v238, s12, v145
    v_lshlrev_b32 v238, 4, v238
    s_sub_u32 s13, s5, 1
    v_mfma_f32_16x16x32_bf16 a[224:227], v[190:193], a[204:207], a[224:227]
    v_lshlrev_b32 v143, 3, v146
    s_waitcnt lgkmcnt(5)
    v_mfma_f32_32x32x16_bf16 v[0:15], a[48:51], a[160:163], v[0:15]
    ds_read_b128 a[56:59], v168 offset:32768
    v_add_u32 v172, 57344, v172
    v_sub_u32 v143, s13, v143
    v_add_u32 v140, 9, v143
    v_mul_u32_u24 v140, 11264, v140
    v_add_u32 v238, v238, v140
    v_mfma_f32_16x16x32_bf16 a[208:211], v[190:193], a[160:163], a[208:211]
    ds_read_b128 a[192:195], v172 offset:0
    buffer_load_dwordx4 v150, s[48:51], s95 offen lds
    s_add_u32 m0, s93, 68608
    v_mfma_f32_32x32x16_bf16 v[16:31], a[48:51], a[164:167], v[16:31]
    ds_read_b128 a[196:199], v172 offset:4096
    s_lshl_b32 s12, s3, 11
    s_add_u32 s12, s12, 148480
    v_lshl_add_u32 v250, v145, 2, s12
    v_lshl_add_u32 v251, v146, 4, s12
    s_waitcnt vmcnt(27)
    v_mfma_f32_32x32x16_bf16 v[48:63], a[48:51], a[168:171], v[48:63]
    ds_read_b128 a[200:203], v172 offset:8192
    buffer_load_dwordx4 v151, s[48:51], s95 offen lds
    s_add_u32 m0, s94, 81920
    v_lshlrev_b32 v116, 16, v96
    v_and_b32 v117, 0xffff0000, v96
    v_lshlrev_b32 v118, 16, v97
    v_mfma_f32_32x32x16_bf16 v[64:79], a[48:51], a[172:175], v[64:79]
    ds_read_b128 a[204:207], v172 offset:12288
    v_and_b32 v119, 0xffff0000, v97
    v_lshlrev_b32 v120, 16, v98
    v_and_b32 v121, 0xffff0000, v98
    v_lshlrev_b32 v122, 16, v99
    v_and_b32 v123, 0xffff0000, v99
    s_waitcnt lgkmcnt(5)
    v_mfma_f32_32x32x16_bf16 v[0:15], a[52:55], a[176:179], v[0:15]
    ds_read_b128 a[60:63], v169 offset:32768
    v_add_u32 v173, 57344, v173
    buffer_load_dwordx4 v152, s[52:55], s95 offen lds
    s_add_u32 m0, s94, 86016
    v_lshlrev_b32 v124, 16, v100
    v_and_b32 v125, 0xffff0000, v100
    v_mfma_f32_32x32x16_bf16 v[16:31], a[52:55], a[180:183], v[16:31]
    ds_read_b128 a[160:163], v173 offset:0
    ds_read_b128 a[164:167], v173 offset:4096
    v_lshlrev_b32 v126, 16, v101
    v_and_b32 v127, 0xffff0000, v101
    v_lshlrev_b32 v128, 16, v102
    v_and_b32 v129, 0xffff0000, v102
    v_mfma_f32_16x16x32_bf16 a[212:215], v[190:193], a[180:183], a[212:215]
    ds_read_b128 a[168:171], v173 offset:8192
    v_mfma_f32_32x32x16_bf16 v[48:63], a[52:55], a[184:187], v[48:63]
    ds_read_b128 a[172:175], v173 offset:12288
    buffer_load_dwordx4 v153, s[52:55], s95 offen lds
    s_add_u32 m0, s94, 90112
    v_lshlrev_b32 v130, 16, v103
    v_and_b32 v131, 0xffff0000, v103
    v_lshlrev_b32 v132, 16, v104
    v_mfma_f32_32x32x16_bf16 v[64:79], a[52:55], a[188:191], v[64:79]
    v_and_b32 v133, 0xffff0000, v104
    v_lshlrev_b32 v134, 16, v105
    v_and_b32 v135, 0xffff0000, v105
    v_add_f32 v136, v116, v117
    v_add_f32 v137, v118, v119
    v_add_f32 v136, v136, v120
    s_waitcnt lgkmcnt(5)
    v_mfma_f32_32x32x16_bf16 v[0:15], a[56:59], a[192:195], v[0:15]
    buffer_load_dwordx4 v152, s[36:39], s95 offen lds
    s_add_u32 m0, s94, 94208
    v_add_f32 v137, v137, v121
    v_add_f32 v136, v136, v122
    v_add_f32 v137, v137, v123
    v_add_f32 v136, v136, v124
    v_mfma_f32_32x32x16_bf16 v[16:31], a[56:59], a[196:199], v[16:31]
    v_add_f32 v137, v137, v125
    v_add_f32 v136, v136, v126
    v_add_f32 v137, v137, v127
    v_add_f32 v136, v136, v128
    v_add_f32 v137, v137, v129
    v_add_f32 v136, v136, v130
    s_waitcnt lgkmcnt(0)
    s_waitcnt vmcnt(19)
    s_barrier
    v_mfma_f32_32x32x16_bf16 v[48:63], a[56:59], a[200:203], v[48:63]
    v_add_u32 v166, 4294901760, v166
    ds_read_b128 a[64:67], v166 offset:0
    v_add_u32 v170, 4294868992, v170
    ds_read_b128 a[176:179], v170 offset:0
    buffer_load_dwordx4 v153, s[36:39], s95 offen lds
    s_add_u32 s95, s7, 384
    s_and_b32 s95, s95, 384
    s_add_u32 s95, s95, 512
    s_add_u32 m0, s93, 98304
    v_mfma_f32_16x16x32_bf16 a[220:223], v[190:193], a[200:203], a[220:223]
    ds_read_b128 a[180:183], v170 offset:4096
    v_mfma_f32_32x32x16_bf16 v[64:79], a[56:59], a[204:207], v[64:79]
    ds_read_b128 a[184:187], v170 offset:8192
    ds_read_b128 a[188:191], v170 offset:12288
    buffer_load_dwordx4 v148, s[48:51], s95 offen lds
    s_add_u32 m0, s93, 99328
    v_add_f32 v137, v137, v131
    v_add_f32 v136, v136, v132
    v_mfma_f32_32x32x16_bf16 v[0:15], a[60:63], a[160:163], v[0:15]
    v_add_u32 v167, 4294901760, v167
    ds_read_b128 a[68:71], v167 offset:0
    v_add_f32 v137, v137, v133
    v_add_f32 v136, v136, v134
    v_add_f32 v137, v137, v135
    v_add_f32 v136, v136, v137
    v_mfma_f32_32x32x16_bf16 v[16:31], a[60:63], a[164:167], v[16:31]
    v_add_u32 v171, 4294868992, v171
    ds_read_b128 a[192:195], v171 offset:0
    buffer_load_dwordx4 v149, s[48:51], s95 offen lds
    s_add_u32 m0, s93, 100352
    v_add_f32_dpp v136, v136, v136 quad_perm:[1,0,3,2] row_mask:0xf bank_mask:0xf
    s_nop 1
    v_add_f32_dpp v136, v136, v136 quad_perm:[2,3,0,1] row_mask:0xf bank_mask:0xf
    v_mfma_f32_32x32x16_bf16 v[48:63], a[60:63], a[168:171], v[48:63]
    ds_read_b128 a[196:199], v171 offset:4096
    ds_read_b128 a[200:203], v171 offset:8192
    v_add_f32_dpp v136, v136, v136 row_half_mirror row_mask:0xf bank_mask:0xf
    s_nop 1
    v_add_f32_dpp v136, v136, v136 row_mirror row_mask:0xf bank_mask:0xf
    v_mov_b32 v137, v136
    s_nop 1
    v_permlane16_swap_b32 v136, v137
    v_mfma_f32_32x32x16_bf16 v[64:79], a[60:63], a[172:175], v[64:79]
    ds_read_b128 a[204:207], v171 offset:12288
    buffer_load_dwordx4 v150, s[48:51], s95 offen lds
    s_add_u32 m0, s93, 101376
    v_add_f32 v136, v136, v137
    v_mul_f32 v136, 0x3acccccd, v136
    v_mov_b32 v138, 0
    v_mfma_f32_16x16x32_bf16 a[224:227], v[190:193], a[172:175], a[224:227]
    v_mov_b32 v139, 0
    s_waitcnt lgkmcnt(5)
    v_mfma_f32_32x32x16_bf16 v[0:15], a[64:67], a[176:179], v[0:15]
    v_add_u32 v168, 4294901760, v168
    ds_read_b128 a[72:75], v168 offset:0
    v_sub_f32 v240, v116, v136
    v_sub_f32 v241, v117, v136
    v_fmac_f32 v138, v240, v240
    v_fmac_f32 v139, v241, v241
    v_mfma_f32_16x16x32_bf16 a[208:211], v[190:193], a[176:179], a[208:211]
    v_add_u32 v172, 4294868992, v172
    buffer_load_dwordx4 v151, s[48:51], s95 offen lds
    s_add_u32 m0, s94, 114688
    v_mfma_f32_32x32x16_bf16 v[16:31], a[64:67], a[180:183], v[16:31]
    ds_read_b128 a[160:163], v172 offset:0
    ds_read_b128 a[164:167], v172 offset:4096
    v_sub_f32 v240, v118, v136
    v_sub_f32 v241, v119, v136
    v_fmac_f32 v138, v240, v240
    v_fmac_f32 v139, v241, v241
    v_mfma_f32_32x32x16_bf16 v[48:63], a[64:67], a[184:187], v[48:63]
    ds_read_b128 a[168:171], v172 offset:8192
    buffer_load_dwordx4 v152, s[52:55], s95 offen lds
    s_add_u32 m0, s94, 118784
    v_sub_f32 v240, v120, v136
    v_sub_f32 v241, v121, v136
    v_fmac_f32 v138, v240, v240
    v_mfma_f32_32x32x16_bf16 v[64:79], a[64:67], a[188:191], v[64:79]
    ds_read_b128 a[172:175], v172 offset:12288
    v_fmac_f32 v139, v241, v241
    v_sub_f32 v240, v122, v136
    v_sub_f32 v241, v123, v136
    v_fmac_f32 v138, v240, v240
    v_fmac_f32 v139, v241, v241
    s_waitcnt lgkmcnt(5)
    v_mfma_f32_32x32x16_bf16 v[0:15], a[68:71], a[192:195], v[0:15]
    v_add_u32 v169, 4294901760, v169
    ds_read_b128 a[76:79], v169 offset:0
    buffer_load_dwordx4 v153, s[52:55], s95 offen lds
    s_add_u32 m0, s94, 122880
    v_sub_f32 v240, v124, v136
    v_sub_f32 v241, v125, v136
    v_mfma_f32_32x32x16_bf16 v[16:31], a[68:71], a[196:199], v[16:31]
    v_add_u32 v173, 4294868992, v173
    ds_read_b128 a[176:179], v173 offset:0
    v_fmac_f32 v138, v240, v240
    v_fmac_f32 v139, v241, v241
    v_sub_f32 v240, v126, v136
    v_sub_f32 v241, v127, v136
    v_mfma_f32_16x16x32_bf16 a[212:215], v[190:193], a[196:199], a[212:215]
    ds_read_b128 a[180:183], v173 offset:4096
    v_mfma_f32_32x32x16_bf16 v[48:63], a[68:71], a[200:203], v[48:63]
    ds_read_b128 a[184:187], v173 offset:8192
    buffer_load_dwordx4 v152, s[36:39], s95 offen lds
    s_add_u32 m0, s94, 126976
    v_fmac_f32 v138, v240, v240
    v_fmac_f32 v139, v241, v241
    v_sub_f32 v240, v128, v136
    v_mfma_f32_32x32x16_bf16 v[64:79], a[68:71], a[204:207], v[64:79]
    ds_read_b128 a[188:191], v173 offset:12288
    v_sub_f32 v241, v129, v136
    v_fmac_f32 v138, v240, v240
    v_fmac_f32 v139, v241, v241
    v_sub_f32 v240, v130, v136
    v_sub_f32 v241, v131, v136
    s_waitcnt lgkmcnt(5)
    v_mfma_f32_32x32x16_bf16 v[0:15], a[72:75], a[160:163], v[0:15]
    buffer_load_dwordx4 v153, s[36:39], s95 offen lds
    v_fmac_f32 v138, v240, v240
    v_fmac_f32 v139, v241, v241
    v_sub_f32 v240, v132, v136
    v_sub_f32 v241, v133, v136
    v_fmac_f32 v138, v240, v240
    v_mfma_f32_32x32x16_bf16 v[16:31], a[72:75], a[164:167], v[16:31]
    v_fmac_f32 v139, v241, v241
    v_sub_f32 v240, v134, v136
    v_sub_f32 v241, v135, v136
    v_fmac_f32 v138, v240, v240
    v_fmac_f32 v139, v241, v241
    v_add_f32 v138, v138, v139
    s_waitcnt lgkmcnt(0)
    s_waitcnt vmcnt(16)
    s_barrier
    v_mfma_f32_32x32x16_bf16 v[48:63], a[72:75], a[168:171], v[48:63]
    ds_read_b128 a[80:83], v166 offset:32768
    ds_read_b128 a[192:195], v170 offset:32768
    ds_read_b128 a[196:199], v170 offset:36864
    s_add_u32 s95, s7, 0
    s_and_b32 s95, s95, 128
    s_add_u32 s95, s95, 1024
    s_add_u32 m0, s93, 0
    v_mfma_f32_16x16x32_bf16 a[220:223], v[190:193], a[168:171], a[220:223]
    ds_read_b128 a[200:203], v170 offset:40960
    buffer_load_dwordx4 v148, s[48:51], s95 offen lds
    s_add_u32 m0, s93, 1024
    v_mfma_f32_32x32x16_bf16 v[64:79], a[72:75], a[172:175], v[64:79]
    ds_read_b128 a[204:207], v170 offset:45056
    buffer_load_dwordx4 v149, s[48:51], s95 offen lds
    s_add_u32 m0, s93, 2048
    v_add_f32_dpp v138, v138, v138 quad_perm:[1,0,3,2] row_mask:0xf bank_mask:0xf
    s_nop 1
    v_add_f32_dpp v138, v138, v138 quad_perm:[2,3,0,1] row_mask:0xf bank_mask:0xf
    s_nop 1
    v_add_f32_dpp v138, v138, v138 row_half_mirror row_mask:0xf bank_mask:0xf
    v_mfma_f32_32x32x16_bf16 v[0:15], a[76:79], a[176:179], v[0:15]
    ds_read_b128 a[84:87], v167 offset:32768
    ds_read_b128 a[160:163], v171 offset:32768
    v_add_f32_dpp v138, v138, v138 row_mirror row_mask:0xf bank_mask:0xf
    v_mov_b32 v139, v138
    s_nop 1
    v_permlane16_swap_b32 v138, v139
    v_add_f32 v138, v138, v139
    v_mfma_f32_32x32x16_bf16 v[16:31], a[76:79], a[180:183], v[16:31]
    ds_read_b128 a[164:167], v171 offset:36864
    buffer_load_dwordx4 v150, s[48:51], s95 offen lds
    s_add_u32 m0, s93, 3072
    v_mul_f32 v138, 0x3acccccd, v138
    v_cvt_pk_bf16_f32 v138, v138, v138
    v_and_b32 v138, 0xffff0000, v138
    v_mfma_f32_32x32x16_bf16 v[48:63], a[76:79], a[184:187], v[48:63]
    ds_read_b128 a[168:171], v171 offset:40960
    v_add_f32 v138, 0x3727c5ac, v138
    v_cvt_pk_bf16_f32 v138, v138, v138
    v_and_b32 v138, 0xffff0000, v138
    v_sqrt_f32 v138, v138
    v_mfma_f32_32x32x16_bf16 v[64:79], a[76:79], a[188:191], v[64:79]
    ds_read_b128 a[172:175], v171 offset:45056
    buffer_load_dwordx4 v151, s[48:51], s95 offen lds
    s_add_u32 m0, s94, 16384
    v_cvt_pk_bf16_f32 v195, v138, v138
    v_and_b32 v195, 0xffff0000, v195
    v_cvt_pk_bf16_f32 v194, v136, v136
    v_mfma_f32_16x16x32_bf16 a[224:227], v[190:193], a[188:191], a[224:227]
    v_and_b32 v194, 0xffff0000, v194
    s_waitcnt lgkmcnt(5)
    v_mfma_f32_32x32x16_bf16 v[0:15], a[80:83], a[192:195], v[0:15]
    ds_read_b128 a[88:91], v168 offset:32768
    ds_read_b128 a[176:179], v172 offset:32768
    v_lshlrev_b32 v201, 4, v252
    v_readfirstlane_b32 s88, v198
    v_readfirstlane_b32 s89, v199
    s_nop 0
    s_cmp_lg_u32 s88, 0
    s_cbranch_scc0 L_rt_33
L_ok_32:
    v_mfma_f32_16x16x32_bf16 a[208:211], v[190:193], a[192:195], a[208:211]
    ds_read_b128 a[180:183], v172 offset:36864
    buffer_load_dwordx4 v152, s[52:55], s95 offen lds
    s_add_u32 m0, s94, 20480
    v_mfma_f32_32x32x16_bf16 v[16:31], a[80:83], a[196:199], v[16:31]
    ds_read_b128 a[184:187], v172 offset:40960
    v_mov_b32 v196, s88
    v_mov_b32 v197, s89
    s_mov_b32 exec_lo, 1
    s_mov_b32 exec_hi, 1
    buffer_store_dwordx4 v[194:197], v201, s[68:71], 0 offen sc1
    s_mov_b64 exec, -1
    v_mfma_f32_32x32x16_bf16 v[48:63], a[80:83], a[200:203], v[48:63]
    ds_read_b128 a[188:191], v172 offset:45056
    buffer_load_dwordx4 v153, s[52:55], s95 offen lds
    s_add_u32 m0, s94, 24576
    v_mfma_f32_32x32x16_bf16 v[64:79], a[80:83], a[204:207], v[64:79]
    s_waitcnt lgkmcnt(5)
    v_mfma_f32_32x32x16_bf16 v[0:15], a[84:87], a[160:163], v[0:15]
    ds_read_b128 a[92:95], v169 offset:32768
    ds_read_b128 a[192:195], v173 offset:32768
    buffer_load_dwordx4 v152, s[36:39], s95 offen lds
    s_add_u32 m0, s94, 28672
    v_mfma_f32_32x32x16_bf16 v[16:31], a[84:87], a[164:167], v[16:31]
    ds_read_b128 a[196:199], v173 offset:36864
    v_mfma_f32_16x16x32_bf16 a[212:215], v[190:193], a[164:167], a[212:215]
    ds_read_b128 a[200:203], v173 offset:40960
    v_mfma_f32_32x32x16_bf16 v[48:63], a[84:87], a[168:171], v[48:63]
    ds_read_b128 a[204:207], v173 offset:45056
    buffer_load_dwordx4 v153, s[36:39], s95 offen lds
    v_mfma_f32_32x32x16_bf16 v[64:79], a[84:87], a[172:175], v[64:79]
    s_waitcnt lgkmcnt(5)
    v_mfma_f32_32x32x16_bf16 v[0:15], a[88:91], a[176:179], v[0:15]
    v_mfma_f32_32x32x16_bf16 v[16:31], a[88:91], a[180:183], v[16:31]
    s_waitcnt lgkmcnt(0)
    s_waitcnt vmcnt(17)
    s_barrier
    v_mfma_f32_32x32x16_bf16 v[48:63], a[88:91], a[184:187], v[48:63]
    v_add_u32 v166, 65536, v166
    ds_read_b128 a[96:99], v166 offset:0
    v_add_u32 v170, 65536, v170
    ds_read_b128 a[160:163], v170 offset:0
    s_add_u32 s95, s7, 128
    s_and_b32 s95, s95, 128
    s_add_u32 s95, s95, 1024
    s_add_u32 m0, s93, 32768
    v_mfma_f32_16x16x32_bf16 a[220:223], v[190:193], a[184:187], a[220:223]
    ds_read_b128 a[164:167], v170 offset:4096
    buffer_load_dwordx4 v148, s[48:51], s95 offen lds
    s_add_u32 m0, s93, 33792
    v_mfma_f32_32x32x16_bf16 v[64:79], a[88:91], a[188:191], v[64:79]
    ds_read_b128 a[168:171], v170 offset:8192
    ds_read_b128 a[172:175], v170 offset:12288
    buffer_load_dwordx4 v149, s[48:51], s95 offen lds
    s_add_u32 m0, s93, 34816
    v_mfma_f32_32x32x16_bf16 v[0:15], a[92:95], a[192:195], v[0:15]
    v_add_u32 v167, 65536, v167
    ds_read_b128 a[100:103], v167 offset:0
    v_mfma_f32_32x32x16_bf16 v[16:31], a[92:95], a[196:199], v[16:31]
    v_add_u32 v171, 65536, v171
    ds_read_b128 a[176:179], v171 offset:0
    buffer_load_dwordx4 v150, s[48:51], s95 offen lds
    s_add_u32 m0, s93, 35840
    v_mfma_f32_32x32x16_bf16 v[48:63], a[92:95], a[200:203], v[48:63]
    ds_read_b128 a[180:183], v171 offset:4096
    ds_read_b128 a[184:187], v171 offset:8192
    v_mfma_f32_32x32x16_bf16 v[64:79], a[92:95], a[204:207], v[64:79]
    ds_read_b128 a[188:191], v171 offset:12288
    buffer_load_dwordx4 v151, s[48:51], s95 offen lds
    s_add_u32 m0, s94, 49152
    v_mfma_f32_16x16x32_bf16 a[224:227], v[190:193], a[204:207], a[224:227]
    s_waitcnt lgkmcnt(5)
    v_mfma_f32_32x32x16_bf16 v[0:15], a[96:99], a[160:163], v[0:15]
    v_add_u32 v168, 65536, v168
    ds_read_b128 a[104:107], v168 offset:0
    v_mfma_f32_16x16x32_bf16 a[208:211], v[190:193], a[160:163], a[208:211]
    v_add_u32 v172, 65536, v172
    buffer_load_dwordx4 v152, s[52:55], s95 offen lds
    s_add_u32 m0, s94, 53248
    v_mfma_f32_32x32x16_bf16 v[16:31], a[96:99], a[164:167], v[16:31]
    ds_read_b128 a[192:195], v172 offset:0
    ds_read_b128 a[196:199], v172 offset:4096
    v_mfma_f32_32x32x16_bf16 v[48:63], a[96:99], a[168:171], v[48:63]
    ds_read_b128 a[200:203], v172 offset:8192
    buffer_load_dwordx4 v153, s[52:55], s95 offen lds
    s_add_u32 m0, s94, 57344
    v_mfma_f32_32x32x16_bf16 v[64:79], a[96:99], a[172:175], v[64:79]
    ds_read_b128 a[204:207], v172 offset:12288
    s_waitcnt lgkmcnt(5)
    v_mfma_f32_32x32x16_bf16 v[0:15], a[100:103], a[176:179], v[0:15]
    v_add_u32 v169, 65536, v169
    ds_read_b128 a[108:111], v169 offset:0
    buffer_load_dwordx4 v152, s[36:39], s95 offen lds
    s_add_u32 m0, s94, 61440
    v_mfma_f32_32x32x16_bf16 v[16:31], a[100:103], a[180:183], v[16:31]
    v_add_u32 v173, 65536, v173
    ds_read_b128 a[160:163], v173 offset:0
    v_mfma_f32_16x16x32_bf16 a[212:215], v[190:193], a[180:183], a[212:215]
    ds_read_b128 a[164:167], v173 offset:4096
    v_mfma_f32_32x32x16_bf16 v[48:63], a[100:103], a[184:187], v[48:63]
    ds_read_b128 a[168:171], v173 offset:8192
    buffer_load_dwordx4 v153, s[36:39], s95 offen lds
    v_mfma_f32_32x32x16_bf16 v[64:79], a[100:103], a[188:191], v[64:79]
    ds_read_b128 a[172:175], v173 offset:12288
    s_waitcnt lgkmcnt(5)
    v_mfma_f32_32x32x16_bf16 v[0:15], a[104:107], a[192:195], v[0:15]
    v_mfma_f32_32x32x16_bf16 v[16:31], a[104:107], a[196:199], v[16:31]
    s_waitcnt lgkmcnt(0)
    s_waitcnt vmcnt(17)
    s_barrier
    v_mfma_f32_32x32x16_bf16 v[48:63], a[104:107], a[200:203], v[48:63]
    ds_read_b128 a[112:115], v166 offset:32768
    ds_read_b128 a[176:179], v170 offset:32768
    ds_read_b128 a[180:183], v170 offset:36864
    s_add_u32 s95, s7, 256
    s_and_b32 s95, s95, 384
    s_add_u32 s95, s95, 0
    s_add_u32 m0, s94, 65536
    v_mfma_f32_16x16x32_bf16 a[220:223], v[190:193], a[200:203], a[220:223]
    ds_read_b128 a[184:187], v170 offset:40960
    buffer_load_dwordx4 v154, s[52:55], s95 offen lds
    s_add_u32 m0, s94, 69632
    v_mfma_f32_32x32x16_bf16 v[64:79], a[104:107], a[204:207], v[64:79]
    ds_read_b128 a[188:191], v170 offset:45056
    buffer_load_dwordx4 v154, s[36:39], s95 offen lds
    s_add_u32 s95, s7, 384
    s_and_b32 s95, s95, 384
    s_add_u32 s95, s95, 0
    s_add_u32 m0, s94, 73728
    v_mfma_f32_32x32x16_bf16 v[0:15], a[108:111], a[160:163], v[0:15]
    ds_read_b128 a[116:119], v167 offset:32768
    ds_read_b128 a[192:195], v171 offset:32768
    v_mfma_f32_32x32x16_bf16 v[16:31], a[108:111], a[164:167], v[16:31]
    ds_read_b128 a[196:199], v171 offset:36864
    buffer_load_dwordx4 v154, s[52:55], s95 offen lds
    s_add_u32 m0, s94, 77824
    v_mfma_f32_32x32x16_bf16 v[48:63], a[108:111], a[168:171], v[48:63]
    ds_read_b128 a[200:203], v171 offset:40960
    v_mfma_f32_32x32x16_bf16 v[64:79], a[108:111], a[172:175], v[64:79]
    ds_read_b128 a[204:207], v171 offset:45056
    buffer_load_dwordx4 v154, s[36:39], s95 offen lds
    s_add_u32 s95, s7, 0
    s_and_b32 s95, s95, 384
    s_add_u32 s95, s95, 512
    s_add_u32 m0, s94, 81920
    v_mfma_f32_16x16x32_bf16 a[224:227], v[190:193], a[172:175], a[224:227]
    s_waitcnt lgkmcnt(5)
    v_mfma_f32_32x32x16_bf16 v[0:15], a[112:115], a[176:179], v[0:15]
    ds_read_b128 a[120:123], v168 offset:32768
    ds_read_b128 a[160:163], v172 offset:32768
    v_bfe_u32 v201, v145, 2, 1
    v_lshlrev_b32 v201, 4, v201
    v_and_b32 v200, 1, v145
    v_lshl_or_b32 v201, v200, 3, v201
    v_mfma_f32_16x16x32_bf16 a[208:211], v[190:193], a[176:179], a[208:211]
    ds_read_b128 a[164:167], v172 offset:36864
    buffer_load_dwordx4 v154, s[52:55], s95 offen lds
    s_add_u32 m0, s94, 86016
    v_mfma_f32_32x32x16_bf16 v[16:31], a[112:115], a[180:183], v[16:31]
    ds_read_b128 a[168:171], v172 offset:40960
    v_bfe_u32 v200, v145, 3, 2
    v_lshl_or_b32 v201, v200, 1, v201
    v_bfe_u32 v200, v145, 1, 1
    v_or_b32 v201, v201, v200
    v_add_u32 v201, s100, v201
    v_mfma_f32_32x32x16_bf16 v[48:63], a[112:115], a[184:187], v[48:63]
    ds_read_b128 a[172:175], v172 offset:45056
    buffer_load_dwordx4 v154, s[36:39], s95 offen lds
    s_add_u32 s95, s7, 128
    s_and_b32 s95, s95, 384
    s_add_u32 s95, s95, 512
    s_add_u32 m0, s94, 90112
    v_mfma_f32_32x32x16_bf16 v[64:79], a[112:115], a[188:191], v[64:79]
    v_lshlrev_b32 v201, 4, v201
    s_waitcnt lgkmcnt(5)
    v_mfma_f32_32x32x16_bf16 v[0:15], a[116:119], a[192:195], v[0:15]
    ds_read_b128 a[124:127], v169 offset:32768
    ds_read_b128 a[176:179], v173 offset:32768
    buffer_load_dwordx4 v[194:197], v201, s[68:71], 0 offen sc1
    v_mfma_f32_32x32x16_bf16 v[16:31], a[116:119], a[196:199], v[16:31]
    ds_read_b128 a[180:183], v173 offset:36864
    v_mfma_f32_16x16x32_bf16 a[212:215], v[190:193], a[196:199], a[212:215]
    ds_read_b128 a[184:187], v173 offset:40960
    v_mfma_f32_32x32x16_bf16 v[48:63], a[116:119], a[200:203], v[48:63]
    ds_read_b128 a[188:191], v173 offset:45056
    buffer_load_dwordx4 v154, s[52:55], s95 offen lds
    s_add_u32 m0, s94, 94208
    v_mfma_f32_32x32x16_bf16 v[64:79], a[116:119], a[204:207], v[64:79]
    s_waitcnt lgkmcnt(5)
    v_mfma_f32_32x32x16_bf16 v[0:15], a[120:123], a[160:163], v[0:15]
    buffer_load_dwordx4 v154, s[36:39], s95 offen lds
    v_mfma_f32_32x32x16_bf16 v[16:31], a[120:123], a[164:167], v[16:31]
    s_waitcnt lgkmcnt(0)
    s_waitcnt vmcnt(17)
    s_barrier
    v_mfma_f32_32x32x16_bf16 v[48:63], a[120:123], a[168:171], v[48:63]
    v_add_u32 v166, 4294901760, v166
    ds_read_b128 a[128:131], v166 offset:0
    v_add_u32 v170, 4294901760, v170
    ds_read_b128 a[192:195], v170 offset:0
    s_add_u32 s95, s7, 256
    s_and_b32 s95, s95, 384
    s_add_u32 s95, s95, 512
    s_add_u32 m0, s94, 98304
    v_mfma_f32_16x16x32_bf16 a[220:223], v[190:193], a[168:171], a[220:223]
    ds_read_b128 a[196:199], v170 offset:4096
    buffer_load_dwordx4 v154, s[52:55], s95 offen lds
    s_add_u32 m0, s94, 102400
    v_mfma_f32_32x32x16_bf16 v[64:79], a[120:123], a[172:175], v[64:79]
    ds_read_b128 a[200:203], v170 offset:8192
    ds_read_b128 a[204:207], v170 offset:12288
    buffer_load_dwordx4 v154, s[36:39], s95 offen lds
    s_add_u32 s95, s7, 384
    s_and_b32 s95, s95, 384
    s_add_u32 s95, s95, 512
    s_add_u32 m0, s94, 106496
    v_mfma_f32_32x32x16_bf16 v[0:15], a[124:127], a[176:179], v[0:15]
    v_add_u32 v167, 4294901760, v167
    ds_read_b128 a[132:135], v167 offset:0
    v_mfma_f32_32x32x16_bf16 v[16:31], a[124:127], a[180:183], v[16:31]
    v_add_u32 v171, 4294901760, v171
    ds_read_b128 a[160:163], v171 offset:0
    buffer_load_dwordx4 v154, s[52:55], s95 offen lds
    s_add_u32 m0, s94, 110592
    v_mfma_f32_32x32x16_bf16 v[48:63], a[124:127], a[184:187], v[48:63]
    ds_read_b128 a[164:167], v171 offset:4096
    ds_read_b128 a[168:171], v171 offset:8192
    v_mfma_f32_32x32x16_bf16 v[64:79], a[124:127], a[188:191], v[64:79]
    ds_read_b128 a[172:175], v171 offset:12288
    buffer_load_dwordx4 v154, s[36:39], s95 offen lds
    s_add_u32 s95, s7, 0
    s_and_b32 s95, s95, 128
    s_add_u32 s95, s95, 1024
    s_add_u32 m0, s94, 114688
    v_mfma_f32_16x16x32_bf16 a[224:227], v[190:193], a[188:191], a[224:227]
    s_waitcnt lgkmcnt(5)
    v_mfma_f32_32x32x16_bf16 v[0:15], a[128:131], a[192:195], v[0:15]
    v_add_u32 v168, 4294901760, v168
    ds_read_b128 a[136:139], v168 offset:0
    v_mfma_f32_16x16x32_bf16 a[208:211], v[190:193], a[192:195], a[208:211]
    v_add_u32 v172, 4294901760, v172
    buffer_load_dwordx4 v154, s[52:55], s95 offen lds
    s_add_u32 m0, s94, 118784
    v_mfma_f32_32x32x16_bf16 v[16:31], a[128:131], a[196:199], v[16:31]
    ds_read_b128 a[176:179], v172 offset:0
    ds_read_b128 a[180:183], v172 offset:4096
    v_mfma_f32_32x32x16_bf16 v[48:63], a[128:131], a[200:203], v[48:63]
    ds_read_b128 a[184:187], v172 offset:8192
    buffer_load_dwordx4 v154, s[36:39], s95 offen lds
    s_add_u32 s95, s7, 128
    s_and_b32 s95, s95, 128
    s_add_u32 s95, s95, 1024
    s_add_u32 m0, s94, 122880
    v_mfma_f32_32x32x16_bf16 v[64:79], a[128:131], a[204:207], v[64:79]
    ds_read_b128 a[188:191], v172 offset:12288
    buffer_load_dwordx4 v154, s[52:55], s95 offen lds
    s_add_u32 m0, s94, 126976
    s_nop 0
    buffer_load_dwordx4 v154, s[36:39], s95 offen lds
    s_and_b32 s96, s5, 7
    s_lshl_b32 s96, s96, 2
    s_add_u32 s96, s96, s6
    s_xor_b32 s96, s96, 0
    s_lshl_b32 s96, s96, 2
    s_add_u32 s96, s96, s3
    s_cmp_eq_u32 s101, 1
    s_cselect_b32 s97, 45, 30
    s_mul_i32 s98, s96, s97
    s_lshl_b32 s98, s98, 7
    s_mul_i32 s99, s4, 491520
    s_add_u32 s98, s98, s99
    s_sub_u32 s97, s97, 1
    v_min_u32 v186, s97, v144
    v_lshlrev_b32 v186, 7, v186
    buffer_load_dword a255, v186, s[56:59], s98 offen
    s_mul_i32 s98, s96, 6400
    s_add_u32 s98, s98, s83
    s_lshl_b32 s97, s101, 1
    s_sub_u32 s97, 2, s97
    v_lshrrev_b32 v187, 2, v144
    v_min_u32 v187, 4, v187
    v_mul_u32_u24 v187, 1280, v187
    v_and_b32 v186, 3, v144
    v_min_u32 v186, s97, v186
    v_lshl_add_u32 v187, v186, 7, v187
    buffer_load_dword a255, v187, s[60:63], s98 offen
    buffer_load_dword a255, v187, s[64:67], s98 offen
    s_waitcnt lgkmcnt(5)
    v_mfma_f32_32x32x16_bf16 v[0:15], a[132:135], a[160:163], v[0:15]
    v_add_u32 v169, 4294901760, v169
    ds_read_b128 a[140:143], v169 offset:0
    v_mfma_f32_32x32x16_bf16 v[16:31], a[132:135], a[164:167], v[16:31]
    v_add_u32 v173, 4294901760, v173
    ds_read_b128 a[192:195], v173 offset:0
    v_mfma_f32_16x16x32_bf16 a[212:215], v[190:193], a[164:167], a[212:215]
    ds_read_b128 a[196:199], v173 offset:4096
    v_mfma_f32_32x32x16_bf16 v[48:63], a[132:135], a[168:171], v[48:63]
    ds_read_b128 a[200:203], v173 offset:8192
    v_mfma_f32_32x32x16_bf16 v[64:79], a[132:135], a[172:175], v[64:79]
    ds_read_b128 a[204:207], v173 offset:12288
    s_waitcnt lgkmcnt(5)
    v_mfma_f32_32x32x16_bf16 v[0:15], a[136:139], a[176:179], v[0:15]
    s_waitcnt vmcnt(13)
    v_cmp_eq_u64 vcc, s[88:89], v[196:197]
    s_nop 1
    s_cmp_eq_u64 vcc, -1
    s_cbranch_scc0 L_rt_35
L_ok_34:
    v_cmp_eq_u32 vcc, 0, v146
    v_xor_b32 v242, 0x80000000, v194
    v_mfma_f32_32x32x16_bf16 v[16:31], a[136:139], a[180:183], v[16:31]
    v_lshrrev_b32 v243, 16, v242
    v_or_b32 v244, v243, v242
    v_or_b32 v245, v243, v195
    v_cndmask_b32 v198, 0, v244, vcc
    v_cndmask_b32 v199, 0, v245, vcc
    v_mov_b32 v200, 0
    s_waitcnt lgkmcnt(0)
    s_barrier
    v_mfma_f32_32x32x16_bf16 v[48:63], a[136:139], a[184:187], v[48:63]
    ds_read_b128 a[144:147], v166 offset:32768
    ds_read_b128 a[160:163], v170 offset:32768
    ds_read_b128 a[164:167], v170 offset:36864
    v_mov_b32 v201, 0
    v_rcp_f32 v196, v195
    v_mfma_f32_16x16x32_bf16 a[220:223], v[190:193], a[184:187], a[220:223]
    ds_read_b128 a[168:171], v170 offset:40960
    v_mfma_f32_32x32x16_bf16 v[64:79], a[136:139], a[188:191], v[64:79]
    ds_read_b128 a[172:175], v170 offset:45056
    v_lshlrev_b32 v240, 4, v145
    s_lshl_b32 s12, s3, 2
    v_add_u32 v240, 147456, v240
    v_add_u32 v241, s12, v240
    v_mov_b32 v242, 0x07060302
    v_mfma_f32_32x32x16_bf16 v[0:15], a[140:143], a[192:195], v[0:15]
    ds_read_b128 a[232:235], v170 offset:32768
    ds_read_b128 a[236:239], v171 offset:36864
    ds_read_b128 a[216:219], v172 offset:40960
    v_mov_b32 v202, 0
    v_mov_b32 v203, 0
    v_mov_b32 v204, 0
    v_mfma_f32_32x32x16_bf16 v[16:31], a[140:143], a[196:199], v[16:31]
    ds_read_b128 a[228:231], v173 offset:45056
    ds_read_b128 a[148:151], v167 offset:32768
    v_mov_b32 v205, 0
    v_mov_b32 v206, 0
    v_mov_b32 v207, 0
    v_mov_b32 v208, 0
    v_mfma_f32_32x32x16_bf16 v[48:63], a[140:143], a[200:203], v[48:63]
    ds_read_b128 a[176:179], v171 offset:32768
    ds_read_b128 a[180:183], v171 offset:36864
    v_mov_b32 v209, 0
    v_mov_b32 v210, 0
    v_mov_b32 v211, 0
    v_mov_b32 v212, 0
    v_mfma_f32_32x32x16_bf16 v[64:79], a[140:143], a[204:207], v[64:79]
    ds_read_b128 a[184:187], v171 offset:40960
    ds_read_b128 a[188:191], v171 offset:45056
    v_mov_b32 v213, 0
    v_mov_b32 v214, 0
    v_mov_b32 v215, 0
    ds_write_b32 v250, v196
    v_mfma_f32_16x16x32_bf16 a[224:227], v[190:193], a[204:207], a[224:227]
    ds_read_b128 v[120:123], v251 offset:0
    s_waitcnt lgkmcnt(11)
    s_waitcnt lgkmcnt(0)
    v_mfma_f32_32x32x16_bf16 v[0:15], a[144:147], a[160:163], v[0:15]
    ds_read_b128 a[152:155], v168 offset:32768
    ds_read_b128 a[192:195], v172 offset:32768
    ds_read_b128 v[124:127], v251 offset:32
    ds_read_b128 v[128:131], v251 offset:64
    ds_read_b128 v[132:135], v251 offset:96
    v_mfma_f32_16x16x32_bf16 a[208:211], v[190:193], a[232:235], a[208:211]
    ds_read_b128 a[196:199], v172 offset:36864
    v_mfma_f32_32x32x16_bf16 v[16:31], a[144:147], a[164:167], v[16:31]
    ds_read_b128 a[200:203], v172 offset:40960
    v_mfma_f32_16x16x32_bf16 a[212:215], v[190:193], a[236:239], a[212:215]
    ds_read_b128 a[204:207], v172 offset:45056
    v_mfma_f32_32x32x16_bf16 v[48:63], a[144:147], a[168:171], v[48:63]
    v_mfma_f32_16x16x32_bf16 a[220:223], v[190:193], a[216:219], a[220:223]
    v_mfma_f32_32x32x16_bf16 v[64:79], a[144:147], a[172:175], v[64:79]
    v_mfma_f32_16x16x32_bf16 a[224:227], v[190:193], a[228:231], a[224:227]
    v_mfma_f32_32x32x16_bf16 v[0:15], a[148:151], a[176:179], v[0:15]
    ds_read_b128 a[156:159], v169 offset:32768
    ds_read_b128 a[160:163], v173 offset:32768
    ds_write_b32 v241, a208 offset:0
    ds_write_b32 v241, a212 offset:2048
    s_nop 0
    ds_write_b32 v241, a220 offset:4096
    s_nop 0
    ds_write_b32 v241, a224 offset:6144
    v_mfma_f32_32x32x16_bf16 v[16:31], a[148:151], a[180:183], v[16:31]
    ds_read_b128 a[164:167], v173 offset:36864
    v_mfma_f32_32x32x16_bf16 v[48:63], a[148:151], a[184:187], v[48:63]
    ds_read_b128 a[168:171], v173 offset:40960
    v_mfma_f32_32x32x16_bf16 v[64:79], a[148:151], a[188:191], v[64:79]
    ds_read_b128 a[172:175], v173 offset:45056
    s_waitcnt lgkmcnt(9)
    v_mfma_f32_32x32x16_bf16 v[0:15], a[152:155], a[192:195], v[0:15]
    s_waitcnt lgkmcnt(0)
    s_barrier
    v_mfma_f32_32x32x16_bf16 v[16:31], a[152:155], a[196:199], v[16:31]
    ds_read_b128 v[96:99], v240 offset:0
    ds_read_b128 v[100:103], v240 offset:2048
    ds_read_b128 v[104:107], v240 offset:4096
    ds_read_b128 v[108:111], v240 offset:6144
    v_mfma_f32_32x32x16_bf16 v[48:63], a[152:155], a[200:203], v[48:63]
    s_waitcnt lgkmcnt(3)
    v_add_f32 v96, v96, v97
    v_add_f32 v98, v98, v99
    v_add_f32 v96, v96, v98
    v_mfma_f32_32x32x16_bf16 v[64:79], a[152:155], a[204:207], v[64:79]
    v_and_b32 v97, 0xffff0000, v96
    v_sub_f32 v98, v96, v97
    v_and_b32 v99, 0xffff0000, v98
    v_sub_f32 v98, v98, v99
    v_alignbit_b32 v203, v155, v98, 16
    v_perm_b32 v202, v99, v96, v242
    v_mfma_f32_32x32x16_bf16 v[0:15], a[156:159], a[160:163], v[0:15]
    s_waitcnt lgkmcnt(2)
    v_add_f32 v100, v100, v101
    v_add_f32 v102, v102, v103
    v_add_f32 v100, v100, v102
    v_and_b32 v101, 0xffff0000, v100
    v_sub_f32 v102, v100, v101
    v_mfma_f32_32x32x16_bf16 v[16:31], a[156:159], a[164:167], v[16:31]
    v_and_b32 v103, 0xffff0000, v102
    v_sub_f32 v102, v102, v103
    v_alignbit_b32 v205, v155, v102, 16
    v_perm_b32 v204, v103, v100, v242
    s_waitcnt lgkmcnt(1)
    v_add_f32 v104, v104, v105
    v_mfma_f32_32x32x16_bf16 v[48:63], a[156:159], a[168:171], v[48:63]
    v_add_f32 v106, v106, v107
    v_add_f32 v104, v104, v106
    v_and_b32 v105, 0xffff0000, v104
    v_sub_f32 v106, v104, v105
    v_and_b32 v107, 0xffff0000, v106
    v_sub_f32 v106, v106, v107
    v_mfma_f32_32x32x16_bf16 v[64:79], a[156:159], a[172:175], v[64:79]
    v_alignbit_b32 v209, v155, v106, 16
    v_perm_b32 v208, v107, v104, v242
    s_waitcnt lgkmcnt(0)
    v_add_f32 v108, v108, v109
    v_add_f32 v110, v110, v111
    v_add_f32 v108, v108, v110
    v_and_b32 v109, 0xffff0000, v108
    v_sub_f32 v110, v108, v109
    v_and_b32 v111, 0xffff0000, v110
    v_sub_f32 v110, v110, v111
    v_alignbit_b32 v211, v155, v110, 16
    v_perm_b32 v210, v111, v108, v242
    v_mfma_f32_32x32x16_bf16 v[0:15], v[198:201], v[202:205], v[0:15]
    v_mfma_f32_32x32x16_bf16 v[16:31], v[198:201], v[204:207], v[16:31]
    v_mfma_f32_32x32x16_bf16 v[48:63], v[198:201], v[208:211], v[48:63]
    v_mfma_f32_32x32x16_bf16 v[64:79], v[198:201], v[210:213], v[64:79]
    s_nop 8
    v_pk_mul_f32 v[0:1], v[0:1], v[120:121]
    v_pk_mul_f32 v[2:3], v[2:3], v[122:123]
    v_pk_mul_f32 v[4:5], v[4:5], v[124:125]
    v_pk_mul_f32 v[6:7], v[6:7], v[126:127]
    v_pk_mul_f32 v[8:9], v[8:9], v[128:129]
    v_pk_mul_f32 v[10:11], v[10:11], v[130:131]
    v_pk_mul_f32 v[12:13], v[12:13], v[132:133]
    v_pk_mul_f32 v[14:15], v[14:15], v[134:135]
    v_pk_mul_f32 v[48:49], v[48:49], v[120:121]
    v_pk_mul_f32 v[50:51], v[50:51], v[122:123]
    v_pk_mul_f32 v[52:53], v[52:53], v[124:125]
    v_pk_mul_f32 v[54:55], v[54:55], v[126:127]
    v_pk_mul_f32 v[56:57], v[56:57], v[128:129]
    v_pk_mul_f32 v[58:59], v[58:59], v[130:131]
    v_pk_mul_f32 v[60:61], v[60:61], v[132:133]
    v_pk_mul_f32 v[62:63], v[62:63], v[134:135]
    v_pk_mul_f32 v[16:17], v[16:17], v[120:121]
    v_pk_mul_f32 v[18:19], v[18:19], v[122:123]
    v_pk_mul_f32 v[20:21], v[20:21], v[124:125]
    v_pk_mul_f32 v[22:23], v[22:23], v[126:127]
    v_pk_mul_f32 v[24:25], v[24:25], v[128:129]
    v_pk_mul_f32 v[26:27], v[26:27], v[130:131]
    v_pk_mul_f32 v[28:29], v[28:29], v[132:133]
    v_pk_mul_f32 v[30:31], v[30:31], v[134:135]
    v_pk_mul_f32 v[64:65], v[64:65], v[120:121]
    v_pk_mul_f32 v[66:67], v[66:67], v[122:123]
    v_pk_mul_f32 v[68:69], v[68:69], v[124:125]
    v_pk_mul_f32 v[70:71], v[70:71], v[126:127]
    v_pk_mul_f32 v[72:73], v[72:73], v[128:129]
    v_pk_mul_f32 v[74:75], v[74:75], v[130:131]
    v_pk_mul_f32 v[76:77], v[76:77], v[132:133]
    v_pk_mul_f32 v[78:79], v[78:79], v[134:135]
    v_pk_fma_f32 v[100:101], v[216:217], v[48:49], v[2:3] op_sel:[1,0,0] op_sel_hi:[1,1,1] neg_lo:[1,0,0] neg_hi:[1,0,0]
    v_pk_fma_f32 v[102:103], v[216:217], v[0:1], v[50:51] op_sel:[1,0,0] op_sel_hi:[1,1,1]
    v_pk_fma_f32 v[108:109], v[218:219], v[64:65], v[18:19] op_sel:[1,0,0] op_sel_hi:[1,1,1] neg_lo:[1,0,0] neg_hi:[1,0,0]
    v_pk_fma_f32 v[110:111], v[218:219], v[16:17], v[66:67] op_sel:[1,0,0] op_sel_hi:[1,1,1]
    v_pk_fma_f32 v[96:97], v[216:217], v[0:1], v[100:101] op_sel_hi:[0,1,1]
    v_pk_fma_f32 v[98:99], v[216:217], v[48:49], v[102:103] op_sel_hi:[0,1,1]
    v_pk_fma_f32 v[104:105], v[218:219], v[16:17], v[108:109] op_sel_hi:[0,1,1]
    v_pk_fma_f32 v[106:107], v[218:219], v[64:65], v[110:111] op_sel_hi:[0,1,1]
    v_pk_fma_f32 v[100:101], v[216:217], v[98:99], v[4:5] op_sel:[1,0,0] op_sel_hi:[1,1,1] neg_lo:[1,0,0] neg_hi:[1,0,0]
    v_pk_fma_f32 v[102:103], v[216:217], v[96:97], v[52:53] op_sel:[1,0,0] op_sel_hi:[1,1,1]
    v_pk_fma_f32 v[108:109], v[218:219], v[106:107], v[20:21] op_sel:[1,0,0] op_sel_hi:[1,1,1] neg_lo:[1,0,0] neg_hi:[1,0,0]
    v_pk_fma_f32 v[110:111], v[218:219], v[104:105], v[68:69] op_sel:[1,0,0] op_sel_hi:[1,1,1]
    v_pk_fma_f32 v[96:97], v[216:217], v[96:97], v[100:101] op_sel_hi:[0,1,1]
    v_pk_fma_f32 v[98:99], v[216:217], v[98:99], v[102:103] op_sel_hi:[0,1,1]
    v_pk_fma_f32 v[104:105], v[218:219], v[104:105], v[108:109] op_sel_hi:[0,1,1]
    v_pk_fma_f32 v[106:107], v[218:219], v[106:107], v[110:111] op_sel_hi:[0,1,1]
    v_pk_fma_f32 v[100:101], v[216:217], v[98:99], v[6:7] op_sel:[1,0,0] op_sel_hi:[1,1,1] neg_lo:[1,0,0] neg_hi:[1,0,0]
    v_pk_fma_f32 v[102:103], v[216:217], v[96:97], v[54:55] op_sel:[1,0,0] op_sel_hi:[1,1,1]
    v_pk_fma_f32 v[108:109], v[218:219], v[106:107], v[22:23] op_sel:[1,0,0] op_sel_hi:[1,1,1] neg_lo:[1,0,0] neg_hi:[1,0,0]
    v_pk_fma_f32 v[110:111], v[218:219], v[104:105], v[70:71] op_sel:[1,0,0] op_sel_hi:[1,1,1]
    v_pk_fma_f32 v[96:97], v[216:217], v[96:97], v[100:101] op_sel_hi:[0,1,1]
    v_pk_fma_f32 v[98:99], v[216:217], v[98:99], v[102:103] op_sel_hi:[0,1,1]
    v_pk_fma_f32 v[104:105], v[218:219], v[104:105], v[108:109] op_sel_hi:[0,1,1]
    v_pk_fma_f32 v[106:107], v[218:219], v[106:107], v[110:111] op_sel_hi:[0,1,1]
    v_pk_fma_f32 v[100:101], v[216:217], v[98:99], v[8:9] op_sel:[1,0,0] op_sel_hi:[1,1,1] neg_lo:[1,0,0] neg_hi:[1,0,0]
    v_pk_fma_f32 v[102:103], v[216:217], v[96:97], v[56:57] op_sel:[1,0,0] op_sel_hi:[1,1,1]
    v_pk_fma_f32 v[108:109], v[218:219], v[106:107], v[24:25] op_sel:[1,0,0] op_sel_hi:[1,1,1] neg_lo:[1,0,0] neg_hi:[1,0,0]
    v_pk_fma_f32 v[110:111], v[218:219], v[104:105], v[72:73] op_sel:[1,0,0] op_sel_hi:[1,1,1]
    v_pk_fma_f32 v[96:97], v[216:217], v[96:97], v[100:101] op_sel_hi:[0,1,1]
    v_pk_fma_f32 v[98:99], v[216:217], v[98:99], v[102:103] op_sel_hi:[0,1,1]
    v_pk_fma_f32 v[104:105], v[218:219], v[104:105], v[108:109] op_sel_hi:[0,1,1]
    v_pk_fma_f32 v[106:107], v[218:219], v[106:107], v[110:111] op_sel_hi:[0,1,1]
    v_pk_fma_f32 v[100:101], v[216:217], v[98:99], v[10:11] op_sel:[1,0,0] op_sel_hi:[1,1,1] neg_lo:[1,0,0] neg_hi:[1,0,0]
    v_pk_fma_f32 v[102:103], v[216:217], v[96:97], v[58:59] op_sel:[1,0,0] op_sel_hi:[1,1,1]
    v_pk_fma_f32 v[108:109], v[218:219], v[106:107], v[26:27] op_sel:[1,0,0] op_sel_hi:[1,1,1] neg_lo:[1,0,0] neg_hi:[1,0,0]
    v_pk_fma_f32 v[110:111], v[218:219], v[104:105], v[74:75] op_sel:[1,0,0] op_sel_hi:[1,1,1]
    v_pk_fma_f32 v[96:97], v[216:217], v[96:97], v[100:101] op_sel_hi:[0,1,1]
    v_pk_fma_f32 v[98:99], v[216:217], v[98:99], v[102:103] op_sel_hi:[0,1,1]
    v_pk_fma_f32 v[104:105], v[218:219], v[104:105], v[108:109] op_sel_hi:[0,1,1]
    v_pk_fma_f32 v[106:107], v[218:219], v[106:107], v[110:111] op_sel_hi:[0,1,1]
    v_pk_fma_f32 v[100:101], v[216:217], v[98:99], v[12:13] op_sel:[1,0,0] op_sel_hi:[1,1,1] neg_lo:[1,0,0] neg_hi:[1,0,0]
    v_pk_fma_f32 v[102:103], v[216:217], v[96:97], v[60:61] op_sel:[1,0,0] op_sel_hi:[1,1,1]
    v_pk_fma_f32 v[108:109], v[218:219], v[106:107], v[28:29] op_sel:[1,0,0] op_sel_hi:[1,1,1] neg_lo:[1,0,0] neg_hi:[1,0,0]
    v_pk_fma_f32 v[110:111], v[218:219], v[104:105], v[76:77] op_sel:[1,0,0] op_sel_hi:[1,1,1]
    v_pk_fma_f32 v[96:97], v[216:217], v[96:97], v[100:101] op_sel_hi:[0,1,1]
    v_pk_fma_f32 v[98:99], v[216:217], v[98:99], v[102:103] op_sel_hi:[0,1,1]
    v_pk_fma_f32 v[104:105], v[218:219], v[104:105], v[108:109] op_sel_hi:[0,1,1]
    v_pk_fma_f32 v[106:107], v[218:219], v[106:107], v[110:111] op_sel_hi:[0,1,1]
    v_pk_fma_f32 v[100:101], v[216:217], v[98:99], v[14:15] op_sel:[1,0,0] op_sel_hi:[1,1,1] neg_lo:[1,0,0] neg_hi:[1,0,0]
    v_pk_fma_f32 v[102:103], v[216:217], v[96:97], v[62:63] op_sel:[1,0,0] op_sel_hi:[1,1,1]
    v_pk_fma_f32 v[108:109], v[218:219], v[106:107], v[30:31] op_sel:[1,0,0] op_sel_hi:[1,1,1] neg_lo:[1,0,0] neg_hi:[1,0,0]
    v_pk_fma_f32 v[110:111], v[218:219], v[104:105], v[78:79] op_sel:[1,0,0] op_sel_hi:[1,1,1]
    v_pk_fma_f32 v[96:97], v[216:217], v[96:97], v[100:101] op_sel_hi:[0,1,1]
    v_pk_fma_f32 v[98:99], v[216:217], v[98:99], v[102:103] op_sel_hi:[0,1,1]
    v_pk_fma_f32 v[104:105], v[218:219], v[104:105], v[108:109] op_sel_hi:[0,1,1]
    v_pk_fma_f32 v[106:107], v[218:219], v[106:107], v[110:111] op_sel_hi:[0,1,1]
    v_fma_f32 v100, v222, v96, v97
    v_fma_f32 v101, v222, v98, v99
    v_fma_f32 v100, -v223, v98, v100
    v_fma_f32 v101, v223, v96, v101
    ds_write_b64 v176, v[100:101] offset:0
    v_fma_f32 v108, v224, v104, v105
    v_fma_f32 v109, v224, v106, v107
    v_fma_f32 v108, -v225, v106, v108
    v_fma_f32 v109, v225, v104, v109
    ds_write_b64 v176, v[108:109] offset:256
    s_waitcnt vmcnt(3)
    s_waitcnt lgkmcnt(0)
    s_barrier
    s_cmp_lt_u32 s3, 2
    s_cbranch_scc0 LS_nd_36
    ds_read_b64 v[120:121], v177 offset:0
    ds_read_b64 v[122:123], v177 offset:768
    ds_read_b64 v[124:125], v177 offset:1536
    ds_read_b64 v[126:127], v177 offset:2304
    ds_read_b64 v[128:129], v177 offset:3072
    ds_read_b64 v[130:131], v177 offset:3840
    ds_read_b64 v[132:133], v177 offset:4608
    ds_read_b64 v[134:135], v177 offset:5376
    v_mov_b32 v142, s88
    v_mov_b32 v143, s89
    s_mov_b32 s13, 155648
    v_mov_b32 v136, 0
    v_mov_b32 v137, 0
    s_waitcnt lgkmcnt(6)
    v_fma_f32 v122, v234, v120, v122
    v_fma_f32 v123, v234, v121, v123
    v_fma_f32 v122, -v235, v121, v122
    v_fma_f32 v123, v235, v120, v123
    s_waitcnt lgkmcnt(5)
    v_fma_f32 v124, v234, v122, v124
    v_fma_f32 v125, v234, v123, v125
    v_fma_f32 v124, -v235, v123, v124
    v_fma_f32 v125, v235, v122, v125
    s_waitcnt lgkmcnt(4)
    v_fma_f32 v126, v234, v124, v126
    v_fma_f32 v127, v234, v125, v127
    v_fma_f32 v126, -v235, v125, v126
    v_fma_f32 v127, v235, v124, v127
    s_waitcnt lgkmcnt(3)
    v_fma_f32 v128, v234, v126, v128
    v_fma_f32 v129, v234, v127, v129
    v_fma_f32 v128, -v235, v127, v128
    v_fma_f32 v129, v235, v126, v129
    s_waitcnt lgkmcnt(2)
    v_fma_f32 v130, v234, v128, v130
    v_fma_f32 v131, v234, v129, v131
    v_fma_f32 v130, -v235, v129, v130
    v_fma_f32 v131, v235, v128, v131
    s_waitcnt lgkmcnt(1)
    v_fma_f32 v132, v234, v130, v132
    v_fma_f32 v133, v234, v131, v133
    v_fma_f32 v132, -v235, v131, v132
    v_fma_f32 v133, v235, v130, v133
    s_waitcnt lgkmcnt(0)
    v_fma_f32 v140, v234, v132, v134
    v_fma_f32 v141, v234, v133, v135
    v_fma_f32 v140, -v235, v133, v140
    v_fma_f32 v141, v235, v132, v141
    s_mov_b32 exec_hi, 0
    buffer_store_dwordx4 v[140:143], v238, s[68:71], s13 offen sc1
    s_mov_b64 exec, -1
    ds_write_b64 v177, v[136:137] offset:0
    ds_write_b64 v177, v[120:121] offset:768
    ds_write_b64 v177, v[122:123] offset:1536
    ds_write_b64 v177, v[124:125] offset:2304
    ds_write_b64 v177, v[126:127] offset:3072
    ds_write_b64 v177, v[128:129] offset:3840
    ds_write_b64 v177, v[130:131] offset:4608
    ds_write_b64 v177, v[132:133] offset:5376
    s_waitcnt lgkmcnt(0)
LS_nd_36:
    s_cmp_eq_u32 s101, 1
    s_cbranch_scc0 LS_full
    s_getpc_b64 s[96:97]
L_pc_37:
    s_sub_u32 s96, s96, L_pc_37-parallel_sum__ssm_conv_s5__dense_activation_mish__prompt_kernel
    s_subb_u32 s97, s97, 0
    s_lshr_b32 s98, s2, 3
    s_lshl_b32 s98, s98, 2
    s_add_u32 s98, s98, s3
    s_mul_i32 s98, s98, 768
    v_min_u32 v252, 5, v144
    v_lshl_add_u32 v252, v252, 7, s98
    v_min_u32 v252, CODE_LAST, v252
    global_load_dword a255, v252, s[96:97]
    v_pk_mul_f32 v[244:245], v[228:229], v[48:49] op_sel:[1,0] op_sel_hi:[1,1]
    v_pk_mul_f32 v[48:49], v[228:229], v[48:49] op_sel_hi:[0,1]
    v_pk_fma_f32 v[48:49], v[228:229], v[0:1], v[48:49] op_sel:[1,0,0] op_sel_hi:[1,1,1]
    v_pk_fma_f32 v[0:1], v[228:229], v[0:1], v[244:245] op_sel_hi:[0,1,1] neg_lo:[0,0,1] neg_hi:[0,0,1]
    v_pk_mul_f32 v[248:249], v[228:229], v[50:51] op_sel:[1,0] op_sel_hi:[1,1]
    v_pk_mul_f32 v[50:51], v[228:229], v[50:51] op_sel_hi:[0,1]
    v_pk_fma_f32 v[50:51], v[228:229], v[2:3], v[50:51] op_sel:[1,0,0] op_sel_hi:[1,1,1]
    v_pk_fma_f32 v[2:3], v[228:229], v[2:3], v[248:249] op_sel_hi:[0,1,1] neg_lo:[0,0,1] neg_hi:[0,0,1]
    v_pk_mul_f32 v[244:245], v[228:229], v[52:53] op_sel:[1,0] op_sel_hi:[1,1]
    v_pk_mul_f32 v[52:53], v[228:229], v[52:53] op_sel_hi:[0,1]
    v_pk_fma_f32 v[52:53], v[228:229], v[4:5], v[52:53] op_sel:[1,0,0] op_sel_hi:[1,1,1]
    v_pk_fma_f32 v[4:5], v[228:229], v[4:5], v[244:245] op_sel_hi:[0,1,1] neg_lo:[0,0,1] neg_hi:[0,0,1]
    v_pk_mul_f32 v[248:249], v[228:229], v[54:55] op_sel:[1,0] op_sel_hi:[1,1]
    v_pk_mul_f32 v[54:55], v[228:229], v[54:55] op_sel_hi:[0,1]
    v_pk_fma_f32 v[54:55], v[228:229], v[6:7], v[54:55] op_sel:[1,0,0] op_sel_hi:[1,1,1]
    v_pk_fma_f32 v[6:7], v[228:229], v[6:7], v[248:249] op_sel_hi:[0,1,1] neg_lo:[0,0,1] neg_hi:[0,0,1]
    v_pk_mul_f32 v[244:245], v[228:229], v[56:57] op_sel:[1,0] op_sel_hi:[1,1]
    v_pk_mul_f32 v[56:57], v[228:229], v[56:57] op_sel_hi:[0,1]
    v_pk_fma_f32 v[56:57], v[228:229], v[8:9], v[56:57] op_sel:[1,0,0] op_sel_hi:[1,1,1]
    v_pk_fma_f32 v[8:9], v[228:229], v[8:9], v[244:245] op_sel_hi:[0,1,1] neg_lo:[0,0,1] neg_hi:[0,0,1]
    v_pk_mul_f32 v[248:249], v[228:229], v[58:59] op_sel:[1,0] op_sel_hi:[1,1]
    v_pk_mul_f32 v[58:59], v[228:229], v[58:59] op_sel_hi:[0,1]
    v_pk_fma_f32 v[58:59], v[228:229], v[10:11], v[58:59] op_sel:[1,0,0] op_sel_hi:[1,1,1]
    v_pk_fma_f32 v[10:11], v[228:229], v[10:11], v[248:249] op_sel_hi:[0,1,1] neg_lo:[0,0,1] neg_hi:[0,0,1]
    v_pk_mul_f32 v[244:245], v[228:229], v[60:61] op_sel:[1,0] op_sel_hi:[1,1]
    v_pk_mul_f32 v[60:61], v[228:229], v[60:61] op_sel_hi:[0,1]
    v_pk_fma_f32 v[60:61], v[228:229], v[12:13], v[60:61] op_sel:[1,0,0] op_sel_hi:[1,1,1]
    v_pk_fma_f32 v[12:13], v[228:229], v[12:13], v[244:245] op_sel_hi:[0,1,1] neg_lo:[0,0,1] neg_hi:[0,0,1]
    v_pk_mul_f32 v[248:249], v[228:229], v[62:63] op_sel:[1,0] op_sel_hi:[1,1]
    v_pk_mul_f32 v[62:63], v[228:229], v[62:63] op_sel_hi:[0,1]
    v_pk_fma_f32 v[62:63], v[228:229], v[14:15], v[62:63] op_sel:[1,0,0] op_sel_hi:[1,1,1]
    v_pk_fma_f32 v[14:15], v[228:229], v[14:15], v[248:249] op_sel_hi:[0,1,1] neg_lo:[0,0,1] neg_hi:[0,0,1]
    v_pk_mul_f32 v[244:245], v[230:231], v[64:65] op_sel:[1,0] op_sel_hi:[1,1]
    v_pk_mul_f32 v[64:65], v[230:231], v[64:65] op_sel_hi:[0,1]
    v_pk_fma_f32 v[64:65], v[230:231], v[16:17], v[64:65] op_sel:[1,0,0] op_sel_hi:[1,1,1]
    v_pk_fma_f32 v[16:17], v[230:231], v[16:17], v[244:245] op_sel_hi:[0,1,1] neg_lo:[0,0,1] neg_hi:[0,0,1]
    v_pk_mul_f32 v[248:249], v[230:231], v[66:67] op_sel:[1,0] op_sel_hi:[1,1]
    v_pk_mul_f32 v[66:67], v[230:231], v[66:67] op_sel_hi:[0,1]
    v_pk_fma_f32 v[66:67], v[230:231], v[18:19], v[66:67] op_sel:[1,0,0] op_sel_hi:[1,1,1]
    v_pk_fma_f32 v[18:19], v[230:231], v[18:19], v[248:249] op_sel_hi:[0,1,1] neg_lo:[0,0,1] neg_hi:[0,0,1]
    v_pk_mul_f32 v[244:245], v[230:231], v[68:69] op_sel:[1,0] op_sel_hi:[1,1]
    v_pk_mul_f32 v[68:69], v[230:231], v[68:69] op_sel_hi:[0,1]
    v_pk_fma_f32 v[68:69], v[230:231], v[20:21], v[68:69] op_sel:[1,0,0] op_sel_hi:[1,1,1]
    v_pk_fma_f32 v[20:21], v[230:231], v[20:21], v[244:245] op_sel_hi:[0,1,1] neg_lo:[0,0,1] neg_hi:[0,0,1]
    v_pk_mul_f32 v[248:249], v[230:231], v[70:71] op_sel:[1,0] op_sel_hi:[1,1]
    v_pk_mul_f32 v[70:71], v[230:231], v[70:71] op_sel_hi:[0,1]
    v_pk_fma_f32 v[70:71], v[230:231], v[22:23], v[70:71] op_sel:[1,0,0] op_sel_hi:[1,1,1]
    v_pk_fma_f32 v[22:23], v[230:231], v[22:23], v[248:249] op_sel_hi:[0,1,1] neg_lo:[0,0,1] neg_hi:[0,0,1]
    v_pk_mul_f32 v[244:245], v[230:231], v[72:73] op_sel:[1,0] op_sel_hi:[1,1]
    v_pk_mul_f32 v[72:73], v[230:231], v[72:73] op_sel_hi:[0,1]
    v_pk_fma_f32 v[72:73], v[230:231], v[24:25], v[72:73] op_sel:[1,0,0] op_sel_hi:[1,1,1]
    v_pk_fma_f32 v[24:25], v[230:231], v[24:25], v[244:245] op_sel_hi:[0,1,1] neg_lo:[0,0,1] neg_hi:[0,0,1]
    v_pk_mul_f32 v[248:249], v[230:231], v[74:75] op_sel:[1,0] op_sel_hi:[1,1]
    v_pk_mul_f32 v[74:75], v[230:231], v[74:75] op_sel_hi:[0,1]
    v_pk_fma_f32 v[74:75], v[230:231], v[26:27], v[74:75] op_sel:[1,0,0] op_sel_hi:[1,1,1]
    v_pk_fma_f32 v[26:27], v[230:231], v[26:27], v[248:249] op_sel_hi:[0,1,1] neg_lo:[0,0,1] neg_hi:[0,0,1]
    v_pk_mul_f32 v[244:245], v[230:231], v[76:77] op_sel:[1,0] op_sel_hi:[1,1]
    v_pk_mul_f32 v[76:77], v[230:231], v[76:77] op_sel_hi:[0,1]
    v_pk_fma_f32 v[76:77], v[230:231], v[28:29], v[76:77] op_sel:[1,0,0] op_sel_hi:[1,1,1]
    v_pk_fma_f32 v[28:29], v[230:231], v[28:29], v[244:245] op_sel_hi:[0,1,1] neg_lo:[0,0,1] neg_hi:[0,0,1]
    v_pk_mul_f32 v[248:249], v[230:231], v[78:79] op_sel:[1,0] op_sel_hi:[1,1]
    v_pk_mul_f32 v[78:79], v[230:231], v[78:79] op_sel_hi:[0,1]
    v_pk_fma_f32 v[78:79], v[230:231], v[30:31], v[78:79] op_sel:[1,0,0] op_sel_hi:[1,1,1]
    v_pk_fma_f32 v[30:31], v[230:231], v[30:31], v[248:249] op_sel_hi:[0,1,1] neg_lo:[0,0,1] neg_hi:[0,0,1]
    s_and_b32 s12, s4, 1
    s_xor_b32 s12, s12, 1
    s_lshl_b32 s12, s12, 1
    s_xor_b32 s12, s12, s3
    s_lshl_b32 s12, s12, 4
    v_lshrrev_b32 v244, 2, v144
    v_add_u32 v253, s12, v244
    v_mul_u32_u24 v253, 1280, v253
    v_lshrrev_b32 v244, 4, v144
    v_xor_b32 v244, v244, v144
    v_and_b32 v244, 3, v244
    v_lshl_add_u32 v253, v244, 4, v253
    v_bfe_u32 v244, v145, 2, 2
    v_xor_b32 v244, v244, v146
    v_lshlrev_b32 v244, 4, v244
    v_lshl_add_u32 v246, v145, 6, v244
    v_xor_b32 v247, 32, v246
    s_lshl_b32 s0, s9, 1
    s_mul_i32 s12, s6, 384
    s_add_u32 s1, s0, 192
    s_sub_u32 s1, s1, s12
    v_mul_f32 v140, v235, v235
    v_add_f32 v237, v235, v235
    v_mul_f32 v237, v237, v234
    v_fma_f32 v236, v234, v234, -v140
    v_mul_f32 v140, v237, v237
    v_add_f32 v237, v237, v237
    v_mul_f32 v237, v237, v236
    v_fma_f32 v236, v236, v236, -v140
    v_mul_f32 v140, v237, v237
    v_add_f32 v237, v237, v237
    v_mul_f32 v237, v237, v236
    v_fma_f32 v236, v236, v236, -v140
    v_mul_f32 v140, v237, v237
    v_add_f32 v175, v237, v237
    v_mul_f32 v175, v175, v236
    v_fma_f32 v174, v236, v236, -v140
    v_accvgpr_write_b32 a246, v174
    v_accvgpr_write_b32 a247, v175
    v_mul_f32 v140, v175, v175
    v_add_f32 v175, v175, v175
    v_mul_f32 v175, v175, v174
    v_fma_f32 v174, v174, v174, -v140
    v_accvgpr_write_b32 a248, v174
    v_accvgpr_write_b32 a249, v175
    v_mul_f32 v140, v175, v175
    v_add_f32 v175, v175, v175
    v_mul_f32 v175, v175, v174
    v_fma_f32 v174, v174, v174, -v140
    v_mul_f32 v140, v223, v223
    v_add_f32 v137, v223, v223
    v_mul_f32 v137, v137, v222
    v_fma_f32 v136, v222, v222, -v140
    v_cmp_eq_u32 vcc, 1, v146
    v_mov_b32 v141, 0
    v_mov_b32 v142, 1.0
    v_cndmask_b32 v138, v142, v136, vcc
    v_cndmask_b32 v139, v141, v137, vcc
    v_mul_f32 v140, v137, v137
    v_add_f32 v137, v137, v137
    v_mul_f32 v137, v137, v136
    v_fma_f32 v136, v136, v136, -v140
    v_fma_f32 v142, v136, v138, v141
    v_fma_f32 v143, v136, v139, v141
    v_fma_f32 v142, -v137, v139, v142
    v_fma_f32 v143, v137, v138, v143
    s_bitcmp1_b32 s3, 0
    s_cselect_b64 vcc, -1, 0
    v_cndmask_b32 v138, v138, v142, vcc
    v_cndmask_b32 v139, v139, v143, vcc
    v_mul_f32 v140, v137, v137
    v_add_f32 v137, v137, v137
    v_mul_f32 v137, v137, v136
    v_fma_f32 v136, v136, v136, -v140
    v_fma_f32 v142, v136, v138, v141
    v_fma_f32 v143, v136, v139, v141
    v_fma_f32 v142, -v137, v139, v142
    v_fma_f32 v143, v137, v138, v143
    s_bitcmp1_b32 s3, 1
    s_cselect_b64 vcc, -1, 0
    v_cndmask_b32 v138, v138, v142, vcc
    v_cndmask_b32 v139, v139, v143, vcc
    v_accvgpr_write_b32 a240, v138
    v_accvgpr_write_b32 a241, v139
    v_mul_f32 v140, v225, v225
    v_add_f32 v137, v225, v225
    v_mul_f32 v137, v137, v224
    v_fma_f32 v136, v224, v224, -v140
    v_cmp_eq_u32 vcc, 1, v146
    v_mov_b32 v141, 0
    v_mov_b32 v142, 1.0
    v_cndmask_b32 v138, v142, v136, vcc
    v_cndmask_b32 v139, v141, v137, vcc
    v_mul_f32 v140, v137, v137
    v_add_f32 v137, v137, v137
    v_mul_f32 v137, v137, v136
    v_fma_f32 v136, v136, v136, -v140
    v_fma_f32 v142, v136, v138, v141
    v_fma_f32 v143, v136, v139, v141
    v_fma_f32 v142, -v137, v139, v142
    v_fma_f32 v143, v137, v138, v143
    s_bitcmp1_b32 s3, 0
    s_cselect_b64 vcc, -1, 0
    v_cndmask_b32 v138, v138, v142, vcc
    v_cndmask_b32 v139, v139, v143, vcc
    v_mul_f32 v140, v137, v137
    v_add_f32 v137, v137, v137
    v_mul_f32 v137, v137, v136
    v_fma_f32 v136, v136, v136, -v140
    v_fma_f32 v142, v136, v138, v141
    v_fma_f32 v143, v136, v139, v141
    v_fma_f32 v142, -v137, v139, v142
    v_fma_f32 v143, v137, v138, v143
    s_bitcmp1_b32 s3, 1
    s_cselect_b64 vcc, -1, 0
    v_cndmask_b32 v138, v138, v142, vcc
    v_cndmask_b32 v139, v139, v143, vcc
    v_accvgpr_write_b32 a242, v138
    v_accvgpr_write_b32 a243, v139
    v_mul_f32 v140, v227, v227
    v_add_f32 v137, v227, v227
    v_mul_f32 v137, v137, v226
    v_fma_f32 v136, v226, v226, -v140
    v_cmp_eq_u32 vcc, 1, v146
    v_mov_b32 v141, 0
    v_mov_b32 v142, 1.0
    v_cndmask_b32 v138, v142, v136, vcc
    v_cndmask_b32 v139, v141, v137, vcc
    v_mul_f32 v140, v137, v137
    v_add_f32 v137, v137, v137
    v_mul_f32 v137, v137, v136
    v_fma_f32 v136, v136, v136, -v140
    v_fma_f32 v142, v136, v138, v141
    v_fma_f32 v143, v136, v139, v141
    v_fma_f32 v142, -v137, v139, v142
    v_fma_f32 v143, v137, v138, v143
    s_bitcmp1_b32 s3, 0
    s_cselect_b64 vcc, -1, 0
    v_cndmask_b32 v138, v138, v142, vcc
    v_cndmask_b32 v139, v139, v143, vcc
    v_mul_f32 v140, v137, v137
    v_add_f32 v137, v137, v137
    v_mul_f32 v137, v137, v136
    v_fma_f32 v136, v136, v136, -v140
    v_fma_f32 v142, v136, v138, v141
    v_fma_f32 v143, v136, v139, v141
    v_fma_f32 v142, -v137, v139, v142
    v_fma_f32 v143, v137, v138, v143
    s_bitcmp1_b32 s3, 1
    s_cselect_b64 vcc, -1, 0
    v_cndmask_b32 v138, v138, v142, vcc
    v_cndmask_b32 v139, v139, v143, vcc
    v_accvgpr_write_b32 a244, v138
    v_accvgpr_write_b32 a245, v139
    s_mov_b32 s15, s20
    s_mul_i32 s13, s6, 6144
    s_add_u32 s13, s13, s15
    s_add_u32 s40, s13, 24576
    s_add_u32 s14, s15, 36864
    s_cmp_eq_u32 s101, 1
    s_cselect_b32 s40, s14, s40
    s_add_u32 s41, s13, 26624
    s_add_u32 s14, s15, 38912
    s_cmp_eq_u32 s101, 1
    s_cselect_b32 s41, s14, s41
    s_add_u32 s42, s13, 28672
    s_mov_b32 s14, 2147418112
    s_cmp_eq_u32 s101, 1
    s_cselect_b32 s42, s14, s42
    s_add_u32 s43, s13, 36864
    s_add_u32 s14, s15, 40960
    s_cmp_eq_u32 s101, 1
    s_cselect_b32 s43, s14, s43
    s_add_u32 s46, s13, 38912
    s_add_u32 s14, s15, 43008
    s_cmp_eq_u32 s101, 1
    s_cselect_b32 s46, s14, s46
    s_add_u32 s47, s13, 40960
    s_mov_b32 s14, 2147418112
    s_cmp_eq_u32 s101, 1
    s_cselect_b32 s47, s14, s47
    s_mul_i32 s12, s3, 2048
    s_add_u32 s12, s12, 147456
    v_bfe_u32 v244, v145, 1, 3
    v_add_u32 v186, 0, v146
    v_xor_b32 v186, v186, v244
    v_lshlrev_b32 v186, 3, v186
    v_lshl_add_u32 v186, v145, 6, v186
    v_add_u32 v186, s12, v186
    v_add_u32 v187, 2, v146
    v_xor_b32 v187, v187, v244
    v_lshlrev_b32 v187, 3, v187
    v_lshl_add_u32 v187, v145, 6, v187
    v_add_u32 v187, s12, v187
    v_add_u32 v188, 4, v146
    v_xor_b32 v188, v188, v244
    v_lshlrev_b32 v188, 3, v188
    v_lshl_add_u32 v188, v145, 6, v188
    v_add_u32 v188, s12, v188
    v_add_u32 v189, 6, v146
    v_xor_b32 v189, v189, v244
    v_lshlrev_b32 v189, 3, v189
    v_lshl_add_u32 v189, v145, 6, v189
    v_add_u32 v189, s12, v189
    v_bfe_u32 v244, v144, 2, 2
    v_lshl_add_u32 v244, v146, 3, v244
    v_add_u32 v244, 0, v244
    v_bfe_u32 v245, v144, 4, 1
    v_lshlrev_b32 v245, 2, v245
    v_and_b32 v184, 3, v144
    v_or_b32 v245, v245, v184
    v_lshrrev_b32 v184, 1, v244
    v_xor_b32 v245, v245, v184
    v_lshlrev_b32 v245, 3, v245
    v_lshl_add_u32 v184, v244, 6, v245
    v_add_u32 v184, s12, v184
    v_bfe_u32 v244, v144, 2, 2
    v_lshl_add_u32 v244, v146, 3, v244
    v_add_u32 v244, 4, v244
    v_bfe_u32 v245, v144, 4, 1
    v_lshlrev_b32 v245, 2, v245
    v_and_b32 v185, 3, v144
    v_or_b32 v245, v245, v185
    v_lshrrev_b32 v185, 1, v244
    v_xor_b32 v245, v245, v185
    v_lshlrev_b32 v245, 3, v245
    v_lshl_add_u32 v185, v244, 6, v245
    v_add_u32 v185, s12, v185
    s_bfm_b32 s36, s5, 0
    v_mov_b32 v198, 0
    v_mov_b32 v199, 0
    v_mov_b32 v200, s88
    v_mov_b32 v201, s89
    v_mov_b32 v202, 0
    v_mov_b32 v203, 0
    v_mov_b32 v204, s88
    v_mov_b32 v205, s89
    v_mov_b32 v206, 0
    v_mov_b32 v207, 0
    v_mov_b32 v208, s88
    v_mov_b32 v209, s89
    v_mov_b32 v210, 0
    v_mov_b32 v211, 0
    v_mov_b32 v212, s88
    v_mov_b32 v213, s89
    v_mov_b32 v166, 0
    v_mov_b32 v167, 0
    v_mov_b32 v168, s88
    v_mov_b32 v169, s89
    v_mov_b32 v170, 0
    v_mov_b32 v171, 0
    v_mov_b32 v172, s88
    v_mov_b32 v173, s89
    v_mov_b32 v190, 0
    v_mov_b32 v191, 0
    v_mov_b32 v192, s88
    v_mov_b32 v193, s89
    v_mov_b32 v240, 0
    v_mov_b32 v241, 0
    v_mov_b32 v242, s88
    v_mov_b32 v243, s89
    s_cmp_lt_u32 s3, 2
    s_cbranch_scc0 LS_np_38
    s_mov_b32 s13, 144384
    s_bfe_i32 exec_lo, s36, 65536
    s_bfe_i32 exec_hi, s36, 65544
    buffer_load_dwordx4 v[198:201], v238, s[68:71], s13 offen sc1
    s_mov_b32 s13, 133120
    s_bfe_i32 exec_lo, s36, 65537
    s_bfe_i32 exec_hi, s36, 65545
    buffer_load_dwordx4 v[202:205], v238, s[68:71], s13 offen sc1
    s_mov_b32 s13, 121856
    s_bfe_i32 exec_lo, s36, 65538
    s_bfe_i32 exec_hi, s36, 65546
    buffer_load_dwordx4 v[206:209], v238, s[68:71], s13 offen sc1
    s_mov_b32 s13, 110592
    s_bfe_i32 exec_lo, s36, 65539
    s_bfe_i32 exec_hi, s36, 65547
    buffer_load_dwordx4 v[210:213], v238, s[68:71], s13 offen sc1
    s_mov_b32 s13, 99328
    s_bfe_i32 exec_lo, s36, 65540
    s_bfe_i32 exec_hi, s36, 65548
    buffer_load_dwordx4 v[166:169], v238, s[68:71], s13 offen sc1
    s_mov_b32 s13, 88064
    s_bfe_i32 exec_lo, s36, 65541
    s_bfe_i32 exec_hi, s36, 65549
    buffer_load_dwordx4 v[170:173], v238, s[68:71], s13 offen sc1
    s_mov_b32 s13, 76800
    s_bfe_i32 exec_lo, s36, 65542
    s_bfe_i32 exec_hi, s36, 65550
    buffer_load_dwordx4 v[190:193], v238, s[68:71], s13 offen sc1
    s_mov_b32 s13, 65536
    s_bfe_i32 exec_lo, s36, 65543
    s_bfe_i32 exec_hi, s36, 65551
    buffer_load_dwordx4 v[240:243], v238, s[68:71], s13 offen sc1
    s_mov_b64 exec, -1
LS_np_38:
    v_accvgpr_read_b32 v148, a240
    v_accvgpr_read_b32 v149, a241
    v_accvgpr_read_b32 v150, a242
    v_accvgpr_read_b32 v151, a243
    v_accvgpr_read_b32 v152, a244
    v_accvgpr_read_b32 v153, a245
    v_lshlrev_b32 v250, 3, v145
    v_add_u32 v250, 161792, v250
    s_cmp_lt_u32 s3, 2
    s_cbranch_scc0 LS_nc_39
    v_accvgpr_read_b32 v136, a246
    v_accvgpr_read_b32 v137, a247
    v_accvgpr_read_b32 v138, a248
    v_accvgpr_read_b32 v139, a249
    s_mov_b32 s87, 0
    s_waitcnt vmcnt(0)
    s_branch LS_ck_41
LS_rt_40:
    s_mov_b32 s13, 144384
    s_bfe_i32 exec_lo, s36, 65536
    s_bfe_i32 exec_hi, s36, 65544
    buffer_load_dwordx4 v[198:201], v238, s[68:71], s13 offen sc1
    s_mov_b32 s13, 133120
    s_bfe_i32 exec_lo, s36, 65537
    s_bfe_i32 exec_hi, s36, 65545
    buffer_load_dwordx4 v[202:205], v238, s[68:71], s13 offen sc1
    s_mov_b32 s13, 121856
    s_bfe_i32 exec_lo, s36, 65538
    s_bfe_i32 exec_hi, s36, 65546
    buffer_load_dwordx4 v[206:209], v238, s[68:71], s13 offen sc1
    s_mov_b32 s13, 110592
    s_bfe_i32 exec_lo, s36, 65539
    s_bfe_i32 exec_hi, s36, 65547
    buffer_load_dwordx4 v[210:213], v238, s[68:71], s13 offen sc1
    s_mov_b32 s13, 99328
    s_bfe_i32 exec_lo, s36, 65540
    s_bfe_i32 exec_hi, s36, 65548
    buffer_load_dwordx4 v[166:169], v238, s[68:71], s13 offen sc1
    s_mov_b32 s13, 88064
    s_bfe_i32 exec_lo, s36, 65541
    s_bfe_i32 exec_hi, s36, 65549
    buffer_load_dwordx4 v[170:173], v238, s[68:71], s13 offen sc1
    s_mov_b32 s13, 76800
    s_bfe_i32 exec_lo, s36, 65542
    s_bfe_i32 exec_hi, s36, 65550
    buffer_load_dwordx4 v[190:193], v238, s[68:71], s13 offen sc1
    s_mov_b32 s13, 65536
    s_bfe_i32 exec_lo, s36, 65543
    s_bfe_i32 exec_hi, s36, 65551
    buffer_load_dwordx4 v[240:243], v238, s[68:71], s13 offen sc1
    s_mov_b64 exec, -1
    s_waitcnt vmcnt(0)
LS_ck_41:
    v_cmp_eq_u64 vcc, s[88:89], v[200:201]
    v_cmp_eq_u64 s[98:99], s[88:89], v[204:205]
    s_nop 1
    s_and_b64 s[96:97], s[98:99], vcc
    v_cmp_eq_u64 vcc, s[88:89], v[208:209]
    v_cmp_eq_u64 s[98:99], s[88:89], v[212:213]
    s_nop 0
    s_and_b64 s[96:97], s[96:97], vcc
    s_and_b64 s[96:97], s[96:97], s[98:99]
    v_cmp_eq_u64 vcc, s[88:89], v[168:169]
    v_cmp_eq_u64 s[98:99], s[88:89], v[172:173]
    s_nop 0
    s_and_b64 s[96:97], s[96:97], vcc
    s_and_b64 s[96:97], s[96:97], s[98:99]
    v_cmp_eq_u64 vcc, s[88:89], v[192:193]
    v_cmp_eq_u64 s[98:99], s[88:89], v[242:243]
    s_nop 0
    s_and_b64 s[96:97], s[96:97], vcc
    s_and_b64 s[96:97], s[96:97], s[98:99]
    s_cmp_eq_u64 s[96:97], -1
    s_cbranch_scc1 LS_ok_42
    s_add_u32 s87, s87, 1
    s_cmp_lt_u32 s87, 40000
    s_cbranch_scc1 LS_rt_40
LS_ok_42:
    v_fma_f32 v198, v236, v202, v198
    v_fma_f32 v199, v236, v203, v199
    v_fma_f32 v206, v236, v210, v206
    v_fma_f32 v207, v236, v211, v207
    v_fma_f32 v166, v236, v170, v166
    v_fma_f32 v167, v236, v171, v167
    v_fma_f32 v190, v236, v240, v190
    v_fma_f32 v191, v236, v241, v191
    v_fma_f32 v198, -v237, v203, v198
    v_fma_f32 v199, v237, v202, v199
    v_fma_f32 v206, -v237, v211, v206
    v_fma_f32 v207, v237, v210, v207
    v_fma_f32 v166, -v237, v171, v166
    v_fma_f32 v167, v237, v170, v167
    v_fma_f32 v190, -v237, v241, v190
    v_fma_f32 v191, v237, v240, v191
    v_fma_f32 v198, v136, v206, v198
    v_fma_f32 v199, v136, v207, v199
    v_fma_f32 v166, v136, v190, v166
    v_fma_f32 v167, v136, v191, v167
    v_fma_f32 v198, -v137, v207, v198
    v_fma_f32 v199, v137, v206, v199
    v_fma_f32 v166, -v137, v191, v166
    v_fma_f32 v167, v137, v190, v167
    v_fma_f32 v198, v138, v166, v198
    v_fma_f32 v199, v138, v167, v199
    v_fma_f32 v198, -v139, v167, v198
    v_fma_f32 v199, v139, v166, v199
    v_mov_b32 v142, v198
    v_mov_b32 v143, v199
    s_nop 0
    v_permlane32_swap_b32 v198, v142
    v_permlane32_swap_b32 v199, v143
    v_fma_f32 v198, v174, v142, v198
    v_fma_f32 v199, v174, v143, v199
    v_fma_f32 v198, -v175, v143, v198
    v_fma_f32 v199, v175, v142, v199
    ds_write_b64 v177, v[198:199] offset:6144
LS_nc_39:
    s_waitcnt lgkmcnt(0)
    s_barrier
    ds_read_b64 v[100:101], v176 offset:0
    ds_read_b64 v[102:103], v250 offset:0
    ds_read_b64 v[108:109], v176 offset:256
    ds_read_b64 v[110:111], v250 offset:256
    s_waitcnt lgkmcnt(0)
    v_fma_f32 v100, v148, v102, v100
    v_fma_f32 v101, v148, v103, v101
    v_fma_f32 v108, v150, v110, v108
    v_fma_f32 v109, v150, v111, v109
    v_fma_f32 v100, -v149, v103, v100
    v_fma_f32 v101, v149, v102, v101
    v_fma_f32 v108, -v151, v111, v108
    v_fma_f32 v109, v151, v110, v109
    v_fma_f32 v97, v222, v100, v96
    v_fma_f32 v99, v222, v101, v98
    v_fma_f32 v97, -v223, v101, v97
    v_fma_f32 v99, v223, v100, v99
    v_fma_f32 v105, v224, v108, v104
    v_fma_f32 v107, v224, v109, v106
    v_fma_f32 v105, -v225, v109, v105
    v_fma_f32 v107, v225, v108, v107
    v_mov_b32 v96, v100
    v_mov_b32 v98, v101
    v_mov_b32 v104, v108
    v_mov_b32 v106, v109
    v_pk_mul_f32 v[120:121], v[228:229], v[96:97] op_sel_hi:[0,1]
    v_pk_mul_f32 v[122:123], v[228:229], v[98:99] op_sel_hi:[0,1]
    v_pk_mul_f32 v[124:125], v[230:231], v[104:105] op_sel_hi:[0,1]
    v_pk_mul_f32 v[126:127], v[230:231], v[106:107] op_sel_hi:[0,1]
    v_pk_fma_f32 v[120:121], v[228:229], v[98:99], v[120:121] op_sel:[1,0,0] op_sel_hi:[1,1,1] neg_lo:[1,0,0] neg_hi:[1,0,0]
    v_pk_fma_f32 v[122:123], v[228:229], v[96:97], v[122:123] op_sel:[1,0,0] op_sel_hi:[1,1,1]
    v_pk_fma_f32 v[124:125], v[230:231], v[106:107], v[124:125] op_sel:[1,0,0] op_sel_hi:[1,1,1] neg_lo:[1,0,0] neg_hi:[1,0,0]
    v_pk_fma_f32 v[126:127], v[230:231], v[104:105], v[126:127] op_sel:[1,0,0] op_sel_hi:[1,1,1]
    v_pk_fma_f32 v[0:1], v[216:217], v[122:123], v[0:1] op_sel:[1,0,0] op_sel_hi:[1,1,1] neg_lo:[1,0,0] neg_hi:[1,0,0]
    v_pk_fma_f32 v[48:49], v[216:217], v[120:121], v[48:49] op_sel:[1,0,0] op_sel_hi:[1,1,1]
    v_pk_fma_f32 v[16:17], v[218:219], v[126:127], v[16:17] op_sel:[1,0,0] op_sel_hi:[1,1,1] neg_lo:[1,0,0] neg_hi:[1,0,0]
    v_pk_fma_f32 v[64:65], v[218:219], v[124:125], v[64:65] op_sel:[1,0,0] op_sel_hi:[1,1,1]
    v_pk_fma_f32 v[0:1], v[216:217], v[120:121], v[0:1] op_sel_hi:[0,1,1]
    v_pk_fma_f32 v[48:49], v[216:217], v[122:123], v[48:49] op_sel_hi:[0,1,1]
    v_pk_fma_f32 v[16:17], v[218:219], v[124:125], v[16:17] op_sel_hi:[0,1,1]
    v_pk_fma_f32 v[64:65], v[218:219], v[126:127], v[64:65] op_sel_hi:[0,1,1]
    v_pk_fma_f32 v[2:3], v[216:217], v[48:49], v[2:3] op_sel:[1,0,0] op_sel_hi:[1,1,1] neg_lo:[1,0,0] neg_hi:[1,0,0]
    v_pk_fma_f32 v[50:51], v[216:217], v[0:1], v[50:51] op_sel:[1,0,0] op_sel_hi:[1,1,1]
    v_pk_fma_f32 v[18:19], v[218:219], v[64:65], v[18:19] op_sel:[1,0,0] op_sel_hi:[1,1,1] neg_lo:[1,0,0] neg_hi:[1,0,0]
    v_pk_fma_f32 v[66:67], v[218:219], v[16:17], v[66:67] op_sel:[1,0,0] op_sel_hi:[1,1,1]
    v_pk_fma_f32 v[2:3], v[216:217], v[0:1], v[2:3] op_sel_hi:[0,1,1]
    v_pk_fma_f32 v[50:51], v[216:217], v[48:49], v[50:51] op_sel_hi:[0,1,1]
    v_pk_fma_f32 v[18:19], v[218:219], v[16:17], v[18:19] op_sel_hi:[0,1,1]
    v_pk_fma_f32 v[66:67], v[218:219], v[64:65], v[66:67] op_sel_hi:[0,1,1]
    v_pk_fma_f32 v[4:5], v[216:217], v[50:51], v[4:5] op_sel:[1,0,0] op_sel_hi:[1,1,1] neg_lo:[1,0,0] neg_hi:[1,0,0]
    v_pk_fma_f32 v[52:53], v[216:217], v[2:3], v[52:53] op_sel:[1,0,0] op_sel_hi:[1,1,1]
    v_pk_fma_f32 v[20:21], v[218:219], v[66:67], v[20:21] op_sel:[1,0,0] op_sel_hi:[1,1,1] neg_lo:[1,0,0] neg_hi:[1,0,0]
    v_pk_fma_f32 v[68:69], v[218:219], v[18:19], v[68:69] op_sel:[1,0,0] op_sel_hi:[1,1,1]
    v_pk_fma_f32 v[4:5], v[216:217], v[2:3], v[4:5] op_sel_hi:[0,1,1]
    v_pk_fma_f32 v[52:53], v[216:217], v[50:51], v[52:53] op_sel_hi:[0,1,1]
    v_pk_fma_f32 v[20:21], v[218:219], v[18:19], v[20:21] op_sel_hi:[0,1,1]
    v_pk_fma_f32 v[68:69], v[218:219], v[66:67], v[68:69] op_sel_hi:[0,1,1]
    v_pk_fma_f32 v[6:7], v[216:217], v[52:53], v[6:7] op_sel:[1,0,0] op_sel_hi:[1,1,1] neg_lo:[1,0,0] neg_hi:[1,0,0]
    v_pk_fma_f32 v[54:55], v[216:217], v[4:5], v[54:55] op_sel:[1,0,0] op_sel_hi:[1,1,1]
    v_pk_fma_f32 v[22:23], v[218:219], v[68:69], v[22:23] op_sel:[1,0,0] op_sel_hi:[1,1,1] neg_lo:[1,0,0] neg_hi:[1,0,0]
    v_pk_fma_f32 v[70:71], v[218:219], v[20:21], v[70:71] op_sel:[1,0,0] op_sel_hi:[1,1,1]
    v_pk_fma_f32 v[6:7], v[216:217], v[4:5], v[6:7] op_sel_hi:[0,1,1]
    v_pk_fma_f32 v[54:55], v[216:217], v[52:53], v[54:55] op_sel_hi:[0,1,1]
    v_pk_fma_f32 v[22:23], v[218:219], v[20:21], v[22:23] op_sel_hi:[0,1,1]
    v_pk_fma_f32 v[70:71], v[218:219], v[68:69], v[70:71] op_sel_hi:[0,1,1]
    v_pk_fma_f32 v[8:9], v[216:217], v[54:55], v[8:9] op_sel:[1,0,0] op_sel_hi:[1,1,1] neg_lo:[1,0,0] neg_hi:[1,0,0]
    v_pk_fma_f32 v[56:57], v[216:217], v[6:7], v[56:57] op_sel:[1,0,0] op_sel_hi:[1,1,1]
    v_pk_fma_f32 v[24:25], v[218:219], v[70:71], v[24:25] op_sel:[1,0,0] op_sel_hi:[1,1,1] neg_lo:[1,0,0] neg_hi:[1,0,0]
    v_pk_fma_f32 v[72:73], v[218:219], v[22:23], v[72:73] op_sel:[1,0,0] op_sel_hi:[1,1,1]
    v_pk_fma_f32 v[8:9], v[216:217], v[6:7], v[8:9] op_sel_hi:[0,1,1]
    v_pk_fma_f32 v[56:57], v[216:217], v[54:55], v[56:57] op_sel_hi:[0,1,1]
    v_pk_fma_f32 v[24:25], v[218:219], v[22:23], v[24:25] op_sel_hi:[0,1,1]
    v_pk_fma_f32 v[72:73], v[218:219], v[70:71], v[72:73] op_sel_hi:[0,1,1]
    v_pk_fma_f32 v[10:11], v[216:217], v[56:57], v[10:11] op_sel:[1,0,0] op_sel_hi:[1,1,1] neg_lo:[1,0,0] neg_hi:[1,0,0]
    v_pk_fma_f32 v[58:59], v[216:217], v[8:9], v[58:59] op_sel:[1,0,0] op_sel_hi:[1,1,1]
    v_pk_fma_f32 v[26:27], v[218:219], v[72:73], v[26:27] op_sel:[1,0,0] op_sel_hi:[1,1,1] neg_lo:[1,0,0] neg_hi:[1,0,0]
    v_pk_fma_f32 v[74:75], v[218:219], v[24:25], v[74:75] op_sel:[1,0,0] op_sel_hi:[1,1,1]
    v_pk_fma_f32 v[10:11], v[216:217], v[8:9], v[10:11] op_sel_hi:[0,1,1]
    v_pk_fma_f32 v[58:59], v[216:217], v[56:57], v[58:59] op_sel_hi:[0,1,1]
    v_pk_fma_f32 v[26:27], v[218:219], v[24:25], v[26:27] op_sel_hi:[0,1,1]
    v_pk_fma_f32 v[74:75], v[218:219], v[72:73], v[74:75] op_sel_hi:[0,1,1]
    v_pk_fma_f32 v[12:13], v[216:217], v[58:59], v[12:13] op_sel:[1,0,0] op_sel_hi:[1,1,1] neg_lo:[1,0,0] neg_hi:[1,0,0]
    v_pk_fma_f32 v[60:61], v[216:217], v[10:11], v[60:61] op_sel:[1,0,0] op_sel_hi:[1,1,1]
    v_pk_fma_f32 v[28:29], v[218:219], v[74:75], v[28:29] op_sel:[1,0,0] op_sel_hi:[1,1,1] neg_lo:[1,0,0] neg_hi:[1,0,0]
    v_pk_fma_f32 v[76:77], v[218:219], v[26:27], v[76:77] op_sel:[1,0,0] op_sel_hi:[1,1,1]
    v_pk_fma_f32 v[12:13], v[216:217], v[10:11], v[12:13] op_sel_hi:[0,1,1]
    v_pk_fma_f32 v[60:61], v[216:217], v[58:59], v[60:61] op_sel_hi:[0,1,1]
    v_pk_fma_f32 v[28:29], v[218:219], v[26:27], v[28:29] op_sel_hi:[0,1,1]
    v_pk_fma_f32 v[76:77], v[218:219], v[74:75], v[76:77] op_sel_hi:[0,1,1]
    v_pk_fma_f32 v[14:15], v[216:217], v[60:61], v[14:15] op_sel:[1,0,0] op_sel_hi:[1,1,1] neg_lo:[1,0,0] neg_hi:[1,0,0]
    v_pk_fma_f32 v[62:63], v[216:217], v[12:13], v[62:63] op_sel:[1,0,0] op_sel_hi:[1,1,1]
    v_pk_fma_f32 v[30:31], v[218:219], v[76:77], v[30:31] op_sel:[1,0,0] op_sel_hi:[1,1,1] neg_lo:[1,0,0] neg_hi:[1,0,0]
    v_pk_fma_f32 v[78:79], v[218:219], v[28:29], v[78:79] op_sel:[1,0,0] op_sel_hi:[1,1,1]
    v_pk_fma_f32 v[14:15], v[216:217], v[12:13], v[14:15] op_sel_hi:[0,1,1]
    v_pk_fma_f32 v[62:63], v[216:217], v[60:61], v[62:63] op_sel_hi:[0,1,1]
    v_pk_fma_f32 v[30:31], v[218:219], v[28:29], v[30:31] op_sel_hi:[0,1,1]
    v_pk_fma_f32 v[78:79], v[218:219], v[76:77], v[78:79] op_sel_hi:[0,1,1]
    v_cvt_pk_bf16_f32 v0, v0, v1
    v_cvt_pk_bf16_f32 v1, v2, v3
    ds_write_b64 v186, v[0:1]
    v_cvt_pk_bf16_f32 v4, v4, v5
    v_cvt_pk_bf16_f32 v5, v6, v7
    ds_write_b64 v187, v[4:5]
    v_cvt_pk_bf16_f32 v8, v8, v9
    v_cvt_pk_bf16_f32 v9, v10, v11
    ds_write_b64 v188, v[8:9]
    v_cvt_pk_bf16_f32 v12, v12, v13
    v_cvt_pk_bf16_f32 v13, v14, v15
    ds_write_b64 v189, v[12:13]
    ds_read_b64_tr_b16 v[96:97], v184 offset:0
    ds_read_b64_tr_b16 v[98:99], v185 offset:0
    ds_read_b64_tr_b16 v[100:101], v184 offset:1024
    ds_read_b64_tr_b16 v[102:103], v185 offset:1024
    v_cvt_pk_bf16_f32 v16, v16, v17
    v_cvt_pk_bf16_f32 v17, v18, v19
    ds_write_b64 v186, v[16:17]
    v_cvt_pk_bf16_f32 v20, v20, v21
    v_cvt_pk_bf16_f32 v21, v22, v23
    ds_write_b64 v187, v[20:21]
    v_cvt_pk_bf16_f32 v24, v24, v25
    v_cvt_pk_bf16_f32 v25, v26, v27
    ds_write_b64 v188, v[24:25]
    v_cvt_pk_bf16_f32 v28, v28, v29
    v_cvt_pk_bf16_f32 v29, v30, v31
    ds_write_b64 v189, v[28:29]
    ds_read_b64_tr_b16 v[104:105], v184 offset:0
    ds_read_b64_tr_b16 v[106:107], v185 offset:0
    ds_read_b64_tr_b16 v[108:109], v184 offset:1024
    ds_read_b64_tr_b16 v[110:111], v185 offset:1024
    s_waitcnt lgkmcnt(8)
    buffer_store_dwordx4 v[96:99], v147, s[68:71], s40 offen offset:0 sc1
    buffer_store_dwordx4 v[100:103], v147, s[68:71], s40 offen offset:1024 sc1
    v_cvt_pk_bf16_f32 v48, -v48, -v49
    v_cvt_pk_bf16_f32 v49, -v50, -v51
    ds_write_b64 v186, v[48:49]
    v_cvt_pk_bf16_f32 v52, -v52, -v53
    v_cvt_pk_bf16_f32 v53, -v54, -v55
    ds_write_b64 v187, v[52:53]
    v_cvt_pk_bf16_f32 v56, -v56, -v57
    v_cvt_pk_bf16_f32 v57, -v58, -v59
    ds_write_b64 v188, v[56:57]
    v_cvt_pk_bf16_f32 v60, -v60, -v61
    v_cvt_pk_bf16_f32 v61, -v62, -v63
    ds_write_b64 v189, v[60:61]
    ds_read_b64_tr_b16 v[120:121], v184 offset:0
    ds_read_b64_tr_b16 v[122:123], v185 offset:0
    ds_read_b64_tr_b16 v[124:125], v184 offset:1024
    ds_read_b64_tr_b16 v[126:127], v185 offset:1024
    s_waitcnt lgkmcnt(8)
    buffer_store_dwordx4 v[104:107], v147, s[68:71], s41 offen offset:0 sc1
    buffer_store_dwordx4 v[108:111], v147, s[68:71], s41 offen offset:1024 sc1
    v_cvt_pk_bf16_f32 v64, -v64, -v65
    v_cvt_pk_bf16_f32 v65, -v66, -v67
    ds_write_b64 v186, v[64:65]
    v_cvt_pk_bf16_f32 v68, -v68, -v69
    v_cvt_pk_bf16_f32 v69, -v70, -v71
    ds_write_b64 v187, v[68:69]
    v_cvt_pk_bf16_f32 v72, -v72, -v73
    v_cvt_pk_bf16_f32 v73, -v74, -v75
    ds_write_b64 v188, v[72:73]
    v_cvt_pk_bf16_f32 v76, -v76, -v77
    v_cvt_pk_bf16_f32 v77, -v78, -v79
    ds_write_b64 v189, v[76:77]
    ds_read_b64_tr_b16 v[128:129], v184 offset:0
    ds_read_b64_tr_b16 v[130:131], v185 offset:0
    ds_read_b64_tr_b16 v[132:133], v184 offset:1024
    ds_read_b64_tr_b16 v[134:135], v185 offset:1024
    s_waitcnt lgkmcnt(8)
    buffer_store_dwordx4 v[120:123], v147, s[68:71], s43 offen offset:0 sc1
    buffer_store_dwordx4 v[124:127], v147, s[68:71], s43 offen offset:1024 sc1
    s_waitcnt lgkmcnt(0)
    buffer_store_dwordx4 v[128:131], v147, s[68:71], s46 offen offset:0 sc1
    buffer_store_dwordx4 v[132:135], v147, s[68:71], s46 offen offset:1024 sc1
    v_mov_b32 v198, s88
    v_mov_b32 v199, s89
    v_mov_b32 v200, s88
    v_mov_b32 v201, s89
    s_add_u32 m0, s94, 0
    s_nop 0
    buffer_load_dwordx4 v158, s[56:59], s76 offen lds
    s_add_u32 m0, s94, 4096
    s_nop 0
    buffer_load_dwordx4 v159, s[56:59], s76 offen lds
    s_add_u32 m0, s94, 8192
    s_nop 0
    buffer_load_dwordx4 v160, s[56:59], s76 offen lds
    s_add_u32 m0, s94, 12288
    s_nop 0
    buffer_load_dwordx4 v161, s[56:59], s76 offen lds
    s_add_u32 m0, s94, 16384
    s_nop 0
    buffer_load_dwordx4 v162, s[56:59], s76 offen lds
    s_add_u32 m0, s94, 20480
    s_nop 0
    buffer_load_dwordx4 v163, s[56:59], s76 offen lds
    s_add_u32 m0, s94, 24576
    s_nop 0
    buffer_load_dwordx4 v158, s[56:59], s77 offen lds
    s_add_u32 m0, s94, 28672
    s_nop 0
    buffer_load_dwordx4 v159, s[56:59], s77 offen lds
    s_add_u32 m0, s94, 32768
    s_nop 0
    buffer_load_dwordx4 v160, s[56:59], s77 offen lds
    s_add_u32 m0, s94, 36864
    s_nop 0
    buffer_load_dwordx4 v161, s[56:59], s77 offen lds
    s_waitcnt vmcnt(10)
    s_lshl_b32 s12, s6, 6
    s_add_u32 s12, s12, s24
    s_mov_b64 exec, 1
    s_add_u32 s96, s12, 589824
    buffer_store_dwordx4 v[198:201], v155, s[68:71], s96 offen
    buffer_store_dwordx4 v[198:201], v155, s[68:71], s12 offen sc1
    s_mov_b64 exec, -1
    buffer_load_dwordx4 v[190:193], v239, s[68:71], s31 offen sc1
    v_mov_b32 v198, s88
    v_mov_b32 v199, s89
    v_mov_b32 v200, s88
    v_mov_b32 v201, s89
    s_or_b32 s13, s16, s17
    s_add_u32 m0, s94, 40960
    s_nop 0
    buffer_load_dwordx4 v162, s[56:59], s77 offen lds
    s_add_u32 m0, s94, 45056
    s_nop 0
    buffer_load_dwordx4 v163, s[56:59], s77 offen lds
    s_add_u32 m0, s94, 49152
    s_nop 0
    buffer_load_dwordx4 v158, s[56:59], s78 offen lds
    s_add_u32 m0, s94, 53248
    s_nop 0
    buffer_load_dwordx4 v159, s[56:59], s78 offen lds
    s_add_u32 m0, s94, 57344
    s_nop 0
    buffer_load_dwordx4 v160, s[56:59], s78 offen lds
    s_add_u32 m0, s94, 61440
    s_nop 0
    buffer_load_dwordx4 v161, s[56:59], s78 offen lds
    s_add_u32 m0, s94, 65536
    s_nop 0
    buffer_load_dwordx4 v162, s[56:59], s78 offen lds
    s_add_u32 m0, s94, 69632
    s_nop 0
    buffer_load_dwordx4 v163, s[56:59], s78 offen lds
    s_add_u32 m0, s94, 73728
    s_nop 0
    buffer_load_dwordx4 v158, s[56:59], s79 offen lds
    s_add_u32 m0, s94, 77824
    s_nop 0
    buffer_load_dwordx4 v159, s[56:59], s79 offen lds
    s_add_u32 m0, s94, 81920
    s_nop 0
    buffer_load_dwordx4 v160, s[56:59], s79 offen lds
    s_add_u32 m0, s94, 86016
    s_nop 0
    buffer_load_dwordx4 v161, s[56:59], s79 offen lds
    s_add_u32 m0, s94, 90112
    s_nop 0
    buffer_load_dwordx4 v162, s[56:59], s79 offen lds
    s_add_u32 m0, s94, 94208
    s_nop 0
    buffer_load_dwordx4 v163, s[56:59], s79 offen lds
    s_add_u32 s35, s82, s84
    s_add_u32 m0, s94, 98304
    s_nop 0
    buffer_load_dwordx4 v158, s[56:59], s35 offen lds
    s_add_u32 m0, s94, 102400
    s_nop 0
    buffer_load_dwordx4 v159, s[56:59], s35 offen lds
    s_add_u32 m0, s94, 106496
    s_nop 0
    buffer_load_dwordx4 v160, s[56:59], s35 offen lds
    s_add_u32 m0, s94, 110592
    s_nop 0
    buffer_load_dwordx4 v161, s[56:59], s35 offen lds
    s_add_u32 m0, s94, 114688
    s_nop 0
    buffer_load_dwordx4 v162, s[56:59], s35 offen lds
    s_add_u32 m0, s94, 118784
    s_nop 0
    buffer_load_dwordx4 v163, s[56:59], s35 offen lds
    s_add_u32 s35, s83, s90
    s_add_u32 m0, s94, 122880
    s_nop 0
    buffer_load_dwordx4 v164, s[60:63], s35 offen lds
    s_add_u32 m0, s94, 126976
    s_nop 0
    buffer_load_dwordx4 v165, s[60:63], s35 offen lds
    s_add_u32 m0, s94, 131072
    s_nop 0
    buffer_load_dwordx4 v164, s[64:67], s35 offen lds
    s_add_u32 m0, s94, 135168
    s_nop 0
    buffer_load_dwordx4 v165, s[64:67], s35 offen lds
    s_waitcnt vmcnt(24)
    v_cmp_eq_u64 vcc, s[88:89], v[190:191]
    s_nop 1
    s_and_b32 s12, vcc_lo, s13
    s_cmp_eq_u32 s12, s13
    s_cbranch_scc0 L_rt_44
L_ok_43:
    s_add_u32 s15, s20, 0
    buffer_load_dwordx4 a[72:75], v147, s[68:71], s15 offen offset:0 sc1
    buffer_load_dwordx4 a[76:79], v147, s[68:71], s15 offen offset:1024 sc1
    buffer_load_dwordx4 a[80:83], v147, s[68:71], s15 offen offset:2048 sc1
    buffer_load_dwordx4 a[84:87], v147, s[68:71], s15 offen offset:3072 sc1
    s_add_u32 s15, s20, 4096
    buffer_load_dwordx4 a[88:91], v147, s[68:71], s15 offen offset:0 sc1
    buffer_load_dwordx4 a[92:95], v147, s[68:71], s15 offen offset:1024 sc1
    buffer_load_dwordx4 a[96:99], v147, s[68:71], s15 offen offset:2048 sc1
    buffer_load_dwordx4 a[100:103], v147, s[68:71], s15 offen offset:3072 sc1
    s_waitcnt vmcnt(8)
    s_barrier
    s_branch LN_entry
LS_full:
    v_add_u32 v170, 114688, v170
    ds_read_b128 a[160:163], v170 offset:0
    ds_read_b128 a[164:167], v170 offset:4096
    v_add_u32 v171, 114688, v171
    ds_read_b128 a[168:171], v171 offset:0
    ds_read_b128 a[172:175], v171 offset:4096
    v_add_u32 v172, 114688, v172
    ds_read_b128 a[176:179], v172 offset:0
    ds_read_b128 a[180:183], v172 offset:4096
    v_add_u32 v173, 114688, v173
    ds_read_b128 a[184:187], v173 offset:0
    ds_read_b128 a[188:191], v173 offset:4096
    v_pk_mul_f32 v[244:245], v[228:229], v[48:49] op_sel:[1,0] op_sel_hi:[1,1]
    v_pk_mul_f32 v[48:49], v[228:229], v[48:49] op_sel_hi:[0,1]
    v_pk_fma_f32 v[48:49], v[228:229], v[0:1], v[48:49] op_sel:[1,0,0] op_sel_hi:[1,1,1]
    v_pk_fma_f32 v[0:1], v[228:229], v[0:1], v[244:245] op_sel_hi:[0,1,1] neg_lo:[0,0,1] neg_hi:[0,0,1]
    v_pk_mul_f32 v[248:249], v[228:229], v[50:51] op_sel:[1,0] op_sel_hi:[1,1]
    v_pk_mul_f32 v[50:51], v[228:229], v[50:51] op_sel_hi:[0,1]
    v_pk_fma_f32 v[50:51], v[228:229], v[2:3], v[50:51] op_sel:[1,0,0] op_sel_hi:[1,1,1]
    v_pk_fma_f32 v[2:3], v[228:229], v[2:3], v[248:249] op_sel_hi:[0,1,1] neg_lo:[0,0,1] neg_hi:[0,0,1]
    v_pk_mul_f32 v[244:245], v[228:229], v[52:53] op_sel:[1,0] op_sel_hi:[1,1]
    v_pk_mul_f32 v[52:53], v[228:229], v[52:53] op_sel_hi:[0,1]
    v_pk_fma_f32 v[52:53], v[228:229], v[4:5], v[52:53] op_sel:[1,0,0] op_sel_hi:[1,1,1]
    v_pk_fma_f32 v[4:5], v[228:229], v[4:5], v[244:245] op_sel_hi:[0,1,1] neg_lo:[0,0,1] neg_hi:[0,0,1]
    v_pk_mul_f32 v[248:249], v[228:229], v[54:55] op_sel:[1,0] op_sel_hi:[1,1]
    v_pk_mul_f32 v[54:55], v[228:229], v[54:55] op_sel_hi:[0,1]
    v_pk_fma_f32 v[54:55], v[228:229], v[6:7], v[54:55] op_sel:[1,0,0] op_sel_hi:[1,1,1]
    v_pk_fma_f32 v[6:7], v[228:229], v[6:7], v[248:249] op_sel_hi:[0,1,1] neg_lo:[0,0,1] neg_hi:[0,0,1]
    v_pk_mul_f32 v[244:245], v[228:229], v[56:57] op_sel:[1,0] op_sel_hi:[1,1]
    v_pk_mul_f32 v[56:57], v[228:229], v[56:57] op_sel_hi:[0,1]
    v_pk_fma_f32 v[56:57], v[228:229], v[8:9], v[56:57] op_sel:[1,0,0] op_sel_hi:[1,1,1]
    v_pk_fma_f32 v[8:9], v[228:229], v[8:9], v[244:245] op_sel_hi:[0,1,1] neg_lo:[0,0,1] neg_hi:[0,0,1]
    v_pk_mul_f32 v[248:249], v[228:229], v[58:59] op_sel:[1,0] op_sel_hi:[1,1]
    v_pk_mul_f32 v[58:59], v[228:229], v[58:59] op_sel_hi:[0,1]
    v_pk_fma_f32 v[58:59], v[228:229], v[10:11], v[58:59] op_sel:[1,0,0] op_sel_hi:[1,1,1]
    v_pk_fma_f32 v[10:11], v[228:229], v[10:11], v[248:249] op_sel_hi:[0,1,1] neg_lo:[0,0,1] neg_hi:[0,0,1]
    v_pk_mul_f32 v[244:245], v[228:229], v[60:61] op_sel:[1,0] op_sel_hi:[1,1]
    v_pk_mul_f32 v[60:61], v[228:229], v[60:61] op_sel_hi:[0,1]
    v_pk_fma_f32 v[60:61], v[228:229], v[12:13], v[60:61] op_sel:[1,0,0] op_sel_hi:[1,1,1]
    v_pk_fma_f32 v[12:13], v[228:229], v[12:13], v[244:245] op_sel_hi:[0,1,1] neg_lo:[0,0,1] neg_hi:[0,0,1]
    v_pk_mul_f32 v[248:249], v[228:229], v[62:63] op_sel:[1,0] op_sel_hi:[1,1]
    v_pk_mul_f32 v[62:63], v[228:229], v[62:63] op_sel_hi:[0,1]
    v_pk_fma_f32 v[62:63], v[228:229], v[14:15], v[62:63] op_sel:[1,0,0] op_sel_hi:[1,1,1]
    v_pk_fma_f32 v[14:15], v[228:229], v[14:15], v[248:249] op_sel_hi:[0,1,1] neg_lo:[0,0,1] neg_hi:[0,0,1]
    v_pk_mul_f32 v[244:245], v[230:231], v[64:65] op_sel:[1,0] op_sel_hi:[1,1]
    v_pk_mul_f32 v[64:65], v[230:231], v[64:65] op_sel_hi:[0,1]
    v_pk_fma_f32 v[64:65], v[230:231], v[16:17], v[64:65] op_sel:[1,0,0] op_sel_hi:[1,1,1]
    v_pk_fma_f32 v[16:17], v[230:231], v[16:17], v[244:245] op_sel_hi:[0,1,1] neg_lo:[0,0,1] neg_hi:[0,0,1]
    v_pk_mul_f32 v[248:249], v[230:231], v[66:67] op_sel:[1,0] op_sel_hi:[1,1]
    v_pk_mul_f32 v[66:67], v[230:231], v[66:67] op_sel_hi:[0,1]
    v_pk_fma_f32 v[66:67], v[230:231], v[18:19], v[66:67] op_sel:[1,0,0] op_sel_hi:[1,1,1]
    v_pk_fma_f32 v[18:19], v[230:231], v[18:19], v[248:249] op_sel_hi:[0,1,1] neg_lo:[0,0,1] neg_hi:[0,0,1]
    v_pk_mul_f32 v[244:245], v[230:231], v[68:69] op_sel:[1,0] op_sel_hi:[1,1]
    v_pk_mul_f32 v[68:69], v[230:231], v[68:69] op_sel_hi:[0,1]
    v_pk_fma_f32 v[68:69], v[230:231], v[20:21], v[68:69] op_sel:[1,0,0] op_sel_hi:[1,1,1]
    v_pk_fma_f32 v[20:21], v[230:231], v[20:21], v[244:245] op_sel_hi:[0,1,1] neg_lo:[0,0,1] neg_hi:[0,0,1]
    v_pk_mul_f32 v[248:249], v[230:231], v[70:71] op_sel:[1,0] op_sel_hi:[1,1]
    v_pk_mul_f32 v[70:71], v[230:231], v[70:71] op_sel_hi:[0,1]
    v_pk_fma_f32 v[70:71], v[230:231], v[22:23], v[70:71] op_sel:[1,0,0] op_sel_hi:[1,1,1]
    v_pk_fma_f32 v[22:23], v[230:231], v[22:23], v[248:249] op_sel_hi:[0,1,1] neg_lo:[0,0,1] neg_hi:[0,0,1]
    v_pk_mul_f32 v[244:245], v[230:231], v[72:73] op_sel:[1,0] op_sel_hi:[1,1]
    v_pk_mul_f32 v[72:73], v[230:231], v[72:73] op_sel_hi:[0,1]
    v_pk_fma_f32 v[72:73], v[230:231], v[24:25], v[72:73] op_sel:[1,0,0] op_sel_hi:[1,1,1]
    v_pk_fma_f32 v[24:25], v[230:231], v[24:25], v[244:245] op_sel_hi:[0,1,1] neg_lo:[0,0,1] neg_hi:[0,0,1]
    v_pk_mul_f32 v[248:249], v[230:231], v[74:75] op_sel:[1,0] op_sel_hi:[1,1]
    v_pk_mul_f32 v[74:75], v[230:231], v[74:75] op_sel_hi:[0,1]
    v_pk_fma_f32 v[74:75], v[230:231], v[26:27], v[74:75] op_sel:[1,0,0] op_sel_hi:[1,1,1]
    v_pk_fma_f32 v[26:27], v[230:231], v[26:27], v[248:249] op_sel_hi:[0,1,1] neg_lo:[0,0,1] neg_hi:[0,0,1]
    v_pk_mul_f32 v[244:245], v[230:231], v[76:77] op_sel:[1,0] op_sel_hi:[1,1]
    v_pk_mul_f32 v[76:77], v[230:231], v[76:77] op_sel_hi:[0,1]
    v_pk_fma_f32 v[76:77], v[230:231], v[28:29], v[76:77] op_sel:[1,0,0] op_sel_hi:[1,1,1]
    v_pk_fma_f32 v[28:29], v[230:231], v[28:29], v[244:245] op_sel_hi:[0,1,1] neg_lo:[0,0,1] neg_hi:[0,0,1]
    v_pk_mul_f32 v[248:249], v[230:231], v[78:79] op_sel:[1,0] op_sel_hi:[1,1]
    v_pk_mul_f32 v[78:79], v[230:231], v[78:79] op_sel_hi:[0,1]
    v_pk_fma_f32 v[78:79], v[230:231], v[30:31], v[78:79] op_sel:[1,0,0] op_sel_hi:[1,1,1]
    v_pk_fma_f32 v[30:31], v[230:231], v[30:31], v[248:249] op_sel_hi:[0,1,1] neg_lo:[0,0,1] neg_hi:[0,0,1]
    s_waitcnt lgkmcnt(4)
    v_mfma_f32_32x32x16_bf16 v[32:47], a[0:3], a[160:163], 0
    ds_read_b128 a[192:195], v170 offset:8192
    s_and_b32 s12, s4, 1
    s_xor_b32 s12, s12, 1
    s_lshl_b32 s12, s12, 1
    s_xor_b32 s12, s12, s3
    s_lshl_b32 s12, s12, 4
    v_mfma_f32_16x16x32_bf16 a[216:219], v[190:193], a[160:163], 0
    ds_read_b128 a[196:199], v170 offset:12288
    v_mfma_f32_32x32x16_bf16 v[80:95], a[0:3], a[164:167], 0
    ds_read_b128 a[200:203], v171 offset:8192
    v_lshrrev_b32 v244, 2, v144
    v_add_u32 v253, s12, v244
    v_mul_u32_u24 v253, 1280, v253
    v_lshrrev_b32 v244, 4, v144
    v_xor_b32 v244, v244, v144
    v_mfma_f32_32x32x16_bf16 v[32:47], a[4:7], a[168:171], v[32:47]
    ds_read_b128 a[204:207], v171 offset:12288
    v_and_b32 v244, 3, v244
    v_lshl_add_u32 v253, v244, 4, v253
    v_bfe_u32 v244, v145, 2, 2
    v_xor_b32 v244, v244, v146
    v_lshlrev_b32 v244, 4, v244
    v_mfma_f32_32x32x16_bf16 v[80:95], a[4:7], a[172:175], v[80:95]
    v_lshl_add_u32 v246, v145, 6, v244
    v_xor_b32 v247, 32, v246
    s_lshl_b32 s0, s9, 1
    s_mul_i32 s12, s6, 384
    s_add_u32 s1, s0, 192
    s_sub_u32 s1, s1, s12
    s_waitcnt lgkmcnt(4)
    v_mfma_f32_32x32x16_bf16 v[32:47], a[8:11], a[176:179], v[32:47]
    ds_read_b128 a[160:163], v172 offset:8192
    v_mul_f32 v140, v235, v235
    v_add_f32 v237, v235, v235
    v_mul_f32 v237, v237, v234
    v_fma_f32 v236, v234, v234, -v140
    v_mul_f32 v140, v237, v237
    v_mfma_f32_32x32x16_bf16 v[80:95], a[8:11], a[180:183], v[80:95]
    ds_read_b128 a[164:167], v172 offset:12288
    v_add_f32 v237, v237, v237
    v_mul_f32 v237, v237, v236
    v_fma_f32 v236, v236, v236, -v140
    v_mul_f32 v140, v237, v237
    v_add_f32 v237, v237, v237
    v_mfma_f32_16x16x32_bf16 a[228:231], v[190:193], a[180:183], 0
    ds_read_b128 a[168:171], v173 offset:8192
    v_mfma_f32_32x32x16_bf16 v[32:47], a[12:15], a[184:187], v[32:47]
    ds_read_b128 a[172:175], v173 offset:12288
    v_mul_f32 v237, v237, v236
    v_fma_f32 v236, v236, v236, -v140
    v_mul_f32 v140, v237, v237
    v_add_f32 v175, v237, v237
    v_mul_f32 v175, v175, v236
    v_mfma_f32_32x32x16_bf16 v[80:95], a[12:15], a[188:191], v[80:95]
    v_fma_f32 v174, v236, v236, -v140
    v_accvgpr_write_b32 a246, v174
    v_accvgpr_write_b32 a247, v175
    v_mul_f32 v140, v175, v175
    v_add_f32 v175, v175, v175
    v_mul_f32 v175, v175, v174
    s_waitcnt lgkmcnt(4)
    v_mfma_f32_32x32x16_bf16 v[32:47], a[16:19], a[192:195], v[32:47]
    v_add_u32 v170, 4294901760, v170
    ds_read_b128 a[176:179], v170 offset:0
    v_fma_f32 v174, v174, v174, -v140
    v_accvgpr_write_b32 a248, v174
    v_accvgpr_write_b32 a249, v175
    v_mul_f32 v140, v175, v175
    v_mfma_f32_16x16x32_bf16 a[216:219], v[190:193], a[192:195], a[216:219]
    ds_read_b128 a[180:183], v170 offset:4096
    v_mfma_f32_32x32x16_bf16 v[80:95], a[16:19], a[196:199], v[80:95]
    v_add_u32 v171, 4294901760, v171
    v_add_f32 v175, v175, v175
    v_mul_f32 v175, v175, v174
    v_fma_f32 v174, v174, v174, -v140
    v_mul_f32 v140, v223, v223
    v_add_f32 v137, v223, v223
    v_mfma_f32_32x32x16_bf16 v[32:47], a[20:23], a[200:203], v[32:47]
    ds_read_b128 a[184:187], v171 offset:0
    v_mul_f32 v137, v137, v222
    v_fma_f32 v136, v222, v222, -v140
    v_cmp_eq_u32 vcc, 1, v146
    v_mov_b32 v141, 0
    v_mov_b32 v142, 1.0
    v_mfma_f32_32x32x16_bf16 v[80:95], a[20:23], a[204:207], v[80:95]
    ds_read_b128 a[188:191], v171 offset:4096
    v_cndmask_b32 v138, v142, v136, vcc
    v_cndmask_b32 v139, v141, v137, vcc
    v_mul_f32 v140, v137, v137
    v_add_f32 v137, v137, v137
    v_mul_f32 v137, v137, v136
    s_waitcnt lgkmcnt(4)
    v_mfma_f32_32x32x16_bf16 v[32:47], a[24:27], a[160:163], v[32:47]
    v_add_u32 v172, 4294901760, v172
    ds_read_b128 a[192:195], v172 offset:0
    v_fma_f32 v136, v136, v136, -v140
    v_fma_f32 v142, v136, v138, v141
    v_fma_f32 v143, v136, v139, v141
    v_fma_f32 v142, -v137, v139, v142
    v_mfma_f32_32x32x16_bf16 v[80:95], a[24:27], a[164:167], v[80:95]
    ds_read_b128 a[196:199], v172 offset:4096
    v_add_u32 v173, 4294901760, v173
    v_fma_f32 v143, v137, v138, v143
    s_bitcmp1_b32 s3, 0
    s_cselect_b64 vcc, -1, 0
    v_cndmask_b32 v138, v138, v142, vcc
    v_mfma_f32_16x16x32_bf16 a[228:231], v[190:193], a[164:167], a[228:231]
    ds_read_b128 a[200:203], v173 offset:0
    v_mfma_f32_32x32x16_bf16 v[32:47], a[28:31], a[168:171], v[32:47]
    ds_read_b128 a[204:207], v173 offset:4096
    v_cndmask_b32 v139, v139, v143, vcc
    v_mul_f32 v140, v137, v137
    v_add_f32 v137, v137, v137
    v_mul_f32 v137, v137, v136
    v_fma_f32 v136, v136, v136, -v140
    v_mfma_f32_32x32x16_bf16 v[80:95], a[28:31], a[172:175], v[80:95]
    v_fma_f32 v142, v136, v138, v141
    v_fma_f32 v143, v136, v139, v141
    v_fma_f32 v142, -v137, v139, v142
    v_fma_f32 v143, v137, v138, v143
    s_bitcmp1_b32 s3, 1
    s_cselect_b64 vcc, -1, 0
    s_waitcnt lgkmcnt(4)
    v_mfma_f32_32x32x16_bf16 v[32:47], a[32:35], a[176:179], v[32:47]
    ds_read_b128 a[160:163], v170 offset:8192
    s_add_u32 s35, s0, s90
    s_add_u32 m0, s94, 0
    v_cndmask_b32 v138, v138, v142, vcc
    v_cndmask_b32 v139, v139, v143, vcc
    v_accvgpr_write_b32 a240, v138
    v_mfma_f32_16x16x32_bf16 a[216:219], v[190:193], a[176:179], a[216:219]
    ds_read_b128 a[164:167], v170 offset:12288
    buffer_load_dwordx4 v253, s[60:63], s35 offen offset:0 lds
    s_add_u32 m0, s94, 4032
    v_mfma_f32_32x32x16_bf16 v[80:95], a[32:35], a[180:183], v[80:95]
    ds_read_b128 a[168:171], v171 offset:8192
    buffer_load_dwordx4 v253, s[60:63], s35 offen offset:64 lds
    s_add_u32 m0, s94, 8064
    v_accvgpr_write_b32 a241, v139
    v_mul_f32 v140, v225, v225
    v_add_f32 v137, v225, v225
    v_mfma_f32_32x32x16_bf16 v[32:47], a[36:39], a[184:187], v[32:47]
    ds_read_b128 a[172:175], v171 offset:12288
    v_mul_f32 v137, v137, v224
    v_fma_f32 v136, v224, v224, -v140
    v_cmp_eq_u32 vcc, 1, v146
    v_mov_b32 v141, 0
    v_mov_b32 v142, 1.0
    v_mfma_f32_32x32x16_bf16 v[80:95], a[36:39], a[188:191], v[80:95]
    buffer_load_dwordx4 v253, s[60:63], s35 offen offset:128 lds
    s_add_u32 m0, s94, 12288
    v_cndmask_b32 v138, v142, v136, vcc
    v_cndmask_b32 v139, v141, v137, vcc
    v_mul_f32 v140, v137, v137
    v_add_f32 v137, v137, v137
    s_waitcnt lgkmcnt(4)
    v_mfma_f32_32x32x16_bf16 v[32:47], a[40:43], a[192:195], v[32:47]
    ds_read_b128 a[176:179], v172 offset:8192
    v_mul_f32 v137, v137, v136
    v_fma_f32 v136, v136, v136, -v140
    v_fma_f32 v142, v136, v138, v141
    v_fma_f32 v143, v136, v139, v141
    v_fma_f32 v142, -v137, v139, v142
    v_mfma_f32_32x32x16_bf16 v[80:95], a[40:43], a[196:199], v[80:95]
    ds_read_b128 a[180:183], v172 offset:12288
    buffer_load_dwordx4 v253, s[64:67], s35 offen offset:0 lds
    s_add_u32 m0, s94, 16320
    v_fma_f32 v143, v137, v138, v143
    s_bitcmp1_b32 s3, 0
    s_cselect_b64 vcc, -1, 0
    v_mfma_f32_16x16x32_bf16 a[228:231], v[190:193], a[196:199], a[228:231]
    ds_read_b128 a[184:187], v173 offset:8192
    v_mfma_f32_32x32x16_bf16 v[32:47], a[44:47], a[200:203], v[32:47]
    ds_read_b128 a[188:191], v173 offset:12288
    v_cndmask_b32 v138, v138, v142, vcc
    v_cndmask_b32 v139, v139, v143, vcc
    v_mul_f32 v140, v137, v137
    v_add_f32 v137, v137, v137
    v_mul_f32 v137, v137, v136
    v_mfma_f32_32x32x16_bf16 v[80:95], a[44:47], a[204:207], v[80:95]
    buffer_load_dwordx4 v253, s[64:67], s35 offen offset:64 lds
    s_add_u32 m0, s94, 20352
    v_fma_f32 v136, v136, v136, -v140
    v_fma_f32 v142, v136, v138, v141
    v_fma_f32 v143, v136, v139, v141
    v_fma_f32 v142, -v137, v139, v142
    s_waitcnt lgkmcnt(4)
    v_mfma_f32_32x32x16_bf16 v[32:47], a[48:51], a[160:163], v[32:47]
    ds_read_b128 a[192:195], v170 offset:16384
    v_fma_f32 v143, v137, v138, v143
    s_bitcmp1_b32 s3, 1
    s_cselect_b64 vcc, -1, 0
    v_cndmask_b32 v138, v138, v142, vcc
    v_cndmask_b32 v139, v139, v143, vcc
    v_mfma_f32_16x16x32_bf16 a[216:219], v[190:193], a[160:163], a[216:219]
    ds_read_b128 a[196:199], v170 offset:20480
    buffer_load_dwordx4 v253, s[64:67], s35 offen offset:128 lds
    s_add_u32 s35, s0, s91
    s_add_u32 m0, s94, 24576
    v_mfma_f32_32x32x16_bf16 v[80:95], a[48:51], a[164:167], v[80:95]
    ds_read_b128 a[200:203], v171 offset:16384
    v_accvgpr_write_b32 a242, v138
    v_accvgpr_write_b32 a243, v139
    v_mul_f32 v140, v227, v227
    v_add_f32 v137, v227, v227
    v_mul_f32 v137, v137, v226
    v_mfma_f32_32x32x16_bf16 v[32:47], a[52:55], a[168:171], v[32:47]
    ds_read_b128 a[204:207], v171 offset:20480
    buffer_load_dwordx4 v253, s[60:63], s35 offen offset:0 lds
    s_add_u32 m0, s94, 28608
    v_fma_f32 v136, v226, v226, -v140
    v_cmp_eq_u32 vcc, 1, v146
    v_mov_b32 v141, 0
    v_mfma_f32_32x32x16_bf16 v[80:95], a[52:55], a[172:175], v[80:95]
    v_mov_b32 v142, 1.0
    v_cndmask_b32 v138, v142, v136, vcc
    v_cndmask_b32 v139, v141, v137, vcc
    v_mul_f32 v140, v137, v137
    v_add_f32 v137, v137, v137
    v_mul_f32 v137, v137, v136
    s_waitcnt lgkmcnt(4)
    v_mfma_f32_32x32x16_bf16 v[32:47], a[56:59], a[176:179], v[32:47]
    ds_read_b128 a[160:163], v172 offset:16384
    buffer_load_dwordx4 v253, s[60:63], s35 offen offset:64 lds
    s_add_u32 m0, s94, 32640
    v_fma_f32 v136, v136, v136, -v140
    v_fma_f32 v142, v136, v138, v141
    v_fma_f32 v143, v136, v139, v141
    v_mfma_f32_32x32x16_bf16 v[80:95], a[56:59], a[180:183], v[80:95]
    ds_read_b128 a[164:167], v172 offset:20480
    v_fma_f32 v142, -v137, v139, v142
    v_fma_f32 v143, v137, v138, v143
    s_bitcmp1_b32 s3, 0
    s_cselect_b64 vcc, -1, 0
    v_cndmask_b32 v138, v138, v142, vcc
    v_mfma_f32_16x16x32_bf16 a[228:231], v[190:193], a[180:183], a[228:231]
    ds_read_b128 a[168:171], v173 offset:16384
    v_mfma_f32_32x32x16_bf16 v[32:47], a[60:63], a[184:187], v[32:47]
    ds_read_b128 a[172:175], v173 offset:20480
    buffer_load_dwordx4 v253, s[60:63], s35 offen offset:128 lds
    s_add_u32 m0, s94, 36864
    v_cndmask_b32 v139, v139, v143, vcc
    v_mul_f32 v140, v137, v137
    v_add_f32 v137, v137, v137
    v_mfma_f32_32x32x16_bf16 v[80:95], a[60:63], a[188:191], v[80:95]
    v_mul_f32 v137, v137, v136
    v_fma_f32 v136, v136, v136, -v140
    v_fma_f32 v142, v136, v138, v141
    v_fma_f32 v143, v136, v139, v141
    v_fma_f32 v142, -v137, v139, v142
    v_fma_f32 v143, v137, v138, v143
    s_waitcnt lgkmcnt(4)
    v_mfma_f32_32x32x16_bf16 v[32:47], a[64:67], a[192:195], v[32:47]
    ds_read_b128 a[176:179], v170 offset:24576
    buffer_load_dwordx4 v253, s[64:67], s35 offen offset:0 lds
    s_add_u32 m0, s94, 40896
    s_bitcmp1_b32 s3, 1
    s_cselect_b64 vcc, -1, 0
    v_cndmask_b32 v138, v138, v142, vcc
    v_mfma_f32_16x16x32_bf16 a[216:219], v[190:193], a[192:195], a[216:219]
    ds_read_b128 a[180:183], v170 offset:28672
    v_mfma_f32_32x32x16_bf16 v[80:95], a[64:67], a[196:199], v[80:95]
    ds_read_b128 a[184:187], v171 offset:24576
    buffer_load_dwordx4 v253, s[64:67], s35 offen offset:64 lds
    s_add_u32 m0, s94, 44928
    v_cndmask_b32 v139, v139, v143, vcc
    v_accvgpr_write_b32 a244, v138
    v_accvgpr_write_b32 a245, v139
    v_mfma_f32_32x32x16_bf16 v[32:47], a[68:71], a[200:203], v[32:47]
    ds_read_b128 a[188:191], v171 offset:28672
    s_mov_b32 s15, s20
    s_mul_i32 s13, s6, 6144
    s_add_u32 s13, s13, s15
    s_add_u32 s40, s13, 24576
    s_add_u32 s14, s15, 36864
    v_mfma_f32_32x32x16_bf16 v[80:95], a[68:71], a[204:207], v[80:95]
    buffer_load_dwordx4 v253, s[64:67], s35 offen offset:128 lds
    s_cmp_eq_u32 s101, 1
    s_cselect_b32 s40, s14, s40
    s_add_u32 s41, s13, 26624
    s_add_u32 s14, s15, 38912
    s_cmp_eq_u32 s101, 1
    s_cselect_b32 s41, s14, s41
    s_getpc_b64 s[96:97]
L_pc_45:
    s_sub_u32 s96, s96, L_pc_45-parallel_sum__ssm_conv_s5__dense_activation_mish__prompt_kernel
    s_subb_u32 s97, s97, 0
    s_lshr_b32 s98, s2, 3
    s_lshl_b32 s98, s98, 2
    s_add_u32 s98, s98, s3
    s_mul_i32 s98, s98, 768
    v_min_u32 v252, 5, v144
    v_lshl_add_u32 v252, v252, 7, s98
    v_min_u32 v252, CODE_LAST, v252
    global_load_dword a255, v252, s[96:97]
    s_waitcnt lgkmcnt(4)
    v_mfma_f32_32x32x16_bf16 v[32:47], a[72:75], a[160:163], v[32:47]
    ds_read_b128 a[192:195], v172 offset:24576
    s_add_u32 s42, s13, 28672
    s_mov_b32 s14, 2147418112
    s_cmp_eq_u32 s101, 1
    s_cselect_b32 s42, s14, s42
    s_add_u32 s43, s13, 36864
    v_mfma_f32_32x32x16_bf16 v[80:95], a[72:75], a[164:167], v[80:95]
    ds_read_b128 a[196:199], v172 offset:28672
    s_add_u32 s14, s15, 40960
    s_cmp_eq_u32 s101, 1
    s_cselect_b32 s43, s14, s43
    s_add_u32 s46, s13, 38912
    s_add_u32 s14, s15, 43008
    v_mfma_f32_16x16x32_bf16 a[228:231], v[190:193], a[164:167], a[228:231]
    ds_read_b128 a[200:203], v173 offset:24576
    v_mfma_f32_32x32x16_bf16 v[32:47], a[76:79], a[168:171], v[32:47]
    ds_read_b128 a[204:207], v173 offset:28672
    s_cmp_eq_u32 s101, 1
    s_cselect_b32 s46, s14, s46
    s_add_u32 s47, s13, 40960
    s_mov_b32 s14, 2147418112
    s_cmp_eq_u32 s101, 1
    s_cselect_b32 s47, s14, s47
    v_mfma_f32_32x32x16_bf16 v[80:95], a[76:79], a[172:175], v[80:95]
    s_mul_i32 s12, s3, 2048
    s_add_u32 s12, s12, 147456
    v_bfe_u32 v244, v145, 1, 3
    v_add_u32 v186, 0, v146
    v_xor_b32 v186, v186, v244
    v_lshlrev_b32 v186, 3, v186
    s_waitcnt lgkmcnt(4)
    v_mfma_f32_32x32x16_bf16 v[32:47], a[80:83], a[176:179], v[32:47]
    ds_read_b128 a[160:163], v170 offset:32768
    v_lshl_add_u32 v186, v145, 6, v186
    v_add_u32 v186, s12, v186
    v_add_u32 v187, 2, v146
    v_xor_b32 v187, v187, v244
    v_lshlrev_b32 v187, 3, v187
    v_mfma_f32_16x16x32_bf16 a[216:219], v[190:193], a[176:179], a[216:219]
    ds_read_b128 a[164:167], v170 offset:36864
    v_mfma_f32_32x32x16_bf16 v[80:95], a[80:83], a[180:183], v[80:95]
    ds_read_b128 a[168:171], v171 offset:32768
    v_lshl_add_u32 v187, v145, 6, v187
    v_add_u32 v187, s12, v187
    v_add_u32 v188, 4, v146
    v_xor_b32 v188, v188, v244
    v_lshlrev_b32 v188, 3, v188
    v_mfma_f32_32x32x16_bf16 v[32:47], a[84:87], a[184:187], v[32:47]
    ds_read_b128 a[172:175], v171 offset:36864
    v_lshl_add_u32 v188, v145, 6, v188
    v_add_u32 v188, s12, v188
    v_add_u32 v189, 6, v146
    v_xor_b32 v189, v189, v244
    v_lshlrev_b32 v189, 3, v189
    v_mfma_f32_32x32x16_bf16 v[80:95], a[84:87], a[188:191], v[80:95]
    v_lshl_add_u32 v189, v145, 6, v189
    v_add_u32 v189, s12, v189
    v_bfe_u32 v244, v144, 2, 2
    v_lshl_add_u32 v244, v146, 3, v244
    v_add_u32 v244, 0, v244
    v_bfe_u32 v245, v144, 4, 1
    s_waitcnt lgkmcnt(4)
    v_mfma_f32_32x32x16_bf16 v[32:47], a[88:91], a[192:195], v[32:47]
    v_lshlrev_b32 v245, 2, v245
    v_and_b32 v184, 3, v144
    v_or_b32 v245, v245, v184
    v_lshrrev_b32 v184, 1, v244
    v_xor_b32 v245, v245, v184
    v_lshlrev_b32 v245, 3, v245
    s_waitcnt lgkmcnt(0)
    s_barrier
    v_mfma_f32_32x32x16_bf16 v[80:95], a[88:91], a[196:199], v[80:95]
    ds_read_b128 a[176:179], v172 offset:32768
    ds_read_b128 a[180:183], v172 offset:36864
    s_add_u32 m0, s94, 49152
    v_lshl_add_u32 v184, v244, 6, v245
    v_add_u32 v184, s12, v184
    v_bfe_u32 v244, v144, 2, 2
    v_mfma_f32_16x16x32_bf16 a[228:231], v[190:193], a[196:199], a[228:231]
    ds_read_b128 a[184:187], v173 offset:32768
    buffer_load_dwordx4 v158, s[56:59], s76 offen lds
    s_add_u32 m0, s94, 53248
    v_mfma_f32_32x32x16_bf16 v[32:47], a[92:95], a[200:203], v[32:47]
    ds_read_b128 a[188:191], v173 offset:36864
    buffer_load_dwordx4 v159, s[56:59], s76 offen lds
    s_add_u32 m0, s94, 57344
    v_lshl_add_u32 v244, v146, 3, v244
    v_add_u32 v244, 4, v244
    v_bfe_u32 v245, v144, 4, 1
    v_mfma_f32_32x32x16_bf16 v[80:95], a[92:95], a[204:207], v[80:95]
    v_lshlrev_b32 v245, 2, v245
    v_and_b32 v185, 3, v144
    v_or_b32 v245, v245, v185
    v_lshrrev_b32 v185, 1, v244
    v_xor_b32 v245, v245, v185
    v_lshlrev_b32 v245, 3, v245
    ds_read_b128 v[120:123], v251 offset:0
    ds_read_b128 v[124:127], v251 offset:32
    ds_read_b128 v[128:131], v251 offset:64
    ds_read_b128 v[132:135], v251 offset:96
    v_mfma_f32_32x32x16_bf16 v[32:47], a[96:99], a[160:163], v[32:47]
    ds_read_b128 a[192:195], v170 offset:40960
    buffer_load_dwordx4 v160, s[56:59], s76 offen lds
    s_add_u32 m0, s94, 61440
    v_lshl_add_u32 v185, v244, 6, v245
    v_add_u32 v185, s12, v185
    v_mfma_f32_16x16x32_bf16 a[216:219], v[190:193], a[160:163], a[216:219]
    ds_read_b128 a[196:199], v170 offset:45056
    v_mfma_f32_32x32x16_bf16 v[80:95], a[96:99], a[164:167], v[80:95]
    ds_read_b128 a[200:203], v171 offset:40960
    v_mfma_f32_32x32x16_bf16 v[32:47], a[100:103], a[168:171], v[32:47]
    ds_read_b128 a[204:207], v171 offset:45056
    buffer_load_dwordx4 v161, s[56:59], s76 offen lds
    s_add_u32 m0, s94, 65536
    v_mfma_f32_32x32x16_bf16 v[80:95], a[100:103], a[172:175], v[80:95]
    s_waitcnt lgkmcnt(8)
    v_mfma_f32_32x32x16_bf16 v[32:47], a[104:107], a[176:179], v[32:47]
    ds_read_b128 a[0:3], v170 offset:49152
    ds_read_b128 a[4:7], v172 offset:53248
    v_add_u32 v170, 57344, v170
    buffer_load_dwordx4 v162, s[56:59], s76 offen lds
    s_add_u32 m0, s94, 69632
    v_mfma_f32_32x32x16_bf16 v[80:95], a[104:107], a[180:183], v[80:95]
    ds_read_b128 a[8:11], v170 offset:0
    v_add_u32 v172, 61440, v172
    ds_read_b128 a[12:15], v172 offset:0
    v_mfma_f32_16x16x32_bf16 a[228:231], v[190:193], a[180:183], a[228:231]
    v_add_u32 v172, 4294946816, v172
    buffer_load_dwordx4 v163, s[56:59], s76 offen lds
    s_add_u32 m0, s94, 73728
    v_mfma_f32_32x32x16_bf16 v[32:47], a[108:111], a[184:187], v[32:47]
    ds_read_b128 a[160:163], v172 offset:0
    ds_read_b128 a[164:167], v172 offset:4096
    v_mfma_f32_32x32x16_bf16 v[80:95], a[108:111], a[188:191], v[80:95]
    ds_read_b128 a[168:171], v173 offset:40960
    ds_read_b128 a[172:175], v173 offset:45056
    buffer_load_dwordx4 v158, s[56:59], s78 offen lds
    s_add_u32 m0, s94, 77824
    s_waitcnt lgkmcnt(8)
    v_mfma_f32_32x32x16_bf16 v[32:47], a[112:115], a[192:195], v[32:47]
    v_add_u32 v170, 4294959104, v170
    ds_read_b128 a[176:179], v170 offset:0
    v_mfma_f32_16x16x32_bf16 a[216:219], v[190:193], a[192:195], a[216:219]
    ds_read_b128 a[180:183], v170 offset:4096
    v_mfma_f32_32x32x16_bf16 v[80:95], a[112:115], a[196:199], v[80:95]
    ds_read_b128 a[184:187], v171 offset:49152
    buffer_load_dwordx4 v159, s[56:59], s78 offen lds
    s_add_u32 m0, s94, 81920
    v_mfma_f32_32x32x16_bf16 v[32:47], a[116:119], a[200:203], v[32:47]
    ds_read_b128 a[188:191], v171 offset:53248
    v_mfma_f32_32x32x16_bf16 v[80:95], a[116:119], a[204:207], v[80:95]
    buffer_load_dwordx4 v160, s[56:59], s78 offen lds
    s_add_u32 m0, s94, 86016
    s_waitcnt lgkmcnt(4)
    v_mfma_f32_32x32x16_bf16 v[32:47], a[120:123], a[160:163], v[32:47]
    ds_read_b128 a[192:195], v172 offset:8192
    v_mfma_f32_16x16x32_bf16 a[216:219], v[190:193], a[0:3], a[216:219]
    ds_read_b128 a[196:199], v172 offset:12288
    buffer_load_dwordx4 v161, s[56:59], s78 offen lds
    s_add_u32 m0, s94, 90112
    v_mfma_f32_32x32x16_bf16 v[80:95], a[120:123], a[164:167], v[80:95]
    ds_read_b128 a[200:203], v173 offset:49152
    v_mfma_f32_16x16x32_bf16 a[228:231], v[190:193], a[164:167], a[228:231]
    ds_read_b128 a[204:207], v173 offset:53248
    v_mfma_f32_16x16x32_bf16 a[228:231], v[190:193], a[4:7], a[228:231]
    buffer_load_dwordx4 v162, s[56:59], s78 offen lds
    s_add_u32 m0, s94, 94208
    v_mfma_f32_32x32x16_bf16 v[32:47], a[124:127], a[168:171], v[32:47]
    v_mfma_f32_16x16x32_bf16 a[216:219], v[190:193], a[8:11], a[216:219]
    v_mfma_f32_32x32x16_bf16 v[80:95], a[124:127], a[172:175], v[80:95]
    buffer_load_dwordx4 v163, s[56:59], s78 offen lds
    v_mfma_f32_16x16x32_bf16 a[228:231], v[190:193], a[12:15], a[228:231]
    s_waitcnt lgkmcnt(4)
    s_nop 3
    ds_write_b32 v241, a216 offset:15360
    s_nop 1
    ds_write_b32 v241, a228 offset:15872
    v_mfma_f32_32x32x16_bf16 v[32:47], a[128:131], a[176:179], v[32:47]
    ds_read_b128 a[160:163], v170 offset:8192
    ds_read_b128 a[164:167], v170 offset:12288
    v_mfma_f32_32x32x16_bf16 v[80:95], a[128:131], a[180:183], v[80:95]
    v_add_u32 v171, 57344, v171
    v_mfma_f32_32x32x16_bf16 v[32:47], a[132:135], a[184:187], v[32:47]
    ds_read_b128 a[168:171], v171 offset:0
    v_mfma_f32_32x32x16_bf16 v[80:95], a[132:135], a[188:191], v[80:95]
    ds_read_b128 a[172:175], v171 offset:4096
    s_waitcnt lgkmcnt(6)
    v_mfma_f32_32x32x16_bf16 v[32:47], a[136:139], a[192:195], v[32:47]
    ds_read_b128 a[176:179], v172 offset:16384
    ds_read_b128 a[180:183], v172 offset:20480
    v_mfma_f32_32x32x16_bf16 v[80:95], a[136:139], a[196:199], v[80:95]
    v_add_u32 v173, 57344, v173
    v_mfma_f32_32x32x16_bf16 v[32:47], a[140:143], a[200:203], v[32:47]
    ds_read_b128 a[184:187], v173 offset:0
    v_mfma_f32_32x32x16_bf16 v[80:95], a[140:143], a[204:207], v[80:95]
    ds_read_b128 a[188:191], v173 offset:4096
    s_waitcnt lgkmcnt(4)
    v_mfma_f32_32x32x16_bf16 v[32:47], a[144:147], a[160:163], v[32:47]
    s_waitcnt lgkmcnt(0)
    s_barrier
    v_mfma_f32_32x32x16_bf16 v[80:95], a[144:147], a[164:167], v[80:95]
    s_add_u32 m0, s94, 98304
    ds_read_b128 v[136:139], v240 offset:15360
    ds_read_b128 v[140:143], v240 offset:15872
    v_mfma_f32_32x32x16_bf16 v[32:47], a[148:151], a[168:171], v[32:47]
    buffer_load_dwordx4 v158, s[56:59], s77 offen lds
    s_add_u32 m0, s94, 102400
    s_waitcnt lgkmcnt(1)
    v_add_f32 v136, v136, v137
    v_add_f32 v138, v138, v139
    v_mfma_f32_32x32x16_bf16 v[80:95], a[148:151], a[172:175], v[80:95]
    buffer_load_dwordx4 v159, s[56:59], s77 offen lds
    s_add_u32 m0, s94, 106496
    v_add_f32 v136, v136, v138
    v_and_b32 v137, 0xffff0000, v136
    v_sub_f32 v138, v136, v137
    v_and_b32 v139, 0xffff0000, v138
    v_mfma_f32_32x32x16_bf16 v[32:47], a[152:155], a[176:179], v[32:47]
    v_sub_f32 v138, v138, v139
    v_alignbit_b32 v207, v155, v138, 16
    v_perm_b32 v206, v139, v136, v242
    s_waitcnt lgkmcnt(0)
    v_add_f32 v140, v140, v141
    v_add_f32 v142, v142, v143
    v_mfma_f32_32x32x16_bf16 v[80:95], a[152:155], a[180:183], v[80:95]
    buffer_load_dwordx4 v160, s[56:59], s77 offen lds
    s_add_u32 m0, s94, 110592
    v_add_f32 v140, v140, v142
    v_and_b32 v141, 0xffff0000, v140
    v_sub_f32 v142, v140, v141
    v_and_b32 v143, 0xffff0000, v142
    v_mfma_f32_32x32x16_bf16 v[32:47], a[156:159], a[184:187], v[32:47]
    v_sub_f32 v142, v142, v143
    v_alignbit_b32 v213, v155, v142, 16
    v_perm_b32 v212, v143, v140, v242
    v_mfma_f32_32x32x16_bf16 v[80:95], a[156:159], a[188:191], v[80:95]
    buffer_load_dwordx4 v161, s[56:59], s77 offen lds
    s_add_u32 m0, s94, 114688
    v_mfma_f32_32x32x16_bf16 v[32:47], v[198:201], v[206:209], v[32:47]
    buffer_load_dwordx4 v162, s[56:59], s77 offen lds
    v_mfma_f32_32x32x16_bf16 v[80:95], v[198:201], v[212:215], v[80:95]
    s_add_u32 m0, s94, 118784
    s_nop 0
    buffer_load_dwordx4 v163, s[56:59], s77 offen lds
    s_bfm_b32 s36, s5, 0
    v_mov_b32 v198, 0
    v_mov_b32 v199, 0
    v_mov_b32 v200, s88
    v_mov_b32 v201, s89
    v_mov_b32 v202, 0
    v_mov_b32 v203, 0
    v_mov_b32 v204, s88
    v_mov_b32 v205, s89
    v_mov_b32 v206, 0
    v_mov_b32 v207, 0
    v_mov_b32 v208, s88
    v_mov_b32 v209, s89
    v_mov_b32 v210, 0
    v_mov_b32 v211, 0
    v_mov_b32 v212, s88
    v_mov_b32 v213, s89
    v_mov_b32 v166, 0
    v_mov_b32 v167, 0
    v_mov_b32 v168, s88
    v_mov_b32 v169, s89
    v_mov_b32 v170, 0
    v_mov_b32 v171, 0
    v_mov_b32 v172, s88
    v_mov_b32 v173, s89
    v_mov_b32 v190, 0
    v_mov_b32 v191, 0
    v_mov_b32 v192, s88
    v_mov_b32 v193, s89
    v_mov_b32 v240, 0
    v_mov_b32 v241, 0
    v_mov_b32 v242, s88
    v_mov_b32 v243, s89
    s_cmp_lt_u32 s3, 2
    s_cbranch_scc0 LS_np_46
    s_mov_b32 s13, 144384
    s_bfe_i32 exec_lo, s36, 65536
    s_bfe_i32 exec_hi, s36, 65544
    buffer_load_dwordx4 v[198:201], v238, s[68:71], s13 offen sc1
    s_mov_b32 s13, 133120
    s_bfe_i32 exec_lo, s36, 65537
    s_bfe_i32 exec_hi, s36, 65545
    buffer_load_dwordx4 v[202:205], v238, s[68:71], s13 offen sc1
    s_mov_b32 s13, 121856
    s_bfe_i32 exec_lo, s36, 65538
    s_bfe_i32 exec_hi, s36, 65546
    buffer_load_dwordx4 v[206:209], v238, s[68:71], s13 offen sc1
    s_mov_b32 s13, 110592
    s_bfe_i32 exec_lo, s36, 65539
    s_bfe_i32 exec_hi, s36, 65547
    buffer_load_dwordx4 v[210:213], v238, s[68:71], s13 offen sc1
    s_mov_b32 s13, 99328
    s_bfe_i32 exec_lo, s36, 65540
    s_bfe_i32 exec_hi, s36, 65548
    buffer_load_dwordx4 v[166:169], v238, s[68:71], s13 offen sc1
    s_mov_b32 s13, 88064
    s_bfe_i32 exec_lo, s36, 65541
    s_bfe_i32 exec_hi, s36, 65549
    buffer_load_dwordx4 v[170:173], v238, s[68:71], s13 offen sc1
    s_mov_b32 s13, 76800
    s_bfe_i32 exec_lo, s36, 65542
    s_bfe_i32 exec_hi, s36, 65550
    buffer_load_dwordx4 v[190:193], v238, s[68:71], s13 offen sc1
    s_mov_b32 s13, 65536
    s_bfe_i32 exec_lo, s36, 65543
    s_bfe_i32 exec_hi, s36, 65551
    buffer_load_dwordx4 v[240:243], v238, s[68:71], s13 offen sc1
    s_mov_b64 exec, -1
LS_np_46:
    v_pk_mul_f32 v[32:33], v[32:33], v[120:121]
    v_pk_mul_f32 v[34:35], v[34:35], v[122:123]
    v_pk_mul_f32 v[36:37], v[36:37], v[124:125]
    v_pk_mul_f32 v[38:39], v[38:39], v[126:127]
    v_pk_mul_f32 v[40:41], v[40:41], v[128:129]
    v_pk_mul_f32 v[42:43], v[42:43], v[130:131]
    v_pk_mul_f32 v[44:45], v[44:45], v[132:133]
    v_pk_mul_f32 v[46:47], v[46:47], v[134:135]
    s_add_u32 m0, s94, 122880
    s_nop 0
    buffer_load_dwordx4 v158, s[56:59], s79 offen lds
    s_add_u32 m0, s94, 126976
    v_pk_mul_f32 v[80:81], v[80:81], v[120:121]
    v_pk_mul_f32 v[82:83], v[82:83], v[122:123]
    v_pk_mul_f32 v[84:85], v[84:85], v[124:125]
    v_pk_mul_f32 v[86:87], v[86:87], v[126:127]
    v_pk_mul_f32 v[88:89], v[88:89], v[128:129]
    v_pk_mul_f32 v[90:91], v[90:91], v[130:131]
    v_pk_mul_f32 v[92:93], v[92:93], v[132:133]
    v_pk_mul_f32 v[94:95], v[94:95], v[134:135]
    buffer_load_dwordx4 v159, s[56:59], s79 offen lds
    s_add_u32 m0, s94, 131072
    v_pk_fma_f32 v[116:117], v[220:221], v[80:81], v[34:35] op_sel:[1,0,0] op_sel_hi:[1,1,1] neg_lo:[1,0,0] neg_hi:[1,0,0]
    v_pk_fma_f32 v[118:119], v[220:221], v[32:33], v[82:83] op_sel:[1,0,0] op_sel_hi:[1,1,1]
    v_pk_fma_f32 v[112:113], v[220:221], v[32:33], v[116:117] op_sel_hi:[0,1,1]
    v_pk_fma_f32 v[114:115], v[220:221], v[80:81], v[118:119] op_sel_hi:[0,1,1]
    buffer_load_dwordx4 v160, s[56:59], s79 offen lds
    s_add_u32 m0, s94, 135168
    v_pk_fma_f32 v[116:117], v[220:221], v[114:115], v[36:37] op_sel:[1,0,0] op_sel_hi:[1,1,1] neg_lo:[1,0,0] neg_hi:[1,0,0]
    v_pk_fma_f32 v[118:119], v[220:221], v[112:113], v[84:85] op_sel:[1,0,0] op_sel_hi:[1,1,1]
    v_pk_fma_f32 v[112:113], v[220:221], v[112:113], v[116:117] op_sel_hi:[0,1,1]
    v_pk_fma_f32 v[114:115], v[220:221], v[114:115], v[118:119] op_sel_hi:[0,1,1]
    buffer_load_dwordx4 v161, s[56:59], s79 offen lds
    s_add_u32 m0, s94, 139264
    v_pk_fma_f32 v[116:117], v[220:221], v[114:115], v[38:39] op_sel:[1,0,0] op_sel_hi:[1,1,1] neg_lo:[1,0,0] neg_hi:[1,0,0]
    v_pk_fma_f32 v[118:119], v[220:221], v[112:113], v[86:87] op_sel:[1,0,0] op_sel_hi:[1,1,1]
    v_pk_fma_f32 v[112:113], v[220:221], v[112:113], v[116:117] op_sel_hi:[0,1,1]
    v_pk_fma_f32 v[114:115], v[220:221], v[114:115], v[118:119] op_sel_hi:[0,1,1]
    buffer_load_dwordx4 v162, s[56:59], s79 offen lds
    s_add_u32 m0, s94, 143360
    v_pk_fma_f32 v[116:117], v[220:221], v[114:115], v[40:41] op_sel:[1,0,0] op_sel_hi:[1,1,1] neg_lo:[1,0,0] neg_hi:[1,0,0]
    v_pk_fma_f32 v[118:119], v[220:221], v[112:113], v[88:89] op_sel:[1,0,0] op_sel_hi:[1,1,1]
    v_pk_fma_f32 v[112:113], v[220:221], v[112:113], v[116:117] op_sel_hi:[0,1,1]
    v_pk_fma_f32 v[114:115], v[220:221], v[114:115], v[118:119] op_sel_hi:[0,1,1]
    buffer_load_dwordx4 v163, s[56:59], s79 offen lds
    v_pk_fma_f32 v[116:117], v[220:221], v[114:115], v[42:43] op_sel:[1,0,0] op_sel_hi:[1,1,1] neg_lo:[1,0,0] neg_hi:[1,0,0]
    v_pk_fma_f32 v[118:119], v[220:221], v[112:113], v[90:91] op_sel:[1,0,0] op_sel_hi:[1,1,1]
    v_pk_fma_f32 v[112:113], v[220:221], v[112:113], v[116:117] op_sel_hi:[0,1,1]
    v_pk_fma_f32 v[114:115], v[220:221], v[114:115], v[118:119] op_sel_hi:[0,1,1]
    v_pk_fma_f32 v[116:117], v[220:221], v[114:115], v[44:45] op_sel:[1,0,0] op_sel_hi:[1,1,1] neg_lo:[1,0,0] neg_hi:[1,0,0]
    v_pk_fma_f32 v[118:119], v[220:221], v[112:113], v[92:93] op_sel:[1,0,0] op_sel_hi:[1,1,1]
    v_pk_fma_f32 v[112:113], v[220:221], v[112:113], v[116:117] op_sel_hi:[0,1,1]
    v_pk_fma_f32 v[114:115], v[220:221], v[114:115], v[118:119] op_sel_hi:[0,1,1]
    v_pk_fma_f32 v[116:117], v[220:221], v[114:115], v[46:47] op_sel:[1,0,0] op_sel_hi:[1,1,1] neg_lo:[1,0,0] neg_hi:[1,0,0]
    v_pk_fma_f32 v[118:119], v[220:221], v[112:113], v[94:95] op_sel:[1,0,0] op_sel_hi:[1,1,1]
    v_pk_fma_f32 v[112:113], v[220:221], v[112:113], v[116:117] op_sel_hi:[0,1,1]
    v_pk_fma_f32 v[114:115], v[220:221], v[114:115], v[118:119] op_sel_hi:[0,1,1]
    v_fma_f32 v116, v226, v112, v113
    v_fma_f32 v117, v226, v114, v115
    v_fma_f32 v116, -v227, v114, v116
    v_fma_f32 v117, v227, v112, v117
    ds_write_b64 v176, v[116:117] offset:512
    s_waitcnt lgkmcnt(0)
    s_barrier
    s_cmp_eq_u32 s3, 2
    s_cbranch_scc0 LS_nd_47
    ds_read_b64 v[120:121], v177 offset:0
    ds_read_b64 v[122:123], v177 offset:768
    ds_read_b64 v[124:125], v177 offset:1536
    ds_read_b64 v[126:127], v177 offset:2304
    ds_read_b64 v[128:129], v177 offset:3072
    ds_read_b64 v[130:131], v177 offset:3840
    ds_read_b64 v[132:133], v177 offset:4608
    ds_read_b64 v[134:135], v177 offset:5376
    v_mov_b32 v142, s88
    v_mov_b32 v143, s89
    s_mov_b32 s13, 155648
    v_mov_b32 v136, 0
    v_mov_b32 v137, 0
    s_waitcnt lgkmcnt(6)
    v_fma_f32 v122, v234, v120, v122
    v_fma_f32 v123, v234, v121, v123
    v_fma_f32 v122, -v235, v121, v122
    v_fma_f32 v123, v235, v120, v123
    s_waitcnt lgkmcnt(5)
    v_fma_f32 v124, v234, v122, v124
    v_fma_f32 v125, v234, v123, v125
    v_fma_f32 v124, -v235, v123, v124
    v_fma_f32 v125, v235, v122, v125
    s_waitcnt lgkmcnt(4)
    v_fma_f32 v126, v234, v124, v126
    v_fma_f32 v127, v234, v125, v127
    v_fma_f32 v126, -v235, v125, v126
    v_fma_f32 v127, v235, v124, v127
    s_waitcnt lgkmcnt(3)
    v_fma_f32 v128, v234, v126, v128
    v_fma_f32 v129, v234, v127, v129
    v_fma_f32 v128, -v235, v127, v128
    v_fma_f32 v129, v235, v126, v129
    s_waitcnt lgkmcnt(2)
    v_fma_f32 v130, v234, v128, v130
    v_fma_f32 v131, v234, v129, v131
    v_fma_f32 v130, -v235, v129, v130
    v_fma_f32 v131, v235, v128, v131
    s_waitcnt lgkmcnt(1)
    v_fma_f32 v132, v234, v130, v132
    v_fma_f32 v133, v234, v131, v133
    v_fma_f32 v132, -v235, v131, v132
    v_fma_f32 v133, v235, v130, v133
    s_waitcnt lgkmcnt(0)
    v_fma_f32 v140, v234, v132, v134
    v_fma_f32 v141, v234, v133, v135
    v_fma_f32 v140, -v235, v133, v140
    v_fma_f32 v141, v235, v132, v141
    s_mov_b32 exec_hi, 0
    buffer_store_dwordx4 v[140:143], v238, s[68:71], s13 offen sc1
    s_mov_b64 exec, -1
    ds_write_b64 v177, v[136:137] offset:0
    ds_write_b64 v177, v[120:121] offset:768
    ds_write_b64 v177, v[122:123] offset:1536
    ds_write_b64 v177, v[124:125] offset:2304
    ds_write_b64 v177, v[126:127] offset:3072
    ds_write_b64 v177, v[128:129] offset:3840
    ds_write_b64 v177, v[130:131] offset:4608
    ds_write_b64 v177, v[132:133] offset:5376
    s_waitcnt lgkmcnt(0)
LS_nd_47:
    v_accvgpr_read_b32 v148, a240
    v_accvgpr_read_b32 v149, a241
    v_accvgpr_read_b32 v150, a242
    v_accvgpr_read_b32 v151, a243
    v_accvgpr_read_b32 v152, a244
    v_accvgpr_read_b32 v153, a245
    v_lshlrev_b32 v250, 3, v145
    v_add_u32 v250, 161792, v250
    v_pk_mul_f32 v[244:245], v[232:233], v[80:81] op_sel:[1,0] op_sel_hi:[1,1]
    v_pk_mul_f32 v[80:81], v[232:233], v[80:81] op_sel_hi:[0,1]
    v_pk_fma_f32 v[80:81], v[232:233], v[32:33], v[80:81] op_sel:[1,0,0] op_sel_hi:[1,1,1]
    v_pk_fma_f32 v[32:33], v[232:233], v[32:33], v[244:245] op_sel_hi:[0,1,1] neg_lo:[0,0,1] neg_hi:[0,0,1]
    v_pk_mul_f32 v[248:249], v[232:233], v[82:83] op_sel:[1,0] op_sel_hi:[1,1]
    v_pk_mul_f32 v[82:83], v[232:233], v[82:83] op_sel_hi:[0,1]
    v_pk_fma_f32 v[82:83], v[232:233], v[34:35], v[82:83] op_sel:[1,0,0] op_sel_hi:[1,1,1]
    v_pk_fma_f32 v[34:35], v[232:233], v[34:35], v[248:249] op_sel_hi:[0,1,1] neg_lo:[0,0,1] neg_hi:[0,0,1]
    v_pk_mul_f32 v[244:245], v[232:233], v[84:85] op_sel:[1,0] op_sel_hi:[1,1]
    v_pk_mul_f32 v[84:85], v[232:233], v[84:85] op_sel_hi:[0,1]
    v_pk_fma_f32 v[84:85], v[232:233], v[36:37], v[84:85] op_sel:[1,0,0] op_sel_hi:[1,1,1]
    v_pk_fma_f32 v[36:37], v[232:233], v[36:37], v[244:245] op_sel_hi:[0,1,1] neg_lo:[0,0,1] neg_hi:[0,0,1]
    v_pk_mul_f32 v[248:249], v[232:233], v[86:87] op_sel:[1,0] op_sel_hi:[1,1]
    v_pk_mul_f32 v[86:87], v[232:233], v[86:87] op_sel_hi:[0,1]
    v_pk_fma_f32 v[86:87], v[232:233], v[38:39], v[86:87] op_sel:[1,0,0] op_sel_hi:[1,1,1]
    v_pk_fma_f32 v[38:39], v[232:233], v[38:39], v[248:249] op_sel_hi:[0,1,1] neg_lo:[0,0,1] neg_hi:[0,0,1]
    v_pk_mul_f32 v[244:245], v[232:233], v[88:89] op_sel:[1,0] op_sel_hi:[1,1]
    v_pk_mul_f32 v[88:89], v[232:233], v[88:89] op_sel_hi:[0,1]
    v_pk_fma_f32 v[88:89], v[232:233], v[40:41], v[88:89] op_sel:[1,0,0] op_sel_hi:[1,1,1]
    v_pk_fma_f32 v[40:41], v[232:233], v[40:41], v[244:245] op_sel_hi:[0,1,1] neg_lo:[0,0,1] neg_hi:[0,0,1]
    v_pk_mul_f32 v[248:249], v[232:233], v[90:91] op_sel:[1,0] op_sel_hi:[1,1]
    v_pk_mul_f32 v[90:91], v[232:233], v[90:91] op_sel_hi:[0,1]
    v_pk_fma_f32 v[90:91], v[232:233], v[42:43], v[90:91] op_sel:[1,0,0] op_sel_hi:[1,1,1]
    v_pk_fma_f32 v[42:43], v[232:233], v[42:43], v[248:249] op_sel_hi:[0,1,1] neg_lo:[0,0,1] neg_hi:[0,0,1]
    v_pk_mul_f32 v[244:245], v[232:233], v[92:93] op_sel:[1,0] op_sel_hi:[1,1]
    v_pk_mul_f32 v[92:93], v[232:233], v[92:93] op_sel_hi:[0,1]
    v_pk_fma_f32 v[92:93], v[232:233], v[44:45], v[92:93] op_sel:[1,0,0] op_sel_hi:[1,1,1]
    v_pk_fma_f32 v[44:45], v[232:233], v[44:45], v[244:245] op_sel_hi:[0,1,1] neg_lo:[0,0,1] neg_hi:[0,0,1]
    v_pk_mul_f32 v[248:249], v[232:233], v[94:95] op_sel:[1,0] op_sel_hi:[1,1]
    v_pk_mul_f32 v[94:95], v[232:233], v[94:95] op_sel_hi:[0,1]
    v_pk_fma_f32 v[94:95], v[232:233], v[46:47], v[94:95] op_sel:[1,0,0] op_sel_hi:[1,1,1]
    v_pk_fma_f32 v[46:47], v[232:233], v[46:47], v[248:249] op_sel_hi:[0,1,1] neg_lo:[0,0,1] neg_hi:[0,0,1]
    s_cmp_lt_u32 s3, 2
    s_cbranch_scc0 LS_nc_48
    v_accvgpr_read_b32 v136, a246
    v_accvgpr_read_b32 v137, a247
    v_accvgpr_read_b32 v138, a248
    v_accvgpr_read_b32 v139, a249
    s_mov_b32 s87, 0
    s_waitcnt vmcnt(6)
    s_branch LS_ck_50
LS_rt_49:
    s_mov_b32 s13, 144384
    s_bfe_i32 exec_lo, s36, 65536
    s_bfe_i32 exec_hi, s36, 65544
    buffer_load_dwordx4 v[198:201], v238, s[68:71], s13 offen sc1
    s_mov_b32 s13, 133120
    s_bfe_i32 exec_lo, s36, 65537
    s_bfe_i32 exec_hi, s36, 65545
    buffer_load_dwordx4 v[202:205], v238, s[68:71], s13 offen sc1
    s_mov_b32 s13, 121856
    s_bfe_i32 exec_lo, s36, 65538
    s_bfe_i32 exec_hi, s36, 65546
    buffer_load_dwordx4 v[206:209], v238, s[68:71], s13 offen sc1
    s_mov_b32 s13, 110592
    s_bfe_i32 exec_lo, s36, 65539
    s_bfe_i32 exec_hi, s36, 65547
    buffer_load_dwordx4 v[210:213], v238, s[68:71], s13 offen sc1
    s_mov_b32 s13, 99328
    s_bfe_i32 exec_lo, s36, 65540
    s_bfe_i32 exec_hi, s36, 65548
    buffer_load_dwordx4 v[166:169], v238, s[68:71], s13 offen sc1
    s_mov_b32 s13, 88064
    s_bfe_i32 exec_lo, s36, 65541
    s_bfe_i32 exec_hi, s36, 65549
    buffer_load_dwordx4 v[170:173], v238, s[68:71], s13 offen sc1
    s_mov_b32 s13, 76800
    s_bfe_i32 exec_lo, s36, 65542
    s_bfe_i32 exec_hi, s36, 65550
    buffer_load_dwordx4 v[190:193], v238, s[68:71], s13 offen sc1
    s_mov_b32 s13, 65536
    s_bfe_i32 exec_lo, s36, 65543
    s_bfe_i32 exec_hi, s36, 65551
    buffer_load_dwordx4 v[240:243], v238, s[68:71], s13 offen sc1
    s_mov_b64 exec, -1
    s_waitcnt vmcnt(0)
LS_ck_50:
    v_cmp_eq_u64 vcc, s[88:89], v[200:201]
    v_cmp_eq_u64 s[98:99], s[88:89], v[204:205]
    s_nop 1
    s_and_b64 s[96:97], s[98:99], vcc
    v_cmp_eq_u64 vcc, s[88:89], v[208:209]
    v_cmp_eq_u64 s[98:99], s[88:89], v[212:213]
    s_nop 0
    s_and_b64 s[96:97], s[96:97], vcc
    s_and_b64 s[96:97], s[96:97], s[98:99]
    v_cmp_eq_u64 vcc, s[88:89], v[168:169]
    v_cmp_eq_u64 s[98:99], s[88:89], v[172:173]
    s_nop 0
    s_and_b64 s[96:97], s[96:97], vcc
    s_and_b64 s[96:97], s[96:97], s[98:99]
    v_cmp_eq_u64 vcc, s[88:89], v[192:193]
    v_cmp_eq_u64 s[98:99], s[88:89], v[242:243]
    s_nop 0
    s_and_b64 s[96:97], s[96:97], vcc
    s_and_b64 s[96:97], s[96:97], s[98:99]
    s_cmp_eq_u64 s[96:97], -1
    s_cbranch_scc1 LS_ok_51
    s_add_u32 s87, s87, 1
    s_cmp_lt_u32 s87, 40000
    s_cbranch_scc1 LS_rt_49
LS_ok_51:
    v_fma_f32 v198, v236, v202, v198
    v_fma_f32 v199, v236, v203, v199
    v_fma_f32 v206, v236, v210, v206
    v_fma_f32 v207, v236, v211, v207
    v_fma_f32 v166, v236, v170, v166
    v_fma_f32 v167, v236, v171, v167
    v_fma_f32 v190, v236, v240, v190
    v_fma_f32 v191, v236, v241, v191
    v_fma_f32 v198, -v237, v203, v198
    v_fma_f32 v199, v237, v202, v199
    v_fma_f32 v206, -v237, v211, v206
    v_fma_f32 v207, v237, v210, v207
    v_fma_f32 v166, -v237, v171, v166
    v_fma_f32 v167, v237, v170, v167
    v_fma_f32 v190, -v237, v241, v190
    v_fma_f32 v191, v237, v240, v191
    v_fma_f32 v198, v136, v206, v198
    v_fma_f32 v199, v136, v207, v199
    v_fma_f32 v166, v136, v190, v166
    v_fma_f32 v167, v136, v191, v167
    v_fma_f32 v198, -v137, v207, v198
    v_fma_f32 v199, v137, v206, v199
    v_fma_f32 v166, -v137, v191, v166
    v_fma_f32 v167, v137, v190, v167
    v_fma_f32 v198, v138, v166, v198
    v_fma_f32 v199, v138, v167, v199
    v_fma_f32 v198, -v139, v167, v198
    v_fma_f32 v199, v139, v166, v199
    v_mov_b32 v142, v198
    v_mov_b32 v143, v199
    s_nop 0
    v_permlane32_swap_b32 v198, v142
    v_permlane32_swap_b32 v199, v143
    v_fma_f32 v198, v174, v142, v198
    v_fma_f32 v199, v174, v143, v199
    v_fma_f32 v198, -v175, v143, v198
    v_fma_f32 v199, v175, v142, v199
    ds_write_b64 v177, v[198:199] offset:6144
LS_nc_48:
    s_waitcnt lgkmcnt(0)
    s_barrier
    s_cmp_eq_u32 s3, 2
    s_cbranch_scc0 LS_np_52
    s_mov_b32 s13, 144384
    s_bfe_i32 exec_lo, s36, 65536
    s_bfe_i32 exec_hi, s36, 65544
    buffer_load_dwordx4 v[198:201], v238, s[68:71], s13 offen sc1
    s_mov_b32 s13, 133120
    s_bfe_i32 exec_lo, s36, 65537
    s_bfe_i32 exec_hi, s36, 65545
    buffer_load_dwordx4 v[202:205], v238, s[68:71], s13 offen sc1
    s_mov_b32 s13, 121856
    s_bfe_i32 exec_lo, s36, 65538
    s_bfe_i32 exec_hi, s36, 65546
    buffer_load_dwordx4 v[206:209], v238, s[68:71], s13 offen sc1
    s_mov_b32 s13, 110592
    s_bfe_i32 exec_lo, s36, 65539
    s_bfe_i32 exec_hi, s36, 65547
    buffer_load_dwordx4 v[210:213], v238, s[68:71], s13 offen sc1
    s_mov_b32 s13, 99328
    s_bfe_i32 exec_lo, s36, 65540
    s_bfe_i32 exec_hi, s36, 65548
    buffer_load_dwordx4 v[166:169], v238, s[68:71], s13 offen sc1
    s_mov_b32 s13, 88064
    s_bfe_i32 exec_lo, s36, 65541
    s_bfe_i32 exec_hi, s36, 65549
    buffer_load_dwordx4 v[170:173], v238, s[68:71], s13 offen sc1
    s_mov_b32 s13, 76800
    s_bfe_i32 exec_lo, s36, 65542
    s_bfe_i32 exec_hi, s36, 65550
    buffer_load_dwordx4 v[190:193], v238, s[68:71], s13 offen sc1
    s_mov_b32 s13, 65536
    s_bfe_i32 exec_lo, s36, 65543
    s_bfe_i32 exec_hi, s36, 65551
    buffer_load_dwordx4 v[240:243], v238, s[68:71], s13 offen sc1
    s_mov_b64 exec, -1
LS_np_52:
    ds_read_b64 v[100:101], v176 offset:0
    ds_read_b64 v[102:103], v250 offset:0
    ds_read_b64 v[108:109], v176 offset:256
    ds_read_b64 v[110:111], v250 offset:256
    s_waitcnt lgkmcnt(0)
    v_fma_f32 v100, v148, v102, v100
    v_fma_f32 v101, v148, v103, v101
    v_fma_f32 v108, v150, v110, v108
    v_fma_f32 v109, v150, v111, v109
    v_fma_f32 v100, -v149, v103, v100
    v_fma_f32 v101, v149, v102, v101
    v_fma_f32 v108, -v151, v111, v108
    v_fma_f32 v109, v151, v110, v109
    v_fma_f32 v97, v222, v100, v96
    v_fma_f32 v99, v222, v101, v98
    v_fma_f32 v97, -v223, v101, v97
    v_fma_f32 v99, v223, v100, v99
    v_fma_f32 v105, v224, v108, v104
    v_fma_f32 v107, v224, v109, v106
    v_fma_f32 v105, -v225, v109, v105
    v_fma_f32 v107, v225, v108, v107
    v_mov_b32 v96, v100
    v_mov_b32 v98, v101
    v_mov_b32 v104, v108
    v_mov_b32 v106, v109
    v_pk_mul_f32 v[120:121], v[228:229], v[96:97] op_sel_hi:[0,1]
    v_pk_mul_f32 v[122:123], v[228:229], v[98:99] op_sel_hi:[0,1]
    v_pk_mul_f32 v[124:125], v[230:231], v[104:105] op_sel_hi:[0,1]
    v_pk_mul_f32 v[126:127], v[230:231], v[106:107] op_sel_hi:[0,1]
    v_pk_fma_f32 v[120:121], v[228:229], v[98:99], v[120:121] op_sel:[1,0,0] op_sel_hi:[1,1,1] neg_lo:[1,0,0] neg_hi:[1,0,0]
    v_pk_fma_f32 v[122:123], v[228:229], v[96:97], v[122:123] op_sel:[1,0,0] op_sel_hi:[1,1,1]
    v_pk_fma_f32 v[124:125], v[230:231], v[106:107], v[124:125] op_sel:[1,0,0] op_sel_hi:[1,1,1] neg_lo:[1,0,0] neg_hi:[1,0,0]
    v_pk_fma_f32 v[126:127], v[230:231], v[104:105], v[126:127] op_sel:[1,0,0] op_sel_hi:[1,1,1]
    v_pk_fma_f32 v[0:1], v[216:217], v[122:123], v[0:1] op_sel:[1,0,0] op_sel_hi:[1,1,1] neg_lo:[1,0,0] neg_hi:[1,0,0]
    v_pk_fma_f32 v[48:49], v[216:217], v[120:121], v[48:49] op_sel:[1,0,0] op_sel_hi:[1,1,1]
    v_pk_fma_f32 v[16:17], v[218:219], v[126:127], v[16:17] op_sel:[1,0,0] op_sel_hi:[1,1,1] neg_lo:[1,0,0] neg_hi:[1,0,0]
    v_pk_fma_f32 v[64:65], v[218:219], v[124:125], v[64:65] op_sel:[1,0,0] op_sel_hi:[1,1,1]
    v_pk_fma_f32 v[0:1], v[216:217], v[120:121], v[0:1] op_sel_hi:[0,1,1]
    v_pk_fma_f32 v[48:49], v[216:217], v[122:123], v[48:49] op_sel_hi:[0,1,1]
    v_pk_fma_f32 v[16:17], v[218:219], v[124:125], v[16:17] op_sel_hi:[0,1,1]
    v_pk_fma_f32 v[64:65], v[218:219], v[126:127], v[64:65] op_sel_hi:[0,1,1]
    v_pk_fma_f32 v[2:3], v[216:217], v[48:49], v[2:3] op_sel:[1,0,0] op_sel_hi:[1,1,1] neg_lo:[1,0,0] neg_hi:[1,0,0]
    v_pk_fma_f32 v[50:51], v[216:217], v[0:1], v[50:51] op_sel:[1,0,0] op_sel_hi:[1,1,1]
    v_pk_fma_f32 v[18:19], v[218:219], v[64:65], v[18:19] op_sel:[1,0,0] op_sel_hi:[1,1,1] neg_lo:[1,0,0] neg_hi:[1,0,0]
    v_pk_fma_f32 v[66:67], v[218:219], v[16:17], v[66:67] op_sel:[1,0,0] op_sel_hi:[1,1,1]
    v_pk_fma_f32 v[2:3], v[216:217], v[0:1], v[2:3] op_sel_hi:[0,1,1]
    v_pk_fma_f32 v[50:51], v[216:217], v[48:49], v[50:51] op_sel_hi:[0,1,1]
    v_pk_fma_f32 v[18:19], v[218:219], v[16:17], v[18:19] op_sel_hi:[0,1,1]
    v_pk_fma_f32 v[66:67], v[218:219], v[64:65], v[66:67] op_sel_hi:[0,1,1]
    v_pk_fma_f32 v[4:5], v[216:217], v[50:51], v[4:5] op_sel:[1,0,0] op_sel_hi:[1,1,1] neg_lo:[1,0,0] neg_hi:[1,0,0]
    v_pk_fma_f32 v[52:53], v[216:217], v[2:3], v[52:53] op_sel:[1,0,0] op_sel_hi:[1,1,1]
    v_pk_fma_f32 v[20:21], v[218:219], v[66:67], v[20:21] op_sel:[1,0,0] op_sel_hi:[1,1,1] neg_lo:[1,0,0] neg_hi:[1,0,0]
    v_pk_fma_f32 v[68:69], v[218:219], v[18:19], v[68:69] op_sel:[1,0,0] op_sel_hi:[1,1,1]
    v_pk_fma_f32 v[4:5], v[216:217], v[2:3], v[4:5] op_sel_hi:[0,1,1]
    v_pk_fma_f32 v[52:53], v[216:217], v[50:51], v[52:53] op_sel_hi:[0,1,1]
    v_pk_fma_f32 v[20:21], v[218:219], v[18:19], v[20:21] op_sel_hi:[0,1,1]
    v_pk_fma_f32 v[68:69], v[218:219], v[66:67], v[68:69] op_sel_hi:[0,1,1]
    v_pk_fma_f32 v[6:7], v[216:217], v[52:53], v[6:7] op_sel:[1,0,0] op_sel_hi:[1,1,1] neg_lo:[1,0,0] neg_hi:[1,0,0]
    v_pk_fma_f32 v[54:55], v[216:217], v[4:5], v[54:55] op_sel:[1,0,0] op_sel_hi:[1,1,1]
    v_pk_fma_f32 v[22:23], v[218:219], v[68:69], v[22:23] op_sel:[1,0,0] op_sel_hi:[1,1,1] neg_lo:[1,0,0] neg_hi:[1,0,0]
    v_pk_fma_f32 v[70:71], v[218:219], v[20:21], v[70:71] op_sel:[1,0,0] op_sel_hi:[1,1,1]
    v_pk_fma_f32 v[6:7], v[216:217], v[4:5], v[6:7] op_sel_hi:[0,1,1]
    v_pk_fma_f32 v[54:55], v[216:217], v[52:53], v[54:55] op_sel_hi:[0,1,1]
    v_pk_fma_f32 v[22:23], v[218:219], v[20:21], v[22:23] op_sel_hi:[0,1,1]
    v_pk_fma_f32 v[70:71], v[218:219], v[68:69], v[70:71] op_sel_hi:[0,1,1]
    v_pk_fma_f32 v[8:9], v[216:217], v[54:55], v[8:9] op_sel:[1,0,0] op_sel_hi:[1,1,1] neg_lo:[1,0,0] neg_hi:[1,0,0]
    v_pk_fma_f32 v[56:57], v[216:217], v[6:7], v[56:57] op_sel:[1,0,0] op_sel_hi:[1,1,1]
    v_pk_fma_f32 v[24:25], v[218:219], v[70:71], v[24:25] op_sel:[1,0,0] op_sel_hi:[1,1,1] neg_lo:[1,0,0] neg_hi:[1,0,0]
    v_pk_fma_f32 v[72:73], v[218:219], v[22:23], v[72:73] op_sel:[1,0,0] op_sel_hi:[1,1,1]
    v_pk_fma_f32 v[8:9], v[216:217], v[6:7], v[8:9] op_sel_hi:[0,1,1]
    v_pk_fma_f32 v[56:57], v[216:217], v[54:55], v[56:57] op_sel_hi:[0,1,1]
    v_pk_fma_f32 v[24:25], v[218:219], v[22:23], v[24:25] op_sel_hi:[0,1,1]
    v_pk_fma_f32 v[72:73], v[218:219], v[70:71], v[72:73] op_sel_hi:[0,1,1]
    v_pk_fma_f32 v[10:11], v[216:217], v[56:57], v[10:11] op_sel:[1,0,0] op_sel_hi:[1,1,1] neg_lo:[1,0,0] neg_hi:[1,0,0]
    v_pk_fma_f32 v[58:59], v[216:217], v[8:9], v[58:59] op_sel:[1,0,0] op_sel_hi:[1,1,1]
    v_pk_fma_f32 v[26:27], v[218:219], v[72:73], v[26:27] op_sel:[1,0,0] op_sel_hi:[1,1,1] neg_lo:[1,0,0] neg_hi:[1,0,0]
    v_pk_fma_f32 v[74:75], v[218:219], v[24:25], v[74:75] op_sel:[1,0,0] op_sel_hi:[1,1,1]
    v_pk_fma_f32 v[10:11], v[216:217], v[8:9], v[10:11] op_sel_hi:[0,1,1]
    v_pk_fma_f32 v[58:59], v[216:217], v[56:57], v[58:59] op_sel_hi:[0,1,1]
    v_pk_fma_f32 v[26:27], v[218:219], v[24:25], v[26:27] op_sel_hi:[0,1,1]
    v_pk_fma_f32 v[74:75], v[218:219], v[72:73], v[74:75] op_sel_hi:[0,1,1]
    v_pk_fma_f32 v[12:13], v[216:217], v[58:59], v[12:13] op_sel:[1,0,0] op_sel_hi:[1,1,1] neg_lo:[1,0,0] neg_hi:[1,0,0]
    v_pk_fma_f32 v[60:61], v[216:217], v[10:11], v[60:61] op_sel:[1,0,0] op_sel_hi:[1,1,1]
    v_pk_fma_f32 v[28:29], v[218:219], v[74:75], v[28:29] op_sel:[1,0,0] op_sel_hi:[1,1,1] neg_lo:[1,0,0] neg_hi:[1,0,0]
    v_pk_fma_f32 v[76:77], v[218:219], v[26:27], v[76:77] op_sel:[1,0,0] op_sel_hi:[1,1,1]
    v_pk_fma_f32 v[12:13], v[216:217], v[10:11], v[12:13] op_sel_hi:[0,1,1]
    v_pk_fma_f32 v[60:61], v[216:217], v[58:59], v[60:61] op_sel_hi:[0,1,1]
    v_pk_fma_f32 v[28:29], v[218:219], v[26:27], v[28:29] op_sel_hi:[0,1,1]
    v_pk_fma_f32 v[76:77], v[218:219], v[74:75], v[76:77] op_sel_hi:[0,1,1]
    v_pk_fma_f32 v[14:15], v[216:217], v[60:61], v[14:15] op_sel:[1,0,0] op_sel_hi:[1,1,1] neg_lo:[1,0,0] neg_hi:[1,0,0]
    v_pk_fma_f32 v[62:63], v[216:217], v[12:13], v[62:63] op_sel:[1,0,0] op_sel_hi:[1,1,1]
    v_pk_fma_f32 v[30:31], v[218:219], v[76:77], v[30:31] op_sel:[1,0,0] op_sel_hi:[1,1,1] neg_lo:[1,0,0] neg_hi:[1,0,0]
    v_pk_fma_f32 v[78:79], v[218:219], v[28:29], v[78:79] op_sel:[1,0,0] op_sel_hi:[1,1,1]
    v_pk_fma_f32 v[14:15], v[216:217], v[12:13], v[14:15] op_sel_hi:[0,1,1]
    v_pk_fma_f32 v[62:63], v[216:217], v[60:61], v[62:63] op_sel_hi:[0,1,1]
    v_pk_fma_f32 v[30:31], v[218:219], v[28:29], v[30:31] op_sel_hi:[0,1,1]
    v_pk_fma_f32 v[78:79], v[218:219], v[76:77], v[78:79] op_sel_hi:[0,1,1]
    v_cvt_pk_bf16_f32 v0, v0, v1
    v_cvt_pk_bf16_f32 v1, v2, v3
    ds_write_b64 v186, v[0:1]
    v_cvt_pk_bf16_f32 v4, v4, v5
    v_cvt_pk_bf16_f32 v5, v6, v7
    ds_write_b64 v187, v[4:5]
    v_cvt_pk_bf16_f32 v8, v8, v9
    v_cvt_pk_bf16_f32 v9, v10, v11
    ds_write_b64 v188, v[8:9]
    v_cvt_pk_bf16_f32 v12, v12, v13
    v_cvt_pk_bf16_f32 v13, v14, v15
    ds_write_b64 v189, v[12:13]
    ds_read_b64_tr_b16 v[96:97], v184 offset:0
    ds_read_b64_tr_b16 v[98:99], v185 offset:0
    ds_read_b64_tr_b16 v[100:101], v184 offset:1024
    ds_read_b64_tr_b16 v[102:103], v185 offset:1024
    v_cvt_pk_bf16_f32 v16, v16, v17
    v_cvt_pk_bf16_f32 v17, v18, v19
    ds_write_b64 v186, v[16:17]
    v_cvt_pk_bf16_f32 v20, v20, v21
    v_cvt_pk_bf16_f32 v21, v22, v23
    ds_write_b64 v187, v[20:21]
    v_cvt_pk_bf16_f32 v24, v24, v25
    v_cvt_pk_bf16_f32 v25, v26, v27
    ds_write_b64 v188, v[24:25]
    v_cvt_pk_bf16_f32 v28, v28, v29
    v_cvt_pk_bf16_f32 v29, v30, v31
    ds_write_b64 v189, v[28:29]
    ds_read_b64_tr_b16 v[104:105], v184 offset:0
    ds_read_b64_tr_b16 v[106:107], v185 offset:0
    ds_read_b64_tr_b16 v[108:109], v184 offset:1024
    ds_read_b64_tr_b16 v[110:111], v185 offset:1024
    s_waitcnt lgkmcnt(8)
    buffer_store_dwordx4 v[96:99], v147, s[68:71], s40 offen offset:0 sc1
    buffer_store_dwordx4 v[100:103], v147, s[68:71], s40 offen offset:1024 sc1
    v_cvt_pk_bf16_f32 v48, -v48, -v49
    v_cvt_pk_bf16_f32 v49, -v50, -v51
    ds_write_b64 v186, v[48:49]
    v_cvt_pk_bf16_f32 v52, -v52, -v53
    v_cvt_pk_bf16_f32 v53, -v54, -v55
    ds_write_b64 v187, v[52:53]
    v_cvt_pk_bf16_f32 v56, -v56, -v57
    v_cvt_pk_bf16_f32 v57, -v58, -v59
    ds_write_b64 v188, v[56:57]
    v_cvt_pk_bf16_f32 v60, -v60, -v61
    v_cvt_pk_bf16_f32 v61, -v62, -v63
    ds_write_b64 v189, v[60:61]
    ds_read_b64_tr_b16 v[120:121], v184 offset:0
    ds_read_b64_tr_b16 v[122:123], v185 offset:0
    ds_read_b64_tr_b16 v[124:125], v184 offset:1024
    ds_read_b64_tr_b16 v[126:127], v185 offset:1024
    s_waitcnt lgkmcnt(8)
    buffer_store_dwordx4 v[104:107], v147, s[68:71], s41 offen offset:0 sc1
    buffer_store_dwordx4 v[108:111], v147, s[68:71], s41 offen offset:1024 sc1
    v_cvt_pk_bf16_f32 v64, -v64, -v65
    v_cvt_pk_bf16_f32 v65, -v66, -v67
    ds_write_b64 v186, v[64:65]
    v_cvt_pk_bf16_f32 v68, -v68, -v69
    v_cvt_pk_bf16_f32 v69, -v70, -v71
    ds_write_b64 v187, v[68:69]
    v_cvt_pk_bf16_f32 v72, -v72, -v73
    v_cvt_pk_bf16_f32 v73, -v74, -v75
    ds_write_b64 v188, v[72:73]
    v_cvt_pk_bf16_f32 v76, -v76, -v77
    v_cvt_pk_bf16_f32 v77, -v78, -v79
    ds_write_b64 v189, v[76:77]
    ds_read_b64_tr_b16 v[128:129], v184 offset:0
    ds_read_b64_tr_b16 v[130:131], v185 offset:0
    ds_read_b64_tr_b16 v[132:133], v184 offset:1024
    ds_read_b64_tr_b16 v[134:135], v185 offset:1024
    s_waitcnt lgkmcnt(8)
    buffer_store_dwordx4 v[120:123], v147, s[68:71], s43 offen offset:0 sc1
    buffer_store_dwordx4 v[124:127], v147, s[68:71], s43 offen offset:1024 sc1
    s_waitcnt lgkmcnt(0)
    buffer_store_dwordx4 v[128:131], v147, s[68:71], s46 offen offset:0 sc1
    buffer_store_dwordx4 v[132:135], v147, s[68:71], s46 offen offset:1024 sc1
    s_waitcnt vmcnt(20)
    s_cmp_eq_u32 s3, 2
    s_cbranch_scc0 LS_nc_53
    v_accvgpr_read_b32 v136, a246
    v_accvgpr_read_b32 v137, a247
    v_accvgpr_read_b32 v138, a248
    v_accvgpr_read_b32 v139, a249
    s_mov_b32 s87, 0
    s_waitcnt vmcnt(8)
    s_branch LS_ck_55
LS_rt_54:
    s_mov_b32 s13, 144384
    s_bfe_i32 exec_lo, s36, 65536
    s_bfe_i32 exec_hi, s36, 65544
    buffer_load_dwordx4 v[198:201], v238, s[68:71], s13 offen sc1
    s_mov_b32 s13, 133120
    s_bfe_i32 exec_lo, s36, 65537
    s_bfe_i32 exec_hi, s36, 65545
    buffer_load_dwordx4 v[202:205], v238, s[68:71], s13 offen sc1
    s_mov_b32 s13, 121856
    s_bfe_i32 exec_lo, s36, 65538
    s_bfe_i32 exec_hi, s36, 65546
    buffer_load_dwordx4 v[206:209], v238, s[68:71], s13 offen sc1
    s_mov_b32 s13, 110592
    s_bfe_i32 exec_lo, s36, 65539
    s_bfe_i32 exec_hi, s36, 65547
    buffer_load_dwordx4 v[210:213], v238, s[68:71], s13 offen sc1
    s_mov_b32 s13, 99328
    s_bfe_i32 exec_lo, s36, 65540
    s_bfe_i32 exec_hi, s36, 65548
    buffer_load_dwordx4 v[166:169], v238, s[68:71], s13 offen sc1
    s_mov_b32 s13, 88064
    s_bfe_i32 exec_lo, s36, 65541
    s_bfe_i32 exec_hi, s36, 65549
    buffer_load_dwordx4 v[170:173], v238, s[68:71], s13 offen sc1
    s_mov_b32 s13, 76800
    s_bfe_i32 exec_lo, s36, 65542
    s_bfe_i32 exec_hi, s36, 65550
    buffer_load_dwordx4 v[190:193], v238, s[68:71], s13 offen sc1
    s_mov_b32 s13, 65536
    s_bfe_i32 exec_lo, s36, 65543
    s_bfe_i32 exec_hi, s36, 65551
    buffer_load_dwordx4 v[240:243], v238, s[68:71], s13 offen sc1
    s_mov_b64 exec, -1
    s_waitcnt vmcnt(0)
LS_ck_55:
    v_cmp_eq_u64 vcc, s[88:89], v[200:201]
    v_cmp_eq_u64 s[98:99], s[88:89], v[204:205]
    s_nop 1
    s_and_b64 s[96:97], s[98:99], vcc
    v_cmp_eq_u64 vcc, s[88:89], v[208:209]
    v_cmp_eq_u64 s[98:99], s[88:89], v[212:213]
    s_nop 0
    s_and_b64 s[96:97], s[96:97], vcc
    s_and_b64 s[96:97], s[96:97], s[98:99]
    v_cmp_eq_u64 vcc, s[88:89], v[168:169]
    v_cmp_eq_u64 s[98:99], s[88:89], v[172:173]
    s_nop 0
    s_and_b64 s[96:97], s[96:97], vcc
    s_and_b64 s[96:97], s[96:97], s[98:99]
    v_cmp_eq_u64 vcc, s[88:89], v[192:193]
    v_cmp_eq_u64 s[98:99], s[88:89], v[242:243]
    s_nop 0
    s_and_b64 s[96:97], s[96:97], vcc
    s_and_b64 s[96:97], s[96:97], s[98:99]
    s_cmp_eq_u64 s[96:97], -1
    s_cbranch_scc1 LS_ok_56
    s_add_u32 s87, s87, 1
    s_cmp_lt_u32 s87, 40000
    s_cbranch_scc1 LS_rt_54
LS_ok_56:
    v_fma_f32 v198, v236, v202, v198
    v_fma_f32 v199, v236, v203, v199
    v_fma_f32 v206, v236, v210, v206
    v_fma_f32 v207, v236, v211, v207
    v_fma_f32 v166, v236, v170, v166
    v_fma_f32 v167, v236, v171, v167
    v_fma_f32 v190, v236, v240, v190
    v_fma_f32 v191, v236, v241, v191
    v_fma_f32 v198, -v237, v203, v198
    v_fma_f32 v199, v237, v202, v199
    v_fma_f32 v206, -v237, v211, v206
    v_fma_f32 v207, v237, v210, v207
    v_fma_f32 v166, -v237, v171, v166
    v_fma_f32 v167, v237, v170, v167
    v_fma_f32 v190, -v237, v241, v190
    v_fma_f32 v191, v237, v240, v191
    v_fma_f32 v198, v136, v206, v198
    v_fma_f32 v199, v136, v207, v199
    v_fma_f32 v166, v136, v190, v166
    v_fma_f32 v167, v136, v191, v167
    v_fma_f32 v198, -v137, v207, v198
    v_fma_f32 v199, v137, v206, v199
    v_fma_f32 v166, -v137, v191, v166
    v_fma_f32 v167, v137, v190, v167
    v_fma_f32 v198, v138, v166, v198
    v_fma_f32 v199, v138, v167, v199
    v_fma_f32 v198, -v139, v167, v198
    v_fma_f32 v199, v139, v166, v199
    v_mov_b32 v142, v198
    v_mov_b32 v143, v199
    s_nop 0
    v_permlane32_swap_b32 v198, v142
    v_permlane32_swap_b32 v199, v143
    v_fma_f32 v198, v174, v142, v198
    v_fma_f32 v199, v174, v143, v199
    v_fma_f32 v198, -v175, v143, v198
    v_fma_f32 v199, v175, v142, v199
    ds_write_b64 v177, v[198:199] offset:6144
LS_nc_53:
    s_waitcnt lgkmcnt(0)
    s_barrier
    ds_read_b64 v[116:117], v176 offset:512
    ds_read_b64 v[118:119], v250 offset:512
    buffer_load_dwordx4 v[190:193], v239, s[68:71], s31 offen sc1
    v_mov_b32 v198, s88
    v_mov_b32 v199, s89
    v_mov_b32 v200, s88
    v_mov_b32 v201, s89
    s_or_b32 s13, s16, s17
    s_waitcnt lgkmcnt(0)
    v_fma_f32 v116, v152, v118, v116
    v_fma_f32 v117, v152, v119, v117
    v_fma_f32 v116, -v153, v119, v116
    v_fma_f32 v117, v153, v118, v117
    v_fma_f32 v113, v226, v116, v112
    v_fma_f32 v115, v226, v117, v114
    v_fma_f32 v113, -v227, v117, v113
    v_fma_f32 v115, v227, v116, v115
    v_mov_b32 v112, v116
    v_mov_b32 v114, v117
    v_pk_mul_f32 v[0:1], v[232:233], v[112:113] op_sel_hi:[0,1]
    v_pk_mul_f32 v[2:3], v[232:233], v[114:115] op_sel_hi:[0,1]
    v_pk_fma_f32 v[0:1], v[232:233], v[114:115], v[0:1] op_sel:[1,0,0] op_sel_hi:[1,1,1] neg_lo:[1,0,0] neg_hi:[1,0,0]
    v_pk_fma_f32 v[2:3], v[232:233], v[112:113], v[2:3] op_sel:[1,0,0] op_sel_hi:[1,1,1]
    v_pk_fma_f32 v[32:33], v[220:221], v[2:3], v[32:33] op_sel:[1,0,0] op_sel_hi:[1,1,1] neg_lo:[1,0,0] neg_hi:[1,0,0]
    v_pk_fma_f32 v[80:81], v[220:221], v[0:1], v[80:81] op_sel:[1,0,0] op_sel_hi:[1,1,1]
    v_pk_fma_f32 v[32:33], v[220:221], v[0:1], v[32:33] op_sel_hi:[0,1,1]
    v_pk_fma_f32 v[80:81], v[220:221], v[2:3], v[80:81] op_sel_hi:[0,1,1]
    v_pk_fma_f32 v[34:35], v[220:221], v[80:81], v[34:35] op_sel:[1,0,0] op_sel_hi:[1,1,1] neg_lo:[1,0,0] neg_hi:[1,0,0]
    v_pk_fma_f32 v[82:83], v[220:221], v[32:33], v[82:83] op_sel:[1,0,0] op_sel_hi:[1,1,1]
    v_pk_fma_f32 v[34:35], v[220:221], v[32:33], v[34:35] op_sel_hi:[0,1,1]
    v_pk_fma_f32 v[82:83], v[220:221], v[80:81], v[82:83] op_sel_hi:[0,1,1]
    v_pk_fma_f32 v[36:37], v[220:221], v[82:83], v[36:37] op_sel:[1,0,0] op_sel_hi:[1,1,1] neg_lo:[1,0,0] neg_hi:[1,0,0]
    v_pk_fma_f32 v[84:85], v[220:221], v[34:35], v[84:85] op_sel:[1,0,0] op_sel_hi:[1,1,1]
    v_pk_fma_f32 v[36:37], v[220:221], v[34:35], v[36:37] op_sel_hi:[0,1,1]
    v_pk_fma_f32 v[84:85], v[220:221], v[82:83], v[84:85] op_sel_hi:[0,1,1]
    v_pk_fma_f32 v[38:39], v[220:221], v[84:85], v[38:39] op_sel:[1,0,0] op_sel_hi:[1,1,1] neg_lo:[1,0,0] neg_hi:[1,0,0]
    v_pk_fma_f32 v[86:87], v[220:221], v[36:37], v[86:87] op_sel:[1,0,0] op_sel_hi:[1,1,1]
    v_pk_fma_f32 v[38:39], v[220:221], v[36:37], v[38:39] op_sel_hi:[0,1,1]
    v_pk_fma_f32 v[86:87], v[220:221], v[84:85], v[86:87] op_sel_hi:[0,1,1]
    v_pk_fma_f32 v[40:41], v[220:221], v[86:87], v[40:41] op_sel:[1,0,0] op_sel_hi:[1,1,1] neg_lo:[1,0,0] neg_hi:[1,0,0]
    v_pk_fma_f32 v[88:89], v[220:221], v[38:39], v[88:89] op_sel:[1,0,0] op_sel_hi:[1,1,1]
    v_pk_fma_f32 v[40:41], v[220:221], v[38:39], v[40:41] op_sel_hi:[0,1,1]
    v_pk_fma_f32 v[88:89], v[220:221], v[86:87], v[88:89] op_sel_hi:[0,1,1]
    v_pk_fma_f32 v[42:43], v[220:221], v[88:89], v[42:43] op_sel:[1,0,0] op_sel_hi:[1,1,1] neg_lo:[1,0,0] neg_hi:[1,0,0]
    v_pk_fma_f32 v[90:91], v[220:221], v[40:41], v[90:91] op_sel:[1,0,0] op_sel_hi:[1,1,1]
    v_pk_fma_f32 v[42:43], v[220:221], v[40:41], v[42:43] op_sel_hi:[0,1,1]
    v_pk_fma_f32 v[90:91], v[220:221], v[88:89], v[90:91] op_sel_hi:[0,1,1]
    v_pk_fma_f32 v[44:45], v[220:221], v[90:91], v[44:45] op_sel:[1,0,0] op_sel_hi:[1,1,1] neg_lo:[1,0,0] neg_hi:[1,0,0]
    v_pk_fma_f32 v[92:93], v[220:221], v[42:43], v[92:93] op_sel:[1,0,0] op_sel_hi:[1,1,1]
    v_pk_fma_f32 v[44:45], v[220:221], v[42:43], v[44:45] op_sel_hi:[0,1,1]
    v_pk_fma_f32 v[92:93], v[220:221], v[90:91], v[92:93] op_sel_hi:[0,1,1]
    v_pk_fma_f32 v[46:47], v[220:221], v[92:93], v[46:47] op_sel:[1,0,0] op_sel_hi:[1,1,1] neg_lo:[1,0,0] neg_hi:[1,0,0]
    v_pk_fma_f32 v[94:95], v[220:221], v[44:45], v[94:95] op_sel:[1,0,0] op_sel_hi:[1,1,1]
    v_pk_fma_f32 v[46:47], v[220:221], v[44:45], v[46:47] op_sel_hi:[0,1,1]
    v_pk_fma_f32 v[94:95], v[220:221], v[92:93], v[94:95] op_sel_hi:[0,1,1]
    v_cvt_pk_bf16_f32 v32, v32, v33
    v_cvt_pk_bf16_f32 v33, v34, v35
    ds_write_b64 v186, v[32:33]
    v_cvt_pk_bf16_f32 v36, v36, v37
    v_cvt_pk_bf16_f32 v37, v38, v39
    ds_write_b64 v187, v[36:37]
    v_cvt_pk_bf16_f32 v40, v40, v41
    v_cvt_pk_bf16_f32 v41, v42, v43
    ds_write_b64 v188, v[40:41]
    v_cvt_pk_bf16_f32 v44, v44, v45
    v_cvt_pk_bf16_f32 v45, v46, v47
    ds_write_b64 v189, v[44:45]
    ds_read_b64_tr_b16 v[112:113], v184 offset:0
    ds_read_b64_tr_b16 v[114:115], v185 offset:0
    ds_read_b64_tr_b16 v[116:117], v184 offset:1024
    ds_read_b64_tr_b16 v[118:119], v185 offset:1024
    v_cvt_pk_bf16_f32 v80, -v80, -v81
    v_cvt_pk_bf16_f32 v81, -v82, -v83
    ds_write_b64 v186, v[80:81]
    v_cvt_pk_bf16_f32 v84, -v84, -v85
    v_cvt_pk_bf16_f32 v85, -v86, -v87
    ds_write_b64 v187, v[84:85]
    v_cvt_pk_bf16_f32 v88, -v88, -v89
    v_cvt_pk_bf16_f32 v89, -v90, -v91
    ds_write_b64 v188, v[88:89]
    v_cvt_pk_bf16_f32 v92, -v92, -v93
    v_cvt_pk_bf16_f32 v93, -v94, -v95
    ds_write_b64 v189, v[92:93]
    ds_read_b64_tr_b16 v[136:137], v184 offset:0
    ds_read_b64_tr_b16 v[138:139], v185 offset:0
    ds_read_b64_tr_b16 v[140:141], v184 offset:1024
    ds_read_b64_tr_b16 v[142:143], v185 offset:1024
    s_waitcnt vmcnt(1)
    s_lshl_b32 s12, s6, 6
    s_add_u32 s12, s12, s24
    s_mov_b64 exec, 1
    s_add_u32 s96, s12, 589824
    buffer_store_dwordx2 v[198:199], v155, s[68:71], s96 offen
    buffer_store_dwordx2 v[198:199], v155, s[68:71], s12 offen sc1
    s_mov_b64 exec, -1
    s_waitcnt vmcnt(2)
    v_cmp_eq_u64 vcc, s[88:89], v[192:193]
    s_nop 1
    s_and_b32 s12, vcc_lo, s13
    s_cmp_eq_u32 s12, s13
    s_cbranch_scc0 L_rt_58
L_ok_57:
    s_waitcnt lgkmcnt(8)
    buffer_store_dwordx4 v[112:115], v147, s[68:71], s42 offen offset:0 sc1
    buffer_store_dwordx4 v[116:119], v147, s[68:71], s42 offen offset:1024 sc1
    s_waitcnt lgkmcnt(0)
    buffer_store_dwordx4 v[136:139], v147, s[68:71], s47 offen offset:0 sc1
    buffer_store_dwordx4 v[140:143], v147, s[68:71], s47 offen offset:1024 sc1
    v_add_u32 v186, 0, v246
    ds_read_b128 a[0:3], v186 offset:0
    ds_read_b128 a[4:7], v186 offset:2048
    v_add_u32 v187, 0, v247
    ds_read_b128 a[8:11], v187 offset:0
    ds_read_b128 a[12:15], v187 offset:2048
    ds_read_b128 a[16:19], v186 offset:4096
    ds_read_b128 a[20:23], v186 offset:6144
    ds_read_b128 a[24:27], v187 offset:4096
    ds_read_b128 a[28:31], v187 offset:6144
    ds_read_b128 a[32:35], v186 offset:8192
    ds_read_b128 a[36:39], v186 offset:10240
    ds_read_b128 a[40:43], v187 offset:8192
    ds_read_b128 a[44:47], v187 offset:10240
    s_waitcnt lgkmcnt(6)
    v_mfma_f32_32x32x16_bf16 v[32:47], v[96:99], a[0:3], 0
    ds_read_b128 a[48:51], v186 offset:12288
    s_add_u32 s40, s20, 0
    v_mfma_f32_32x32x16_bf16 v[48:63], v[96:99], a[4:7], 0
    ds_read_b128 a[52:55], v186 offset:14336
    buffer_load_dwordx4 a[72:75], v147, s[68:71], s40 offen offset:0 sc1
    v_mfma_f32_32x32x16_bf16 v[32:47], v[100:103], a[8:11], v[32:47]
    ds_read_b128 a[56:59], v187 offset:12288
    buffer_load_dwordx4 a[76:79], v147, s[68:71], s40 offen offset:1024 sc1
    v_mfma_f32_32x32x16_bf16 v[48:63], v[100:103], a[12:15], v[48:63]
    ds_read_b128 a[60:63], v187 offset:14336
    buffer_load_dwordx4 a[80:83], v147, s[68:71], s40 offen offset:2048 sc1
    v_mfma_f32_32x32x16_bf16 v[32:47], v[104:107], a[16:19], v[32:47]
    ds_read_b128 a[64:67], v186 offset:16384
    buffer_load_dwordx4 a[84:87], v147, s[68:71], s40 offen offset:3072 sc1
    s_add_u32 s40, s20, 4096
    v_mfma_f32_32x32x16_bf16 v[48:63], v[104:107], a[20:23], v[48:63]
    ds_read_b128 a[68:71], v186 offset:18432
    buffer_load_dwordx4 a[88:91], v147, s[68:71], s40 offen offset:0 sc1
    s_waitcnt lgkmcnt(6)
    v_mfma_f32_32x32x16_bf16 v[32:47], v[108:111], a[24:27], v[32:47]
    ds_read_b128 a[0:3], v187 offset:16384
    buffer_load_dwordx4 a[92:95], v147, s[68:71], s40 offen offset:1024 sc1
    v_mfma_f32_32x32x16_bf16 v[48:63], v[108:111], a[28:31], v[48:63]
    ds_read_b128 a[4:7], v187 offset:18432
    buffer_load_dwordx4 a[96:99], v147, s[68:71], s40 offen offset:2048 sc1
    v_mfma_f32_32x32x16_bf16 v[32:47], v[112:115], a[32:35], v[32:47]
    ds_read_b128 a[8:11], v186 offset:20480
    buffer_load_dwordx4 a[100:103], v147, s[68:71], s40 offen offset:3072 sc1
    s_add_u32 s40, s20, 8192
    v_mfma_f32_32x32x16_bf16 v[48:63], v[112:115], a[36:39], v[48:63]
    ds_read_b128 a[12:15], v186 offset:22528
    v_mfma_f32_32x32x16_bf16 v[32:47], v[116:119], a[40:43], v[32:47]
    ds_read_b128 a[16:19], v187 offset:20480
    buffer_load_dwordx4 a[104:107], v147, s[68:71], s40 offen offset:0 sc1
    v_mfma_f32_32x32x16_bf16 v[48:63], v[116:119], a[44:47], v[48:63]
    ds_read_b128 a[20:23], v187 offset:22528
    s_waitcnt lgkmcnt(6)
    v_mfma_f32_32x32x16_bf16 v[32:47], v[120:123], a[48:51], v[32:47]
    buffer_load_dwordx4 a[108:111], v147, s[68:71], s40 offen offset:1024 sc1
    v_mfma_f32_32x32x16_bf16 v[48:63], v[120:123], a[52:55], v[48:63]
    v_mfma_f32_32x32x16_bf16 v[32:47], v[124:127], a[56:59], v[32:47]
    buffer_load_dwordx4 a[112:115], v147, s[68:71], s40 offen offset:2048 sc1
    s_waitcnt lgkmcnt(0)
    s_barrier
    v_mfma_f32_32x32x16_bf16 v[48:63], v[124:127], a[60:63], v[48:63]
    v_add_u32 v186, 24576, v246
    ds_read_b128 a[24:27], v186 offset:0
    v_add_u32 v187, 24576, v247
    v_mfma_f32_32x32x16_bf16 v[32:47], v[128:131], a[64:67], v[32:47]
    ds_read_b128 a[28:31], v187 offset:0
    ds_read_b128 a[32:35], v186 offset:4096
    ds_read_b128 a[36:39], v187 offset:4096
    buffer_load_dwordx4 a[116:119], v147, s[68:71], s40 offen offset:3072 sc1
    s_add_u32 s40, s21, 0
    v_mfma_f32_32x32x16_bf16 v[48:63], v[128:131], a[68:71], v[48:63]
    ds_read_b128 a[40:43], v186 offset:8192
    ds_read_b128 a[44:47], v187 offset:8192
    v_mfma_f32_32x32x16_bf16 v[32:47], v[132:135], a[0:3], v[32:47]
    ds_read_b128 a[48:51], v186 offset:12288
    v_mfma_f32_32x32x16_bf16 v[48:63], v[132:135], a[4:7], v[48:63]
    ds_read_b128 a[52:55], v187 offset:12288
    v_mfma_f32_32x32x16_bf16 v[32:47], v[136:139], a[8:11], v[32:47]
    ds_read_b128 a[56:59], v186 offset:16384
    v_mfma_f32_32x32x16_bf16 v[48:63], v[136:139], a[12:15], v[48:63]
    ds_read_b128 a[60:63], v187 offset:16384
    v_mfma_f32_32x32x16_bf16 v[32:47], v[140:143], a[16:19], v[32:47]
    ds_read_b128 a[64:67], v186 offset:20480
    v_mfma_f32_32x32x16_bf16 v[48:63], v[140:143], a[20:23], v[48:63]
    ds_read_b128 a[68:71], v187 offset:20480
    s_waitcnt lgkmcnt(6)
    v_mfma_f32_32x32x16_bf16 v[16:31], v[96:99], a[24:27], 0
    s_waitcnt vmcnt(12)
    s_lshl_b32 s12, s6, 6
    s_add_u32 s12, s12, s24
    s_mov_b64 exec, 1
    s_add_u32 s96, s12, 589824
    buffer_store_dwordx4 v[198:201], v155, s[68:71], s96 offen
    buffer_store_dwordx4 v[198:201], v155, s[68:71], s12 offen sc1
    s_mov_b64 exec, -1
    v_mfma_f32_32x32x16_bf16 v[16:31], v[100:103], a[28:31], v[16:31]
    v_add_u32 v184, 49152, v178
    ds_read_b64_tr_b16 a[0:1], v184 offset:0
    ds_read_b64_tr_b16 a[2:3], v184 offset:512
    buffer_load_dwordx4 a[120:123], v147, s[68:71], s40 offen offset:0 sc1
    v_mfma_f32_32x32x16_bf16 v[16:31], v[104:107], a[32:35], v[16:31]
    v_add_u32 v185, 49152, v179
    ds_read_b64_tr_b16 a[4:5], v185 offset:0
    ds_read_b64_tr_b16 a[6:7], v185 offset:512
    buffer_load_dwordx4 a[124:127], v147, s[68:71], s40 offen offset:1024 sc1
    v_mfma_f32_32x32x16_bf16 v[16:31], v[108:111], a[36:39], v[16:31]
    ds_read_b64_tr_b16 a[8:9], v184 offset:2048
    ds_read_b64_tr_b16 a[10:11], v184 offset:2560
    ds_read_b64_tr_b16 a[12:13], v185 offset:2048
    buffer_load_dwordx4 a[128:131], v147, s[68:71], s40 offen offset:2048 sc1
    v_mfma_f32_32x32x16_bf16 v[16:31], v[112:115], a[40:43], v[16:31]
    ds_read_b64_tr_b16 a[14:15], v185 offset:2560
    ds_read_b64_tr_b16 a[16:17], v184 offset:4096
    ds_read_b64_tr_b16 a[18:19], v184 offset:4608
    buffer_load_dwordx4 a[132:135], v147, s[68:71], s40 offen offset:3072 sc1
    s_add_u32 s40, s21, 4096
    v_mfma_f32_32x32x16_bf16 v[16:31], v[116:119], a[44:47], v[16:31]
    ds_read_b64_tr_b16 a[20:21], v185 offset:4096
    ds_read_b64_tr_b16 a[22:23], v185 offset:4608
    s_waitcnt lgkmcnt(12)
    v_mfma_f32_32x32x16_bf16 v[16:31], v[120:123], a[48:51], v[16:31]
    ds_read_b64_tr_b16 a[24:25], v184 offset:6144
    ds_read_b64_tr_b16 a[26:27], v184 offset:6656
    buffer_load_dwordx4 a[136:139], v147, s[68:71], s40 offen offset:0 sc1
    v_mfma_f32_32x32x16_bf16 v[16:31], v[124:127], a[52:55], v[16:31]
    ds_read_b64_tr_b16 a[28:29], v185 offset:6144
    ds_read_b64_tr_b16 a[30:31], v185 offset:6656
    buffer_load_dwordx4 a[140:143], v147, s[68:71], s40 offen offset:1024 sc1
    v_mfma_f32_32x32x16_bf16 v[16:31], v[128:131], a[56:59], v[16:31]
    ds_read_b64_tr_b16 a[32:33], v184 offset:8192
    ds_read_b64_tr_b16 a[34:35], v184 offset:8704
    buffer_load_dwordx4 a[144:147], v147, s[68:71], s40 offen offset:2048 sc1
    v_mfma_f32_32x32x16_bf16 v[16:31], v[132:135], a[60:63], v[16:31]
    ds_read_b64_tr_b16 a[36:37], v185 offset:8192
    ds_read_b64_tr_b16 a[38:39], v185 offset:8704
    buffer_load_dwordx4 a[148:151], v147, s[68:71], s40 offen offset:3072 sc1
    s_add_u32 s40, s21, 8192
    v_mfma_f32_32x32x16_bf16 v[16:31], v[136:139], a[64:67], v[16:31]
    ds_read_b64_tr_b16 a[40:41], v184 offset:10240
    ds_read_b64_tr_b16 a[42:43], v184 offset:10752
    v_mfma_f32_32x32x16_bf16 v[16:31], v[140:143], a[68:71], v[16:31]
    ds_read_b64_tr_b16 a[44:45], v185 offset:10240
    ds_read_b64_tr_b16 a[46:47], v185 offset:10752
    s_waitcnt vmcnt(18)
    s_waitcnt lgkmcnt(12)
    v_mfma_f32_32x32x16_bf16 v[32:47], a[72:75], a[0:3], v[32:47]
    ds_read_b64_tr_b16 a[48:49], v184 offset:12288
    ds_read_b64_tr_b16 a[50:51], v184 offset:12800
    buffer_load_dwordx4 a[152:155], v147, s[68:71], s40 offen offset:0 sc1
    v_mfma_f32_32x32x16_bf16 v[48:63], a[72:75], a[4:7], v[48:63]
    ds_read_b64_tr_b16 a[52:53], v185 offset:12288
    ds_read_b64_tr_b16 a[54:55], v185 offset:12800
    buffer_load_dwordx4 a[156:159], v147, s[68:71], s40 offen offset:1024 sc1
    v_mfma_f32_32x32x16_bf16 v[32:47], a[76:79], a[8:11], v[32:47]
    ds_read_b64_tr_b16 a[56:57], v184 offset:14336
    ds_read_b64_tr_b16 a[58:59], v184 offset:14848
    buffer_load_dwordx4 a[160:163], v147, s[68:71], s40 offen offset:2048 sc1
    v_mfma_f32_32x32x16_bf16 v[48:63], a[76:79], a[12:15], v[48:63]
    ds_read_b64_tr_b16 a[60:61], v185 offset:14336
    ds_read_b64_tr_b16 a[62:63], v185 offset:14848
    v_mfma_f32_32x32x16_bf16 v[32:47], a[80:83], a[16:19], v[32:47]
    ds_read_b64_tr_b16 a[64:65], v184 offset:16384
    ds_read_b64_tr_b16 a[66:67], v184 offset:16896
    buffer_load_dwordx4 a[164:167], v147, s[68:71], s40 offen offset:3072 sc1
    s_add_u32 s35, s1, s90
    s_add_u32 m0, s94, 0
    v_mfma_f32_32x32x16_bf16 v[48:63], a[80:83], a[20:23], v[48:63]
    ds_read_b64_tr_b16 a[68:69], v185 offset:16384
    ds_read_b64_tr_b16 a[70:71], v185 offset:16896
    s_waitcnt vmcnt(18)
    s_waitcnt lgkmcnt(12)
    v_mfma_f32_32x32x16_bf16 v[32:47], a[84:87], a[24:27], v[32:47]
    buffer_load_dwordx4 v[190:193], v239, s[68:71], s31 offen sc1
    ds_read_b64_tr_b16 a[0:1], v184 offset:18432
    ds_read_b64_tr_b16 a[2:3], v184 offset:18944
    v_mfma_f32_32x32x16_bf16 v[48:63], a[84:87], a[28:31], v[48:63]
    ds_read_b64_tr_b16 a[4:5], v185 offset:18432
    ds_read_b64_tr_b16 a[6:7], v185 offset:18944
    v_mfma_f32_32x32x16_bf16 v[32:47], a[88:91], a[32:35], v[32:47]
    ds_read_b64_tr_b16 a[8:9], v184 offset:20480
    ds_read_b64_tr_b16 a[10:11], v184 offset:20992
    v_mfma_f32_32x32x16_bf16 v[48:63], a[88:91], a[36:39], v[48:63]
    ds_read_b64_tr_b16 a[12:13], v185 offset:20480
    ds_read_b64_tr_b16 a[14:15], v185 offset:20992
    v_mfma_f32_32x32x16_bf16 v[32:47], a[92:95], a[40:43], v[32:47]
    ds_read_b64_tr_b16 a[16:17], v184 offset:22528
    ds_read_b64_tr_b16 a[18:19], v184 offset:23040
    v_mfma_f32_32x32x16_bf16 v[48:63], a[92:95], a[44:47], v[48:63]
    ds_read_b64_tr_b16 a[20:21], v185 offset:22528
    ds_read_b64_tr_b16 a[22:23], v185 offset:23040
    s_waitcnt vmcnt(15)
    s_waitcnt lgkmcnt(12)
    v_mfma_f32_32x32x16_bf16 v[32:47], a[96:99], a[48:51], v[32:47]
    v_mfma_f32_32x32x16_bf16 v[48:63], a[96:99], a[52:55], v[48:63]
    buffer_load_dwordx4 v253, s[60:63], s35 offen offset:0 lds
    s_add_u32 m0, s94, 4032
    v_mfma_f32_32x32x16_bf16 v[32:47], a[100:103], a[56:59], v[32:47]
    s_waitcnt lgkmcnt(0)
    s_barrier
    v_mfma_f32_32x32x16_bf16 v[48:63], a[100:103], a[60:63], v[48:63]
    v_add_u32 v184, 73728, v178
    ds_read_b64_tr_b16 a[24:25], v184 offset:0
    ds_read_b64_tr_b16 a[26:27], v184 offset:512
    ds_read_b64_tr_b16 a[28:29], v184 offset:2048
    ds_read_b64_tr_b16 a[30:31], v184 offset:2560
    buffer_load_dwordx4 v253, s[60:63], s35 offen offset:64 lds
    s_add_u32 m0, s94, 8064
    v_mfma_f32_32x32x16_bf16 v[32:47], a[104:107], a[64:67], v[32:47]
    ds_read_b64_tr_b16 a[32:33], v184 offset:4096
    ds_read_b64_tr_b16 a[34:35], v184 offset:4608
    ds_read_b64_tr_b16 a[36:37], v184 offset:6144
    ds_read_b64_tr_b16 a[38:39], v184 offset:6656
    v_mfma_f32_32x32x16_bf16 v[48:63], a[104:107], a[68:71], v[48:63]
    ds_read_b64_tr_b16 a[40:41], v184 offset:8192
    ds_read_b64_tr_b16 a[42:43], v184 offset:8704
    ds_read_b64_tr_b16 a[44:45], v184 offset:10240
    ds_read_b64_tr_b16 a[46:47], v184 offset:10752
    buffer_load_dwordx4 v253, s[60:63], s35 offen offset:128 lds
    s_add_u32 m0, s94, 12288
    v_mfma_f32_32x32x16_bf16 v[32:47], a[108:111], a[0:3], v[32:47]
    ds_read_b64_tr_b16 a[48:49], v184 offset:12288
    ds_read_b64_tr_b16 a[50:51], v184 offset:12800
    v_mfma_f32_32x32x16_bf16 v[48:63], a[108:111], a[4:7], v[48:63]
    ds_read_b64_tr_b16 a[52:53], v184 offset:14336
    ds_read_b64_tr_b16 a[54:55], v184 offset:14848
    buffer_load_dwordx4 v253, s[64:67], s35 offen offset:0 lds
    s_add_u32 m0, s94, 16320
    v_mfma_f32_32x32x16_bf16 v[32:47], a[112:115], a[8:11], v[32:47]
    ds_read_b64_tr_b16 a[56:57], v184 offset:16384
    ds_read_b64_tr_b16 a[58:59], v184 offset:16896
    v_mfma_f32_32x32x16_bf16 v[48:63], a[112:115], a[12:15], v[48:63]
    ds_read_b64_tr_b16 a[60:61], v184 offset:18432
    ds_read_b64_tr_b16 a[62:63], v184 offset:18944
    buffer_load_dwordx4 v253, s[64:67], s35 offen offset:64 lds
    s_add_u32 m0, s94, 20352
    v_mfma_f32_32x32x16_bf16 v[32:47], a[116:119], a[16:19], v[32:47]
    ds_read_b64_tr_b16 a[64:65], v184 offset:20480
    ds_read_b64_tr_b16 a[66:67], v184 offset:20992
    v_mfma_f32_32x32x16_bf16 v[48:63], a[116:119], a[20:23], v[48:63]
    ds_read_b64_tr_b16 a[68:69], v184 offset:22528
    ds_read_b64_tr_b16 a[70:71], v184 offset:23040
    buffer_load_dwordx4 v253, s[64:67], s35 offen offset:128 lds
    s_add_u32 s35, s1, s91
    s_add_u32 m0, s94, 49152
    s_waitcnt lgkmcnt(12)
    v_mfma_f32_32x32x16_bf16 v[16:31], a[72:75], a[24:27], v[16:31]
    s_xor_b32 s13, s6, 1
    s_mul_i32 s14, s13, 6144
    s_lshl_b32 s13, 1, s13
    s_add_u32 s22, s22, s14
    s_add_u32 s23, s23, s14
    s_waitcnt vmcnt(6)
    v_cmp_eq_u64 vcc, s[88:89], v[192:193]
    s_nop 1
    s_and_b32 s12, vcc_lo, s13
    s_cmp_eq_u32 s12, s13
    s_cbranch_scc0 L_rt_60
L_ok_59:
    v_mfma_f32_32x32x16_bf16 v[16:31], a[76:79], a[28:31], v[16:31]
    v_add_u32 v184, 98304, v178
    ds_read_b64_tr_b16 a[0:1], v184 offset:0
    ds_read_b64_tr_b16 a[2:3], v184 offset:512
    buffer_load_dwordx4 v253, s[60:63], s35 offen offset:0 lds
    s_add_u32 s40, s22, 0
    v_mfma_f32_32x32x16_bf16 v[16:31], a[80:83], a[32:35], v[16:31]
    v_add_u32 v185, 98304, v179
    ds_read_b64_tr_b16 a[4:5], v185 offset:0
    ds_read_b64_tr_b16 a[6:7], v185 offset:512
    buffer_load_dwordx4 a[168:171], v147, s[68:71], s40 offen offset:0 sc1
    v_mfma_f32_32x32x16_bf16 v[16:31], a[84:87], a[36:39], v[16:31]
    ds_read_b64_tr_b16 a[8:9], v184 offset:2048
    ds_read_b64_tr_b16 a[10:11], v184 offset:2560
    ds_read_b64_tr_b16 a[12:13], v185 offset:2048
    buffer_load_dwordx4 a[172:175], v147, s[68:71], s40 offen offset:1024 sc1
    v_mfma_f32_32x32x16_bf16 v[16:31], a[88:91], a[40:43], v[16:31]
    ds_read_b64_tr_b16 a[14:15], v185 offset:2560
    ds_read_b64_tr_b16 a[16:17], v184 offset:4096
    ds_read_b64_tr_b16 a[18:19], v184 offset:4608
    buffer_load_dwordx4 a[176:179], v147, s[68:71], s40 offen offset:2048 sc1
    s_add_u32 s40, s22, 3072
    v_mfma_f32_32x32x16_bf16 v[16:31], a[92:95], a[44:47], v[16:31]
    ds_read_b64_tr_b16 a[20:21], v185 offset:4096
    ds_read_b64_tr_b16 a[22:23], v185 offset:4608
    buffer_load_dwordx4 a[180:183], v147, s[68:71], s40 offen offset:0 sc1
    s_waitcnt lgkmcnt(12)
    v_mfma_f32_32x32x16_bf16 v[16:31], a[96:99], a[48:51], v[16:31]
    ds_read_b64_tr_b16 a[24:25], v184 offset:6144
    ds_read_b64_tr_b16 a[26:27], v184 offset:6656
    buffer_load_dwordx4 a[184:187], v147, s[68:71], s40 offen offset:1024 sc1
    v_mfma_f32_32x32x16_bf16 v[16:31], a[100:103], a[52:55], v[16:31]
    ds_read_b64_tr_b16 a[28:29], v185 offset:6144
    ds_read_b64_tr_b16 a[30:31], v185 offset:6656
    buffer_load_dwordx4 a[188:191], v147, s[68:71], s40 offen offset:2048 sc1
    s_add_u32 s40, s23, 0
    v_mfma_f32_32x32x16_bf16 v[16:31], a[104:107], a[56:59], v[16:31]
    ds_read_b64_tr_b16 a[32:33], v184 offset:8192
    ds_read_b64_tr_b16 a[34:35], v184 offset:8704
    buffer_load_dwordx4 a[192:195], v147, s[68:71], s40 offen offset:0 sc1
    v_mfma_f32_32x32x16_bf16 v[16:31], a[108:111], a[60:63], v[16:31]
    ds_read_b64_tr_b16 a[36:37], v185 offset:8192
    ds_read_b64_tr_b16 a[38:39], v185 offset:8704
    v_mfma_f32_32x32x16_bf16 v[16:31], a[112:115], a[64:67], v[16:31]
    ds_read_b64_tr_b16 a[40:41], v184 offset:10240
    ds_read_b64_tr_b16 a[42:43], v184 offset:10752
    buffer_load_dwordx4 a[196:199], v147, s[68:71], s40 offen offset:1024 sc1
    v_mfma_f32_32x32x16_bf16 v[16:31], a[116:119], a[68:71], v[16:31]
    ds_read_b64_tr_b16 a[44:45], v185 offset:10240
    ds_read_b64_tr_b16 a[46:47], v185 offset:10752
    s_waitcnt lgkmcnt(12)
    v_mfma_f32_32x32x16_bf16 v[32:47], a[120:123], a[0:3], v[32:47]
    ds_read_b64_tr_b16 a[48:49], v184 offset:12288
    ds_read_b64_tr_b16 a[50:51], v184 offset:12800
    buffer_load_dwordx4 a[200:203], v147, s[68:71], s40 offen offset:2048 sc1
    s_add_u32 s40, s23, 3072
    v_mfma_f32_32x32x16_bf16 v[48:63], a[120:123], a[4:7], v[48:63]
    ds_read_b64_tr_b16 a[52:53], v185 offset:12288
    ds_read_b64_tr_b16 a[54:55], v185 offset:12800
    v_mfma_f32_32x32x16_bf16 v[32:47], a[124:127], a[8:11], v[32:47]
    ds_read_b64_tr_b16 a[56:57], v184 offset:14336
    ds_read_b64_tr_b16 a[58:59], v184 offset:14848
    buffer_load_dwordx4 a[204:207], v147, s[68:71], s40 offen offset:0 sc1
    v_mfma_f32_32x32x16_bf16 v[48:63], a[124:127], a[12:15], v[48:63]
    ds_read_b64_tr_b16 a[60:61], v185 offset:14336
    ds_read_b64_tr_b16 a[62:63], v185 offset:14848
    v_mfma_f32_32x32x16_bf16 v[32:47], a[128:131], a[16:19], v[32:47]
    ds_read_b64_tr_b16 a[64:65], v184 offset:16384
    ds_read_b64_tr_b16 a[66:67], v184 offset:16896
    buffer_load_dwordx4 a[208:211], v147, s[68:71], s40 offen offset:1024 sc1
    v_mfma_f32_32x32x16_bf16 v[48:63], a[128:131], a[20:23], v[48:63]
    ds_read_b64_tr_b16 a[68:69], v185 offset:16384
    ds_read_b64_tr_b16 a[70:71], v185 offset:16896
    s_waitcnt lgkmcnt(12)
    v_mfma_f32_32x32x16_bf16 v[32:47], a[132:135], a[24:27], v[32:47]
    ds_read_b64_tr_b16 a[0:1], v184 offset:18432
    ds_read_b64_tr_b16 a[2:3], v184 offset:18944
    buffer_load_dwordx4 a[212:215], v147, s[68:71], s40 offen offset:2048 sc1
    s_add_u32 m0, s94, 53184
    v_bfe_u32 v148, v145, 2, 1
    v_lshlrev_b32 v148, 4, v148
    v_mfma_f32_32x32x16_bf16 v[48:63], a[132:135], a[28:31], v[48:63]
    ds_read_b64_tr_b16 a[4:5], v185 offset:18432
    ds_read_b64_tr_b16 a[6:7], v185 offset:18944
    v_and_b32 v149, 1, v145
    v_lshl_or_b32 v148, v149, 3, v148
    v_bfe_u32 v149, v145, 3, 2
    v_lshl_or_b32 v148, v149, 1, v148
    v_mfma_f32_32x32x16_bf16 v[32:47], a[136:139], a[32:35], v[32:47]
    ds_read_b64_tr_b16 a[8:9], v184 offset:20480
    ds_read_b64_tr_b16 a[10:11], v184 offset:20992
    v_bfe_u32 v149, v145, 1, 1
    v_or_b32 v148, v148, v149
    v_add_u32 v148, s100, v148
    v_mul_u32_u24 v148, 1280, v148
    v_mfma_f32_32x32x16_bf16 v[48:63], a[136:139], a[36:39], v[48:63]
    ds_read_b64_tr_b16 a[12:13], v185 offset:20480
    ds_read_b64_tr_b16 a[14:15], v185 offset:20992
    v_lshl_add_u32 v148, v146, 4, v148
    v_lshl_add_u32 v149, v145, 1, s30
    v_min_u32 v149, 1278, v149
    v_mfma_f32_32x32x16_bf16 v[32:47], a[140:143], a[40:43], v[32:47]
    ds_read_b64_tr_b16 a[16:17], v184 offset:22528
    ds_read_b64_tr_b16 a[18:19], v184 offset:23040
    v_mfma_f32_32x32x16_bf16 v[48:63], a[140:143], a[44:47], v[48:63]
    ds_read_b64_tr_b16 a[20:21], v185 offset:22528
    ds_read_b64_tr_b16 a[22:23], v185 offset:23040
    s_waitcnt lgkmcnt(12)
    v_mfma_f32_32x32x16_bf16 v[32:47], a[144:147], a[48:51], v[32:47]
    v_add_u32 v184, 122880, v178
    ds_read_b64_tr_b16 a[24:25], v184 offset:0
    ds_read_b64_tr_b16 a[26:27], v184 offset:512
    v_mfma_f32_32x32x16_bf16 v[48:63], a[144:147], a[52:55], v[48:63]
    ds_read_b64_tr_b16 a[28:29], v184 offset:2048
    ds_read_b64_tr_b16 a[30:31], v184 offset:2560
    v_mfma_f32_32x32x16_bf16 v[32:47], a[148:151], a[56:59], v[32:47]
    ds_read_b64_tr_b16 a[32:33], v184 offset:4096
    ds_read_b64_tr_b16 a[34:35], v184 offset:4608
    v_mfma_f32_32x32x16_bf16 v[48:63], a[148:151], a[60:63], v[48:63]
    ds_read_b64_tr_b16 a[36:37], v184 offset:6144
    ds_read_b64_tr_b16 a[38:39], v184 offset:6656
    buffer_load_dwordx4 v[202:205], v148, s[48:51], s30 offen offset:0
    v_mfma_f32_32x32x16_bf16 v[32:47], a[152:155], a[64:67], v[32:47]
    ds_read_b64_tr_b16 a[40:41], v184 offset:8192
    ds_read_b64_tr_b16 a[42:43], v184 offset:8704
    v_mfma_f32_32x32x16_bf16 v[48:63], a[152:155], a[68:71], v[48:63]
    ds_read_b64_tr_b16 a[44:45], v184 offset:10240
    ds_read_b64_tr_b16 a[46:47], v184 offset:10752
    buffer_load_dwordx4 v[206:209], v148, s[48:51], s30 offen offset:32
    s_waitcnt lgkmcnt(12)
    v_mfma_f32_32x32x16_bf16 v[32:47], a[156:159], a[0:3], v[32:47]
    ds_read_b64_tr_b16 a[48:49], v184 offset:12288
    ds_read_b64_tr_b16 a[50:51], v184 offset:12800
    global_load_ushort v152, v149, s[32:33] offset:0
    v_and_b32 v150, 1, v145
    v_lshlrev_b32 v150, 4, v150
    v_mfma_f32_32x32x16_bf16 v[48:63], a[156:159], a[4:7], v[48:63]
    ds_read_b64_tr_b16 a[52:53], v184 offset:14336
    ds_read_b64_tr_b16 a[54:55], v184 offset:14848
    buffer_load_dwordx4 v253, s[60:63], s35 offen offset:64 lds
    s_add_u32 m0, s94, 57216
    v_mov_b32 v151, 0x3f80
    v_lshlrev_b32 v151, v150, v151
    v_mfma_f32_32x32x16_bf16 v[32:47], a[160:163], a[8:11], v[32:47]
    ds_read_b64_tr_b16 a[56:57], v184 offset:16384
    ds_read_b64_tr_b16 a[58:59], v184 offset:16896
    buffer_load_dwordx4 v253, s[60:63], s35 offen offset:128 lds
    s_add_u32 m0, s94, 61440
    v_lshrrev_b32 v148, 1, v145
    v_lshlrev_b32 v149, 2, v146
    v_mfma_f32_32x32x16_bf16 v[48:63], a[160:163], a[12:15], v[48:63]
    ds_read_b64_tr_b16 a[60:61], v184 offset:18432
    ds_read_b64_tr_b16 a[62:63], v184 offset:18944
    buffer_load_dwordx4 v253, s[64:67], s35 offen offset:0 lds
    s_add_u32 m0, s94, 65472
    v_sub_u32 v148, v148, v149
    v_mul_f32 v195, v194, v196
    v_mfma_f32_32x32x16_bf16 v[32:47], a[164:167], a[16:19], v[32:47]
    ds_read_b64_tr_b16 a[64:65], v184 offset:20480
    ds_read_b64_tr_b16 a[66:67], v184 offset:20992
    buffer_load_dwordx4 v253, s[64:67], s35 offen offset:64 lds
    s_add_u32 m0, s94, 69504
    v_mfma_f32_32x32x16_bf16 v[48:63], a[164:167], a[20:23], v[48:63]
    ds_read_b64_tr_b16 a[68:69], v184 offset:22528
    ds_read_b64_tr_b16 a[70:71], v184 offset:23040
    buffer_load_dwordx4 v253, s[64:67], s35 offen offset:128 lds
    s_waitcnt lgkmcnt(12)
    v_mfma_f32_32x32x16_bf16 v[16:31], a[120:123], a[24:27], v[16:31]
    v_mfma_f32_32x32x16_bf16 v[16:31], a[124:127], a[28:31], v[16:31]
    v_mfma_f32_32x32x16_bf16 v[16:31], a[128:131], a[32:35], v[16:31]
    s_waitcnt lgkmcnt(0)
    s_waitcnt vmcnt(21)
    s_barrier
    v_mfma_f32_32x32x16_bf16 v[16:31], a[132:135], a[36:39], v[16:31]
    v_add_u32 v186, 0, v246
    ds_read_b128 a[0:3], v186 offset:0
    ds_read_b128 a[4:7], v186 offset:2048
    v_mfma_f32_32x32x16_bf16 v[16:31], a[136:139], a[40:43], v[16:31]
    v_add_u32 v187, 0, v247
    ds_read_b128 a[8:11], v187 offset:0
    ds_read_b128 a[12:15], v187 offset:2048
    v_mfma_f32_32x32x16_bf16 v[16:31], a[140:143], a[44:47], v[16:31]
    ds_read_b128 a[16:19], v186 offset:4096
    ds_read_b128 a[20:23], v186 offset:6144
    v_mfma_f32_32x32x16_bf16 v[16:31], a[144:147], a[48:51], v[16:31]
    ds_read_b128 a[24:27], v187 offset:4096
    v_mfma_f32_32x32x16_bf16 v[16:31], a[148:151], a[52:55], v[16:31]
    ds_read_b128 a[28:31], v187 offset:6144
    v_mfma_f32_32x32x16_bf16 v[16:31], a[152:155], a[56:59], v[16:31]
    ds_read_b128 a[32:35], v186 offset:8192
    v_mfma_f32_32x32x16_bf16 v[16:31], a[156:159], a[60:63], v[16:31]
    ds_read_b128 a[36:39], v186 offset:10240
    v_mfma_f32_32x32x16_bf16 v[16:31], a[160:163], a[64:67], v[16:31]
    ds_read_b128 a[40:43], v187 offset:8192
    v_mfma_f32_32x32x16_bf16 v[16:31], a[164:167], a[68:71], v[16:31]
    ds_read_b128 a[44:47], v187 offset:10240
    s_waitcnt vmcnt(16)
    s_waitcnt lgkmcnt(6)
    v_mfma_f32_32x32x16_bf16 v[32:47], a[168:171], a[0:3], v[32:47]
    ds_read_b128 a[48:51], v186 offset:12288
    v_mfma_f32_32x32x16_bf16 v[48:63], a[168:171], a[4:7], v[48:63]
    ds_read_b128 a[52:55], v186 offset:14336
    v_mfma_f32_32x32x16_bf16 v[32:47], a[172:175], a[8:11], v[32:47]
    ds_read_b128 a[56:59], v187 offset:12288
    v_mfma_f32_32x32x16_bf16 v[48:63], a[172:175], a[12:15], v[48:63]
    ds_read_b128 a[60:63], v187 offset:14336
    v_mfma_f32_32x32x16_bf16 v[32:47], a[176:179], a[16:19], v[32:47]
    ds_read_b128 a[64:67], v186 offset:16384
    v_mfma_f32_32x32x16_bf16 v[48:63], a[176:179], a[20:23], v[48:63]
    ds_read_b128 a[68:71], v186 offset:18432
    s_waitcnt vmcnt(12)
    s_waitcnt lgkmcnt(6)
    v_mfma_f32_32x32x16_bf16 v[32:47], a[180:183], a[24:27], v[32:47]
    ds_read_b128 a[0:3], v187 offset:16384
    v_mfma_f32_32x32x16_bf16 v[48:63], a[180:183], a[28:31], v[48:63]
    ds_read_b128 a[4:7], v187 offset:18432
    v_mfma_f32_32x32x16_bf16 v[32:47], a[184:187], a[32:35], v[32:47]
    ds_read_b128 a[8:11], v186 offset:20480
    v_mfma_f32_32x32x16_bf16 v[48:63], a[184:187], a[36:39], v[48:63]
    ds_read_b128 a[12:15], v186 offset:22528
    v_mfma_f32_32x32x16_bf16 v[32:47], a[188:191], a[40:43], v[32:47]
    ds_read_b128 a[16:19], v187 offset:20480
    v_mfma_f32_32x32x16_bf16 v[48:63], a[188:191], a[44:47], v[48:63]
    ds_read_b128 a[20:23], v187 offset:22528
    s_waitcnt vmcnt(8)
    s_waitcnt lgkmcnt(6)
    v_mfma_f32_32x32x16_bf16 v[32:47], a[192:195], a[48:51], v[32:47]
    v_mfma_f32_32x32x16_bf16 v[48:63], a[192:195], a[52:55], v[48:63]
    v_mfma_f32_32x32x16_bf16 v[32:47], a[196:199], a[56:59], v[32:47]
    s_waitcnt lgkmcnt(0)
    s_waitcnt vmcnt(0)
    s_barrier
    v_mfma_f32_32x32x16_bf16 v[48:63], a[196:199], a[60:63], v[48:63]
    v_add_u32 v186, 49152, v246
    ds_read_b128 a[24:27], v186 offset:0
    v_add_u32 v187, 49152, v247
    v_mfma_f32_32x32x16_bf16 v[32:47], a[200:203], a[64:67], v[32:47]
    ds_read_b128 a[28:31], v187 offset:0
    ds_read_b128 a[32:35], v186 offset:4096
    ds_read_b128 a[36:39], v187 offset:4096
    v_mfma_f32_32x32x16_bf16 v[48:63], a[200:203], a[68:71], v[48:63]
    ds_read_b128 a[40:43], v186 offset:8192
    ds_read_b128 a[44:47], v187 offset:8192
    v_mfma_f32_32x32x16_bf16 v[32:47], a[204:207], a[0:3], v[32:47]
    ds_read_b128 a[48:51], v186 offset:12288
    v_lshlrev_b32 v152, v150, v152
    v_cmp_eq_u32 s[76:77], 0, v148
    v_lshlrev_b32 v248, 16, v202
    v_mfma_f32_32x32x16_bf16 v[48:63], a[204:207], a[4:7], v[48:63]
    ds_read_b128 a[52:55], v187 offset:12288
    v_and_b32 v249, 0xffff0000, v202
    v_cndmask_b32 v166, 0, v151, s[76:77]
    v_cndmask_b32 v174, 0, v152, s[76:77]
    v_fma_f32 v248, v248, v196, -v195
    v_fma_f32 v249, v249, v196, -v195
    v_mfma_f32_32x32x16_bf16 v[32:47], a[208:211], a[8:11], v[32:47]
    ds_read_b128 a[56:59], v186 offset:16384
    v_cvt_pk_bf16_f32 v218, v248, v249
    v_cmp_eq_u32 s[76:77], 1, v148
    v_lshlrev_b32 v248, 16, v203
    v_and_b32 v249, 0xffff0000, v203
    v_cndmask_b32 v167, 0, v151, s[76:77]
    v_mfma_f32_32x32x16_bf16 v[48:63], a[208:211], a[12:15], v[48:63]
    ds_read_b128 a[60:63], v187 offset:16384
    v_cndmask_b32 v175, 0, v152, s[76:77]
    v_fma_f32 v248, v248, v196, -v195
    v_fma_f32 v249, v249, v196, -v195
    v_cvt_pk_bf16_f32 v219, v248, v249
    v_cmp_eq_u32 s[76:77], 2, v148
    v_mfma_f32_32x32x16_bf16 v[32:47], a[212:215], a[16:19], v[32:47]
    ds_read_b128 a[64:67], v186 offset:20480
    v_lshlrev_b32 v248, 16, v204
    v_and_b32 v249, 0xffff0000, v204
    v_cndmask_b32 v168, 0, v151, s[76:77]
    v_cndmask_b32 v176, 0, v152, s[76:77]
    v_fma_f32 v248, v248, v196, -v195
    v_mfma_f32_32x32x16_bf16 v[48:63], a[212:215], a[20:23], v[48:63]
    ds_read_b128 a[68:71], v187 offset:20480
    v_fma_f32 v249, v249, v196, -v195
    v_cvt_pk_bf16_f32 v220, v248, v249
    v_cmp_eq_u32 s[76:77], 3, v148
    v_lshlrev_b32 v248, 16, v205
    v_and_b32 v249, 0xffff0000, v205
    s_waitcnt lgkmcnt(6)
    v_mfma_f32_32x32x16_bf16 v[16:31], a[168:171], a[24:27], v[16:31]
    v_add_u32 v186, 24576, v246
    ds_read_b128 a[0:3], v186 offset:2048
    v_cndmask_b32 v169, 0, v151, s[76:77]
    v_cndmask_b32 v177, 0, v152, s[76:77]
    v_fma_f32 v248, v248, v196, -v195
    v_fma_f32 v249, v249, v196, -v195
    v_mfma_f32_32x32x16_bf16 v[16:31], a[172:175], a[28:31], v[16:31]
    v_add_u32 v187, 24576, v247
    ds_read_b128 a[4:7], v187 offset:2048
    v_cvt_pk_bf16_f32 v221, v248, v249
    v_cmp_eq_u32 s[76:77], 8, v148
    v_lshlrev_b32 v248, 16, v206
    v_and_b32 v249, 0xffff0000, v206
    v_mfma_f32_32x32x16_bf16 v[16:31], a[176:179], a[32:35], v[16:31]
    ds_read_b128 a[8:11], v186 offset:6144
    v_cndmask_b32 v170, 0, v151, s[76:77]
    v_cndmask_b32 v234, 0, v152, s[76:77]
    v_fma_f32 v248, v248, v196, -v195
    v_fma_f32 v249, v249, v196, -v195
    v_cvt_pk_bf16_f32 v222, v248, v249
    v_mfma_f32_32x32x16_bf16 v[16:31], a[180:183], a[36:39], v[16:31]
    ds_read_b128 a[12:15], v187 offset:6144
    v_cmp_eq_u32 s[76:77], 9, v148
    v_lshlrev_b32 v248, 16, v207
    v_and_b32 v249, 0xffff0000, v207
    v_cndmask_b32 v171, 0, v151, s[76:77]
    v_cndmask_b32 v235, 0, v152, s[76:77]
    v_mfma_f32_32x32x16_bf16 v[16:31], a[184:187], a[40:43], v[16:31]
    ds_read_b128 a[16:19], v186 offset:10240
    v_fma_f32 v248, v248, v196, -v195
    v_fma_f32 v249, v249, v196, -v195
    v_cvt_pk_bf16_f32 v223, v248, v249
    v_cmp_eq_u32 s[76:77], 10, v148
    v_lshlrev_b32 v248, 16, v208
    v_mfma_f32_32x32x16_bf16 v[16:31], a[188:191], a[44:47], v[16:31]
    ds_read_b128 a[20:23], v187 offset:10240
    v_and_b32 v249, 0xffff0000, v208
    v_cndmask_b32 v172, 0, v151, s[76:77]
    v_cndmask_b32 v236, 0, v152, s[76:77]
    v_fma_f32 v248, v248, v196, -v195
    v_fma_f32 v249, v249, v196, -v195
    s_waitcnt lgkmcnt(6)
    v_mfma_f32_32x32x16_bf16 v[16:31], a[192:195], a[48:51], v[16:31]
    ds_read_b128 a[24:27], v186 offset:14336
    v_cvt_pk_bf16_f32 v224, v248, v249
    v_cmp_eq_u32 s[76:77], 11, v148
    v_lshlrev_b32 v248, 16, v209
    v_and_b32 v249, 0xffff0000, v209
    v_cndmask_b32 v173, 0, v151, s[76:77]
    v_mfma_f32_32x32x16_bf16 v[16:31], a[196:199], a[52:55], v[16:31]
    ds_read_b128 a[28:31], v187 offset:14336
    v_cndmask_b32 v237, 0, v152, s[76:77]
    v_fma_f32 v248, v248, v196, -v195
    v_fma_f32 v249, v249, v196, -v195
    v_cvt_pk_bf16_f32 v225, v248, v249
    s_lshl_b32 s41, s26, 12
    v_mfma_f32_32x32x16_bf16 v[16:31], a[200:203], a[56:59], v[16:31]
    ds_read_b128 a[32:35], v186 offset:18432
    s_add_u32 s41, s41, 20971520
    v_cvt_pk_bf16_f32 v32, v32, v33
    v_cvt_pk_bf16_f32 v33, v34, v35
    v_cvt_pk_bf16_f32 v34, v36, v37
    v_cvt_pk_bf16_f32 v35, v38, v39
    v_mfma_f32_32x32x16_bf16 v[16:31], a[204:207], a[60:63], v[16:31]
    ds_read_b128 a[36:39], v187 offset:18432
    buffer_store_dwordx4 v[32:35], v147, s[68:71], s41 offen offset:0 sc1
    v_cvt_pk_bf16_f32 v40, v40, v41
    v_cvt_pk_bf16_f32 v41, v42, v43
    v_cvt_pk_bf16_f32 v42, v44, v45
    v_mfma_f32_32x32x16_bf16 v[16:31], a[208:211], a[64:67], v[16:31]
    ds_read_b128 a[40:43], v186 offset:22528
    v_cvt_pk_bf16_f32 v43, v46, v47
    buffer_store_dwordx4 v[40:43], v147, s[68:71], s41 offen offset:1024 sc1
    s_lshl_b32 s41, s27, 12
    s_add_u32 s41, s41, 20971520
    v_mfma_f32_32x32x16_bf16 v[16:31], a[212:215], a[68:71], v[16:31]
    ds_read_b128 a[44:47], v187 offset:22528
    v_cvt_pk_bf16_f32 v48, v48, v49
    v_cvt_pk_bf16_f32 v49, v50, v51
    v_cvt_pk_bf16_f32 v50, v52, v53
    v_cvt_pk_bf16_f32 v51, v54, v55
    s_waitcnt lgkmcnt(6)
    v_mfma_f32_32x32x16_bf16 v[0:15], v[96:99], a[0:3], 0
    v_add_u32 v185, 73728, v179
    ds_read_b64_tr_b16 a[48:49], v185 offset:0
    ds_read_b64_tr_b16 a[50:51], v185 offset:512
    buffer_store_dwordx4 v[48:51], v147, s[68:71], s41 offen offset:0 sc1
    v_cvt_pk_bf16_f32 v56, v56, v57
    v_mfma_f32_32x32x16_bf16 v[0:15], v[100:103], a[4:7], v[0:15]
    ds_read_b64_tr_b16 a[52:53], v185 offset:2048
    ds_read_b64_tr_b16 a[54:55], v185 offset:2560
    v_cvt_pk_bf16_f32 v57, v58, v59
    v_cvt_pk_bf16_f32 v58, v60, v61
    v_cvt_pk_bf16_f32 v59, v62, v63
    v_mfma_f32_32x32x16_bf16 v[0:15], v[104:107], a[8:11], v[0:15]
    ds_read_b64_tr_b16 a[56:57], v185 offset:4096
    ds_read_b64_tr_b16 a[58:59], v185 offset:4608
    buffer_store_dwordx4 v[56:59], v147, s[68:71], s41 offen offset:1024 sc1
    s_lshl_b32 s41, s28, 12
    s_add_u32 s41, s41, 20971520
    v_mfma_f32_32x32x16_bf16 v[0:15], v[108:111], a[12:15], v[0:15]
    ds_read_b64_tr_b16 a[60:61], v185 offset:6144
    ds_read_b64_tr_b16 a[62:63], v185 offset:6656
    v_cvt_pk_bf16_f32 v16, v16, v17
    v_cvt_pk_bf16_f32 v17, v18, v19
    v_cvt_pk_bf16_f32 v18, v20, v21
    v_cvt_pk_bf16_f32 v19, v22, v23
    v_mfma_f32_32x32x16_bf16 v[0:15], v[112:115], a[16:19], v[0:15]
    ds_read_b64_tr_b16 a[64:65], v185 offset:8192
    ds_read_b64_tr_b16 a[66:67], v185 offset:8704
    buffer_store_dwordx4 v[16:19], v147, s[68:71], s41 offen offset:0 sc1
    v_cvt_pk_bf16_f32 v24, v24, v25
    v_cvt_pk_bf16_f32 v25, v26, v27
    v_mfma_f32_32x32x16_bf16 v[0:15], v[116:119], a[20:23], v[0:15]
    ds_read_b64_tr_b16 a[68:69], v185 offset:10240
    ds_read_b64_tr_b16 a[70:71], v185 offset:10752
    v_cvt_pk_bf16_f32 v26, v28, v29
    v_cvt_pk_bf16_f32 v27, v30, v31
    s_waitcnt lgkmcnt(12)
    v_mfma_f32_32x32x16_bf16 v[0:15], v[120:123], a[24:27], v[0:15]
    ds_read_b64_tr_b16 a[0:1], v185 offset:12288
    ds_read_b64_tr_b16 a[2:3], v185 offset:12800
    buffer_store_dwordx4 v[24:27], v147, s[68:71], s41 offen offset:1024 sc1
    v_mfma_f32_32x32x16_bf16 v[0:15], v[124:127], a[28:31], v[0:15]
    ds_read_b64_tr_b16 a[4:5], v185 offset:14336
    ds_read_b64_tr_b16 a[6:7], v185 offset:14848
    v_mfma_f32_32x32x16_bf16 v[0:15], v[128:131], a[32:35], v[0:15]
    ds_read_b64_tr_b16 a[8:9], v185 offset:16384
    ds_read_b64_tr_b16 a[10:11], v185 offset:16896
    v_mfma_f32_32x32x16_bf16 v[0:15], v[132:135], a[36:39], v[0:15]
    ds_read_b64_tr_b16 a[12:13], v185 offset:18432
    ds_read_b64_tr_b16 a[14:15], v185 offset:18944
    v_mfma_f32_32x32x16_bf16 v[0:15], v[136:139], a[40:43], v[0:15]
    ds_read_b64_tr_b16 a[16:17], v185 offset:20480
    ds_read_b64_tr_b16 a[18:19], v185 offset:20992
    v_mfma_f32_32x32x16_bf16 v[0:15], v[140:143], a[44:47], v[0:15]
    ds_read_b64_tr_b16 a[20:21], v185 offset:22528
    ds_read_b64_tr_b16 a[22:23], v185 offset:23040
    s_waitcnt lgkmcnt(12)
    v_mfma_f32_32x32x16_bf16 v[0:15], a[72:75], a[48:51], v[0:15]
    s_lshl_b32 s92, s25, 6
    s_add_u32 s92, s92, 786432
    s_lshl_b32 s90, 1, s4
    buffer_load_dwordx4 v[190:193], v239, s[68:71], s92 offen sc1
    s_xor_b32 s80, s4, 3
    s_add_u32 s84, s80, s25
    s_lshl_b32 s84, s84, 12
    s_add_u32 s84, s84, 20971520
    s_xor_b32 s81, s4, 2
    s_add_u32 s85, s81, s25
    s_lshl_b32 s85, s85, 12
    s_add_u32 s85, s85, 20971520
    s_xor_b32 s82, s4, 1
    s_add_u32 s86, s82, s25
    s_lshl_b32 s86, s86, 12
    s_add_u32 s86, s86, 20971520
    v_mfma_f32_32x32x16_bf16 v[0:15], a[76:79], a[52:55], v[0:15]
    v_add_u32 v185, 122880, v179
    ds_read_b64_tr_b16 a[24:25], v185 offset:0
    ds_read_b64_tr_b16 a[26:27], v185 offset:512
    v_mfma_f32_32x32x16_bf16 v[0:15], a[80:83], a[56:59], v[0:15]
    ds_read_b64_tr_b16 a[28:29], v185 offset:2048
    ds_read_b64_tr_b16 a[30:31], v185 offset:2560
    ds_read_b64_tr_b16 a[32:33], v185 offset:4096
    v_mfma_f32_32x32x16_bf16 v[0:15], a[84:87], a[60:63], v[0:15]
    ds_read_b64_tr_b16 a[34:35], v185 offset:4608
    ds_read_b64_tr_b16 a[36:37], v185 offset:6144
    ds_read_b64_tr_b16 a[38:39], v185 offset:6656
    v_mfma_f32_32x32x16_bf16 v[0:15], a[88:91], a[64:67], v[0:15]
    ds_read_b64_tr_b16 a[40:41], v185 offset:8192
    ds_read_b64_tr_b16 a[42:43], v185 offset:8704
    v_mfma_f32_32x32x16_bf16 v[0:15], a[92:95], a[68:71], v[0:15]
    ds_read_b64_tr_b16 a[44:45], v185 offset:10240
    ds_read_b64_tr_b16 a[46:47], v185 offset:10752
    s_waitcnt lgkmcnt(12)
    v_mfma_f32_32x32x16_bf16 v[0:15], a[96:99], a[0:3], v[0:15]
    s_waitcnt vmcnt(5)
    s_lshl_b32 s12, s26, 6
    s_add_u32 s12, s12, 786432
    s_mov_b64 exec, 1
    buffer_store_dwordx2 v[198:199], v155, s[68:71], s12 offen sc1
    s_mov_b64 exec, -1
    v_mfma_f32_32x32x16_bf16 v[0:15], a[100:103], a[4:7], v[0:15]
    s_waitcnt vmcnt(4)
    s_lshl_b32 s12, s27, 6
    s_add_u32 s12, s12, 786432
    s_mov_b64 exec, 1
    buffer_store_dwordx2 v[198:199], v155, s[68:71], s12 offen sc1
    s_mov_b64 exec, -1
    v_mfma_f32_32x32x16_bf16 v[0:15], a[104:107], a[8:11], v[0:15]
    ds_read_b64_tr_b16 a[48:49], v185 offset:12288
    ds_read_b64_tr_b16 a[50:51], v185 offset:12800
    ds_read_b64_tr_b16 a[52:53], v185 offset:14336
    v_mfma_f32_32x32x16_bf16 v[0:15], a[108:111], a[12:15], v[0:15]
    ds_read_b64_tr_b16 a[54:55], v185 offset:14848
    ds_read_b64_tr_b16 a[56:57], v185 offset:16384
    ds_read_b64_tr_b16 a[58:59], v185 offset:16896
    v_mfma_f32_32x32x16_bf16 v[0:15], a[112:115], a[16:19], v[0:15]
    ds_read_b64_tr_b16 a[60:61], v185 offset:18432
    ds_read_b64_tr_b16 a[62:63], v185 offset:18944
    ds_read_b64_tr_b16 a[64:65], v185 offset:20480
    v_mfma_f32_32x32x16_bf16 v[0:15], a[116:119], a[20:23], v[0:15]
    ds_read_b64_tr_b16 a[66:67], v185 offset:20992
    ds_read_b64_tr_b16 a[68:69], v185 offset:22528
    ds_read_b64_tr_b16 a[70:71], v185 offset:23040
    s_waitcnt lgkmcnt(12)
    v_mfma_f32_32x32x16_bf16 v[0:15], a[120:123], a[24:27], v[0:15]
    v_add_u32 v186, 49152, v246
    ds_read_b128 a[0:3], v186 offset:2048
    v_mfma_f32_32x32x16_bf16 v[0:15], a[124:127], a[28:31], v[0:15]
    v_add_u32 v187, 49152, v247
    ds_read_b128 a[4:7], v187 offset:2048
    v_mfma_f32_32x32x16_bf16 v[0:15], a[128:131], a[32:35], v[0:15]
    ds_read_b128 a[8:11], v186 offset:6144
    v_mfma_f32_32x32x16_bf16 v[0:15], a[132:135], a[36:39], v[0:15]
    ds_read_b128 a[12:15], v187 offset:6144
    v_mfma_f32_32x32x16_bf16 v[0:15], a[136:139], a[40:43], v[0:15]
    ds_read_b128 a[16:19], v186 offset:10240
    v_mfma_f32_32x32x16_bf16 v[0:15], a[140:143], a[44:47], v[0:15]
    ds_read_b128 a[20:23], v187 offset:10240
    s_waitcnt lgkmcnt(6)
    v_mfma_f32_32x32x16_bf16 v[0:15], a[144:147], a[48:51], v[0:15]
    s_waitcnt vmcnt(3)
    s_lshl_b32 s12, s28, 6
    s_add_u32 s12, s12, 786432
    s_mov_b64 exec, 1
    buffer_store_dwordx2 v[198:199], v155, s[68:71], s12 offen sc1
    s_mov_b64 exec, -1
    v_mfma_f32_32x32x16_bf16 v[0:15], a[148:151], a[52:55], v[0:15]
    s_waitcnt vmcnt(3)
    v_cmp_eq_u64 vcc, s[88:89], v[190:191]
    s_nop 1
    s_and_b32 s91, vcc_lo, 15
    s_andn2_b32 s91, s91, s90
    s_or_b32 s90, s90, s91
    s_bitcmp1_b32 s91, s80
    s_cbranch_scc0 L_rs_61
    buffer_load_dwordx4 v[64:67], v147, s[68:71], s84 offen offset:0 sc1
    buffer_load_dwordx4 v[68:71], v147, s[68:71], s84 offen offset:1024 sc1
L_rs_61:
    s_bitcmp1_b32 s91, s81
    s_cbranch_scc0 L_rs_62
    buffer_load_dwordx4 v[72:75], v147, s[68:71], s85 offen offset:0 sc1
    buffer_load_dwordx4 v[76:79], v147, s[68:71], s85 offen offset:1024 sc1
L_rs_62:
    s_bitcmp1_b32 s91, s82
    s_cbranch_scc0 L_rs_63
    buffer_load_dwordx4 v[80:83], v147, s[68:71], s86 offen offset:0 sc1
    buffer_load_dwordx4 v[84:87], v147, s[68:71], s86 offen offset:1024 sc1
L_rs_63:
    buffer_load_dwordx4 v[190:193], v239, s[68:71], s92 offen sc1
    v_mfma_f32_32x32x16_bf16 v[0:15], a[152:155], a[56:59], v[0:15]
    ds_read_b128 a[24:27], v186 offset:14336
    ds_read_b128 a[28:31], v187 offset:14336
    v_mfma_f32_32x32x16_bf16 v[0:15], a[156:159], a[60:63], v[0:15]
    ds_read_b128 a[32:35], v186 offset:18432
    ds_read_b128 a[36:39], v187 offset:18432
    v_mfma_f32_32x32x16_bf16 v[0:15], a[160:163], a[64:67], v[0:15]
    ds_read_b128 a[40:43], v186 offset:22528
    v_mfma_f32_32x32x16_bf16 v[0:15], a[164:167], a[68:71], v[0:15]
    ds_read_b128 a[44:47], v187 offset:22528
    s_waitcnt lgkmcnt(6)
    v_mfma_f32_32x32x16_bf16 v[0:15], a[168:171], a[0:3], v[0:15]
    v_mfma_f32_32x32x16_bf16 v[0:15], a[172:175], a[4:7], v[0:15]
    v_mfma_f32_32x32x16_bf16 v[0:15], a[176:179], a[8:11], v[0:15]
    v_mfma_f32_32x32x16_bf16 v[0:15], a[180:183], a[12:15], v[0:15]
    v_mfma_f32_32x32x16_bf16 v[0:15], a[184:187], a[16:19], v[0:15]
    v_mfma_f32_32x32x16_bf16 v[0:15], a[188:191], a[20:23], v[0:15]
    v_mfma_f32_32x32x16_bf16 v[0:15], v[202:205], v[166:169], v[0:15]
    v_mfma_f32_32x32x16_bf16 v[0:15], v[206:209], v[170:173], v[0:15]
    v_mfma_f32_32x32x16_bf16 v[0:15], v[218:221], v[174:177], v[0:15]
    v_mfma_f32_32x32x16_bf16 v[0:15], v[222:225], v[234:237], v[0:15]
    s_waitcnt lgkmcnt(0)
    v_mfma_f32_32x32x16_bf16 v[0:15], a[192:195], a[24:27], v[0:15]
    v_mfma_f32_32x32x16_bf16 v[0:15], a[196:199], a[28:31], v[0:15]
    v_mfma_f32_32x32x16_bf16 v[0:15], a[200:203], a[32:35], v[0:15]
    v_mfma_f32_32x32x16_bf16 v[0:15], a[204:207], a[36:39], v[0:15]
    v_mfma_f32_32x32x16_bf16 v[0:15], a[208:211], a[40:43], v[0:15]
    v_mfma_f32_32x32x16_bf16 v[0:15], a[212:215], a[44:47], v[0:15]
    s_add_u32 s13, s93, 147456
    v_lshl_add_u32 v184, v145, 2, s13
    v_lshl_add_u32 v184, v146, 11, v184
    v_add_u32 v185, 128, v184
    s_mov_b32 s87, 0
    s_nop 7
L_rl_64:
    s_waitcnt vmcnt(0)
    s_mov_b32 s14, s91
    s_mov_b32 s15, s90
    v_cmp_eq_u64 vcc, s[88:89], v[190:191]
    s_nop 1
    s_and_b32 s91, vcc_lo, 15
    s_andn2_b32 s91, s91, s90
    s_or_b32 s90, s90, s91
    s_bitcmp1_b32 s91, s80
    s_cbranch_scc0 L_rs_66
    buffer_load_dwordx4 v[64:67], v147, s[68:71], s84 offen offset:0 sc1
    buffer_load_dwordx4 v[68:71], v147, s[68:71], s84 offen offset:1024 sc1
L_rs_66:
    s_bitcmp1_b32 s91, s81
    s_cbranch_scc0 L_rs_67
    buffer_load_dwordx4 v[72:75], v147, s[68:71], s85 offen offset:0 sc1
    buffer_load_dwordx4 v[76:79], v147, s[68:71], s85 offen offset:1024 sc1
L_rs_67:
    s_bitcmp1_b32 s91, s82
    s_cbranch_scc0 L_rs_68
    buffer_load_dwordx4 v[80:83], v147, s[68:71], s86 offen offset:0 sc1
    buffer_load_dwordx4 v[84:87], v147, s[68:71], s86 offen offset:1024 sc1
L_rs_68:
    buffer_load_dwordx4 v[190:193], v239, s[68:71], s92 offen sc1
    s_bitcmp1_b32 s14, s80
    s_cbranch_scc0 L_ra_69
    v_lshlrev_b32 v224, 16, v64
    v_and_b32 v225, 0xffff0000, v64
    v_pk_add_f32 v[0:1], v[0:1], v[224:225]
    v_lshlrev_b32 v226, 16, v65
    v_and_b32 v227, 0xffff0000, v65
    v_pk_add_f32 v[2:3], v[2:3], v[226:227]
    v_lshlrev_b32 v228, 16, v66
    v_and_b32 v229, 0xffff0000, v66
    v_pk_add_f32 v[4:5], v[4:5], v[228:229]
    v_lshlrev_b32 v230, 16, v67
    v_and_b32 v231, 0xffff0000, v67
    v_pk_add_f32 v[6:7], v[6:7], v[230:231]
    v_lshlrev_b32 v224, 16, v68
    v_and_b32 v225, 0xffff0000, v68
    v_pk_add_f32 v[8:9], v[8:9], v[224:225]
    v_lshlrev_b32 v226, 16, v69
    v_and_b32 v227, 0xffff0000, v69
    v_pk_add_f32 v[10:11], v[10:11], v[226:227]
    v_lshlrev_b32 v228, 16, v70
    v_and_b32 v229, 0xffff0000, v70
    v_pk_add_f32 v[12:13], v[12:13], v[228:229]
    v_lshlrev_b32 v230, 16, v71
    v_and_b32 v231, 0xffff0000, v71
    v_pk_add_f32 v[14:15], v[14:15], v[230:231]
L_ra_69:
    s_bitcmp1_b32 s14, s81
    s_cbranch_scc0 L_ra_70
    v_lshlrev_b32 v224, 16, v72
    v_and_b32 v225, 0xffff0000, v72
    v_pk_add_f32 v[0:1], v[0:1], v[224:225]
    v_lshlrev_b32 v226, 16, v73
    v_and_b32 v227, 0xffff0000, v73
    v_pk_add_f32 v[2:3], v[2:3], v[226:227]
    v_lshlrev_b32 v228, 16, v74
    v_and_b32 v229, 0xffff0000, v74
    v_pk_add_f32 v[4:5], v[4:5], v[228:229]
    v_lshlrev_b32 v230, 16, v75
    v_and_b32 v231, 0xffff0000, v75
    v_pk_add_f32 v[6:7], v[6:7], v[230:231]
    v_lshlrev_b32 v224, 16, v76
    v_and_b32 v225, 0xffff0000, v76
    v_pk_add_f32 v[8:9], v[8:9], v[224:225]
    v_lshlrev_b32 v226, 16, v77
    v_and_b32 v227, 0xffff0000, v77
    v_pk_add_f32 v[10:11], v[10:11], v[226:227]
    v_lshlrev_b32 v228, 16, v78
    v_and_b32 v229, 0xffff0000, v78
    v_pk_add_f32 v[12:13], v[12:13], v[228:229]
    v_lshlrev_b32 v230, 16, v79
    v_and_b32 v231, 0xffff0000, v79
    v_pk_add_f32 v[14:15], v[14:15], v[230:231]
L_ra_70:
    s_bitcmp1_b32 s14, s82
    s_cbranch_scc0 L_ra_71
    v_lshlrev_b32 v224, 16, v80
    v_and_b32 v225, 0xffff0000, v80
    v_pk_add_f32 v[0:1], v[0:1], v[224:225]
    v_lshlrev_b32 v226, 16, v81
    v_and_b32 v227, 0xffff0000, v81
    v_pk_add_f32 v[2:3], v[2:3], v[226:227]
    v_lshlrev_b32 v228, 16, v82
    v_and_b32 v229, 0xffff0000, v82
    v_pk_add_f32 v[4:5], v[4:5], v[228:229]
    v_lshlrev_b32 v230, 16, v83
    v_and_b32 v231, 0xffff0000, v83
    v_pk_add_f32 v[6:7], v[6:7], v[230:231]
    v_lshlrev_b32 v224, 16, v84
    v_and_b32 v225, 0xffff0000, v84
    v_pk_add_f32 v[8:9], v[8:9], v[224:225]
    v_lshlrev_b32 v226, 16, v85
    v_and_b32 v227, 0xffff0000, v85
    v_pk_add_f32 v[10:11], v[10:11], v[226:227]
    v_lshlrev_b32 v228, 16, v86
    v_and_b32 v229, 0xffff0000, v86
    v_pk_add_f32 v[12:13], v[12:13], v[228:229]
    v_lshlrev_b32 v230, 16, v87
    v_and_b32 v231, 0xffff0000, v87
    v_pk_add_f32 v[14:15], v[14:15], v[230:231]
L_ra_71:
    s_cmp_eq_u32 s15, 15
    s_cbranch_scc1 L_rf_65
    s_add_u32 s87, s87, 1
    s_cmp_lt_u32 s87, 40000
    s_cbranch_scc1 L_rl_64
L_rf_65:
    ds_write2st64_b32 v184, v0, v4 offset0:0 offset1:1
    ds_write2st64_b32 v184, v8, v12 offset0:2 offset1:3
    ds_write2st64_b32 v184, v1, v5 offset0:4 offset1:5
    ds_write2st64_b32 v184, v9, v13 offset0:6 offset1:7
    ds_write2st64_b32 v185, v2, v6 offset0:0 offset1:1
    ds_write2st64_b32 v185, v10, v14 offset0:2 offset1:3
    ds_write2st64_b32 v185, v3, v7 offset0:4 offset1:5
    ds_write2st64_b32 v185, v11, v15 offset0:6 offset1:7
    ds_read_b128 v[0:3], v157 offset:0
    ds_read_b128 v[4:7], v157 offset:1024
    ds_read_b128 v[8:11], v157 offset:2048
    ds_read_b128 v[12:15], v157 offset:3072
    s_waitcnt lgkmcnt(3)
    s_add_u32 s13, s29, 0
    buffer_store_dwordx4 v[0:3], v156, s[72:75], s13 offen offset:0 nt
    s_waitcnt lgkmcnt(2)
    s_add_u32 s13, s29, 20480
    buffer_store_dwordx4 v[4:7], v156, s[72:75], s13 offen offset:0 nt
    s_waitcnt lgkmcnt(1)
    s_add_u32 s13, s29, 40960
    buffer_store_dwordx4 v[8:11], v156, s[72:75], s13 offen offset:0 nt
    s_waitcnt lgkmcnt(0)
    s_add_u32 s13, s29, 61440
    buffer_store_dwordx4 v[12:15], v156, s[72:75], s13 offen offset:0 nt
    s_endpgm
LN_entry:
    v_add_u32 v184, 0, v178
    ds_read_b64_tr_b16 a[0:1], v184 offset:0
    ds_read_b64_tr_b16 a[2:3], v184 offset:512
    v_add_u32 v185, 0, v179
    ds_read_b64_tr_b16 a[4:5], v185 offset:0
    ds_read_b64_tr_b16 a[6:7], v185 offset:512
    ds_read_b64_tr_b16 a[8:9], v184 offset:2048
    ds_read_b64_tr_b16 a[10:11], v184 offset:2560
    ds_read_b64_tr_b16 a[12:13], v185 offset:2048
    ds_read_b64_tr_b16 a[14:15], v185 offset:2560
    ds_read_b64_tr_b16 a[16:17], v184 offset:4096
    ds_read_b64_tr_b16 a[18:19], v184 offset:4608
    ds_read_b64_tr_b16 a[20:21], v185 offset:4096
    ds_read_b64_tr_b16 a[22:23], v185 offset:4608
    ds_read_b64_tr_b16 a[24:25], v184 offset:6144
    ds_read_b64_tr_b16 a[26:27], v184 offset:6656
    ds_read_b64_tr_b16 a[28:29], v185 offset:6144
    ds_read_b64_tr_b16 a[30:31], v185 offset:6656
    ds_read_b64_tr_b16 a[32:33], v184 offset:8192
    ds_read_b64_tr_b16 a[34:35], v184 offset:8704
    ds_read_b64_tr_b16 a[36:37], v185 offset:8192
    ds_read_b64_tr_b16 a[38:39], v185 offset:8704
    ds_read_b64_tr_b16 a[40:41], v184 offset:10240
    ds_read_b64_tr_b16 a[42:43], v184 offset:10752
    ds_read_b64_tr_b16 a[44:45], v185 offset:10240
    ds_read_b64_tr_b16 a[46:47], v185 offset:10752
    s_waitcnt vmcnt(4)
    s_waitcnt lgkmcnt(12)
    v_mfma_f32_32x32x16_bf16 v[32:47], a[72:75], a[0:3], 0
    buffer_load_dwordx4 v[190:193], v239, s[68:71], s31 offen sc1
    ds_read_b64_tr_b16 a[48:49], v184 offset:12288
    ds_read_b64_tr_b16 a[50:51], v184 offset:12800
    ds_read_b64_tr_b16 a[52:53], v185 offset:12288
    s_add_u32 s40, s21, 0
    v_mfma_f32_32x32x16_bf16 v[48:63], a[72:75], a[4:7], 0
    ds_read_b64_tr_b16 a[54:55], v185 offset:12800
    ds_read_b64_tr_b16 a[56:57], v184 offset:14336
    ds_read_b64_tr_b16 a[58:59], v184 offset:14848
    buffer_load_dwordx4 a[120:123], v147, s[68:71], s40 offen offset:0 sc1
    v_mfma_f32_32x32x16_bf16 v[32:47], a[76:79], a[8:11], v[32:47]
    ds_read_b64_tr_b16 a[60:61], v185 offset:14336
    ds_read_b64_tr_b16 a[62:63], v185 offset:14848
    buffer_load_dwordx4 a[124:127], v147, s[68:71], s40 offen offset:1024 sc1
    v_mfma_f32_32x32x16_bf16 v[48:63], a[76:79], a[12:15], v[48:63]
    v_add_u32 v184, 24576, v178
    ds_read_b64_tr_b16 a[64:65], v184 offset:0
    buffer_load_dwordx4 a[128:131], v147, s[68:71], s40 offen offset:2048 sc1
    v_mfma_f32_32x32x16_bf16 v[32:47], a[80:83], a[16:19], v[32:47]
    ds_read_b64_tr_b16 a[66:67], v184 offset:512
    v_add_u32 v185, 24576, v179
    buffer_load_dwordx4 a[132:135], v147, s[68:71], s40 offen offset:3072 sc1
    s_add_u32 s40, s21, 4096
    v_mfma_f32_32x32x16_bf16 v[48:63], a[80:83], a[20:23], v[48:63]
    ds_read_b64_tr_b16 a[68:69], v185 offset:0
    ds_read_b64_tr_b16 a[70:71], v185 offset:512
    buffer_load_dwordx4 a[136:139], v147, s[68:71], s40 offen offset:0 sc1
    s_waitcnt vmcnt(6)
    s_waitcnt lgkmcnt(12)
    v_mfma_f32_32x32x16_bf16 v[32:47], a[84:87], a[24:27], v[32:47]
    ds_read_b64_tr_b16 a[0:1], v184 offset:2048
    ds_read_b64_tr_b16 a[2:3], v184 offset:2560
    buffer_load_dwordx4 a[140:143], v147, s[68:71], s40 offen offset:1024 sc1
    v_mfma_f32_32x32x16_bf16 v[48:63], a[84:87], a[28:31], v[48:63]
    ds_read_b64_tr_b16 a[4:5], v185 offset:2048
    ds_read_b64_tr_b16 a[6:7], v185 offset:2560
    buffer_load_dwordx4 a[144:147], v147, s[68:71], s40 offen offset:2048 sc1
    v_mfma_f32_32x32x16_bf16 v[32:47], a[88:91], a[32:35], v[32:47]
    ds_read_b64_tr_b16 a[8:9], v184 offset:4096
    ds_read_b64_tr_b16 a[10:11], v184 offset:4608
    buffer_load_dwordx4 a[148:151], v147, s[68:71], s40 offen offset:3072 sc1
    v_mfma_f32_32x32x16_bf16 v[48:63], a[88:91], a[36:39], v[48:63]
    ds_read_b64_tr_b16 a[12:13], v185 offset:4096
    ds_read_b64_tr_b16 a[14:15], v185 offset:4608
    v_mfma_f32_32x32x16_bf16 v[32:47], a[92:95], a[40:43], v[32:47]
    ds_read_b64_tr_b16 a[16:17], v184 offset:6144
    ds_read_b64_tr_b16 a[18:19], v184 offset:6656
    v_mfma_f32_32x32x16_bf16 v[48:63], a[92:95], a[44:47], v[48:63]
    ds_read_b64_tr_b16 a[20:21], v185 offset:6144
    ds_read_b64_tr_b16 a[22:23], v185 offset:6656
    s_waitcnt vmcnt(4)
    s_waitcnt lgkmcnt(12)
    v_mfma_f32_32x32x16_bf16 v[32:47], a[96:99], a[48:51], v[32:47]
    ds_read_b64_tr_b16 a[24:25], v184 offset:8192
    ds_read_b64_tr_b16 a[26:27], v184 offset:8704
    v_mfma_f32_32x32x16_bf16 v[48:63], a[96:99], a[52:55], v[48:63]
    ds_read_b64_tr_b16 a[28:29], v185 offset:8192
    ds_read_b64_tr_b16 a[30:31], v185 offset:8704
    v_mfma_f32_32x32x16_bf16 v[32:47], a[100:103], a[56:59], v[32:47]
    ds_read_b64_tr_b16 a[32:33], v184 offset:10240
    ds_read_b64_tr_b16 a[34:35], v184 offset:10752
    v_mfma_f32_32x32x16_bf16 v[48:63], a[100:103], a[60:63], v[48:63]
    ds_read_b64_tr_b16 a[36:37], v185 offset:10240
    ds_read_b64_tr_b16 a[38:39], v185 offset:10752
    v_mfma_f32_32x32x16_bf16 v[32:47], a[120:123], a[64:67], v[32:47]
    ds_read_b64_tr_b16 a[40:41], v184 offset:12288
    ds_read_b64_tr_b16 a[42:43], v184 offset:12800
    v_mfma_f32_32x32x16_bf16 v[48:63], a[120:123], a[68:71], v[48:63]
    ds_read_b64_tr_b16 a[44:45], v185 offset:12288
    ds_read_b64_tr_b16 a[46:47], v185 offset:12800
    s_waitcnt lgkmcnt(12)
    v_mfma_f32_32x32x16_bf16 v[32:47], a[124:127], a[0:3], v[32:47]
    s_or_b32 s13, s16, s17
    v_cmp_eq_u64 vcc, s[88:89], v[192:193]
    s_nop 1
    s_and_b32 s12, vcc_lo, s13
    s_cmp_eq_u32 s12, s13
    s_cbranch_scc0 L_rt_73
L_ok_72:
    v_mfma_f32_32x32x16_bf16 v[48:63], a[124:127], a[4:7], v[48:63]
    buffer_load_dwordx4 v[190:193], v239, s[68:71], s31 offen sc1
    ds_read_b64_tr_b16 a[48:49], v184 offset:14336
    ds_read_b64_tr_b16 a[50:51], v184 offset:14848
    ds_read_b64_tr_b16 a[52:53], v185 offset:14336
    s_add_u32 s40, s20, 8192
    v_mfma_f32_32x32x16_bf16 v[32:47], a[128:131], a[8:11], v[32:47]
    ds_read_b64_tr_b16 a[54:55], v185 offset:14848
    v_add_u32 v184, 0, v178
    ds_read_b64_tr_b16 a[56:57], v184 offset:16384
    buffer_load_dwordx4 a[104:107], v147, s[68:71], s40 offen offset:0 sc1
    v_mfma_f32_32x32x16_bf16 v[48:63], a[128:131], a[12:15], v[48:63]
    ds_read_b64_tr_b16 a[58:59], v184 offset:16896
    v_add_u32 v185, 0, v179
    ds_read_b64_tr_b16 a[60:61], v185 offset:16384
    buffer_load_dwordx4 a[108:111], v147, s[68:71], s40 offen offset:1024 sc1
    v_mfma_f32_32x32x16_bf16 v[32:47], a[132:135], a[16:19], v[32:47]
    ds_read_b64_tr_b16 a[62:63], v185 offset:16896
    ds_read_b64_tr_b16 a[64:65], v184 offset:18432
    ds_read_b64_tr_b16 a[66:67], v184 offset:18944
    buffer_load_dwordx4 a[112:115], v147, s[68:71], s40 offen offset:2048 sc1
    v_mfma_f32_32x32x16_bf16 v[48:63], a[132:135], a[20:23], v[48:63]
    ds_read_b64_tr_b16 a[68:69], v185 offset:18432
    ds_read_b64_tr_b16 a[70:71], v185 offset:18944
    buffer_load_dwordx4 a[116:119], v147, s[68:71], s40 offen offset:3072 sc1
    s_add_u32 s40, s21, 8192
    s_waitcnt vmcnt(5)
    s_waitcnt lgkmcnt(12)
    v_mfma_f32_32x32x16_bf16 v[32:47], a[136:139], a[24:27], v[32:47]
    ds_read_b64_tr_b16 a[0:1], v184 offset:20480
    ds_read_b64_tr_b16 a[2:3], v184 offset:20992
    ds_read_b64_tr_b16 a[4:5], v185 offset:20480
    buffer_load_dwordx4 a[152:155], v147, s[68:71], s40 offen offset:0 sc1
    v_mfma_f32_32x32x16_bf16 v[48:63], a[136:139], a[28:31], v[48:63]
    ds_read_b64_tr_b16 a[6:7], v185 offset:20992
    ds_read_b64_tr_b16 a[8:9], v184 offset:22528
    ds_read_b64_tr_b16 a[10:11], v184 offset:23040
    buffer_load_dwordx4 a[156:159], v147, s[68:71], s40 offen offset:1024 sc1
    v_mfma_f32_32x32x16_bf16 v[32:47], a[140:143], a[32:35], v[32:47]
    ds_read_b64_tr_b16 a[12:13], v185 offset:22528
    ds_read_b64_tr_b16 a[14:15], v185 offset:23040
    buffer_load_dwordx4 a[160:163], v147, s[68:71], s40 offen offset:2048 sc1
    v_mfma_f32_32x32x16_bf16 v[48:63], a[140:143], a[36:39], v[48:63]
    v_add_u32 v184, 24576, v178
    ds_read_b64_tr_b16 a[16:17], v184 offset:16384
    buffer_load_dwordx4 a[164:167], v147, s[68:71], s40 offen offset:3072 sc1
    v_mfma_f32_32x32x16_bf16 v[32:47], a[144:147], a[40:43], v[32:47]
    ds_read_b64_tr_b16 a[18:19], v184 offset:16896
    v_add_u32 v185, 24576, v179
    v_mfma_f32_32x32x16_bf16 v[48:63], a[144:147], a[44:47], v[48:63]
    ds_read_b64_tr_b16 a[20:21], v185 offset:16384
    ds_read_b64_tr_b16 a[22:23], v185 offset:16896
    s_waitcnt vmcnt(4)
    s_waitcnt lgkmcnt(12)
    v_mfma_f32_32x32x16_bf16 v[32:47], a[148:151], a[48:51], v[32:47]
    v_mfma_f32_32x32x16_bf16 v[48:63], a[148:151], a[52:55], v[48:63]
    v_mfma_f32_32x32x16_bf16 v[32:47], a[104:107], a[56:59], v[32:47]
    s_waitcnt lgkmcnt(0)
    s_barrier
    v_mfma_f32_32x32x16_bf16 v[48:63], a[104:107], a[60:63], v[48:63]
    ds_read_b64_tr_b16 a[24:25], v184 offset:18432
    ds_read_b64_tr_b16 a[26:27], v184 offset:18944
    ds_read_b64_tr_b16 a[28:29], v185 offset:18432
    ds_read_b64_tr_b16 a[30:31], v185 offset:18944
    s_add_u32 s35, s82, s85
    s_add_u32 m0, s94, 0
    v_mfma_f32_32x32x16_bf16 v[32:47], a[108:111], a[64:67], v[32:47]
    ds_read_b64_tr_b16 a[32:33], v184 offset:20480
    ds_read_b64_tr_b16 a[34:35], v184 offset:20992
    ds_read_b64_tr_b16 a[36:37], v185 offset:20480
    ds_read_b64_tr_b16 a[38:39], v185 offset:20992
    v_mfma_f32_32x32x16_bf16 v[48:63], a[108:111], a[68:71], v[48:63]
    ds_read_b64_tr_b16 a[40:41], v184 offset:22528
    ds_read_b64_tr_b16 a[42:43], v184 offset:23040
    ds_read_b64_tr_b16 a[44:45], v185 offset:22528
    ds_read_b64_tr_b16 a[46:47], v185 offset:23040
    buffer_load_dwordx4 v158, s[56:59], s35 offen lds
    s_add_u32 m0, s94, 4096
    s_waitcnt vmcnt(1)
    v_mfma_f32_32x32x16_bf16 v[32:47], a[112:115], a[0:3], v[32:47]
    v_cmp_eq_u64 vcc, s[88:89], v[192:193]
    s_nop 1
    s_and_b32 s12, vcc_lo, s18
    s_cmp_eq_u32 s12, s18
    s_cbranch_scc0 L_rt_75
L_ok_74:
    v_mfma_f32_32x32x16_bf16 v[48:63], a[112:115], a[4:7], v[48:63]
    buffer_load_dwordx4 v[190:193], v239, s[68:71], s31 offen sc1
    buffer_load_dwordx4 v159, s[56:59], s35 offen lds
    s_add_u32 s40, s22, 0
    v_mfma_f32_32x32x16_bf16 v[32:47], a[116:119], a[8:11], v[32:47]
    buffer_load_dwordx4 a[168:171], v147, s[68:71], s40 offen offset:0 sc1
    s_waitcnt lgkmcnt(0)
    s_barrier
    v_mfma_f32_32x32x16_bf16 v[48:63], a[116:119], a[12:15], v[48:63]
    v_add_u32 v184, 49152, v178
    ds_read_b64_tr_b16 a[48:49], v184 offset:0
    ds_read_b64_tr_b16 a[50:51], v184 offset:512
    ds_read_b64_tr_b16 a[52:53], v184 offset:2048
    ds_read_b64_tr_b16 a[54:55], v184 offset:2560
    buffer_load_dwordx4 a[172:175], v147, s[68:71], s40 offen offset:1024 sc1
    v_mfma_f32_32x32x16_bf16 v[32:47], a[152:155], a[16:19], v[32:47]
    ds_read_b64_tr_b16 a[56:57], v184 offset:4096
    ds_read_b64_tr_b16 a[58:59], v184 offset:4608
    ds_read_b64_tr_b16 a[60:61], v184 offset:6144
    ds_read_b64_tr_b16 a[62:63], v184 offset:6656
    buffer_load_dwordx4 a[176:179], v147, s[68:71], s40 offen offset:2048 sc1
    v_mfma_f32_32x32x16_bf16 v[48:63], a[152:155], a[20:23], v[48:63]
    ds_read_b64_tr_b16 a[64:65], v184 offset:8192
    ds_read_b64_tr_b16 a[66:67], v184 offset:8704
    ds_read_b64_tr_b16 a[68:69], v184 offset:10240
    ds_read_b64_tr_b16 a[70:71], v184 offset:10752
    buffer_load_dwordx4 a[180:183], v147, s[68:71], s40 offen offset:3072 sc1
    s_add_u32 s40, s22, 4096
    v_mfma_f32_32x32x16_bf16 v[32:47], a[156:159], a[24:27], v[32:47]
    ds_read_b64_tr_b16 a[0:1], v184 offset:12288
    ds_read_b64_tr_b16 a[2:3], v184 offset:12800
    buffer_load_dwordx4 a[184:187], v147, s[68:71], s40 offen offset:0 sc1
    v_mfma_f32_32x32x16_bf16 v[48:63], a[156:159], a[28:31], v[48:63]
    ds_read_b64_tr_b16 a[4:5], v184 offset:14336
    ds_read_b64_tr_b16 a[6:7], v184 offset:14848
    buffer_load_dwordx4 a[188:191], v147, s[68:71], s40 offen offset:1024 sc1
    v_mfma_f32_32x32x16_bf16 v[32:47], a[160:163], a[32:35], v[32:47]
    ds_read_b64_tr_b16 a[8:9], v184 offset:16384
    ds_read_b64_tr_b16 a[10:11], v184 offset:16896
    buffer_load_dwordx4 a[192:195], v147, s[68:71], s40 offen offset:2048 sc1
    v_mfma_f32_32x32x16_bf16 v[48:63], a[160:163], a[36:39], v[48:63]
    ds_read_b64_tr_b16 a[12:13], v184 offset:18432
    ds_read_b64_tr_b16 a[14:15], v184 offset:18944
    v_mfma_f32_32x32x16_bf16 v[32:47], a[164:167], a[40:43], v[32:47]
    ds_read_b64_tr_b16 a[16:17], v184 offset:20480
    ds_read_b64_tr_b16 a[18:19], v184 offset:20992
    buffer_load_dwordx4 a[196:199], v147, s[68:71], s40 offen offset:3072 sc1
    s_add_u32 s40, s22, 8192
    v_mfma_f32_32x32x16_bf16 v[48:63], a[164:167], a[44:47], v[48:63]
    ds_read_b64_tr_b16 a[20:21], v184 offset:22528
    ds_read_b64_tr_b16 a[22:23], v184 offset:23040
    s_waitcnt lgkmcnt(12)
    v_mfma_f32_32x32x16_bf16 v[16:31], a[72:75], a[48:51], 0
    v_add_u32 v184, 73728, v178
    ds_read_b64_tr_b16 a[24:25], v184 offset:0
    ds_read_b64_tr_b16 a[26:27], v184 offset:512
    buffer_load_dwordx4 a[200:203], v147, s[68:71], s40 offen offset:0 sc1
    v_mfma_f32_32x32x16_bf16 v[16:31], a[76:79], a[52:55], v[16:31]
    ds_read_b64_tr_b16 a[28:29], v184 offset:2048
    ds_read_b64_tr_b16 a[30:31], v184 offset:2560
    v_mfma_f32_32x32x16_bf16 v[16:31], a[80:83], a[56:59], v[16:31]
    ds_read_b64_tr_b16 a[32:33], v184 offset:4096
    ds_read_b64_tr_b16 a[34:35], v184 offset:4608
    buffer_load_dwordx4 a[204:207], v147, s[68:71], s40 offen offset:1024 sc1
    v_mfma_f32_32x32x16_bf16 v[16:31], a[84:87], a[60:63], v[16:31]
    ds_read_b64_tr_b16 a[36:37], v184 offset:6144
    ds_read_b64_tr_b16 a[38:39], v184 offset:6656
    v_mfma_f32_32x32x16_bf16 v[16:31], a[88:91], a[64:67], v[16:31]
    ds_read_b64_tr_b16 a[40:41], v184 offset:8192
    ds_read_b64_tr_b16 a[42:43], v184 offset:8704
    buffer_load_dwordx4 a[208:211], v147, s[68:71], s40 offen offset:2048 sc1
    v_mfma_f32_32x32x16_bf16 v[16:31], a[92:95], a[68:71], v[16:31]
    ds_read_b64_tr_b16 a[44:45], v184 offset:10240
    ds_read_b64_tr_b16 a[46:47], v184 offset:10752
    s_waitcnt lgkmcnt(12)
    v_mfma_f32_32x32x16_bf16 v[16:31], a[96:99], a[0:3], v[16:31]
    s_waitcnt vmcnt(12)
    v_cmp_eq_u64 vcc, s[88:89], v[192:193]
    s_nop 1
    s_and_b32 s12, vcc_lo, s19
    s_cmp_eq_u32 s12, s19
    s_cbranch_scc0 L_rt_77
L_ok_76:
    v_mfma_f32_32x32x16_bf16 v[16:31], a[100:103], a[4:7], v[16:31]
    ds_read_b64_tr_b16 a[48:49], v184 offset:12288
    ds_read_b64_tr_b16 a[50:51], v184 offset:12800
    ds_read_b64_tr_b16 a[52:53], v184 offset:14336
    buffer_load_dwordx4 a[212:215], v147, s[68:71], s40 offen offset:3072 sc1
    s_add_u32 s40, s23, 0
    v_mfma_f32_32x32x16_bf16 v[16:31], a[104:107], a[8:11], v[16:31]
    ds_read_b64_tr_b16 a[54:55], v184 offset:14848
    ds_read_b64_tr_b16 a[56:57], v184 offset:16384
    ds_read_b64_tr_b16 a[58:59], v184 offset:16896
    buffer_load_dwordx4 v[96:99], v147, s[68:71], s40 offen offset:0 sc1
    v_mfma_f32_32x32x16_bf16 v[16:31], a[108:111], a[12:15], v[16:31]
    ds_read_b64_tr_b16 a[60:61], v184 offset:18432
    ds_read_b64_tr_b16 a[62:63], v184 offset:18944
    v_mfma_f32_32x32x16_bf16 v[16:31], a[112:115], a[16:19], v[16:31]
    ds_read_b64_tr_b16 a[64:65], v184 offset:20480
    ds_read_b64_tr_b16 a[66:67], v184 offset:20992
    buffer_load_dwordx4 v[100:103], v147, s[68:71], s40 offen offset:1024 sc1
    v_mfma_f32_32x32x16_bf16 v[16:31], a[116:119], a[20:23], v[16:31]
    ds_read_b64_tr_b16 a[68:69], v184 offset:22528
    ds_read_b64_tr_b16 a[70:71], v184 offset:23040
    s_waitcnt lgkmcnt(12)
    v_mfma_f32_32x32x16_bf16 v[16:31], a[120:123], a[24:27], v[16:31]
    v_add_u32 v184, 98304, v178
    ds_read_b64_tr_b16 a[0:1], v184 offset:0
    ds_read_b64_tr_b16 a[2:3], v184 offset:512
    buffer_load_dwordx4 v[104:107], v147, s[68:71], s40 offen offset:2048 sc1
    v_mfma_f32_32x32x16_bf16 v[16:31], a[124:127], a[28:31], v[16:31]
    v_add_u32 v185, 98304, v179
    ds_read_b64_tr_b16 a[4:5], v185 offset:0
    ds_read_b64_tr_b16 a[6:7], v185 offset:512
    v_mfma_f32_32x32x16_bf16 v[16:31], a[128:131], a[32:35], v[16:31]
    ds_read_b64_tr_b16 a[8:9], v184 offset:2048
    ds_read_b64_tr_b16 a[10:11], v184 offset:2560
    buffer_load_dwordx4 v[108:111], v147, s[68:71], s40 offen offset:3072 sc1
    s_add_u32 s40, s23, 4096
    v_mfma_f32_32x32x16_bf16 v[16:31], a[132:135], a[36:39], v[16:31]
    ds_read_b64_tr_b16 a[12:13], v185 offset:2048
    ds_read_b64_tr_b16 a[14:15], v185 offset:2560
    v_mfma_f32_32x32x16_bf16 v[16:31], a[136:139], a[40:43], v[16:31]
    ds_read_b64_tr_b16 a[16:17], v184 offset:4096
    ds_read_b64_tr_b16 a[18:19], v184 offset:4608
    buffer_load_dwordx4 v[112:115], v147, s[68:71], s40 offen offset:0 sc1
    v_mfma_f32_32x32x16_bf16 v[16:31], a[140:143], a[44:47], v[16:31]
    ds_read_b64_tr_b16 a[20:21], v185 offset:4096
    ds_read_b64_tr_b16 a[22:23], v185 offset:4608
    s_waitcnt lgkmcnt(12)
    v_mfma_f32_32x32x16_bf16 v[16:31], a[144:147], a[48:51], v[16:31]
    ds_read_b64_tr_b16 a[24:25], v184 offset:6144
    ds_read_b64_tr_b16 a[26:27], v184 offset:6656
    buffer_load_dwordx4 v[116:119], v147, s[68:71], s40 offen offset:1024 sc1
    v_mfma_f32_32x32x16_bf16 v[16:31], a[148:151], a[52:55], v[16:31]
    ds_read_b64_tr_b16 a[28:29], v185 offset:6144
    ds_read_b64_tr_b16 a[30:31], v185 offset:6656
    v_mfma_f32_32x32x16_bf16 v[16:31], a[152:155], a[56:59], v[16:31]
    ds_read_b64_tr_b16 a[32:33], v184 offset:8192
    ds_read_b64_tr_b16 a[34:35], v184 offset:8704
    buffer_load_dwordx4 v[120:123], v147, s[68:71], s40 offen offset:2048 sc1
    v_mfma_f32_32x32x16_bf16 v[16:31], a[156:159], a[60:63], v[16:31]
    ds_read_b64_tr_b16 a[36:37], v185 offset:8192
    ds_read_b64_tr_b16 a[38:39], v185 offset:8704
    v_mfma_f32_32x32x16_bf16 v[16:31], a[160:163], a[64:67], v[16:31]
    ds_read_b64_tr_b16 a[40:41], v184 offset:10240
    ds_read_b64_tr_b16 a[42:43], v184 offset:10752
    buffer_load_dwordx4 v[124:127], v147, s[68:71], s40 offen offset:3072 sc1
    s_add_u32 m0, s94, 8192
    v_mfma_f32_32x32x16_bf16 v[16:31], a[164:167], a[68:71], v[16:31]
    ds_read_b64_tr_b16 a[44:45], v185 offset:10240
    ds_read_b64_tr_b16 a[46:47], v185 offset:10752
    s_waitcnt vmcnt(16)
    s_waitcnt lgkmcnt(12)
    v_mfma_f32_32x32x16_bf16 v[32:47], a[168:171], a[0:3], v[32:47]
    ds_read_b64_tr_b16 a[48:49], v184 offset:12288
    ds_read_b64_tr_b16 a[50:51], v184 offset:12800
    buffer_load_dwordx4 v160, s[56:59], s35 offen lds
    s_add_u32 m0, s94, 12288
    v_mfma_f32_32x32x16_bf16 v[48:63], a[168:171], a[4:7], v[48:63]
    ds_read_b64_tr_b16 a[52:53], v185 offset:12288
    ds_read_b64_tr_b16 a[54:55], v185 offset:12800
    v_mfma_f32_32x32x16_bf16 v[32:47], a[172:175], a[8:11], v[32:47]
    ds_read_b64_tr_b16 a[56:57], v184 offset:14336
    ds_read_b64_tr_b16 a[58:59], v184 offset:14848
    buffer_load_dwordx4 v161, s[56:59], s35 offen lds
    s_add_u32 m0, s94, 16384
    v_mfma_f32_32x32x16_bf16 v[48:63], a[172:175], a[12:15], v[48:63]
    ds_read_b64_tr_b16 a[60:61], v185 offset:14336
    ds_read_b64_tr_b16 a[62:63], v185 offset:14848
    v_mfma_f32_32x32x16_bf16 v[32:47], a[176:179], a[16:19], v[32:47]
    ds_read_b64_tr_b16 a[64:65], v184 offset:16384
    ds_read_b64_tr_b16 a[66:67], v184 offset:16896
    buffer_load_dwordx4 v162, s[56:59], s35 offen lds
    s_add_u32 m0, s94, 20480
    v_mfma_f32_32x32x16_bf16 v[48:63], a[176:179], a[20:23], v[48:63]
    ds_read_b64_tr_b16 a[68:69], v185 offset:16384
    ds_read_b64_tr_b16 a[70:71], v185 offset:16896
    s_waitcnt vmcnt(15)
    s_waitcnt lgkmcnt(12)
    v_mfma_f32_32x32x16_bf16 v[32:47], a[180:183], a[24:27], v[32:47]
    ds_read_b64_tr_b16 a[0:1], v184 offset:18432
    ds_read_b64_tr_b16 a[2:3], v184 offset:18944
    buffer_load_dwordx4 v163, s[56:59], s35 offen lds
    s_add_u32 s35, s83, s91
    s_add_u32 m0, s94, 24576
    v_bfe_u32 v148, v145, 2, 1
    v_mfma_f32_32x32x16_bf16 v[48:63], a[180:183], a[28:31], v[48:63]
    ds_read_b64_tr_b16 a[4:5], v185 offset:18432
    ds_read_b64_tr_b16 a[6:7], v185 offset:18944
    v_lshlrev_b32 v148, 4, v148
    v_and_b32 v149, 1, v145
    v_lshl_or_b32 v148, v149, 3, v148
    v_bfe_u32 v149, v145, 3, 2
    v_mfma_f32_32x32x16_bf16 v[32:47], a[184:187], a[32:35], v[32:47]
    ds_read_b64_tr_b16 a[8:9], v184 offset:20480
    ds_read_b64_tr_b16 a[10:11], v184 offset:20992
    buffer_load_dwordx4 v164, s[60:63], s35 offen lds
    s_add_u32 m0, s94, 28672
    v_lshl_or_b32 v148, v149, 1, v148
    v_bfe_u32 v149, v145, 1, 1
    v_mfma_f32_32x32x16_bf16 v[48:63], a[184:187], a[36:39], v[48:63]
    ds_read_b64_tr_b16 a[12:13], v185 offset:20480
    ds_read_b64_tr_b16 a[14:15], v185 offset:20992
    v_or_b32 v148, v148, v149
    v_add_u32 v148, s100, v148
    v_mul_u32_u24 v148, 1280, v148
    v_lshl_add_u32 v148, v146, 4, v148
    v_mfma_f32_32x32x16_bf16 v[32:47], a[188:191], a[40:43], v[32:47]
    ds_read_b64_tr_b16 a[16:17], v184 offset:22528
    ds_read_b64_tr_b16 a[18:19], v184 offset:23040
    buffer_load_dwordx4 v165, s[60:63], s35 offen lds
    s_add_u32 m0, s94, 32768
    v_lshl_add_u32 v149, v145, 1, s30
    v_min_u32 v149, 1278, v149
    v_mfma_f32_32x32x16_bf16 v[48:63], a[188:191], a[44:47], v[48:63]
    ds_read_b64_tr_b16 a[20:21], v185 offset:22528
    ds_read_b64_tr_b16 a[22:23], v185 offset:23040
    s_waitcnt vmcnt(14)
    s_waitcnt lgkmcnt(12)
    v_mfma_f32_32x32x16_bf16 v[32:47], a[192:195], a[48:51], v[32:47]
    v_add_u32 v186, 122880, v180
    ds_read_b128 a[24:27], v186 offset:0
    v_mfma_f32_32x32x16_bf16 v[48:63], a[192:195], a[52:55], v[48:63]
    ds_read_b128 a[28:31], v186 offset:4096
    v_add_u32 v187, 122880, v181
    v_mfma_f32_32x32x16_bf16 v[32:47], a[196:199], a[56:59], v[32:47]
    ds_read_b128 a[32:35], v187 offset:0
    ds_read_b128 a[36:39], v187 offset:4096
    v_mfma_f32_32x32x16_bf16 v[48:63], a[196:199], a[60:63], v[48:63]
    v_add_u32 v188, 122880, v182
    v_mfma_f32_32x32x16_bf16 v[32:47], a[200:203], a[64:67], v[32:47]
    ds_read_b128 a[40:43], v188 offset:0
    v_mfma_f32_32x32x16_bf16 v[48:63], a[200:203], a[68:71], v[48:63]
    ds_read_b128 a[44:47], v188 offset:4096
    s_waitcnt lgkmcnt(6)
    v_mfma_f32_32x32x16_bf16 v[32:47], a[204:207], a[0:3], v[32:47]
    v_add_u32 v189, 122880, v183
    ds_read_b128 a[48:51], v189 offset:0
    v_mfma_f32_32x32x16_bf16 v[48:63], a[204:207], a[4:7], v[48:63]
    ds_read_b128 a[52:55], v189 offset:4096
    buffer_load_dwordx4 v[202:205], v148, s[48:51], s30 offen offset:0
    v_mfma_f32_32x32x16_bf16 v[32:47], a[208:211], a[8:11], v[32:47]
    ds_read_b128 a[56:59], v186 offset:8192
    v_mfma_f32_32x32x16_bf16 v[48:63], a[208:211], a[12:15], v[48:63]
    ds_read_b128 a[60:63], v186 offset:12288
    buffer_load_dwordx4 v[206:209], v148, s[48:51], s30 offen offset:32
    v_mfma_f32_32x32x16_bf16 v[32:47], a[212:215], a[16:19], v[32:47]
    ds_read_b128 a[64:67], v187 offset:8192
    global_load_ushort v152, v149, s[32:33] offset:0
    v_and_b32 v150, 1, v145
    v_lshlrev_b32 v150, 4, v150
    v_mov_b32 v151, 0x3f80
    v_mfma_f32_32x32x16_bf16 v[48:63], a[212:215], a[20:23], v[48:63]
    ds_read_b128 a[68:71], v187 offset:12288
    buffer_load_dwordx4 v164, s[64:67], s35 offen lds
    s_add_u32 m0, s94, 36864
    v_lshlrev_b32 v151, v150, v151
    v_lshrrev_b32 v148, 1, v145
    v_lshlrev_b32 v149, 2, v146
    s_waitcnt vmcnt(14)
    s_waitcnt lgkmcnt(6)
    v_mfma_f32_32x32x16_bf16 v[32:47], v[96:99], a[24:27], v[32:47]
    buffer_load_dwordx4 v165, s[64:67], s35 offen lds
    v_sub_u32 v148, v148, v149
    v_mul_f32 v195, v194, v196
    v_mfma_f32_32x32x16_bf16 v[48:63], v[96:99], a[28:31], v[48:63]
    v_mfma_f32_32x32x16_bf16 v[32:47], v[100:103], a[32:35], v[32:47]
    s_waitcnt lgkmcnt(0)
    s_waitcnt vmcnt(7)
    s_barrier
    v_mfma_f32_32x32x16_bf16 v[48:63], v[100:103], a[36:39], v[48:63]
    ds_read_b128 a[0:3], v188 offset:8192
    ds_read_b128 a[4:7], v188 offset:12288
    ds_read_b128 a[8:11], v189 offset:8192
    v_mfma_f32_32x32x16_bf16 v[32:47], v[104:107], a[40:43], v[32:47]
    ds_read_b128 a[12:15], v189 offset:12288
    v_add_u32 v184, 0, v178
    ds_read_b64_tr_b16 a[16:17], v184 offset:0
    v_mfma_f32_32x32x16_bf16 v[48:63], v[104:107], a[44:47], v[48:63]
    ds_read_b64_tr_b16 a[18:19], v184 offset:512
    ds_read_b64_tr_b16 a[20:21], v184 offset:2048
    ds_read_b64_tr_b16 a[22:23], v184 offset:2560
    v_mfma_f32_32x32x16_bf16 v[32:47], v[108:111], a[48:51], v[32:47]
    ds_read_b64_tr_b16 a[24:25], v184 offset:4096
    ds_read_b64_tr_b16 a[26:27], v184 offset:4608
    v_mfma_f32_32x32x16_bf16 v[48:63], v[108:111], a[52:55], v[48:63]
    ds_read_b64_tr_b16 a[28:29], v184 offset:6144
    ds_read_b64_tr_b16 a[30:31], v184 offset:6656
    v_mfma_f32_32x32x16_bf16 v[32:47], v[112:115], a[56:59], v[32:47]
    ds_read_b64_tr_b16 a[32:33], v184 offset:8192
    ds_read_b64_tr_b16 a[34:35], v184 offset:8704
    v_mfma_f32_32x32x16_bf16 v[48:63], v[112:115], a[60:63], v[48:63]
    ds_read_b64_tr_b16 a[36:37], v184 offset:10240
    ds_read_b64_tr_b16 a[38:39], v184 offset:10752
    v_mfma_f32_32x32x16_bf16 v[32:47], v[116:119], a[64:67], v[32:47]
    ds_read_b64_tr_b16 a[40:41], v184 offset:12288
    ds_read_b64_tr_b16 a[42:43], v184 offset:12800
    v_mfma_f32_32x32x16_bf16 v[48:63], v[116:119], a[68:71], v[48:63]
    ds_read_b64_tr_b16 a[44:45], v184 offset:14336
    ds_read_b64_tr_b16 a[46:47], v184 offset:14848
    s_waitcnt lgkmcnt(12)
    v_mfma_f32_32x32x16_bf16 v[32:47], v[120:123], a[0:3], v[32:47]
    v_mfma_f32_32x32x16_bf16 v[48:63], v[120:123], a[4:7], v[48:63]
    v_mfma_f32_32x32x16_bf16 v[32:47], v[124:127], a[8:11], v[32:47]
    s_waitcnt lgkmcnt(0)
    s_waitcnt vmcnt(0)
    s_barrier
    v_mfma_f32_32x32x16_bf16 v[48:63], v[124:127], a[12:15], v[48:63]
    ds_read_b64_tr_b16 a[48:49], v184 offset:16384
    ds_read_b64_tr_b16 a[50:51], v184 offset:16896
    ds_read_b64_tr_b16 a[52:53], v184 offset:18432
    ds_read_b64_tr_b16 a[54:55], v184 offset:18944
    v_mfma_f32_32x32x16_bf16 v[16:31], a[168:171], a[16:19], v[16:31]
    ds_read_b64_tr_b16 a[56:57], v184 offset:20480
    ds_read_b64_tr_b16 a[58:59], v184 offset:20992
    ds_read_b64_tr_b16 a[60:61], v184 offset:22528
    ds_read_b64_tr_b16 a[62:63], v184 offset:23040
    v_mfma_f32_32x32x16_bf16 v[16:31], a[172:175], a[20:23], v[16:31]
    v_add_u32 v186, 24576, v180
    ds_read_b128 a[64:67], v186 offset:0
    v_add_u32 v187, 24576, v181
    ds_read_b128 a[68:71], v187 offset:0
    v_mfma_f32_32x32x16_bf16 v[16:31], a[176:179], a[24:27], v[16:31]
    v_add_u32 v188, 24576, v182
    ds_read_b128 a[0:3], v188 offset:0
    s_lshl_b32 s41, s26, 12
    s_add_u32 s41, s41, 20971520
    v_cvt_pk_bf16_f32 v32, v32, v33
    v_cvt_pk_bf16_f32 v33, v34, v35
    v_mfma_f32_32x32x16_bf16 v[16:31], a[180:183], a[28:31], v[16:31]
    v_add_u32 v189, 24576, v183
    ds_read_b128 a[4:7], v189 offset:0
    v_cvt_pk_bf16_f32 v34, v36, v37
    v_cvt_pk_bf16_f32 v35, v38, v39
    buffer_store_dwordx4 v[32:35], v147, s[68:71], s41 offen offset:0 sc1
    v_mfma_f32_32x32x16_bf16 v[16:31], a[184:187], a[32:35], v[16:31]
    ds_read_b128 a[8:11], v186 offset:8192
    v_cvt_pk_bf16_f32 v40, v40, v41
    v_cvt_pk_bf16_f32 v41, v42, v43
    v_cvt_pk_bf16_f32 v42, v44, v45
    v_cvt_pk_bf16_f32 v43, v46, v47
    buffer_store_dwordx4 v[40:43], v147, s[68:71], s41 offen offset:1024 sc1
    v_mfma_f32_32x32x16_bf16 v[16:31], a[188:191], a[36:39], v[16:31]
    ds_read_b128 a[12:15], v187 offset:8192
    s_lshl_b32 s41, s27, 12
    s_add_u32 s41, s41, 20971520
    v_cvt_pk_bf16_f32 v48, v48, v49
    v_cvt_pk_bf16_f32 v49, v50, v51
    v_cvt_pk_bf16_f32 v50, v52, v53
    v_mfma_f32_32x32x16_bf16 v[16:31], a[192:195], a[40:43], v[16:31]
    ds_read_b128 a[16:19], v188 offset:8192
    v_cvt_pk_bf16_f32 v51, v54, v55
    buffer_store_dwordx4 v[48:51], v147, s[68:71], s41 offen offset:0 sc1
    v_cvt_pk_bf16_f32 v56, v56, v57
    v_cvt_pk_bf16_f32 v57, v58, v59
    v_mfma_f32_32x32x16_bf16 v[16:31], a[196:199], a[44:47], v[16:31]
    ds_read_b128 a[20:23], v189 offset:8192
    v_cvt_pk_bf16_f32 v58, v60, v61
    v_cvt_pk_bf16_f32 v59, v62, v63
    s_waitcnt lgkmcnt(6)
    v_mfma_f32_32x32x16_bf16 v[16:31], a[200:203], a[48:51], v[16:31]
    v_add_u32 v185, 49152, v179
    ds_read_b64_tr_b16 a[24:25], v185 offset:0
    ds_read_b64_tr_b16 a[26:27], v185 offset:512
    buffer_store_dwordx4 v[56:59], v147, s[68:71], s41 offen offset:1024 sc1
    v_mfma_f32_32x32x16_bf16 v[16:31], a[204:207], a[52:55], v[16:31]
    ds_read_b64_tr_b16 a[28:29], v185 offset:2048
    ds_read_b64_tr_b16 a[30:31], v185 offset:2560
    v_mfma_f32_32x32x16_bf16 v[16:31], a[208:211], a[56:59], v[16:31]
    ds_read_b64_tr_b16 a[32:33], v185 offset:4096
    ds_read_b64_tr_b16 a[34:35], v185 offset:4608
    v_mfma_f32_32x32x16_bf16 v[16:31], a[212:215], a[60:63], v[16:31]
    ds_read_b64_tr_b16 a[36:37], v185 offset:6144
    ds_read_b64_tr_b16 a[38:39], v185 offset:6656
    v_mfma_f32_32x32x16_bf16 v[16:31], v[96:99], a[64:67], v[16:31]
    ds_read_b64_tr_b16 a[40:41], v185 offset:8192
    ds_read_b64_tr_b16 a[42:43], v185 offset:8704
    v_mfma_f32_32x32x16_bf16 v[16:31], v[100:103], a[68:71], v[16:31]
    ds_read_b64_tr_b16 a[44:45], v185 offset:10240
    ds_read_b64_tr_b16 a[46:47], v185 offset:10752
    s_waitcnt lgkmcnt(12)
    v_mfma_f32_32x32x16_bf16 v[16:31], v[104:107], a[0:3], v[16:31]
    ds_read_b64_tr_b16 a[48:49], v185 offset:12288
    ds_read_b64_tr_b16 a[50:51], v185 offset:12800
    v_lshlrev_b32 v152, v150, v152
    v_cmp_eq_u32 s[76:77], 0, v148
    v_mfma_f32_32x32x16_bf16 v[16:31], v[108:111], a[4:7], v[16:31]
    ds_read_b64_tr_b16 a[52:53], v185 offset:14336
    ds_read_b64_tr_b16 a[54:55], v185 offset:14848
    v_lshlrev_b32 v248, 16, v202
    v_and_b32 v249, 0xffff0000, v202
    v_cndmask_b32 v166, 0, v151, s[76:77]
    v_cndmask_b32 v174, 0, v152, s[76:77]
    v_mfma_f32_32x32x16_bf16 v[16:31], v[112:115], a[8:11], v[16:31]
    ds_read_b64_tr_b16 a[56:57], v185 offset:16384
    ds_read_b64_tr_b16 a[58:59], v185 offset:16896
    v_fma_f32 v248, v248, v196, -v195
    v_fma_f32 v249, v249, v196, -v195
    v_cvt_pk_bf16_f32 v218, v248, v249
    v_cmp_eq_u32 s[76:77], 1, v148
    v_mfma_f32_32x32x16_bf16 v[16:31], v[116:119], a[12:15], v[16:31]
    ds_read_b64_tr_b16 a[60:61], v185 offset:18432
    ds_read_b64_tr_b16 a[62:63], v185 offset:18944
    v_lshlrev_b32 v248, 16, v203
    v_and_b32 v249, 0xffff0000, v203
    v_cndmask_b32 v167, 0, v151, s[76:77]
    v_cndmask_b32 v175, 0, v152, s[76:77]
    v_mfma_f32_32x32x16_bf16 v[16:31], v[120:123], a[16:19], v[16:31]
    ds_read_b64_tr_b16 a[64:65], v185 offset:20480
    ds_read_b64_tr_b16 a[66:67], v185 offset:20992
    v_fma_f32 v248, v248, v196, -v195
    v_fma_f32 v249, v249, v196, -v195
    v_cvt_pk_bf16_f32 v219, v248, v249
    v_cmp_eq_u32 s[76:77], 2, v148
    v_mfma_f32_32x32x16_bf16 v[16:31], v[124:127], a[20:23], v[16:31]
    ds_read_b64_tr_b16 a[68:69], v185 offset:22528
    ds_read_b64_tr_b16 a[70:71], v185 offset:23040
    v_lshlrev_b32 v248, 16, v204
    v_and_b32 v249, 0xffff0000, v204
    v_cndmask_b32 v168, 0, v151, s[76:77]
    v_cndmask_b32 v176, 0, v152, s[76:77]
    s_waitcnt lgkmcnt(12)
    v_mfma_f32_32x32x16_bf16 v[0:15], a[72:75], a[24:27], 0
    v_add_u32 v185, 73728, v179
    ds_read_b64_tr_b16 a[0:1], v185 offset:0
    ds_read_b64_tr_b16 a[2:3], v185 offset:512
    v_fma_f32 v248, v248, v196, -v195
    v_fma_f32 v249, v249, v196, -v195
    v_cvt_pk_bf16_f32 v220, v248, v249
    v_mfma_f32_32x32x16_bf16 v[0:15], a[76:79], a[28:31], v[0:15]
    ds_read_b64_tr_b16 a[4:5], v185 offset:2048
    ds_read_b64_tr_b16 a[6:7], v185 offset:2560
    v_cmp_eq_u32 s[76:77], 3, v148
    v_lshlrev_b32 v248, 16, v205
    v_and_b32 v249, 0xffff0000, v205
    v_cndmask_b32 v169, 0, v151, s[76:77]
    v_mfma_f32_32x32x16_bf16 v[0:15], a[80:83], a[32:35], v[0:15]
    ds_read_b64_tr_b16 a[8:9], v185 offset:4096
    ds_read_b64_tr_b16 a[10:11], v185 offset:4608
    v_cndmask_b32 v177, 0, v152, s[76:77]
    v_fma_f32 v248, v248, v196, -v195
    v_fma_f32 v249, v249, v196, -v195
    v_cvt_pk_bf16_f32 v221, v248, v249
    v_mfma_f32_32x32x16_bf16 v[0:15], a[84:87], a[36:39], v[0:15]
    ds_read_b64_tr_b16 a[12:13], v185 offset:6144
    ds_read_b64_tr_b16 a[14:15], v185 offset:6656
    v_cmp_eq_u32 s[76:77], 8, v148
    v_lshlrev_b32 v248, 16, v206
    v_and_b32 v249, 0xffff0000, v206
    v_cndmask_b32 v170, 0, v151, s[76:77]
    v_mfma_f32_32x32x16_bf16 v[0:15], a[88:91], a[40:43], v[0:15]
    ds_read_b64_tr_b16 a[16:17], v185 offset:8192
    ds_read_b64_tr_b16 a[18:19], v185 offset:8704
    v_cndmask_b32 v234, 0, v152, s[76:77]
    v_fma_f32 v248, v248, v196, -v195
    v_fma_f32 v249, v249, v196, -v195
    v_cvt_pk_bf16_f32 v222, v248, v249
    v_mfma_f32_32x32x16_bf16 v[0:15], a[92:95], a[44:47], v[0:15]
    ds_read_b64_tr_b16 a[20:21], v185 offset:10240
    ds_read_b64_tr_b16 a[22:23], v185 offset:10752
    v_cmp_eq_u32 s[76:77], 9, v148
    v_lshlrev_b32 v248, 16, v207
    v_and_b32 v249, 0xffff0000, v207
    v_cndmask_b32 v171, 0, v151, s[76:77]
    s_waitcnt lgkmcnt(12)
    v_mfma_f32_32x32x16_bf16 v[0:15], a[96:99], a[48:51], v[0:15]
    ds_read_b64_tr_b16 a[24:25], v185 offset:12288
    ds_read_b64_tr_b16 a[26:27], v185 offset:12800
    v_cndmask_b32 v235, 0, v152, s[76:77]
    v_fma_f32 v248, v248, v196, -v195
    v_fma_f32 v249, v249, v196, -v195
    v_cvt_pk_bf16_f32 v223, v248, v249
    v_mfma_f32_32x32x16_bf16 v[0:15], a[100:103], a[52:55], v[0:15]
    ds_read_b64_tr_b16 a[28:29], v185 offset:14336
    ds_read_b64_tr_b16 a[30:31], v185 offset:14848
    v_cmp_eq_u32 s[76:77], 10, v148
    v_lshlrev_b32 v248, 16, v208
    v_and_b32 v249, 0xffff0000, v208
    v_cndmask_b32 v172, 0, v151, s[76:77]
    v_mfma_f32_32x32x16_bf16 v[0:15], a[104:107], a[56:59], v[0:15]
    ds_read_b64_tr_b16 a[32:33], v185 offset:16384
    ds_read_b64_tr_b16 a[34:35], v185 offset:16896
    v_cndmask_b32 v236, 0, v152, s[76:77]
    v_fma_f32 v248, v248, v196, -v195
    v_fma_f32 v249, v249, v196, -v195
    v_cvt_pk_bf16_f32 v224, v248, v249
    v_mfma_f32_32x32x16_bf16 v[0:15], a[108:111], a[60:63], v[0:15]
    ds_read_b64_tr_b16 a[36:37], v185 offset:18432
    ds_read_b64_tr_b16 a[38:39], v185 offset:18944
    v_cmp_eq_u32 s[76:77], 11, v148
    v_lshlrev_b32 v248, 16, v209
    v_and_b32 v249, 0xffff0000, v209
    v_cndmask_b32 v173, 0, v151, s[76:77]
    v_mfma_f32_32x32x16_bf16 v[0:15], a[112:115], a[64:67], v[0:15]
    ds_read_b64_tr_b16 a[40:41], v185 offset:20480
    ds_read_b64_tr_b16 a[42:43], v185 offset:20992
    v_cndmask_b32 v237, 0, v152, s[76:77]
    v_fma_f32 v248, v248, v196, -v195
    v_fma_f32 v249, v249, v196, -v195
    v_cvt_pk_bf16_f32 v225, v248, v249
    v_mfma_f32_32x32x16_bf16 v[0:15], a[116:119], a[68:71], v[0:15]
    ds_read_b64_tr_b16 a[44:45], v185 offset:22528
    ds_read_b64_tr_b16 a[46:47], v185 offset:23040
    s_lshl_b32 s41, s28, 12
    s_add_u32 s41, s41, 20971520
    v_cvt_pk_bf16_f32 v16, v16, v17
    v_cvt_pk_bf16_f32 v17, v18, v19
    s_waitcnt lgkmcnt(12)
    v_mfma_f32_32x32x16_bf16 v[0:15], a[120:123], a[0:3], v[0:15]
    v_cvt_pk_bf16_f32 v18, v20, v21
    v_cvt_pk_bf16_f32 v19, v22, v23
    buffer_store_dwordx4 v[16:19], v147, s[68:71], s41 offen offset:0 sc1
    v_cvt_pk_bf16_f32 v24, v24, v25
    v_cvt_pk_bf16_f32 v25, v26, v27
    v_cvt_pk_bf16_f32 v26, v28, v29
    v_cvt_pk_bf16_f32 v27, v30, v31
    buffer_store_dwordx4 v[24:27], v147, s[68:71], s41 offen offset:1024 sc1
    s_waitcnt vmcnt(4)
    s_lshl_b32 s12, s26, 6
    s_add_u32 s12, s12, 786432
    s_mov_b64 exec, 1
    buffer_store_dwordx2 v[198:199], v155, s[68:71], s12 offen sc1
    s_mov_b64 exec, -1
    v_mfma_f32_32x32x16_bf16 v[0:15], a[124:127], a[4:7], v[0:15]
    s_waitcnt vmcnt(3)
    s_lshl_b32 s12, s27, 6
    s_add_u32 s12, s12, 786432
    s_mov_b64 exec, 1
    buffer_store_dwordx2 v[198:199], v155, s[68:71], s12 offen sc1
    s_mov_b64 exec, -1
    v_mfma_f32_32x32x16_bf16 v[0:15], a[128:131], a[8:11], v[0:15]
    s_lshl_b32 s92, s25, 6
    s_add_u32 s92, s92, 786432
    s_lshl_b32 s90, 1, s4
    buffer_load_dwordx4 v[190:193], v239, s[68:71], s92 offen sc1
    s_xor_b32 s80, s4, 3
    s_add_u32 s84, s80, s25
    s_lshl_b32 s84, s84, 12
    s_add_u32 s84, s84, 20971520
    s_xor_b32 s81, s4, 2
    s_add_u32 s85, s81, s25
    s_lshl_b32 s85, s85, 12
    s_add_u32 s85, s85, 20971520
    s_xor_b32 s82, s4, 1
    s_add_u32 s86, s82, s25
    s_lshl_b32 s86, s86, 12
    s_add_u32 s86, s86, 20971520
    v_mfma_f32_32x32x16_bf16 v[0:15], a[132:135], a[12:15], v[0:15]
    v_add_u32 v185, 0, v179
    ds_read_b64_tr_b16 a[48:49], v185 offset:0
    ds_read_b64_tr_b16 a[50:51], v185 offset:512
    ds_read_b64_tr_b16 a[52:53], v185 offset:2048
    ds_read_b64_tr_b16 a[54:55], v185 offset:2560
    v_mfma_f32_32x32x16_bf16 v[0:15], a[136:139], a[16:19], v[0:15]
    ds_read_b64_tr_b16 a[56:57], v185 offset:4096
    ds_read_b64_tr_b16 a[58:59], v185 offset:4608
    ds_read_b64_tr_b16 a[60:61], v185 offset:6144
    ds_read_b64_tr_b16 a[62:63], v185 offset:6656
    v_mfma_f32_32x32x16_bf16 v[0:15], a[140:143], a[20:23], v[0:15]
    ds_read_b64_tr_b16 a[64:65], v185 offset:8192
    ds_read_b64_tr_b16 a[66:67], v185 offset:8704
    ds_read_b64_tr_b16 a[68:69], v185 offset:10240
    ds_read_b64_tr_b16 a[70:71], v185 offset:10752
    s_waitcnt lgkmcnt(12)
    v_mfma_f32_32x32x16_bf16 v[0:15], a[144:147], a[24:27], v[0:15]
    ds_read_b64_tr_b16 a[0:1], v185 offset:12288
    ds_read_b64_tr_b16 a[2:3], v185 offset:12800
    v_mfma_f32_32x32x16_bf16 v[0:15], a[148:151], a[28:31], v[0:15]
    ds_read_b64_tr_b16 a[4:5], v185 offset:14336
    ds_read_b64_tr_b16 a[6:7], v185 offset:14848
    v_mfma_f32_32x32x16_bf16 v[0:15], a[152:155], a[32:35], v[0:15]
    ds_read_b64_tr_b16 a[8:9], v185 offset:16384
    ds_read_b64_tr_b16 a[10:11], v185 offset:16896
    v_mfma_f32_32x32x16_bf16 v[0:15], a[156:159], a[36:39], v[0:15]
    ds_read_b64_tr_b16 a[12:13], v185 offset:18432
    ds_read_b64_tr_b16 a[14:15], v185 offset:18944
    v_mfma_f32_32x32x16_bf16 v[0:15], a[160:163], a[40:43], v[0:15]
    ds_read_b64_tr_b16 a[16:17], v185 offset:20480
    ds_read_b64_tr_b16 a[18:19], v185 offset:20992
    v_mfma_f32_32x32x16_bf16 v[0:15], a[164:167], a[44:47], v[0:15]
    ds_read_b64_tr_b16 a[20:21], v185 offset:22528
    ds_read_b64_tr_b16 a[22:23], v185 offset:23040
    s_waitcnt lgkmcnt(12)
    v_mfma_f32_32x32x16_bf16 v[0:15], a[168:171], a[48:51], v[0:15]
    ds_read_b128 a[24:27], v186 offset:4096
    v_mfma_f32_32x32x16_bf16 v[0:15], a[172:175], a[52:55], v[0:15]
    ds_read_b128 a[28:31], v187 offset:4096
    v_mfma_f32_32x32x16_bf16 v[0:15], a[176:179], a[56:59], v[0:15]
    ds_read_b128 a[32:35], v188 offset:4096
    v_mfma_f32_32x32x16_bf16 v[0:15], a[180:183], a[60:63], v[0:15]
    ds_read_b128 a[36:39], v189 offset:4096
    v_mfma_f32_32x32x16_bf16 v[0:15], a[184:187], a[64:67], v[0:15]
    ds_read_b128 a[40:43], v186 offset:12288
    v_mfma_f32_32x32x16_bf16 v[0:15], a[188:191], a[68:71], v[0:15]
    ds_read_b128 a[44:47], v187 offset:12288
    s_waitcnt lgkmcnt(6)
    v_mfma_f32_32x32x16_bf16 v[0:15], a[192:195], a[0:3], v[0:15]
    s_waitcnt vmcnt(3)
    s_lshl_b32 s12, s28, 6
    s_add_u32 s12, s12, 786432
    s_mov_b64 exec, 1
    buffer_store_dwordx2 v[198:199], v155, s[68:71], s12 offen sc1
    s_mov_b64 exec, -1
    v_mfma_f32_32x32x16_bf16 v[0:15], a[196:199], a[4:7], v[0:15]
    s_waitcnt vmcnt(1)
    v_cmp_eq_u64 vcc, s[88:89], v[190:191]
    s_nop 1
    s_and_b32 s91, vcc_lo, 15
    s_andn2_b32 s91, s91, s90
    s_or_b32 s90, s90, s91
    s_bitcmp1_b32 s91, s80
    s_cbranch_scc0 L_rs_78
    buffer_load_dwordx4 v[64:67], v147, s[68:71], s84 offen offset:0 sc1
    buffer_load_dwordx4 v[68:71], v147, s[68:71], s84 offen offset:1024 sc1
L_rs_78:
    s_bitcmp1_b32 s91, s81
    s_cbranch_scc0 L_rs_79
    buffer_load_dwordx4 v[72:75], v147, s[68:71], s85 offen offset:0 sc1
    buffer_load_dwordx4 v[76:79], v147, s[68:71], s85 offen offset:1024 sc1
L_rs_79:
    s_bitcmp1_b32 s91, s82
    s_cbranch_scc0 L_rs_80
    buffer_load_dwordx4 v[80:83], v147, s[68:71], s86 offen offset:0 sc1
    buffer_load_dwordx4 v[84:87], v147, s[68:71], s86 offen offset:1024 sc1
L_rs_80:
    buffer_load_dwordx4 v[190:193], v239, s[68:71], s92 offen sc1
    v_mfma_f32_32x32x16_bf16 v[0:15], a[200:203], a[8:11], v[0:15]
    ds_read_b128 a[48:51], v188 offset:12288
    v_mfma_f32_32x32x16_bf16 v[0:15], a[204:207], a[12:15], v[0:15]
    ds_read_b128 a[52:55], v189 offset:12288
    v_mfma_f32_32x32x16_bf16 v[0:15], a[208:211], a[16:19], v[0:15]
    v_mfma_f32_32x32x16_bf16 v[0:15], a[212:215], a[20:23], v[0:15]
    s_waitcnt lgkmcnt(2)
    v_mfma_f32_32x32x16_bf16 v[0:15], v[96:99], a[24:27], v[0:15]
    v_mfma_f32_32x32x16_bf16 v[0:15], v[100:103], a[28:31], v[0:15]
    v_mfma_f32_32x32x16_bf16 v[0:15], v[104:107], a[32:35], v[0:15]
    v_mfma_f32_32x32x16_bf16 v[0:15], v[108:111], a[36:39], v[0:15]
    v_mfma_f32_32x32x16_bf16 v[0:15], v[112:115], a[40:43], v[0:15]
    v_mfma_f32_32x32x16_bf16 v[0:15], v[116:119], a[44:47], v[0:15]
    v_mfma_f32_32x32x16_bf16 v[0:15], v[202:205], v[166:169], v[0:15]
    v_mfma_f32_32x32x16_bf16 v[0:15], v[206:209], v[170:173], v[0:15]
    v_mfma_f32_32x32x16_bf16 v[0:15], v[218:221], v[174:177], v[0:15]
    v_mfma_f32_32x32x16_bf16 v[0:15], v[222:225], v[234:237], v[0:15]
    s_waitcnt lgkmcnt(0)
    v_mfma_f32_32x32x16_bf16 v[0:15], v[120:123], a[48:51], v[0:15]
    v_mfma_f32_32x32x16_bf16 v[0:15], v[124:127], a[52:55], v[0:15]
    s_add_u32 s13, s93, 147456
    v_lshl_add_u32 v184, v145, 2, s13
    v_lshl_add_u32 v184, v146, 11, v184
    v_add_u32 v185, 128, v184
    s_mov_b32 s87, 0
    s_nop 7
L_rl_81:
    s_waitcnt vmcnt(0)
    s_mov_b32 s14, s91
    s_mov_b32 s15, s90
    v_cmp_eq_u64 vcc, s[88:89], v[190:191]
    s_nop 1
    s_and_b32 s91, vcc_lo, 15
    s_andn2_b32 s91, s91, s90
    s_or_b32 s90, s90, s91
    s_bitcmp1_b32 s91, s80
    s_cbranch_scc0 L_rs_83
    buffer_load_dwordx4 v[64:67], v147, s[68:71], s84 offen offset:0 sc1
    buffer_load_dwordx4 v[68:71], v147, s[68:71], s84 offen offset:1024 sc1
L_rs_83:
    s_bitcmp1_b32 s91, s81
    s_cbranch_scc0 L_rs_84
    buffer_load_dwordx4 v[72:75], v147, s[68:71], s85 offen offset:0 sc1
    buffer_load_dwordx4 v[76:79], v147, s[68:71], s85 offen offset:1024 sc1
L_rs_84:
    s_bitcmp1_b32 s91, s82
    s_cbranch_scc0 L_rs_85
    buffer_load_dwordx4 v[80:83], v147, s[68:71], s86 offen offset:0 sc1
    buffer_load_dwordx4 v[84:87], v147, s[68:71], s86 offen offset:1024 sc1
L_rs_85:
    buffer_load_dwordx4 v[190:193], v239, s[68:71], s92 offen sc1
    s_bitcmp1_b32 s14, s80
    s_cbranch_scc0 L_ra_86
    v_lshlrev_b32 v224, 16, v64
    v_and_b32 v225, 0xffff0000, v64
    v_pk_add_f32 v[0:1], v[0:1], v[224:225]
    v_lshlrev_b32 v226, 16, v65
    v_and_b32 v227, 0xffff0000, v65
    v_pk_add_f32 v[2:3], v[2:3], v[226:227]
    v_lshlrev_b32 v228, 16, v66
    v_and_b32 v229, 0xffff0000, v66
    v_pk_add_f32 v[4:5], v[4:5], v[228:229]
    v_lshlrev_b32 v230, 16, v67
    v_and_b32 v231, 0xffff0000, v67
    v_pk_add_f32 v[6:7], v[6:7], v[230:231]
    v_lshlrev_b32 v224, 16, v68
    v_and_b32 v225, 0xffff0000, v68
    v_pk_add_f32 v[8:9], v[8:9], v[224:225]
    v_lshlrev_b32 v226, 16, v69
    v_and_b32 v227, 0xffff0000, v69
    v_pk_add_f32 v[10:11], v[10:11], v[226:227]
    v_lshlrev_b32 v228, 16, v70
    v_and_b32 v229, 0xffff0000, v70
    v_pk_add_f32 v[12:13], v[12:13], v[228:229]
    v_lshlrev_b32 v230, 16, v71
    v_and_b32 v231, 0xffff0000, v71
    v_pk_add_f32 v[14:15], v[14:15], v[230:231]
L_ra_86:
    s_bitcmp1_b32 s14, s81
    s_cbranch_scc0 L_ra_87
    v_lshlrev_b32 v224, 16, v72
    v_and_b32 v225, 0xffff0000, v72
    v_pk_add_f32 v[0:1], v[0:1], v[224:225]
    v_lshlrev_b32 v226, 16, v73
    v_and_b32 v227, 0xffff0000, v73
    v_pk_add_f32 v[2:3], v[2:3], v[226:227]
    v_lshlrev_b32 v228, 16, v74
    v_and_b32 v229, 0xffff0000, v74
    v_pk_add_f32 v[4:5], v[4:5], v[228:229]
    v_lshlrev_b32 v230, 16, v75
    v_and_b32 v231, 0xffff0000, v75
    v_pk_add_f32 v[6:7], v[6:7], v[230:231]
    v_lshlrev_b32 v224, 16, v76
    v_and_b32 v225, 0xffff0000, v76
    v_pk_add_f32 v[8:9], v[8:9], v[224:225]
    v_lshlrev_b32 v226, 16, v77
    v_and_b32 v227, 0xffff0000, v77
    v_pk_add_f32 v[10:11], v[10:11], v[226:227]
    v_lshlrev_b32 v228, 16, v78
    v_and_b32 v229, 0xffff0000, v78
    v_pk_add_f32 v[12:13], v[12:13], v[228:229]
    v_lshlrev_b32 v230, 16, v79
    v_and_b32 v231, 0xffff0000, v79
    v_pk_add_f32 v[14:15], v[14:15], v[230:231]
L_ra_87:
    s_bitcmp1_b32 s14, s82
    s_cbranch_scc0 L_ra_88
    v_lshlrev_b32 v224, 16, v80
    v_and_b32 v225, 0xffff0000, v80
    v_pk_add_f32 v[0:1], v[0:1], v[224:225]
    v_lshlrev_b32 v226, 16, v81
    v_and_b32 v227, 0xffff0000, v81
    v_pk_add_f32 v[2:3], v[2:3], v[226:227]
    v_lshlrev_b32 v228, 16, v82
    v_and_b32 v229, 0xffff0000, v82
    v_pk_add_f32 v[4:5], v[4:5], v[228:229]
    v_lshlrev_b32 v230, 16, v83
    v_and_b32 v231, 0xffff0000, v83
    v_pk_add_f32 v[6:7], v[6:7], v[230:231]
    v_lshlrev_b32 v224, 16, v84
    v_and_b32 v225, 0xffff0000, v84
    v_pk_add_f32 v[8:9], v[8:9], v[224:225]
    v_lshlrev_b32 v226, 16, v85
    v_and_b32 v227, 0xffff0000, v85
    v_pk_add_f32 v[10:11], v[10:11], v[226:227]
    v_lshlrev_b32 v228, 16, v86
    v_and_b32 v229, 0xffff0000, v86
    v_pk_add_f32 v[12:13], v[12:13], v[228:229]
    v_lshlrev_b32 v230, 16, v87
    v_and_b32 v231, 0xffff0000, v87
    v_pk_add_f32 v[14:15], v[14:15], v[230:231]
L_ra_88:
    s_cmp_eq_u32 s15, 15
    s_cbranch_scc1 L_rf_82
    s_add_u32 s87, s87, 1
    s_cmp_lt_u32 s87, 40000
    s_cbranch_scc1 L_rl_81
L_rf_82:
    ds_write2st64_b32 v184, v0, v4 offset0:0 offset1:1
    ds_write2st64_b32 v184, v8, v12 offset0:2 offset1:3
    ds_write2st64_b32 v184, v1, v5 offset0:4 offset1:5
    ds_write2st64_b32 v184, v9, v13 offset0:6 offset1:7
    ds_write2st64_b32 v185, v2, v6 offset0:0 offset1:1
    ds_write2st64_b32 v185, v10, v14 offset0:2 offset1:3
    ds_write2st64_b32 v185, v3, v7 offset0:4 offset1:5
    ds_write2st64_b32 v185, v11, v15 offset0:6 offset1:7
    ds_read_b128 v[0:3], v157 offset:0
    ds_read_b128 v[4:7], v157 offset:1024
    ds_read_b128 v[8:11], v157 offset:2048
    ds_read_b128 v[12:15], v157 offset:3072
    s_waitcnt lgkmcnt(3)
    s_add_u32 s13, s29, 0
    buffer_store_dwordx4 v[0:3], v156, s[72:75], s13 offen offset:0 nt
    s_waitcnt lgkmcnt(2)
    s_add_u32 s13, s29, 20480
    buffer_store_dwordx4 v[4:7], v156, s[72:75], s13 offen offset:0 nt
    s_waitcnt lgkmcnt(1)
    s_add_u32 s13, s29, 40960
    buffer_store_dwordx4 v[8:11], v156, s[72:75], s13 offen offset:0 nt
    s_waitcnt lgkmcnt(0)
    s_add_u32 s13, s29, 61440
    buffer_store_dwordx4 v[12:15], v156, s[72:75], s13 offen offset:0 nt
    s_endpgm
L_rt_2:
    s_mov_b32 s87, 0
L_rt_2_l:
    global_load_dwordx2 v[198:199], v155, s[44:45] sc1
    s_waitcnt vmcnt(0)
    v_readfirstlane_b32 s88, v198
    v_readfirstlane_b32 s89, v199
    s_nop 0
    s_cmp_lg_u32 s88, 0
    s_cbranch_scc1 L_ok_1
    s_add_u32 s87, s87, 1
    s_cmp_lt_u32 s87, 40000
    s_cbranch_scc1 L_rt_2_l
    s_branch L_ok_1
L_rt_4:
    s_mov_b32 s87, 0
L_rt_4_l:
    buffer_load_dwordx4 v[194:197], v201, s[68:71], 0 offen sc1
    s_waitcnt vmcnt(0)
    v_cmp_eq_u64 vcc, s[88:89], v[196:197]
    s_nop 1
    s_cmp_eq_u64 vcc, -1
    s_cbranch_scc1 L_ok_3
    s_add_u32 s87, s87, 1
    s_cmp_lt_u32 s87, 40000
    s_cbranch_scc1 L_rt_4_l
    s_branch L_ok_3
L_rt_7:
    s_mov_b32 s87, 0
L_rt_7_l:
    s_cmp_lt_u32 s87, 6
    s_cselect_b32 s96, s31, s24
    buffer_load_dwordx4 v[186:189], v239, s[68:71], s96 offen sc1
    s_waitcnt vmcnt(0)
    v_cmp_eq_u64 vcc, s[88:89], v[186:187]
    s_nop 1
    s_and_b32 s12, vcc_lo, s17
    s_cmp_eq_u32 s12, s17
    s_cbranch_scc1 L_ok_6
    s_add_u32 s87, s87, 1
    s_cmp_lt_u32 s87, 40000
    s_cbranch_scc1 L_rt_7_l
    s_branch L_ok_6
L_rt_9:
    s_mov_b32 s87, 0
L_rt_9_l:
    s_cmp_lt_u32 s87, 6
    s_cselect_b32 s96, s31, s24
    buffer_load_dwordx4 v[190:193], v239, s[68:71], s96 offen sc1
    s_waitcnt vmcnt(0)
    v_cmp_eq_u64 vcc, s[88:89], v[192:193]
    s_nop 1
    s_and_b32 s12, vcc_lo, s17
    s_cmp_eq_u32 s12, s17
    s_cbranch_scc1 L_ok_8
    s_add_u32 s87, s87, 1
    s_cmp_lt_u32 s87, 40000
    s_cbranch_scc1 L_rt_9_l
    s_branch L_ok_8
L_rt_11:
    s_mov_b32 s87, 0
L_rt_11_l:
    s_cmp_lt_u32 s87, 6
    s_cselect_b32 s96, s31, s24
    buffer_load_dwordx4 v[190:193], v239, s[68:71], s96 offen sc1
    s_waitcnt vmcnt(0)
    v_cmp_eq_u64 vcc, s[88:89], v[190:191]
    s_nop 1
    s_and_b32 s12, vcc_lo, s18
    s_cmp_eq_u32 s12, s18
    s_cbranch_scc1 L_ok_10
    s_add_u32 s87, s87, 1
    s_cmp_lt_u32 s87, 40000
    s_cbranch_scc1 L_rt_11_l
    s_branch L_ok_10
L_rt_13:
    s_mov_b32 s87, 0
L_rt_13_l:
    s_cmp_lt_u32 s87, 6
    s_cselect_b32 s96, s31, s24
    buffer_load_dwordx4 v[190:193], v239, s[68:71], s96 offen sc1
    s_waitcnt vmcnt(0)
    v_cmp_eq_u64 vcc, s[88:89], v[192:193]
    s_nop 1
    s_and_b32 s12, vcc_lo, s18
    s_cmp_eq_u32 s12, s18
    s_cbranch_scc1 L_ok_12
    s_add_u32 s87, s87, 1
    s_cmp_lt_u32 s87, 40000
    s_cbranch_scc1 L_rt_13_l
    s_branch L_ok_12
L_rt_26:
    s_mov_b32 s87, 0
L_rt_26_l:
    s_cmp_lt_u32 s87, 6
    s_cselect_b32 s96, s31, s24
    buffer_load_dwordx4 v[190:193], v239, s[68:71], s96 offen sc1
    s_waitcnt vmcnt(0)
    v_cmp_eq_u64 vcc, s[88:89], v[192:193]
    s_nop 1
    s_and_b32 s12, vcc_lo, s13
    s_cmp_eq_u32 s12, s13
    s_cbranch_scc1 L_ok_25
    s_add_u32 s87, s87, 1
    s_cmp_lt_u32 s87, 40000
    s_cbranch_scc1 L_rt_26_l
    s_branch L_ok_25
L_rt_28:
    s_mov_b32 s87, 0
L_rt_28_l:
    s_cmp_lt_u32 s87, 6
    s_cselect_b32 s96, s31, s24
    buffer_load_dwordx4 v[190:193], v239, s[68:71], s96 offen sc1
    s_waitcnt vmcnt(0)
    v_cmp_eq_u64 vcc, s[88:89], v[192:193]
    s_nop 1
    s_and_b32 s12, vcc_lo, s19
    s_cmp_eq_u32 s12, s19
    s_cbranch_scc1 L_ok_27
    s_add_u32 s87, s87, 1
    s_cmp_lt_u32 s87, 40000
    s_cbranch_scc1 L_rt_28_l
    s_branch L_ok_27
L_rt_30:
    s_mov_b32 s87, 0
L_rt_30_l:
    s_cmp_lt_u32 s87, 6
    s_cselect_b32 s96, s31, s24
    buffer_load_dwordx4 v[190:193], v239, s[68:71], s96 offen sc1
    s_waitcnt vmcnt(0)
    v_cmp_eq_u64 vcc, s[88:89], v[190:191]
    s_nop 1
    s_and_b32 s12, vcc_lo, s13
    s_cmp_eq_u32 s12, s13
    s_cbranch_scc1 L_ok_29
    s_add_u32 s87, s87, 1
    s_cmp_lt_u32 s87, 40000
    s_cbranch_scc1 L_rt_30_l
    s_branch L_ok_29
L_rt_33:
    s_mov_b32 s87, 0
L_rt_33_l:
    global_load_dwordx2 v[198:199], v155, s[44:45] sc1
    s_waitcnt vmcnt(0)
    v_readfirstlane_b32 s88, v198
    v_readfirstlane_b32 s89, v199
    s_nop 0
    s_cmp_lg_u32 s88, 0
    s_cbranch_scc1 L_ok_32
    s_add_u32 s87, s87, 1
    s_cmp_lt_u32 s87, 40000
    s_cbranch_scc1 L_rt_33_l
    s_branch L_ok_32
L_rt_35:
    s_mov_b32 s87, 0
L_rt_35_l:
    buffer_load_dwordx4 v[194:197], v201, s[68:71], 0 offen sc1
    s_waitcnt vmcnt(0)
    v_cmp_eq_u64 vcc, s[88:89], v[196:197]
    s_nop 1
    s_cmp_eq_u64 vcc, -1
    s_cbranch_scc1 L_ok_34
    s_add_u32 s87, s87, 1
    s_cmp_lt_u32 s87, 40000
    s_cbranch_scc1 L_rt_35_l
    s_branch L_ok_34
L_rt_44:
    s_mov_b32 s87, 0
L_rt_44_l:
    s_cmp_lt_u32 s87, 6
    s_cselect_b32 s96, s31, s24
    buffer_load_dwordx4 v[190:193], v239, s[68:71], s96 offen sc1
    s_waitcnt vmcnt(0)
    v_cmp_eq_u64 vcc, s[88:89], v[190:191]
    s_nop 1
    s_and_b32 s12, vcc_lo, s13
    s_cmp_eq_u32 s12, s13
    s_cbranch_scc1 L_ok_43
    s_add_u32 s87, s87, 1
    s_cmp_lt_u32 s87, 40000
    s_cbranch_scc1 L_rt_44_l
    s_branch L_ok_43
L_rt_58:
    s_mov_b32 s87, 0
L_rt_58_l:
    s_cmp_lt_u32 s87, 6
    s_cselect_b32 s96, s31, s24
    buffer_load_dwordx4 v[190:193], v239, s[68:71], s96 offen sc1
    s_waitcnt vmcnt(0)
    v_cmp_eq_u64 vcc, s[88:89], v[192:193]
    s_nop 1
    s_and_b32 s12, vcc_lo, s13
    s_cmp_eq_u32 s12, s13
    s_cbranch_scc1 L_ok_57
    s_add_u32 s87, s87, 1
    s_cmp_lt_u32 s87, 40000
    s_cbranch_scc1 L_rt_58_l
    s_branch L_ok_57
L_rt_60:
    s_mov_b32 s87, 0
L_rt_60_l:
    s_cmp_lt_u32 s87, 6
    s_cselect_b32 s96, s31, s24
    buffer_load_dwordx4 v[190:193], v239, s[68:71], s96 offen sc1
    s_waitcnt vmcnt(0)
    v_cmp_eq_u64 vcc, s[88:89], v[192:193]
    s_nop 1
    s_and_b32 s12, vcc_lo, s13
    s_cmp_eq_u32 s12, s13
    s_cbranch_scc1 L_ok_59
    s_add_u32 s87, s87, 1
    s_cmp_lt_u32 s87, 40000
    s_cbranch_scc1 L_rt_60_l
    s_branch L_ok_59
L_rt_73:
    s_mov_b32 s87, 0
L_rt_73_l:
    s_cmp_lt_u32 s87, 6
    s_cselect_b32 s96, s31, s24
    buffer_load_dwordx4 v[190:193], v239, s[68:71], s96 offen sc1
    s_waitcnt vmcnt(0)
    v_cmp_eq_u64 vcc, s[88:89], v[192:193]
    s_nop 1
    s_and_b32 s12, vcc_lo, s13
    s_cmp_eq_u32 s12, s13
    s_cbranch_scc1 L_ok_72
    s_add_u32 s87, s87, 1
    s_cmp_lt_u32 s87, 40000
    s_cbranch_scc1 L_rt_73_l
    s_branch L_ok_72
L_rt_75:
    s_mov_b32 s87, 0
L_rt_75_l:
    s_cmp_lt_u32 s87, 6
    s_cselect_b32 s96, s31, s24
    buffer_load_dwordx4 v[190:193], v239, s[68:71], s96 offen sc1
    s_waitcnt vmcnt(0)
    v_cmp_eq_u64 vcc, s[88:89], v[192:193]
    s_nop 1
    s_and_b32 s12, vcc_lo, s18
    s_cmp_eq_u32 s12, s18
    s_cbranch_scc1 L_ok_74
    s_add_u32 s87, s87, 1
    s_cmp_lt_u32 s87, 40000
    s_cbranch_scc1 L_rt_75_l
    s_branch L_ok_74
L_rt_77:
    s_mov_b32 s87, 0
L_rt_77_l:
    s_cmp_lt_u32 s87, 6
    s_cselect_b32 s96, s31, s24
    buffer_load_dwordx4 v[190:193], v239, s[68:71], s96 offen sc1
    s_waitcnt vmcnt(0)
    v_cmp_eq_u64 vcc, s[88:89], v[192:193]
    s_nop 1
    s_and_b32 s12, vcc_lo, s19
    s_cmp_eq_u32 s12, s19
    s_cbranch_scc1 L_ok_76
    s_add_u32 s87, s87, 1
    s_cmp_lt_u32 s87, 40000
    s_cbranch_scc1 L_rt_77_l
    s_branch L_ok_76
L_end:
    s_endpgm
.section .rodata,"a"
.p2align 6
.amdhsa_kernel parallel_sum__ssm_conv_s5__dense_activation_mish__prompt_kernel
  .amdhsa_next_free_vgpr 512
  .amdhsa_next_free_sgpr 102
  .amdhsa_accum_offset 256
  .amdhsa_group_segment_fixed_size 0
  .amdhsa_kernarg_size 128
  .amdhsa_user_sgpr_count 2
  .amdhsa_user_sgpr_kernarg_segment_ptr 1
  .amdhsa_system_sgpr_workgroup_id_x 1
  .amdhsa_float_denorm_mode_32 3
.end_amdhsa_kernel
```
